```python
import torch

def _softmax(x, axis=-1):
    return torch.softmax(x, dim=axis)
def _gelu(x):
    return torch.nn.functional.gelu(x, approximate="tanh")
def _silu(x):
    return torch.nn.functional.silu(x)
def _sigmoid(x):
    return torch.sigmoid(x)
def _layernorm(x, axis=-1, eps=1e-5):
    m = x.mean(dim=axis, keepdim=True)
    v = x.var(dim=axis, keepdim=True, unbiased=False)
    return (x - m) / torch.sqrt(v + eps)
def _scatter_add(tgt, idx, src, axis=0):
    return tgt.clone().index_add_(axis, idx, src)
def _segment_sum(src, seg, n):
    out = torch.zeros((n,) + src.shape[1:], dtype=src.dtype)
    return out.index_add_(0, seg, src)
def _pad(x, pw):
    flat = tuple(v for pair in reversed(pw) for v in pair)
    return torch.nn.functional.pad(x, flat)

kernel_name = 'standalone__gqa_softmax__near_ridge'

def setup_inputs():

    _w = (lambda a: (lambda t: t.to(torch.bfloat16) if t.is_floating_point() else t)(torch.as_tensor(a)))
    B, Hq, Hkv, Sq, Sk, D = 32, 32, 8, 192, 512, 128
    return {
        "q": _w((lambda *s: torch.randn(*s, dtype=torch.bfloat16) * 0.8)(B, Hq, Sq, D)),
        "k": _w((lambda *s: torch.randn(*s, dtype=torch.bfloat16) * 0.8)(B, Hkv, Sk, D)),
        "v": _w((lambda *s: torch.randn(*s, dtype=torch.bfloat16) * 0.05)(B, Hkv, Sk, D)),
    }

def reference(q, k, v):
    B, Hq, Sq, D = q.shape
    Hkv = k.shape[1]
    rep = Hq // Hkv
    k = (lambda x, n, axis: torch.repeat_interleave(x, n, dim=axis))(k, rep, axis=1)
    v = (lambda x, n, axis: torch.repeat_interleave(x, n, dim=axis))(v, rep, axis=1)
    scale = D ** -0.5
    scores = torch.einsum("bhqd,bhkd->bhqk", q, k) * scale
    p = _softmax(scores, axis=-1)
    return torch.einsum("bhqk,bhkd->bhqd", p, v)
```

```asm
; @launch grid=(256,1,1) block=(256,1,1) lds=163840
.amdgcn_target "amdgcn-amd-amdhsa--gfx950"
.text
.globl standalone__gqa_softmax__near_ridge_kernel
.p2align 8
.type standalone__gqa_softmax__near_ridge_kernel,@function
standalone__gqa_softmax__near_ridge_kernel:
    s_load_dwordx2 s[8:9], s[0:1], 8
    s_load_dwordx2 s[4:5], s[0:1], 0
    s_load_dwordx2 s[12:13], s[0:1], 16
    s_load_dwordx2 s[16:17], s[0:1], 24
    s_lshr_b32 s51, s2, 3
    s_mov_b32 s55, 0x20000
    s_getpc_b64 s[52:53]
    L_pc:
    s_mov_b32 s54, L_exit - L_pc
    s_lshl_b32 s50, s51, 12
    v_lshlrev_b32 v7, 4, v0
    buffer_load_dword v8, v7, s[52:55], s50 offen
    s_cmp_ge_u32 s51, 32
    s_cbranch_scc1 L_exit
    v_lshrrev_b32 v1, 6, v0
    v_and_b32 v0, 63, v0
    v_readfirstlane_b32 s20, v1
    v_lshrrev_b32 v1, 3, v0
    v_and_b32 v2, 6, v1
    v_and_b32 v3, 7, v0
    v_xor_b32 v2, v2, v3
    v_lshlrev_b32 v2, 4, v2
    v_lshl_add_u32 v248, v1, 8, v2
    s_and_b32 s3, s2, 7
    s_lshl_b32 s27, s20, 11
    s_and_b32 s46, s51, 30
    s_lshl_b32 s3, s3, 5
    s_add_u32 s46, s46, s3
    s_and_b32 s47, s51, 1
    s_lshl2_add_u32 s47, s47, s20
    s_lshl3_add_u32 s21, s46, s47
    s_mulk_i32 s21, 24576
    s_lshl_b32 s24, s46, 17
    s_add_u32 s24, s24, s27
    s_mul_i32 s28, s20, 24576
    s_add_u32 s28, s28, 65536
    s_mov_b32 s6, 0x3000000
    s_mov_b32 s7, s55
    s_mov_b32 s10, 0x2000000
    s_mov_b32 s11, s55
    s_mov_b32 s14, s10
    s_mov_b32 s15, s55
    s_waitcnt lgkmcnt(0)
    s_add_u32 m0, s27, 16384
    s_add_u32 s30, s24, 16384
    buffer_load_dwordx4 v248, s[8:11], s30 offen sc1 nt lds
    s_addk_i32 m0, 896
    s_nop 0
    buffer_load_dwordx4 v248, s[8:11], s30 offen offset:128 sc1 nt lds
    s_mov_b32 m0, s28
    s_mov_b32 s30, s21
    buffer_load_dwordx4 v248, s[4:7], s30 offen sc1 nt lds
    s_addk_i32 m0, 896
    s_nop 0
    buffer_load_dwordx4 v248, s[4:7], s30 offen offset:128 sc1 nt lds
    s_addk_i32 m0, 1152
    s_addk_i32 s30, 2048
    buffer_load_dwordx4 v248, s[4:7], s30 offen sc1 nt lds
    s_addk_i32 m0, 896
    s_nop 0
    buffer_load_dwordx4 v248, s[4:7], s30 offen offset:128 sc1 nt lds
    s_addk_i32 m0, 1152
    s_addk_i32 s30, 2048
    buffer_load_dwordx4 v248, s[4:7], s30 offen sc1 nt lds
    s_addk_i32 m0, 896
    s_nop 0
    buffer_load_dwordx4 v248, s[4:7], s30 offen offset:128 sc1 nt lds
    s_addk_i32 m0, 1152
    s_addk_i32 s30, 2048
    buffer_load_dwordx4 v248, s[4:7], s30 offen sc1 nt lds
    s_addk_i32 m0, 896
    s_nop 0
    buffer_load_dwordx4 v248, s[4:7], s30 offen offset:128 sc1 nt lds
    s_branch L_main
L_slow:
    s_waitcnt vmcnt(0) lgkmcnt(0)
    s_add_u32 s37, s28, 8192
    s_sub_u32 s37, s37, 32768
    v_add_u32 v242, s37, v242
    v_add_u32 v243, s37, v243
    v_add_u32 v244, s37, v244
    v_add_u32 v245, s37, v245
    s_mov_b32 s36, 0
    s_mov_b32 s38, s21
    s_sub_u32 s39, s24, s27
L_slow_q:
    s_add_u32 s30, s38, 0
    s_add_u32 m0, s28, 16384
    s_nop 0
    buffer_load_dwordx4 v248, s[4:7], s30 offen lds
    s_add_u32 m0, s28, 17280
    s_nop 0
    buffer_load_dwordx4 v248, s[4:7], s30 offen offset:128 lds
    s_add_u32 s30, s38, 2048
    s_add_u32 m0, s28, 18432
    s_nop 0
    buffer_load_dwordx4 v248, s[4:7], s30 offen lds
    s_add_u32 m0, s28, 19328
    s_nop 0
    buffer_load_dwordx4 v248, s[4:7], s30 offen offset:128 lds
    s_waitcnt vmcnt(0)
    ds_read_b128 a[0:3], v246 offset:16384
    ds_read_b128 a[4:7], v247 offset:16384
    ds_read_b128 a[8:11], v246 offset:17408
    ds_read_b128 a[12:15], v247 offset:17408
    v_mov_b32 v216, 0xff800000
    s_mov_b32 s37, 0
    s_mov_b32 s40, s39
L_slow_p1:
    s_add_u32 s30, s40, 0
    s_add_u32 m0, s28, 0
    s_nop 0
    buffer_load_dwordx4 v248, s[8:11], s30 offen lds
    s_add_u32 m0, s28, 896
    s_nop 0
    buffer_load_dwordx4 v248, s[8:11], s30 offen offset:128 lds
    s_add_u32 s30, s40, 2048
    s_add_u32 m0, s28, 2048
    s_nop 0
    buffer_load_dwordx4 v248, s[8:11], s30 offen lds
    s_add_u32 m0, s28, 2944
    s_nop 0
    buffer_load_dwordx4 v248, s[8:11], s30 offen offset:128 lds
    s_add_u32 s30, s40, 4096
    s_add_u32 m0, s28, 4096
    s_nop 0
    buffer_load_dwordx4 v248, s[8:11], s30 offen lds
    s_add_u32 m0, s28, 4992
    s_nop 0
    buffer_load_dwordx4 v248, s[8:11], s30 offen offset:128 lds
    s_add_u32 s30, s40, 6144
    s_add_u32 m0, s28, 6144
    s_nop 0
    buffer_load_dwordx4 v248, s[8:11], s30 offen lds
    s_add_u32 m0, s28, 7040
    s_nop 0
    buffer_load_dwordx4 v248, s[8:11], s30 offen offset:128 lds
    s_waitcnt vmcnt(0)
    ds_read_b128 a[96:99], v246 offset:0
    ds_read_b128 a[100:103], v247 offset:0
    ds_read_b128 a[104:107], v246 offset:1024
    ds_read_b128 a[108:111], v247 offset:1024
    ds_read_b128 a[112:115], v246 offset:4096
    ds_read_b128 a[116:119], v247 offset:4096
    ds_read_b128 a[120:123], v246 offset:5120
    ds_read_b128 a[124:127], v247 offset:5120
    s_waitcnt lgkmcnt(0)
    v_mfma_f32_16x16x32_bf16 v[192:195], a[96:99], a[0:3], 0
    v_mfma_f32_16x16x32_bf16 v[192:195], a[100:103], a[4:7], v[192:195]
    v_mfma_f32_16x16x32_bf16 v[192:195], a[104:107], a[8:11], v[192:195]
    v_mfma_f32_16x16x32_bf16 v[192:195], a[108:111], a[12:15], v[192:195]
    v_mfma_f32_16x16x32_bf16 v[196:199], a[112:115], a[0:3], 0
    v_mfma_f32_16x16x32_bf16 v[196:199], a[116:119], a[4:7], v[196:199]
    v_mfma_f32_16x16x32_bf16 v[196:199], a[120:123], a[8:11], v[196:199]
    v_mfma_f32_16x16x32_bf16 v[196:199], a[124:127], a[12:15], v[196:199]
    s_nop 7
    s_nop 7
    v_max3_f32 v216, v216, v192, v193
    v_max3_f32 v216, v216, v194, v195
    v_max3_f32 v216, v216, v196, v197
    v_max3_f32 v216, v216, v198, v199
    s_add_u32 s40, s40, 8192
    s_add_u32 s37, s37, 1
    s_cmp_lt_u32 s37, 16
    s_cbranch_scc1 L_slow_p1
    v_mov_b32 v217, v216
    s_nop 1
    v_permlane32_swap_b32 v216, v217
    s_nop 1
    v_max_f32 v216, v216, v217
    v_mov_b32 v217, v216
    s_nop 1
    v_permlane16_swap_b32 v216, v217
    s_nop 1
    v_max_f32 v216, v216, v217
    v_mov_b32 v0, 0
    v_mov_b32 v1, 0
    v_mov_b32 v2, 0
    v_mov_b32 v3, 0
    v_mov_b32 v4, 0
    v_mov_b32 v5, 0
    v_mov_b32 v6, 0
    v_mov_b32 v7, 0
    v_mov_b32 v8, 0
    v_mov_b32 v9, 0
    v_mov_b32 v10, 0
    v_mov_b32 v11, 0
    v_mov_b32 v12, 0
    v_mov_b32 v13, 0
    v_mov_b32 v14, 0
    v_mov_b32 v15, 0
    v_mov_b32 v16, 0
    v_mov_b32 v17, 0
    v_mov_b32 v18, 0
    v_mov_b32 v19, 0
    v_mov_b32 v20, 0
    v_mov_b32 v21, 0
    v_mov_b32 v22, 0
    v_mov_b32 v23, 0
    v_mov_b32 v24, 0
    v_mov_b32 v25, 0
    v_mov_b32 v26, 0
    v_mov_b32 v27, 0
    v_mov_b32 v28, 0
    v_mov_b32 v29, 0
    v_mov_b32 v30, 0
    v_mov_b32 v31, 0
    v_accvgpr_write_b32 a224, 0
    v_accvgpr_write_b32 a225, 0
    v_accvgpr_write_b32 a226, 0
    v_accvgpr_write_b32 a227, 0
    s_mov_b32 s37, 0
    s_mov_b32 s40, s39
L_slow_p2:
    s_add_u32 s30, s40, 0
    s_add_u32 m0, s28, 0
    s_nop 0
    buffer_load_dwordx4 v248, s[8:11], s30 offen lds
    s_add_u32 m0, s28, 896
    s_nop 0
    buffer_load_dwordx4 v248, s[8:11], s30 offen offset:128 lds
    s_add_u32 s30, s40, 2048
    s_add_u32 m0, s28, 2048
    s_nop 0
    buffer_load_dwordx4 v248, s[8:11], s30 offen lds
    s_add_u32 m0, s28, 2944
    s_nop 0
    buffer_load_dwordx4 v248, s[8:11], s30 offen offset:128 lds
    s_add_u32 s30, s40, 4096
    s_add_u32 m0, s28, 4096
    s_nop 0
    buffer_load_dwordx4 v248, s[8:11], s30 offen lds
    s_add_u32 m0, s28, 4992
    s_nop 0
    buffer_load_dwordx4 v248, s[8:11], s30 offen offset:128 lds
    s_add_u32 s30, s40, 6144
    s_add_u32 m0, s28, 6144
    s_nop 0
    buffer_load_dwordx4 v248, s[8:11], s30 offen lds
    s_add_u32 m0, s28, 7040
    s_nop 0
    buffer_load_dwordx4 v248, s[8:11], s30 offen offset:128 lds
    s_add_u32 s30, s40, 0
    s_add_u32 m0, s28, 8192
    s_nop 0
    buffer_load_dwordx4 v248, s[12:15], s30 offen lds
    s_add_u32 m0, s28, 9088
    s_nop 0
    buffer_load_dwordx4 v248, s[12:15], s30 offen offset:128 lds
    s_add_u32 s30, s40, 2048
    s_add_u32 m0, s28, 10240
    s_nop 0
    buffer_load_dwordx4 v248, s[12:15], s30 offen lds
    s_add_u32 m0, s28, 11136
    s_nop 0
    buffer_load_dwordx4 v248, s[12:15], s30 offen offset:128 lds
    s_add_u32 s30, s40, 4096
    s_add_u32 m0, s28, 12288
    s_nop 0
    buffer_load_dwordx4 v248, s[12:15], s30 offen lds
    s_add_u32 m0, s28, 13184
    s_nop 0
    buffer_load_dwordx4 v248, s[12:15], s30 offen offset:128 lds
    s_add_u32 s30, s40, 6144
    s_add_u32 m0, s28, 14336
    s_nop 0
    buffer_load_dwordx4 v248, s[12:15], s30 offen lds
    s_add_u32 m0, s28, 15232
    s_nop 0
    buffer_load_dwordx4 v248, s[12:15], s30 offen offset:128 lds
    s_waitcnt vmcnt(0)
    ds_read_b64_tr_b16 a[160:161], v242 offset:0
    ds_read_b64_tr_b16 a[162:163], v242 offset:4096
    ds_read_b64_tr_b16 a[164:165], v243 offset:0
    ds_read_b64_tr_b16 a[166:167], v243 offset:4096
    ds_read_b64_tr_b16 a[168:169], v244 offset:0
    ds_read_b64_tr_b16 a[170:171], v244 offset:4096
    ds_read_b64_tr_b16 a[172:173], v245 offset:0
    ds_read_b64_tr_b16 a[174:175], v245 offset:4096
    s_waitcnt lgkmcnt(0)
    ds_read_b64_tr_b16 a[176:177], v242 offset:1024
    ds_read_b64_tr_b16 a[178:179], v242 offset:5120
    ds_read_b64_tr_b16 a[180:181], v243 offset:1024
    ds_read_b64_tr_b16 a[182:183], v243 offset:5120
    ds_read_b64_tr_b16 a[184:185], v244 offset:1024
    ds_read_b64_tr_b16 a[186:187], v244 offset:5120
    ds_read_b64_tr_b16 a[188:189], v245 offset:1024
    ds_read_b64_tr_b16 a[190:191], v245 offset:5120
    s_waitcnt lgkmcnt(0)
    ds_read_b128 a[96:99], v246 offset:0
    ds_read_b128 a[100:103], v247 offset:0
    ds_read_b128 a[104:107], v246 offset:1024
    ds_read_b128 a[108:111], v247 offset:1024
    ds_read_b128 a[112:115], v246 offset:4096
    ds_read_b128 a[116:119], v247 offset:4096
    ds_read_b128 a[120:123], v246 offset:5120
    ds_read_b128 a[124:127], v247 offset:5120
    s_waitcnt lgkmcnt(0)
    v_mfma_f32_16x16x32_bf16 v[192:195], a[96:99], a[0:3], 0
    v_mfma_f32_16x16x32_bf16 v[192:195], a[100:103], a[4:7], v[192:195]
    v_mfma_f32_16x16x32_bf16 v[192:195], a[104:107], a[8:11], v[192:195]
    v_mfma_f32_16x16x32_bf16 v[192:195], a[108:111], a[12:15], v[192:195]
    v_mfma_f32_16x16x32_bf16 v[196:199], a[112:115], a[0:3], 0
    v_mfma_f32_16x16x32_bf16 v[196:199], a[116:119], a[4:7], v[196:199]
    v_mfma_f32_16x16x32_bf16 v[196:199], a[120:123], a[8:11], v[196:199]
    v_mfma_f32_16x16x32_bf16 v[196:199], a[124:127], a[12:15], v[196:199]
    s_nop 7
    s_nop 7
    v_sub_f32 v192, v192, v216
    v_sub_f32 v193, v193, v216
    v_sub_f32 v194, v194, v216
    v_sub_f32 v195, v195, v216
    v_sub_f32 v196, v196, v216
    v_sub_f32 v197, v197, v216
    v_sub_f32 v198, v198, v216
    v_sub_f32 v199, v199, v216
    v_mul_f32 v192, s44, v192
    v_mul_f32 v193, s44, v193
    v_mul_f32 v194, s44, v194
    v_mul_f32 v195, s44, v195
    v_mul_f32 v196, s44, v196
    v_mul_f32 v197, s44, v197
    v_mul_f32 v198, s44, v198
    v_mul_f32 v199, s44, v199
    v_exp_f32 v192, v192
    v_exp_f32 v193, v193
    v_exp_f32 v194, v194
    v_exp_f32 v195, v195
    v_exp_f32 v196, v196
    v_exp_f32 v197, v197
    v_exp_f32 v198, v198
    v_exp_f32 v199, v199
    s_nop 0
    v_cvt_pk_bf16_f32 v192, v192, v193
    v_cvt_pk_bf16_f32 v193, v194, v195
    v_cvt_pk_bf16_f32 v194, v196, v197
    v_cvt_pk_bf16_f32 v195, v198, v199
    s_nop 1
    v_mfma_f32_16x16x32_bf16 a[224:227], a[236:239], v[192:195], a[224:227]
    v_mfma_f32_16x16x32_bf16 v[0:3], a[160:163], v[192:195], v[0:3]
    v_mfma_f32_16x16x32_bf16 v[4:7], a[164:167], v[192:195], v[4:7]
    v_mfma_f32_16x16x32_bf16 v[8:11], a[168:171], v[192:195], v[8:11]
    v_mfma_f32_16x16x32_bf16 v[12:15], a[172:175], v[192:195], v[12:15]
    v_mfma_f32_16x16x32_bf16 v[16:19], a[176:179], v[192:195], v[16:19]
    v_mfma_f32_16x16x32_bf16 v[20:23], a[180:183], v[192:195], v[20:23]
    v_mfma_f32_16x16x32_bf16 v[24:27], a[184:187], v[192:195], v[24:27]
    v_mfma_f32_16x16x32_bf16 v[28:31], a[188:191], v[192:195], v[28:31]
    s_add_u32 s40, s40, 8192
    s_add_u32 s37, s37, 1
    s_cmp_lt_u32 s37, 16
    s_cbranch_scc1 L_slow_p2
    s_nop 7
    s_nop 7
    v_accvgpr_read_b32 v252, a224
    s_nop 0
    v_rcp_f32 v252, v252
    s_nop 0
    v_mul_f32 v0, v0, v252
    v_mul_f32 v1, v1, v252
    v_mul_f32 v2, v2, v252
    v_mul_f32 v3, v3, v252
    v_mul_f32 v4, v4, v252
    v_mul_f32 v5, v5, v252
    v_mul_f32 v6, v6, v252
    v_mul_f32 v7, v7, v252
    v_mul_f32 v8, v8, v252
    v_mul_f32 v9, v9, v252
    v_mul_f32 v10, v10, v252
    v_mul_f32 v11, v11, v252
    v_mul_f32 v12, v12, v252
    v_mul_f32 v13, v13, v252
    v_mul_f32 v14, v14, v252
    v_mul_f32 v15, v15, v252
    v_mul_f32 v16, v16, v252
    v_mul_f32 v17, v17, v252
    v_mul_f32 v18, v18, v252
    v_mul_f32 v19, v19, v252
    v_mul_f32 v20, v20, v252
    v_mul_f32 v21, v21, v252
    v_mul_f32 v22, v22, v252
    v_mul_f32 v23, v23, v252
    v_mul_f32 v24, v24, v252
    v_mul_f32 v25, v25, v252
    v_mul_f32 v26, v26, v252
    v_mul_f32 v27, v27, v252
    v_mul_f32 v28, v28, v252
    v_mul_f32 v29, v29, v252
    v_mul_f32 v30, v30, v252
    v_mul_f32 v31, v31, v252
    v_cvt_pk_bf16_f32 v0, v0, v1
    v_cvt_pk_bf16_f32 v1, v2, v3
    v_cvt_pk_bf16_f32 v4, v4, v5
    v_cvt_pk_bf16_f32 v5, v6, v7
    v_cvt_pk_bf16_f32 v8, v8, v9
    v_cvt_pk_bf16_f32 v9, v10, v11
    v_cvt_pk_bf16_f32 v12, v12, v13
    v_cvt_pk_bf16_f32 v13, v14, v15
    v_cvt_pk_bf16_f32 v16, v16, v17
    v_cvt_pk_bf16_f32 v17, v18, v19
    v_cvt_pk_bf16_f32 v20, v20, v21
    v_cvt_pk_bf16_f32 v21, v22, v23
    v_cvt_pk_bf16_f32 v24, v24, v25
    v_cvt_pk_bf16_f32 v25, v26, v27
    v_cvt_pk_bf16_f32 v28, v28, v29
    v_cvt_pk_bf16_f32 v29, v30, v31
    ds_write_b64 v249, v[0:1] offset:0
    ds_write_b64 v249, v[4:5] offset:32
    ds_write_b64 v249, v[8:9] offset:64
    ds_write_b64 v249, v[12:13] offset:96
    ds_write_b64 v249, v[16:17] offset:128
    ds_write_b64 v249, v[20:21] offset:160
    ds_write_b64 v249, v[24:25] offset:192
    ds_write_b64 v249, v[28:29] offset:224
    s_waitcnt lgkmcnt(0)
    ds_read_b128 v[32:35], v250 offset:0
    ds_read_b128 v[36:39], v250 offset:128
    ds_read_b128 v[40:43], v250 offset:2176
    ds_read_b128 v[44:47], v250 offset:2304
    s_waitcnt lgkmcnt(0)
    buffer_store_dwordx4 v[32:35], v248, s[16:19], s38 offen offset:0
    buffer_store_dwordx4 v[36:39], v248, s[16:19], s38 offen offset:128
    buffer_store_dwordx4 v[40:43], v248, s[16:19], s38 offen offset:2048
    buffer_store_dwordx4 v[44:47], v248, s[16:19], s38 offen offset:2176
    s_waitcnt vmcnt(0)
    s_add_u32 s38, s38, 4096
    s_add_u32 s36, s36, 1
    s_cmp_lg_u32 s36, 6
    s_cbranch_scc1 L_slow_n1
    s_mov_b32 s38, s22
    s_sub_u32 s39, s25, s27
L_slow_n1:
    s_cmp_lt_u32 s36, 12
    s_cbranch_scc1 L_slow_q
    s_endpgm
.p2align 12
L_main:
    s_add_u32 s22, s21, 196608
    s_add_u32 s25, s24, 131072
    s_mov_b32 s18, s6
    s_mov_b32 s19, s55
    s_mov_b32 s45, 0x3e0293ee
    s_mov_b32 s46, 0x53800000
    s_mov_b32 s29, 0xffff0000
    s_mov_b32 s44, 0x3e0293ee
    s_mov_b64 s[32:33], 0
    v_and_b32 v1, 15, v0
    v_lshrrev_b32 v2, 4, v0
    v_lshrrev_b32 v3, 3, v1
    v_lshlrev_b32 v3, 11, v3
    v_and_b32 v4, 7, v1
    v_lshl_add_u32 v3, v4, 7, v3
    v_and_b32 v4, 6, v1
    v_xor_b32 v4, v4, v2
    v_lshl_add_u32 v240, v4, 4, v3
    v_xor_b32 v241, 64, v240
    v_add_u32 v246, s28, v240
    v_add_u32 v247, s28, v241
    v_mul_u32_u24 v3, 272, v1
    v_lshl_add_u32 v3, v2, 3, v3
    v_add_u32 v249, s28, v3
    v_lshrrev_b32 v3, 3, v0
    v_lshl_add_u32 v3, v3, 4, v248
    v_add_u32 v250, s28, v3
    v_lshrrev_b32 v1, 2, v0
    v_and_b32 v2, 3, v0
    v_lshrrev_b32 v3, 3, v1
    v_lshlrev_b32 v3, 11, v3
    v_and_b32 v4, 7, v1
    v_lshl_add_u32 v3, v4, 7, v3
    v_and_b32 v4, 6, v1
    v_lshrrev_b32 v5, 1, v2
    v_xor_b32 v4, v4, v5
    v_lshl_add_u32 v3, v4, 4, v3
    v_and_b32 v4, 1, v2
    v_lshl_add_u32 v3, v4, 3, v3
    v_add_u32 v242, 32768, v3
    v_xor_b32 v243, 32, v242
    v_xor_b32 v244, 64, v242
    v_xor_b32 v245, 96, v242
    v_cmp_eq_u32 vcc, 0, v2
    v_mov_b32 v4, 0x3f803f80
    s_nop 1
    v_cndmask_b32 v4, 0, v4, vcc
    s_nop 0
    v_accvgpr_write_b32 a236, v4
    v_accvgpr_write_b32 a237, v4
    v_accvgpr_write_b32 a238, v4
    v_accvgpr_write_b32 a239, v4
    v_cmp_eq_u32 vcc, 2, v2
    v_mov_b32 v5, 0x3f803f80
    v_lshrrev_b32 v3, 5, v0
    v_cndmask_b32 v4, 0, v5, vcc
    v_lshrrev_b32 v1, 1, v2
    v_accvgpr_write_b32 a240, v4
    v_accvgpr_write_b32 a241, v4
    v_accvgpr_write_b32 a242, v4
    v_accvgpr_write_b32 a243, v4
    v_cmp_eq_u32 vcc, v1, v3
    v_and_b32 v1, 1, v0
    v_mul_u32_u24 v1, 0xaaaa, v1
    v_cndmask_b32 v4, 0, v5, vcc
    v_add_u32 v253, 0x4444, v1
    v_accvgpr_write_b32 a244, v4
    v_accvgpr_write_b32 a245, v4
    v_accvgpr_write_b32 a246, v4
    v_accvgpr_write_b32 a247, v4
    s_mov_b64 exec, 0
    s_cmp_eq_u32 s20, 0
    s_cbranch_scc1 L_pad0
    s_cmp_eq_u32 s20, 1
    s_cbranch_scc1 L_pad1
    s_cmp_eq_u32 s20, 2
    s_cbranch_scc1 L_pad2
    s_branch L_pad3
L_padend0:
    s_mov_b64 exec, -1
    s_waitcnt vmcnt(8)
    s_addk_i32 m0, 1152
    s_addk_i32 s30, 2048
    buffer_load_dwordx4 v248, s[4:7], s30 offen sc1 nt lds
    s_addk_i32 m0, 896
    s_nop 0
    buffer_load_dwordx4 v248, s[4:7], s30 offen offset:128 sc1 nt lds
    s_barrier
    ds_read_b128 a[96:99], v240 offset:16384
    ds_read_b128 a[100:103], v241 offset:16384
    ds_read_b128 a[104:107], v240 offset:17408
    ds_read_b128 a[108:111], v241 offset:17408
    ds_read_b128 a[112:115], v240 offset:20480
    ds_read_b128 a[116:119], v241 offset:20480
    ds_read_b128 a[120:123], v240 offset:21504
    ds_read_b128 a[124:127], v241 offset:21504
    s_waitcnt vmcnt(8)
    s_addk_i32 m0, 1152
    s_addk_i32 s30, 2048
    buffer_load_dwordx4 v248, s[4:7], s30 offen sc1 nt lds
    s_addk_i32 m0, 896
    s_nop 0
    buffer_load_dwordx4 v248, s[4:7], s30 offen offset:128 sc1 nt lds
    s_waitcnt vmcnt(8)
    s_add_u32 m0, s27, 49152
    s_add_u32 s30, s24, 16384
    buffer_load_dwordx4 v248, s[12:15], s30 offen sc1 nt lds
    s_addk_i32 m0, 896
    s_nop 0
    buffer_load_dwordx4 v248, s[12:15], s30 offen offset:128 sc1 nt lds
    ds_read_b128 v[0:3], v246 offset:0
    ds_read_b128 v[4:7], v247 offset:0
    ds_read_b128 v[8:11], v246 offset:1024
    ds_read_b128 v[12:15], v247 offset:1024
    s_waitcnt lgkmcnt(3)
    v_lshlrev_b32 v16, 16, v0
    v_lshlrev_b32 v18, 16, v1
    v_lshlrev_b32 v20, 16, v2
    v_lshlrev_b32 v22, 16, v3
    v_and_b32 v17, s29, v0
    v_and_b32 v19, s29, v1
    v_and_b32 v21, s29, v2
    v_and_b32 v23, s29, v3
    v_pk_mul_f32 v[16:17], v[16:17], s[44:45]
    v_pk_mul_f32 v[18:19], v[18:19], s[44:45]
    v_pk_mul_f32 v[20:21], v[20:21], s[44:45]
    v_pk_mul_f32 v[22:23], v[22:23], s[44:45]
    v_cvt_pk_bf16_f32 v0, v16, v17
    v_cvt_pk_bf16_f32 v1, v18, v19
    v_cvt_pk_bf16_f32 v2, v20, v21
    v_cvt_pk_bf16_f32 v3, v22, v23
    v_accvgpr_write_b32 a0, v0
    v_accvgpr_write_b32 a1, v1
    v_accvgpr_write_b32 a2, v2
    v_accvgpr_write_b32 a3, v3
    s_nop 1
    v_mfma_f32_16x16x32_bf16 v[192:195], a[96:99], a[0:3], 0
    s_waitcnt lgkmcnt(2)
    v_lshlrev_b32 v24, 16, v4
    v_lshlrev_b32 v26, 16, v5
    v_lshlrev_b32 v28, 16, v6
    v_lshlrev_b32 v30, 16, v7
    v_and_b32 v25, s29, v4
    v_and_b32 v27, s29, v5
    v_and_b32 v29, s29, v6
    v_and_b32 v31, s29, v7
    v_pk_mul_f32 v[24:25], v[24:25], s[44:45]
    v_pk_mul_f32 v[26:27], v[26:27], s[44:45]
    v_pk_mul_f32 v[28:29], v[28:29], s[44:45]
    v_pk_mul_f32 v[30:31], v[30:31], s[44:45]
    v_cvt_pk_bf16_f32 v4, v24, v25
    v_cvt_pk_bf16_f32 v5, v26, v27
    v_cvt_pk_bf16_f32 v6, v28, v29
    v_cvt_pk_bf16_f32 v7, v30, v31
    v_accvgpr_write_b32 a4, v4
    v_accvgpr_write_b32 a5, v5
    v_accvgpr_write_b32 a6, v6
    v_accvgpr_write_b32 a7, v7
    s_nop 1
    v_mfma_f32_16x16x32_bf16 v[192:195], a[100:103], a[4:7], v[192:195]
    s_waitcnt lgkmcnt(1)
    v_lshlrev_b32 v16, 16, v8
    v_lshlrev_b32 v18, 16, v9
    v_lshlrev_b32 v20, 16, v10
    v_lshlrev_b32 v22, 16, v11
    v_and_b32 v17, s29, v8
    v_and_b32 v19, s29, v9
    v_and_b32 v21, s29, v10
    v_and_b32 v23, s29, v11
    v_pk_mul_f32 v[16:17], v[16:17], s[44:45]
    v_pk_mul_f32 v[18:19], v[18:19], s[44:45]
    v_pk_mul_f32 v[20:21], v[20:21], s[44:45]
    v_pk_mul_f32 v[22:23], v[22:23], s[44:45]
    v_cvt_pk_bf16_f32 v8, v16, v17
    v_cvt_pk_bf16_f32 v9, v18, v19
    v_cvt_pk_bf16_f32 v10, v20, v21
    v_cvt_pk_bf16_f32 v11, v22, v23
    v_accvgpr_write_b32 a8, v8
    v_accvgpr_write_b32 a9, v9
    v_accvgpr_write_b32 a10, v10
    v_accvgpr_write_b32 a11, v11
    s_nop 1
    v_mfma_f32_16x16x32_bf16 v[192:195], a[104:107], a[8:11], v[192:195]
    s_waitcnt lgkmcnt(0)
    v_lshlrev_b32 v24, 16, v12
    v_lshlrev_b32 v26, 16, v13
    v_lshlrev_b32 v28, 16, v14
    v_lshlrev_b32 v30, 16, v15
    v_and_b32 v25, s29, v12
    v_and_b32 v27, s29, v13
    v_and_b32 v29, s29, v14
    v_and_b32 v31, s29, v15
    v_pk_mul_f32 v[24:25], v[24:25], s[44:45]
    v_pk_mul_f32 v[26:27], v[26:27], s[44:45]
    v_pk_mul_f32 v[28:29], v[28:29], s[44:45]
    v_pk_mul_f32 v[30:31], v[30:31], s[44:45]
    v_cvt_pk_bf16_f32 v12, v24, v25
    v_cvt_pk_bf16_f32 v13, v26, v27
    v_cvt_pk_bf16_f32 v14, v28, v29
    v_cvt_pk_bf16_f32 v15, v30, v31
    v_accvgpr_write_b32 a12, v12
    v_accvgpr_write_b32 a13, v13
    v_accvgpr_write_b32 a14, v14
    v_accvgpr_write_b32 a15, v15
    s_nop 1
    v_mfma_f32_16x16x32_bf16 v[192:195], a[108:111], a[12:15], v[192:195]
    v_mfma_f32_16x16x32_bf16 v[196:199], a[124:127], a[12:15], 0
    s_waitcnt vmcnt(8)
    s_mov_b32 m0, s27
    s_addk_i32 s30, -16384
    buffer_load_dwordx4 v248, s[8:11], s30 offen sc1 nt lds
    s_addk_i32 m0, 896
    s_nop 0
    buffer_load_dwordx4 v248, s[8:11], s30 offen offset:128 sc1 nt lds
    s_waitcnt vmcnt(8)
    s_addk_i32 m0, 31872
    s_nop 0
    buffer_load_dwordx4 v248, s[12:15], s30 offen sc1 nt lds
    s_addk_i32 m0, 896
    s_nop 0
    buffer_load_dwordx4 v248, s[12:15], s30 offen offset:128 sc1 nt lds
    ds_read_b128 v[32:35], v246 offset:4096
    ds_read_b128 v[36:39], v247 offset:4096
    ds_read_b128 v[40:43], v246 offset:5120
    ds_read_b128 v[44:47], v247 offset:5120
    v_mfma_f32_16x16x32_bf16 v[196:199], a[120:123], a[8:11], v[196:199]
    v_mfma_f32_16x16x32_bf16 v[196:199], a[116:119], a[4:7], v[196:199]
    v_mfma_f32_16x16x32_bf16 v[196:199], a[112:115], a[0:3], v[196:199]
    s_waitcnt lgkmcnt(3)
    v_lshlrev_b32 v48, 16, v32
    v_lshlrev_b32 v50, 16, v33
    v_lshlrev_b32 v52, 16, v34
    v_lshlrev_b32 v54, 16, v35
    v_and_b32 v49, s29, v32
    v_and_b32 v51, s29, v33
    v_and_b32 v53, s29, v34
    v_and_b32 v55, s29, v35
    v_pk_mul_f32 v[48:49], v[48:49], s[44:45]
    v_pk_mul_f32 v[50:51], v[50:51], s[44:45]
    v_pk_mul_f32 v[52:53], v[52:53], s[44:45]
    v_pk_mul_f32 v[54:55], v[54:55], s[44:45]
    v_cvt_pk_bf16_f32 v32, v48, v49
    v_cvt_pk_bf16_f32 v33, v50, v51
    v_cvt_pk_bf16_f32 v34, v52, v53
    v_cvt_pk_bf16_f32 v35, v54, v55
    v_accvgpr_write_b32 a16, v32
    v_accvgpr_write_b32 a17, v33
    v_accvgpr_write_b32 a18, v34
    v_accvgpr_write_b32 a19, v35
    s_nop 1
    v_mfma_f32_16x16x32_bf16 v[200:203], a[96:99], a[16:19], 0
    s_waitcnt lgkmcnt(2)
    v_lshlrev_b32 v56, 16, v36
    v_lshlrev_b32 v58, 16, v37
    v_lshlrev_b32 v60, 16, v38
    v_lshlrev_b32 v62, 16, v39
    v_and_b32 v57, s29, v36
    v_and_b32 v59, s29, v37
    v_and_b32 v61, s29, v38
    v_and_b32 v63, s29, v39
    v_pk_mul_f32 v[56:57], v[56:57], s[44:45]
    v_pk_mul_f32 v[58:59], v[58:59], s[44:45]
    v_pk_mul_f32 v[60:61], v[60:61], s[44:45]
    v_pk_mul_f32 v[62:63], v[62:63], s[44:45]
    v_cvt_pk_bf16_f32 v36, v56, v57
    v_cvt_pk_bf16_f32 v37, v58, v59
    v_cvt_pk_bf16_f32 v38, v60, v61
    v_cvt_pk_bf16_f32 v39, v62, v63
    v_accvgpr_write_b32 a20, v36
    v_accvgpr_write_b32 a21, v37
    v_accvgpr_write_b32 a22, v38
    v_accvgpr_write_b32 a23, v39
    s_nop 1
    v_mfma_f32_16x16x32_bf16 v[200:203], a[100:103], a[20:23], v[200:203]
    s_waitcnt lgkmcnt(1)
    v_lshlrev_b32 v48, 16, v40
    v_lshlrev_b32 v50, 16, v41
    v_lshlrev_b32 v52, 16, v42
    v_lshlrev_b32 v54, 16, v43
    v_and_b32 v49, s29, v40
    v_and_b32 v51, s29, v41
    v_and_b32 v53, s29, v42
    v_and_b32 v55, s29, v43
    v_pk_mul_f32 v[48:49], v[48:49], s[44:45]
    v_pk_mul_f32 v[50:51], v[50:51], s[44:45]
    v_pk_mul_f32 v[52:53], v[52:53], s[44:45]
    v_pk_mul_f32 v[54:55], v[54:55], s[44:45]
    v_cvt_pk_bf16_f32 v40, v48, v49
    v_cvt_pk_bf16_f32 v41, v50, v51
    v_cvt_pk_bf16_f32 v42, v52, v53
    v_cvt_pk_bf16_f32 v43, v54, v55
    v_accvgpr_write_b32 a24, v40
    v_accvgpr_write_b32 a25, v41
    v_accvgpr_write_b32 a26, v42
    v_accvgpr_write_b32 a27, v43
    s_nop 1
    v_mfma_f32_16x16x32_bf16 v[200:203], a[104:107], a[24:27], v[200:203]
    s_waitcnt lgkmcnt(0)
    v_lshlrev_b32 v56, 16, v44
    v_lshlrev_b32 v58, 16, v45
    v_lshlrev_b32 v60, 16, v46
    v_lshlrev_b32 v62, 16, v47
    v_and_b32 v57, s29, v44
    v_and_b32 v59, s29, v45
    v_and_b32 v61, s29, v46
    v_and_b32 v63, s29, v47
    v_pk_mul_f32 v[56:57], v[56:57], s[44:45]
    v_pk_mul_f32 v[58:59], v[58:59], s[44:45]
    v_pk_mul_f32 v[60:61], v[60:61], s[44:45]
    v_pk_mul_f32 v[62:63], v[62:63], s[44:45]
    v_cvt_pk_bf16_f32 v44, v56, v57
    v_cvt_pk_bf16_f32 v45, v58, v59
    v_cvt_pk_bf16_f32 v46, v60, v61
    v_cvt_pk_bf16_f32 v47, v62, v63
    v_accvgpr_write_b32 a28, v44
    v_accvgpr_write_b32 a29, v45
    v_accvgpr_write_b32 a30, v46
    v_accvgpr_write_b32 a31, v47
    s_nop 1
    v_mfma_f32_16x16x32_bf16 v[200:203], a[108:111], a[28:31], v[200:203]
    v_max3_f32 v217, v192, v193, v194
    v_max3_f32 v218, v195, v196, v197
    v_max3_f32 v217, v217, v198, v199
    v_max_f32 v217, v217, v218
    v_mov_b32 v218, v217
    v_mfma_f32_16x16x32_bf16 v[204:207], a[124:127], a[28:31], 0
    v_mfma_f32_16x16x32_bf16 v[204:207], a[120:123], a[24:27], v[204:207]
    v_permlane32_swap_b32 v217, v218
    v_max_f32 v217, v217, v218
    v_mov_b32 v218, v217
    s_nop 1
    v_permlane16_swap_b32 v217, v218
    v_min_f32 v216, -v217, -v218
    v_add_f32 v192, v192, v216
    v_add_f32 v193, v193, v216
    v_add_f32 v194, v194, v216
    v_add_f32 v195, v195, v216
    v_add_f32 v196, v196, v216
    v_add_f32 v197, v197, v216
    v_add_f32 v198, v198, v216
    v_add_f32 v199, v199, v216
    v_mov_b32 v217, v216
    v_mov_b32 v218, v216
    v_mov_b32 v219, v216
    v_exp_f32 v192, v192
    v_exp_f32 v193, v193
    v_exp_f32 v194, v194
    v_exp_f32 v195, v195
    v_exp_f32 v196, v196
    v_exp_f32 v197, v197
    v_exp_f32 v198, v198
    v_exp_f32 v199, v199
    v_cvt_pk_bf16_f32 v192, v192, v193
    v_cvt_pk_bf16_f32 v193, v194, v195
    v_cvt_pk_bf16_f32 v194, v196, v197
    v_cvt_pk_bf16_f32 v195, v198, v199
    s_waitcnt vmcnt(8)
    s_addk_i32 m0, -25472
    s_addk_i32 s30, 8192
    buffer_load_dwordx4 v248, s[8:11], s30 offen sc1 nt lds
    s_addk_i32 m0, 896
    s_nop 0
    buffer_load_dwordx4 v248, s[8:11], s30 offen offset:128 sc1 nt lds
    s_waitcnt vmcnt(8)
    s_addk_i32 m0, 31872
    s_nop 0
    buffer_load_dwordx4 v248, s[12:15], s30 offen sc1 nt lds
    s_addk_i32 m0, 896
    s_nop 0
    buffer_load_dwordx4 v248, s[12:15], s30 offen offset:128 sc1 nt lds
    s_waitcnt vmcnt(8)
    s_add_u32 m0, s28, 12288
    s_add_u32 s30, s21, 12288
    buffer_load_dwordx4 v248, s[4:7], s30 offen sc1 nt lds
    s_addk_i32 m0, 896
    s_nop 0
    buffer_load_dwordx4 v248, s[4:7], s30 offen offset:128 sc1 nt lds
    s_barrier
    ds_read_b128 a[32:35], v246 offset:8192
    ds_read_b128 a[36:39], v247 offset:8192
    ds_read_b128 a[40:43], v246 offset:9216
    ds_read_b128 a[44:47], v247 offset:9216
    v_mfma_f32_16x16x32_bf16 v[204:207], a[116:119], a[20:23], v[204:207]
    ds_read_b64_tr_b16 a[160:161], v242 offset:16384
    v_mfma_f32_16x16x32_bf16 v[204:207], a[112:115], a[16:19], v[204:207]
    s_waitcnt lgkmcnt(4)
    ds_read_b64_tr_b16 a[162:163], v242 offset:20480
    v_mfma_f32_16x16x32_bf16 v[208:211], a[96:99], a[32:35], 0
    s_waitcnt lgkmcnt(4)
    ds_read_b64_tr_b16 a[164:165], v243 offset:16384
    v_mfma_f32_16x16x32_bf16 v[208:211], a[100:103], a[36:39], v[208:211]
    s_waitcnt lgkmcnt(4)
    ds_read_b64_tr_b16 a[166:167], v243 offset:20480
    v_mfma_f32_16x16x32_bf16 v[208:211], a[104:107], a[40:43], v[208:211]
    s_waitcnt lgkmcnt(4)
    ds_read_b64_tr_b16 a[168:169], v244 offset:16384
    v_mfma_f32_16x16x32_bf16 v[208:211], a[108:111], a[44:47], v[208:211]
    ds_read_b64_tr_b16 a[170:171], v244 offset:20480
    ds_read_b64_tr_b16 a[172:173], v245 offset:16384
    ds_read_b64_tr_b16 a[174:175], v245 offset:20480
    v_max3_f32 v221, v200, v201, v202
    v_max3_f32 v222, v203, v204, v205
    v_max3_f32 v221, v221, v206, v207
    v_max_f32 v221, v221, v222
    v_mov_b32 v222, v221
    v_mfma_f32_16x16x32_bf16 v[212:215], a[124:127], a[44:47], 0
    ds_read_b64_tr_b16 a[176:177], v242 offset:17408
    ds_read_b64_tr_b16 a[178:179], v242 offset:21504
    ds_read_b64_tr_b16 a[180:181], v243 offset:17408
    ds_read_b64_tr_b16 a[182:183], v243 offset:21504
    v_mfma_f32_16x16x32_bf16 v[212:215], a[120:123], a[40:43], v[212:215]
    ds_read_b64_tr_b16 a[184:185], v244 offset:17408
    ds_read_b64_tr_b16 a[186:187], v244 offset:21504
    ds_read_b64_tr_b16 a[188:189], v245 offset:17408
    ds_read_b64_tr_b16 a[190:191], v245 offset:21504
    v_permlane32_swap_b32 v221, v222
    v_mfma_f32_16x16x32_bf16 v[212:215], a[116:119], a[36:39], v[212:215]
    s_waitcnt vmcnt(8)
    s_addk_i32 m0, 1152
    s_addk_i32 s30, 2048
    buffer_load_dwordx4 v248, s[4:7], s30 offen sc1 nt lds
    s_addk_i32 m0, 896
    s_nop 0
    buffer_load_dwordx4 v248, s[4:7], s30 offen offset:128 sc1 nt lds
    s_barrier
    v_max_f32 v221, v221, v222
    v_mov_b32 v222, v221
    v_mfma_f32_16x16x32_bf16 v[212:215], a[112:115], a[32:35], v[212:215]
    s_addk_i32 m0, 1152
    ds_read_b128 a[128:131], v240 offset:0
    v_mfma_f32_16x16x32_bf16 a[224:227], a[236:239], v[192:195], 0
    s_waitcnt lgkmcnt(14)
    v_permlane16_swap_b32 v221, v222
    v_mfma_f32_16x16x32_bf16 v[0:3], a[160:163], v[192:195], 0
    s_waitcnt lgkmcnt(13)
    v_min_f32 v220, -v221, -v222
    v_add_f32 v200, v200, v220
    v_exp_f32 v200, v200
    v_add_f32 v201, v201, v220
    v_exp_f32 v201, v201
    v_add_f32 v202, v202, v220
    v_exp_f32 v202, v202
    v_mfma_f32_16x16x32_bf16 v[4:7], a[164:167], v[192:195], 0
    s_waitcnt lgkmcnt(11)
    ds_read_b128 a[132:135], v241 offset:0
    v_add_f32 v203, v203, v220
    v_cvt_pk_bf16_f32 v200, v200, v201
    v_exp_f32 v203, v203
    v_add_f32 v204, v204, v220
    v_exp_f32 v204, v204
    v_add_f32 v205, v205, v220
    v_mfma_f32_16x16x32_bf16 v[8:11], a[168:171], v[192:195], 0
    s_waitcnt lgkmcnt(10)
    ds_read_b128 a[136:139], v240 offset:1024
    ds_read_b128 a[140:143], v241 offset:1024
    v_max3_f32 v225, v208, v209, v210
    v_max3_f32 v226, v211, v212, v213
    v_max3_f32 v225, v225, v214, v215
    v_max_f32 v225, v225, v226
    v_mov_b32 v226, v225
    v_cvt_pk_bf16_f32 v201, v202, v203
    v_mfma_f32_16x16x32_bf16 v[12:15], a[172:175], v[192:195], 0
    s_waitcnt lgkmcnt(8)
    ds_read_b128 a[144:147], v240 offset:4096
    ds_read_b128 a[148:151], v241 offset:4096
    v_exp_f32 v205, v205
    v_add_f32 v206, v206, v220
    v_mfma_f32_16x16x32_bf16 v[16:19], a[176:179], v[192:195], 0
    s_addk_i32 s30, 2048
    ds_read_b128 a[152:155], v240 offset:5120
    ds_read_b128 a[156:159], v241 offset:5120
    v_permlane32_swap_b32 v225, v226
    v_mfma_f32_16x16x32_bf16 v[20:23], a[180:183], v[192:195], 0
    s_waitcnt lgkmcnt(8)
    buffer_load_dwordx4 v248, s[4:7], s30 offen sc1 nt lds
    v_max_f32 v225, v225, v226
    v_mov_b32 v226, v225
    v_exp_f32 v206, v206
    v_add_f32 v207, v207, v220
    v_cvt_pk_bf16_f32 v202, v204, v205
    v_mfma_f32_16x16x32_bf16 v[24:27], a[184:187], v[192:195], 0
    s_addk_i32 m0, 896
    v_exp_f32 v207, v207
    v_mfma_f32_16x16x32_bf16 v[28:31], a[188:191], v[192:195], 0
    s_waitcnt lgkmcnt(7)
    v_permlane16_swap_b32 v225, v226
    v_mfma_f32_16x16x32_bf16 v[192:195], a[128:131], a[0:3], v[216:219]
    s_waitcnt lgkmcnt(0)
    v_min_f32 v224, -v225, -v226
    v_mul_f32 v251, s44, v224
    v_fma_f32 v208, v208, s44, v251
    v_mfma_f32_16x16x32_bf16 v[192:195], a[132:135], a[4:7], v[192:195]
    s_barrier
    v_cvt_pk_bf16_f32 v203, v206, v207
    v_mfma_f32_16x16x32_bf16 v[192:195], a[136:139], a[8:11], v[192:195]
    buffer_load_dwordx4 v248, s[4:7], s30 offen offset:128 sc1 nt lds
    v_exp_f32 v208, v208
    v_fma_f32 v209, v209, s44, v251
    v_mfma_f32_16x16x32_bf16 v[192:195], a[140:143], a[12:15], v[192:195]
    s_addk_i32 m0, 1152
    v_exp_f32 v209, v209
    v_mfma_f32_16x16x32_bf16 v[196:199], a[156:159], a[12:15], v[216:219]
    s_addk_i32 s30, 2048
    v_fma_f32 v210, v210, s44, v251
    v_fma_f32 v211, v211, s44, v251
    v_mfma_f32_16x16x32_bf16 v[196:199], a[152:155], a[8:11], v[196:199]
    v_exp_f32 v210, v210
    v_mfma_f32_16x16x32_bf16 v[196:199], a[148:151], a[4:7], v[196:199]
    v_cvt_pk_bf16_f32 v208, v208, v209
    v_fma_f32 v212, v212, s44, v251
    v_mfma_f32_16x16x32_bf16 v[196:199], a[144:147], a[0:3], v[196:199]
    v_exp_f32 v211, v211
    v_mfma_f32_16x16x32_bf16 a[224:227], a[240:243], v[200:203], a[224:227]
    buffer_load_dwordx4 v248, s[4:7], s30 offen sc1 nt lds
    v_mfma_f32_16x16x32_bf16 v[32:35], a[160:163], v[200:203], 0
    s_addk_i32 m0, 896
    v_mov_b32 v221, v220
    v_mov_b32 v222, v220
    v_mfma_f32_16x16x32_bf16 v[36:39], a[164:167], v[200:203], 0
    v_mov_b32 v223, v220
    v_fma_f32 v213, v213, s44, v251
    v_exp_f32 v212, v212
    v_cvt_pk_bf16_f32 v209, v210, v211
    v_mfma_f32_16x16x32_bf16 v[40:43], a[168:171], v[200:203], 0
    v_exp_f32 v213, v213
    v_mfma_f32_16x16x32_bf16 v[44:47], a[172:175], v[200:203], 0
    v_fma_f32 v214, v214, s44, v251
    v_fma_f32 v215, v215, s44, v251
    v_mfma_f32_16x16x32_bf16 v[48:51], a[176:179], v[200:203], 0
    v_exp_f32 v214, v214
    v_mfma_f32_16x16x32_bf16 v[52:55], a[180:183], v[200:203], 0
    s_waitcnt vmcnt(9)
    buffer_load_dwordx4 v248, s[4:7], s30 offen offset:128 sc1 nt lds
    v_cvt_pk_bf16_f32 v210, v212, v213
    v_mfma_f32_16x16x32_bf16 v[56:59], a[184:187], v[200:203], 0
    s_barrier
    v_mov_b32 v225, v224
    v_mfma_f32_16x16x32_bf16 v[60:63], a[188:191], v[200:203], 0
    s_addk_i32 m0, 1152
    v_exp_f32 v215, v215
    v_mfma_f32_16x16x32_bf16 v[200:203], a[128:131], a[16:19], v[220:223]
    s_addk_i32 s30, 2048
    v_mov_b32 v226, v224
    v_mov_b32 v227, v224
    v_mfma_f32_16x16x32_bf16 v[200:203], a[132:135], a[20:23], v[200:203]
    ds_read_b128 a[96:99], v240 offset:8192
    v_cvt_pk_bf16_f32 v211, v214, v215
    v_mfma_f32_16x16x32_bf16 v[200:203], a[136:139], a[24:27], v[200:203]
    s_barrier
    v_exp_f32 v192, v192
    v_mfma_f32_16x16x32_bf16 v[200:203], a[140:143], a[28:31], v[200:203]
    buffer_load_dwordx4 v248, s[4:7], s30 offen sc1 nt lds
    v_mfma_f32_16x16x32_bf16 v[204:207], a[156:159], a[28:31], v[220:223]
    s_addk_i32 m0, 896
    v_exp_f32 v193, v193
    v_mfma_f32_16x16x32_bf16 v[204:207], a[152:155], a[24:27], v[204:207]
    ds_read_b128 a[100:103], v241 offset:8192
    v_cvt_pk_bf16_f32 v192, v192, v193
    v_mfma_f32_16x16x32_bf16 v[204:207], a[148:151], a[20:23], v[204:207]
    ds_read_b64_tr_b16 a[192:193], v242 offset:0
    v_exp_f32 v194, v194
    v_mfma_f32_16x16x32_bf16 v[204:207], a[144:147], a[16:19], v[204:207]
    ds_read_b64_tr_b16 a[194:195], v242 offset:4096
    v_exp_f32 v195, v195
    v_mfma_f32_16x16x32_bf16 a[228:231], a[236:239], v[208:211], 0
    ds_read_b64_tr_b16 a[196:197], v243 offset:0
    v_cvt_pk_bf16_f32 v193, v194, v195
    v_mfma_f32_16x16x32_bf16 v[64:67], a[160:163], v[208:211], 0
    buffer_load_dwordx4 v248, s[4:7], s30 offen offset:128 sc1 nt lds
    s_addk_i32 m0, 1152
    s_addk_i32 s30, 2048
    ds_read_b64_tr_b16 a[198:199], v243 offset:4096
    ds_read_b128 a[104:107], v240 offset:9216
    v_mfma_f32_16x16x32_bf16 v[68:71], a[164:167], v[208:211], 0
    ds_read_b64_tr_b16 a[200:201], v244 offset:0
    v_exp_f32 v196, v196
    v_mfma_f32_16x16x32_bf16 v[72:75], a[168:171], v[208:211], 0
    ds_read_b64_tr_b16 a[202:203], v244 offset:4096
    v_exp_f32 v197, v197
    v_mfma_f32_16x16x32_bf16 v[76:79], a[172:175], v[208:211], 0
    ds_read_b64_tr_b16 a[204:205], v245 offset:0
    ds_read_b128 a[108:111], v241 offset:9216
    v_mfma_f32_16x16x32_bf16 v[80:83], a[176:179], v[208:211], 0
    ds_read_b64_tr_b16 a[206:207], v245 offset:4096
    v_cvt_pk_bf16_f32 v194, v196, v197
    v_mfma_f32_16x16x32_bf16 v[84:87], a[180:183], v[208:211], 0
    ds_read_b64_tr_b16 a[208:209], v242 offset:1024
    v_exp_f32 v198, v198
    v_mfma_f32_16x16x32_bf16 v[88:91], a[184:187], v[208:211], 0
    buffer_load_dwordx4 v248, s[4:7], s30 offen sc1 nt lds
    s_addk_i32 m0, 896
    ds_read_b64_tr_b16 a[210:211], v242 offset:5120
    v_mfma_f32_16x16x32_bf16 v[92:95], a[188:191], v[208:211], 0
    ds_read_b64_tr_b16 a[212:213], v243 offset:1024
    ds_read_b128 a[112:115], v240 offset:12288
    v_exp_f32 v199, v199
    v_mfma_f32_16x16x32_bf16 v[208:211], a[128:131], a[32:35], v[224:227]
    ds_read_b64_tr_b16 a[214:215], v243 offset:5120
    v_cvt_pk_bf16_f32 v195, v198, v199
    v_mfma_f32_16x16x32_bf16 v[208:211], a[132:135], a[36:39], v[208:211]
    ds_read_b64_tr_b16 a[216:217], v244 offset:1024
    v_exp_f32 v200, v200
    v_mfma_f32_16x16x32_bf16 v[208:211], a[136:139], a[40:43], v[208:211]
    ds_read_b64_tr_b16 a[218:219], v244 offset:5120
    ds_read_b128 a[116:119], v241 offset:12288
    v_exp_f32 v201, v201
    v_mfma_f32_16x16x32_bf16 v[208:211], a[140:143], a[44:47], v[208:211]
    ds_read_b64_tr_b16 a[220:221], v245 offset:1024
    v_cvt_pk_bf16_f32 v196, v200, v201
    v_mfma_f32_16x16x32_bf16 v[212:215], a[156:159], a[44:47], v[224:227]
    buffer_load_dwordx4 v248, s[4:7], s30 offen offset:128 sc1 nt lds
    s_add_u32 m0, s27, 24576
    s_add_u32 s30, s24, 24576
    ds_read_b64_tr_b16 a[222:223], v245 offset:5120
    v_mfma_f32_16x16x32_bf16 v[212:215], a[152:155], a[40:43], v[212:215]
    v_exp_f32 v202, v202
    v_mfma_f32_16x16x32_bf16 v[212:215], a[148:151], a[36:39], v[212:215]
    ds_read_b128 a[120:123], v240 offset:13312
    v_exp_f32 v203, v203
    v_mfma_f32_16x16x32_bf16 v[212:215], a[144:147], a[32:35], v[212:215]
    s_waitcnt lgkmcnt(7)
    ds_read_b128 a[124:127], v241 offset:13312
    v_cvt_pk_bf16_f32 v197, v202, v203
    v_mfma_f32_16x16x32_bf16 v[0:3], a[192:195], v[192:195], v[0:3]
    v_exp_f32 v204, v204
    v_mfma_f32_16x16x32_bf16 v[4:7], a[196:199], v[192:195], v[4:7]
    v_exp_f32 v205, v205
    v_mfma_f32_16x16x32_bf16 v[8:11], a[200:203], v[192:195], v[8:11]
    v_exp_f32 v206, v206
    v_mfma_f32_16x16x32_bf16 v[12:15], a[204:207], v[192:195], v[12:15]
    v_cvt_pk_bf16_f32 v198, v204, v205
    v_mul_f32 v208, s44, v208
    v_mfma_f32_16x16x32_bf16 v[16:19], a[208:211], v[192:195], v[16:19]
    s_waitcnt lgkmcnt(2)
    v_exp_f32 v207, v207
    v_mfma_f32_16x16x32_bf16 v[20:23], a[212:215], v[192:195], v[20:23]
    v_cvt_pk_bf16_f32 v199, v206, v207
    v_mul_f32 v209, s44, v209
    v_mfma_f32_16x16x32_bf16 v[24:27], a[216:219], v[192:195], v[24:27]
    s_waitcnt vmcnt(12)
    v_exp_f32 v208, v208
    v_mfma_f32_16x16x32_bf16 v[28:31], a[220:223], v[192:195], v[28:31]
    s_barrier
    v_mul_f32 v210, s44, v210
    v_mfma_f32_16x16x32_bf16 v[200:203], a[96:99], a[0:3], v[216:219]
    s_waitcnt lgkmcnt(0)
    ds_read_b64_tr_b16 a[160:161], v242 offset:8192
    v_mul_f32 v211, s44, v211
    v_mfma_f32_16x16x32_bf16 v[200:203], a[100:103], a[4:7], v[200:203]
    s_barrier
    v_mul_f32 v212, s44, v212
    v_mfma_f32_16x16x32_bf16 v[200:203], a[104:107], a[8:11], v[200:203]
    v_exp_f32 v209, v209
    v_mfma_f32_16x16x32_bf16 v[200:203], a[108:111], a[12:15], v[200:203]
    ds_read_b64_tr_b16 a[162:163], v242 offset:12288
    v_cvt_pk_bf16_f32 v208, v208, v209
    v_mfma_f32_16x16x32_bf16 v[204:207], a[124:127], a[12:15], v[216:219]
    v_exp_f32 v210, v210
    v_mfma_f32_16x16x32_bf16 v[204:207], a[120:123], a[8:11], v[204:207]
    ds_read_b64_tr_b16 a[164:165], v243 offset:8192
    v_mul_f32 v213, s44, v213
    v_mfma_f32_16x16x32_bf16 v[204:207], a[116:119], a[4:7], v[204:207]
    v_exp_f32 v211, v211
    v_mfma_f32_16x16x32_bf16 v[204:207], a[112:115], a[0:3], v[204:207]
L_pad0:
    s_cbranch_execz L_pad4
    ds_read_b64_tr_b16 a[166:167], v243 offset:12288
    v_cvt_pk_bf16_f32 v209, v210, v211
    v_smfmac_f32_16x16x64_bf16 a[224:227], a[244:247], v[192:199], v253
    ds_read_b64_tr_b16 a[168:169], v244 offset:8192
    v_mfma_f32_16x16x32_bf16 v[32:35], a[192:195], v[196:199], v[32:35]
    v_exp_f32 v212, v212
    v_mfma_f32_16x16x32_bf16 v[36:39], a[196:199], v[196:199], v[36:39]
    v_exp_f32 v213, v213
    v_mfma_f32_16x16x32_bf16 v[40:43], a[200:203], v[196:199], v[40:43]
    ds_read_b64_tr_b16 a[170:171], v244 offset:12288
    v_mul_f32 v214, s44, v214
    v_mfma_f32_16x16x32_bf16 v[44:47], a[204:207], v[196:199], v[44:47]
    v_exp_f32 v214, v214
    v_mfma_f32_16x16x32_bf16 v[48:51], a[208:211], v[196:199], v[48:51]
    v_mul_f32 v215, s44, v215
    v_cvt_pk_bf16_f32 v210, v212, v213
    v_mfma_f32_16x16x32_bf16 v[52:55], a[212:215], v[196:199], v[52:55]
    v_exp_f32 v215, v215
    v_mfma_f32_16x16x32_bf16 v[56:59], a[216:219], v[196:199], v[56:59]
    ds_read_b64_tr_b16 a[172:173], v245 offset:8192
    v_cvt_pk_bf16_f32 v211, v214, v215
    v_mfma_f32_16x16x32_bf16 v[60:63], a[220:223], v[196:199], v[60:63]
    v_exp_f32 v200, v200
    v_mfma_f32_16x16x32_bf16 v[192:195], a[96:99], a[16:19], v[220:223]
    v_exp_f32 v201, v201
    v_mfma_f32_16x16x32_bf16 v[192:195], a[100:103], a[20:23], v[192:195]
    ds_read_b64_tr_b16 a[174:175], v245 offset:12288
    v_cvt_pk_bf16_f32 v200, v200, v201
    v_mfma_f32_16x16x32_bf16 v[192:195], a[104:107], a[24:27], v[192:195]
    v_exp_f32 v202, v202
    v_mfma_f32_16x16x32_bf16 v[192:195], a[108:111], a[28:31], v[192:195]
    v_exp_f32 v203, v203
    v_mfma_f32_16x16x32_bf16 v[196:199], a[124:127], a[28:31], v[220:223]
    ds_read_b64_tr_b16 a[176:177], v242 offset:9216
    v_cvt_pk_bf16_f32 v201, v202, v203
    v_mfma_f32_16x16x32_bf16 v[196:199], a[120:123], a[24:27], v[196:199]
    v_exp_f32 v204, v204
    v_mfma_f32_16x16x32_bf16 v[196:199], a[116:119], a[20:23], v[196:199]
    ds_read_b64_tr_b16 a[178:179], v242 offset:13312
    v_exp_f32 v205, v205
    v_mfma_f32_16x16x32_bf16 v[196:199], a[112:115], a[16:19], v[196:199]
    ds_read_b64_tr_b16 a[180:181], v243 offset:9216
    v_cvt_pk_bf16_f32 v202, v204, v205
    v_mfma_f32_16x16x32_bf16 a[228:231], a[236:239], v[208:211], a[228:231]
    v_exp_f32 v206, v206
    v_mfma_f32_16x16x32_bf16 v[64:67], a[192:195], v[208:211], v[64:67]
    v_exp_f32 v207, v207
    v_mfma_f32_16x16x32_bf16 v[68:71], a[196:199], v[208:211], v[68:71]
    ds_read_b64_tr_b16 a[182:183], v243 offset:13312
    v_cvt_pk_bf16_f32 v203, v206, v207
    v_mfma_f32_16x16x32_bf16 v[72:75], a[200:203], v[208:211], v[72:75]
    v_exp_f32 v192, v192
    v_mfma_f32_16x16x32_bf16 v[76:79], a[204:207], v[208:211], v[76:79]
    v_exp_f32 v193, v193
    v_mfma_f32_16x16x32_bf16 v[80:83], a[208:211], v[208:211], v[80:83]
    ds_read_b64_tr_b16 a[184:185], v244 offset:9216
    v_cvt_pk_bf16_f32 v204, v192, v193
    v_mfma_f32_16x16x32_bf16 v[84:87], a[212:215], v[208:211], v[84:87]
    v_exp_f32 v194, v194
    v_mfma_f32_16x16x32_bf16 v[88:91], a[216:219], v[208:211], v[88:91]
    ds_read_b64_tr_b16 a[186:187], v244 offset:13312
    v_exp_f32 v195, v195
    v_mfma_f32_16x16x32_bf16 v[92:95], a[220:223], v[208:211], v[92:95]
    ds_read_b64_tr_b16 a[188:189], v245 offset:9216
    v_cvt_pk_bf16_f32 v205, v194, v195
    v_mfma_f32_16x16x32_bf16 v[208:211], a[96:99], a[32:35], v[224:227]
    v_exp_f32 v196, v196
    v_mfma_f32_16x16x32_bf16 v[208:211], a[100:103], a[36:39], v[208:211]
    v_exp_f32 v197, v197
    v_mfma_f32_16x16x32_bf16 v[208:211], a[104:107], a[40:43], v[208:211]
    ds_read_b64_tr_b16 a[190:191], v245 offset:13312
    v_cvt_pk_bf16_f32 v206, v196, v197
    v_mfma_f32_16x16x32_bf16 v[208:211], a[108:111], a[44:47], v[208:211]
    v_exp_f32 v198, v198
    v_mfma_f32_16x16x32_bf16 v[212:215], a[124:127], a[44:47], v[224:227]
    v_exp_f32 v199, v199
    v_mfma_f32_16x16x32_bf16 v[212:215], a[120:123], a[40:43], v[212:215]
    v_cvt_pk_bf16_f32 v207, v198, v199
    v_mfma_f32_16x16x32_bf16 v[212:215], a[116:119], a[36:39], v[212:215]
    v_mfma_f32_16x16x32_bf16 v[212:215], a[112:115], a[32:35], v[212:215]
    s_waitcnt vmcnt(8) lgkmcnt(1)
    ds_read_b128 v[96:99], v246 offset:12288
    ds_read_b128 v[100:103], v247 offset:12288
    ds_read_b128 v[104:107], v246 offset:13312
    ds_read_b128 v[108:111], v247 offset:13312
    v_mfma_f32_16x16x32_bf16 v[0:3], a[160:163], v[200:203], v[0:3]
    v_mfma_f32_16x16x32_bf16 v[4:7], a[164:167], v[200:203], v[4:7]
    v_mfma_f32_16x16x32_bf16 v[8:11], a[168:171], v[200:203], v[8:11]
    v_mfma_f32_16x16x32_bf16 v[12:15], a[172:175], v[200:203], v[12:15]
    v_mul_f32 v208, s44, v208
    v_mul_f32 v209, s44, v209
    v_mfma_f32_16x16x32_bf16 v[16:19], a[176:179], v[200:203], v[16:19]
    v_exp_f32 v208, v208
    v_mfma_f32_16x16x32_bf16 v[20:23], a[180:183], v[200:203], v[20:23]
    v_exp_f32 v209, v209
    v_mfma_f32_16x16x32_bf16 v[24:27], a[184:187], v[200:203], v[24:27]
    s_waitcnt lgkmcnt(3)
    v_lshlrev_b32 v112, 16, v96
    v_lshlrev_b32 v114, 16, v97
    v_lshlrev_b32 v116, 16, v98
    v_lshlrev_b32 v118, 16, v99
    v_and_b32 v113, s29, v96
    v_and_b32 v115, s29, v97
    v_and_b32 v117, s29, v98
    v_and_b32 v119, s29, v99
    v_pk_mul_f32 v[112:113], v[112:113], s[44:45]
    v_pk_mul_f32 v[114:115], v[114:115], s[44:45]
    v_pk_mul_f32 v[116:117], v[116:117], s[44:45]
    v_pk_mul_f32 v[118:119], v[118:119], s[44:45]
    v_cvt_pk_bf16_f32 v96, v112, v113
    v_cvt_pk_bf16_f32 v97, v114, v115
    v_cvt_pk_bf16_f32 v98, v116, v117
    v_cvt_pk_bf16_f32 v99, v118, v119
    v_accvgpr_write_b32 a48, v96
    v_accvgpr_write_b32 a49, v97
    v_accvgpr_write_b32 a50, v98
    v_accvgpr_write_b32 a51, v99
    v_mfma_f32_16x16x32_bf16 v[28:31], a[188:191], v[200:203], v[28:31]
    s_waitcnt lgkmcnt(0)
    v_lshlrev_b32 v120, 16, v100
    v_lshlrev_b32 v122, 16, v101
    v_lshlrev_b32 v124, 16, v102
    v_lshlrev_b32 v126, 16, v103
    v_and_b32 v121, s29, v100
    v_and_b32 v123, s29, v101
    v_and_b32 v125, s29, v102
    v_and_b32 v127, s29, v103
    v_pk_mul_f32 v[120:121], v[120:121], s[44:45]
    v_pk_mul_f32 v[122:123], v[122:123], s[44:45]
    v_pk_mul_f32 v[124:125], v[124:125], s[44:45]
    v_pk_mul_f32 v[126:127], v[126:127], s[44:45]
    v_cvt_pk_bf16_f32 v100, v120, v121
    v_cvt_pk_bf16_f32 v101, v122, v123
    v_cvt_pk_bf16_f32 v102, v124, v125
    v_cvt_pk_bf16_f32 v103, v126, v127
    v_accvgpr_write_b32 a52, v100
    v_accvgpr_write_b32 a53, v101
    v_accvgpr_write_b32 a54, v102
    v_accvgpr_write_b32 a55, v103
    v_mfma_f32_16x16x32_bf16 v[192:195], a[128:131], a[48:51], 0
    v_lshlrev_b32 v112, 16, v104
    v_lshlrev_b32 v114, 16, v105
    v_lshlrev_b32 v116, 16, v106
    v_lshlrev_b32 v118, 16, v107
    v_and_b32 v113, s29, v104
    v_and_b32 v115, s29, v105
    v_and_b32 v117, s29, v106
    v_and_b32 v119, s29, v107
    v_pk_mul_f32 v[112:113], v[112:113], s[44:45]
    v_pk_mul_f32 v[114:115], v[114:115], s[44:45]
    v_pk_mul_f32 v[116:117], v[116:117], s[44:45]
    v_pk_mul_f32 v[118:119], v[118:119], s[44:45]
    v_cvt_pk_bf16_f32 v104, v112, v113
    v_cvt_pk_bf16_f32 v105, v114, v115
    v_cvt_pk_bf16_f32 v106, v116, v117
    v_cvt_pk_bf16_f32 v107, v118, v119
    v_accvgpr_write_b32 a56, v104
    v_accvgpr_write_b32 a57, v105
    v_accvgpr_write_b32 a58, v106
    v_accvgpr_write_b32 a59, v107
    v_mfma_f32_16x16x32_bf16 v[192:195], a[132:135], a[52:55], v[192:195]
    v_lshlrev_b32 v120, 16, v108
    v_lshlrev_b32 v122, 16, v109
    v_lshlrev_b32 v124, 16, v110
    v_lshlrev_b32 v126, 16, v111
    v_and_b32 v121, s29, v108
    v_and_b32 v123, s29, v109
    v_and_b32 v125, s29, v110
    v_and_b32 v127, s29, v111
    v_pk_mul_f32 v[120:121], v[120:121], s[44:45]
    v_pk_mul_f32 v[122:123], v[122:123], s[44:45]
    v_pk_mul_f32 v[124:125], v[124:125], s[44:45]
    v_pk_mul_f32 v[126:127], v[126:127], s[44:45]
    v_cvt_pk_bf16_f32 v108, v120, v121
    v_cvt_pk_bf16_f32 v109, v122, v123
    v_cvt_pk_bf16_f32 v110, v124, v125
    v_cvt_pk_bf16_f32 v111, v126, v127
    v_accvgpr_write_b32 a60, v108
    v_accvgpr_write_b32 a61, v109
    v_accvgpr_write_b32 a62, v110
    v_accvgpr_write_b32 a63, v111
    v_mfma_f32_16x16x32_bf16 v[192:195], a[136:139], a[56:59], v[192:195]
    s_barrier
    v_mfma_f32_16x16x32_bf16 v[192:195], a[140:143], a[60:63], v[192:195]
    v_mul_f32 v210, s44, v210
    v_mul_f32 v211, s44, v211
    v_mfma_f32_16x16x32_bf16 v[196:199], a[156:159], a[60:63], 0
    v_exp_f32 v210, v210
    v_mfma_f32_16x16x32_bf16 v[196:199], a[152:155], a[56:59], v[196:199]
    v_cvt_pk_bf16_f32 v208, v208, v209
    v_mul_f32 v212, s44, v212
    v_mfma_f32_16x16x32_bf16 v[196:199], a[148:151], a[52:55], v[196:199]
    v_exp_f32 v211, v211
    v_mfma_f32_16x16x32_bf16 v[196:199], a[144:147], a[48:51], v[196:199]
    v_exp_f32 v212, v212
    v_smfmac_f32_16x16x64_bf16 a[224:227], a[244:247], v[200:207], v253
    v_mul_f32 v213, s44, v213
    v_mfma_f32_16x16x32_bf16 v[32:35], a[160:163], v[204:207], v[32:35]
    s_waitcnt vmcnt(4)
    ds_read_b128 a[64:67], v246 offset:16384
    ds_read_b128 a[68:71], v247 offset:16384
    ds_read_b128 a[72:75], v246 offset:17408
    ds_read_b128 a[76:79], v247 offset:17408
    v_mfma_f32_16x16x32_bf16 v[36:39], a[164:167], v[204:207], v[36:39]
    v_cvt_pk_bf16_f32 v209, v210, v211
    v_mul_f32 v214, s44, v214
    v_mfma_f32_16x16x32_bf16 v[40:43], a[168:171], v[204:207], v[40:43]
    v_max3_f32 v229, v192, v193, v194
    v_max3_f32 v230, v195, v196, v197
    v_max3_f32 v229, v229, v198, v199
    v_max_f32 v229, v229, v230
    v_mov_b32 v230, v229
    v_mfma_f32_16x16x32_bf16 v[44:47], a[172:175], v[204:207], v[44:47]
    v_exp_f32 v213, v213
    v_mfma_f32_16x16x32_bf16 v[48:51], a[176:179], v[204:207], v[48:51]
    v_permlane32_swap_b32 v229, v230
    v_mfma_f32_16x16x32_bf16 v[52:55], a[180:183], v[204:207], v[52:55]
    v_max_f32 v229, v229, v230
    v_mov_b32 v230, v229
    v_exp_f32 v214, v214
    v_mul_f32 v215, s44, v215
    v_cvt_pk_bf16_f32 v210, v212, v213
    v_mfma_f32_16x16x32_bf16 v[56:59], a[184:187], v[204:207], v[56:59]
    v_exp_f32 v215, v215
    v_mfma_f32_16x16x32_bf16 v[60:63], a[188:191], v[204:207], v[60:63]
    s_waitcnt lgkmcnt(3)
    v_permlane16_swap_b32 v229, v230
    v_mfma_f32_16x16x32_bf16 v[200:203], a[128:131], a[64:67], 0
    s_waitcnt lgkmcnt(0)
    v_min_f32 v228, -v229, -v230
    v_add_f32 v192, v192, v228
    v_mfma_f32_16x16x32_bf16 v[200:203], a[132:135], a[68:71], v[200:203]
    v_cvt_pk_bf16_f32 v211, v214, v215
    v_add_f32 v193, v193, v228
    v_mfma_f32_16x16x32_bf16 v[200:203], a[136:139], a[72:75], v[200:203]
    v_exp_f32 v192, v192
    v_mfma_f32_16x16x32_bf16 v[200:203], a[140:143], a[76:79], v[200:203]
    v_exp_f32 v193, v193
    v_mfma_f32_16x16x32_bf16 v[204:207], a[156:159], a[76:79], 0
    v_add_f32 v194, v194, v228
    v_add_f32 v195, v195, v228
    v_mfma_f32_16x16x32_bf16 v[204:207], a[152:155], a[72:75], v[204:207]
    v_exp_f32 v194, v194
    v_mfma_f32_16x16x32_bf16 v[204:207], a[148:151], a[68:71], v[204:207]
    v_cvt_pk_bf16_f32 v192, v192, v193
    v_add_f32 v196, v196, v228
    v_mfma_f32_16x16x32_bf16 v[204:207], a[144:147], a[64:67], v[204:207]
    v_exp_f32 v195, v195
    v_mfma_f32_16x16x32_bf16 a[228:231], a[236:239], v[208:211], a[228:231]
    v_exp_f32 v196, v196
    v_mfma_f32_16x16x32_bf16 v[64:67], a[160:163], v[208:211], v[64:67]
    v_add_f32 v197, v197, v228
    v_cvt_pk_bf16_f32 v193, v194, v195
    v_mfma_f32_16x16x32_bf16 v[68:71], a[164:167], v[208:211], v[68:71]
    buffer_load_dwordx4 v248, s[8:11], s30 offen sc1 nt lds
    s_addk_i32 m0, 896
    v_mfma_f32_16x16x32_bf16 v[72:75], a[168:171], v[208:211], v[72:75]
    v_max3_f32 v233, v200, v201, v202
    v_max3_f32 v234, v203, v204, v205
    v_max3_f32 v233, v233, v206, v207
    v_max_f32 v233, v233, v234
    v_mov_b32 v234, v233
    v_mfma_f32_16x16x32_bf16 v[76:79], a[172:175], v[208:211], v[76:79]
    v_exp_f32 v197, v197
    v_add_f32 v198, v198, v228
    v_mfma_f32_16x16x32_bf16 v[80:83], a[176:179], v[208:211], v[80:83]
    v_permlane32_swap_b32 v233, v234
    v_mfma_f32_16x16x32_bf16 v[84:87], a[180:183], v[208:211], v[84:87]
    v_max_f32 v233, v233, v234
    v_exp_f32 v198, v198
    v_add_f32 v199, v199, v228
    v_cvt_pk_bf16_f32 v194, v196, v197
    v_mov_b32 v229, v228
    v_mov_b32 v230, v228
    v_mov_b32 v231, v228
    v_mov_b32 v234, v233
    v_exp_f32 v199, v199
    s_nop 0
    v_permlane16_swap_b32 v233, v234
    v_cvt_pk_bf16_f32 v195, v198, v199
    v_min_f32 v232, -v233, -v234
    v_mul_f32 v255, s44, v232
    v_mov_b32 v233, v232
    v_mov_b32 v234, v232
    v_mov_b32 v235, v232
    v_fma_f32 v200, v200, s44, v255
    v_fma_f32 v201, v201, s44, v255
    v_fma_f32 v202, v202, s44, v255
    v_fma_f32 v203, v203, s44, v255
    v_fma_f32 v204, v204, s44, v255
    v_fma_f32 v205, v205, s44, v255
    v_fma_f32 v206, v206, s44, v255
    v_fma_f32 v207, v207, s44, v255
    v_exp_f32 v200, v200
    v_exp_f32 v201, v201
    v_exp_f32 v202, v202
    v_exp_f32 v203, v203
    v_exp_f32 v204, v204
    v_exp_f32 v205, v205
    v_exp_f32 v206, v206
    v_exp_f32 v207, v207
    v_cvt_pk_bf16_f32 v200, v200, v201
    v_cvt_pk_bf16_f32 v201, v202, v203
    v_cvt_pk_bf16_f32 v202, v204, v205
    v_cvt_pk_bf16_f32 v203, v206, v207
    s_waitcnt vmcnt(1)
    ds_read_b128 a[80:83], v246 offset:20480
    ds_read_b128 a[84:87], v247 offset:20480
    ds_read_b128 a[88:91], v246 offset:21504
    ds_read_b128 a[92:95], v247 offset:21504
    v_mfma_f32_16x16x32_bf16 v[88:91], a[184:187], v[208:211], v[88:91]
    v_mfma_f32_16x16x32_bf16 v[92:95], a[188:191], v[208:211], v[92:95]
    s_waitcnt lgkmcnt(3)
    buffer_load_dwordx4 v248, s[8:11], s30 offen offset:128 sc1 nt lds
    s_addk_i32 m0, 31872
    v_mfma_f32_16x16x32_bf16 v[208:211], a[128:131], a[80:83], 0
    s_waitcnt lgkmcnt(2)
    v_mfma_f32_16x16x32_bf16 v[208:211], a[132:135], a[84:87], v[208:211]
    s_waitcnt lgkmcnt(1)
    v_mfma_f32_16x16x32_bf16 v[208:211], a[136:139], a[88:91], v[208:211]
    s_waitcnt lgkmcnt(0)
    v_mfma_f32_16x16x32_bf16 v[208:211], a[140:143], a[92:95], v[208:211]
    v_mfma_f32_16x16x32_bf16 v[212:215], a[156:159], a[92:95], 0
    v_mfma_f32_16x16x32_bf16 v[212:215], a[152:155], a[88:91], v[212:215]
    v_mfma_f32_16x16x32_bf16 v[212:215], a[148:151], a[84:87], v[212:215]
    v_mfma_f32_16x16x32_bf16 v[212:215], a[144:147], a[80:83], v[212:215]
    buffer_load_dwordx4 v248, s[12:15], s30 offen sc1 nt lds
    s_addk_i32 m0, 896
    v_mfma_f32_16x16x32_bf16 a[228:231], a[240:243], v[192:195], a[228:231]
    v_mfma_f32_16x16x32_bf16 v[96:99], a[192:195], v[192:195], 0
    v_mfma_f32_16x16x32_bf16 v[100:103], a[196:199], v[192:195], 0
    v_mfma_f32_16x16x32_bf16 v[104:107], a[200:203], v[192:195], 0
    v_max3_f32 v237, v208, v209, v210
    s_nop 0
    v_max3_f32 v238, v211, v212, v213
    v_max3_f32 v237, v237, v214, v215
    v_max_f32 v237, v237, v238
    v_mov_b32 v238, v237
    v_mfma_f32_16x16x32_bf16 v[108:111], a[204:207], v[192:195], 0
    v_mfma_f32_16x16x32_bf16 v[112:115], a[208:211], v[192:195], 0
    buffer_load_dwordx4 v248, s[12:15], s30 offen offset:128 sc1 nt lds
    s_mov_b32 m0, s27
    s_addk_i32 s30, 8192
    v_permlane32_swap_b32 v237, v238
    v_mfma_f32_16x16x32_bf16 v[116:119], a[212:215], v[192:195], 0
    buffer_load_dwordx4 v248, s[8:11], s30 offen sc1 nt lds
    s_addk_i32 m0, 896
    v_max_f32 v237, v237, v238
    v_mov_b32 v238, v237
    v_mfma_f32_16x16x32_bf16 v[120:123], a[216:219], v[192:195], 0
    buffer_load_dwordx4 v248, s[8:11], s30 offen offset:128 sc1 nt lds
    s_addk_i32 m0, 7296
    s_addk_i32 s30, 8192
    v_mfma_f32_16x16x32_bf16 v[124:127], a[220:223], v[192:195], 0
    buffer_load_dwordx4 v248, s[8:11], s30 offen sc1 nt lds
    s_addk_i32 m0, 896
    v_permlane16_swap_b32 v237, v238
    v_mfma_f32_16x16x32_bf16 v[192:195], a[96:99], a[48:51], v[228:231]
    buffer_load_dwordx4 v248, s[8:11], s30 offen offset:128 sc1 nt lds
    s_addk_i32 m0, 23680
    s_addk_i32 s30, -8192
    v_min_f32 v236, -v237, -v238
    v_mul_f32 v251, s44, v236
    v_fma_f32 v208, v208, s44, v251
    v_mfma_f32_16x16x32_bf16 v[192:195], a[100:103], a[52:55], v[192:195]
    buffer_load_dwordx4 v248, s[12:15], s30 offen sc1 nt lds
    s_addk_i32 m0, 896
    v_mfma_f32_16x16x32_bf16 v[192:195], a[104:107], a[56:59], v[192:195]
    buffer_load_dwordx4 v248, s[12:15], s30 offen offset:128 sc1 nt lds
    v_exp_f32 v208, v208
    v_fma_f32 v209, v209, s44, v251
    v_mfma_f32_16x16x32_bf16 v[192:195], a[108:111], a[60:63], v[192:195]
    s_addk_i32 m0, 7296
    s_addk_i32 s30, 8192
    v_exp_f32 v209, v209
    v_mfma_f32_16x16x32_bf16 v[196:199], a[124:127], a[60:63], v[228:231]
    buffer_load_dwordx4 v248, s[12:15], s30 offen sc1 nt lds
    v_fma_f32 v210, v210, s44, v251
    v_mfma_f32_16x16x32_bf16 v[196:199], a[120:123], a[56:59], v[196:199]
    s_addk_i32 m0, 896
    ds_read_b128 a[128:131], v240 offset:16384
    v_fma_f32 v211, v211, s44, v251
    v_mfma_f32_16x16x32_bf16 v[196:199], a[116:119], a[52:55], v[196:199]
    buffer_load_dwordx4 v248, s[12:15], s30 offen offset:128 sc1 nt lds
    v_exp_f32 v210, v210
    v_cvt_pk_bf16_f32 v208, v208, v209
    v_mfma_f32_16x16x32_bf16 v[196:199], a[112:115], a[48:51], v[196:199]
    v_exp_f32 v211, v211
    v_mfma_f32_16x16x32_bf16 a[232:235], a[236:239], v[200:203], 0
    ds_read_b128 a[132:135], v241 offset:16384
    v_fma_f32 v212, v212, s44, v251
    v_mfma_f32_16x16x32_bf16 v[128:131], a[192:195], v[200:203], 0
    s_addk_i32 m0, -25472
    v_exp_f32 v212, v212
    v_mfma_f32_16x16x32_bf16 v[132:135], a[196:199], v[200:203], 0
    s_addk_i32 s30, 8192
    v_fma_f32 v213, v213, s44, v251
    v_cvt_pk_bf16_f32 v209, v210, v211
    v_mfma_f32_16x16x32_bf16 v[136:139], a[200:203], v[200:203], 0
    v_exp_f32 v213, v213
    v_mfma_f32_16x16x32_bf16 v[140:143], a[204:207], v[200:203], 0
    v_fma_f32 v214, v214, s44, v251
    v_fma_f32 v215, v215, s44, v251
    v_mfma_f32_16x16x32_bf16 v[144:147], a[208:211], v[200:203], 0
    v_exp_f32 v214, v214
    v_mfma_f32_16x16x32_bf16 v[148:151], a[212:215], v[200:203], 0
    ds_read_b128 a[136:139], v240 offset:17408
    v_cvt_pk_bf16_f32 v210, v212, v213
    v_mfma_f32_16x16x32_bf16 v[152:155], a[216:219], v[200:203], 0
    v_exp_f32 v215, v215
    v_mfma_f32_16x16x32_bf16 v[156:159], a[220:223], v[200:203], 0
    v_mov_b32 v237, v236
    v_mov_b32 v238, v236
    v_mfma_f32_16x16x32_bf16 v[200:203], a[96:99], a[64:67], v[232:235]
    v_mov_b32 v239, v236
    v_cvt_pk_bf16_f32 v211, v214, v215
    v_mfma_f32_16x16x32_bf16 v[200:203], a[100:103], a[68:71], v[200:203]
    v_exp_f32 v192, v192
    v_mfma_f32_16x16x32_bf16 v[200:203], a[104:107], a[72:75], v[200:203]
    v_exp_f32 v193, v193
    v_mfma_f32_16x16x32_bf16 v[200:203], a[108:111], a[76:79], v[200:203]
    ds_read_b128 a[140:143], v241 offset:17408
    v_cvt_pk_bf16_f32 v192, v192, v193
    v_mfma_f32_16x16x32_bf16 v[204:207], a[124:127], a[76:79], v[232:235]
    v_exp_f32 v194, v194
    v_mfma_f32_16x16x32_bf16 v[204:207], a[120:123], a[72:75], v[204:207]
    v_exp_f32 v195, v195
    v_mfma_f32_16x16x32_bf16 v[204:207], a[116:119], a[68:71], v[204:207]
    ds_read_b128 a[144:147], v240 offset:20480
    v_cvt_pk_bf16_f32 v193, v194, v195
    v_mfma_f32_16x16x32_bf16 v[204:207], a[112:115], a[64:67], v[204:207]
    v_exp_f32 v196, v196
    v_mfma_f32_16x16x32_bf16 a[232:235], a[240:243], v[208:211], a[232:235]
    v_exp_f32 v197, v197
    v_mfma_f32_16x16x32_bf16 v[160:163], a[192:195], v[208:211], 0
    ds_read_b64_tr_b16 a[192:193], v242 offset:16384
    v_cvt_pk_bf16_f32 v194, v196, v197
    v_mfma_f32_16x16x32_bf16 v[164:167], a[196:199], v[208:211], 0
    v_exp_f32 v198, v198
    v_mfma_f32_16x16x32_bf16 v[168:171], a[200:203], v[208:211], 0
    ds_read_b128 a[148:151], v241 offset:20480
    v_mul_f32 v200, s44, v200
    v_mfma_f32_16x16x32_bf16 v[172:175], a[204:207], v[208:211], 0
    ds_read_b64_tr_b16 a[194:195], v242 offset:20480
    v_mul_f32 v201, s44, v201
    v_mfma_f32_16x16x32_bf16 v[176:179], a[208:211], v[208:211], 0
    v_exp_f32 v199, v199
    v_mfma_f32_16x16x32_bf16 v[180:183], a[212:215], v[208:211], 0
    ds_read_b128 a[152:155], v240 offset:21504
    v_cvt_pk_bf16_f32 v195, v198, v199
    v_mfma_f32_16x16x32_bf16 v[184:187], a[216:219], v[208:211], 0
    v_exp_f32 v200, v200
    v_mfma_f32_16x16x32_bf16 v[188:191], a[220:223], v[208:211], 0
    ds_read_b64_tr_b16 a[196:197], v243 offset:16384
    v_mul_f32 v202, s44, v202
    v_mfma_f32_16x16x32_bf16 v[208:211], a[96:99], a[80:83], v[236:239]
    v_exp_f32 v201, v201
    v_mfma_f32_16x16x32_bf16 v[208:211], a[100:103], a[84:87], v[208:211]
    v_exp_f32 v202, v202
    v_mfma_f32_16x16x32_bf16 v[208:211], a[104:107], a[88:91], v[208:211]
    v_mul_f32 v203, s44, v203
    v_cvt_pk_bf16_f32 v200, v200, v201
    v_mfma_f32_16x16x32_bf16 v[208:211], a[108:111], a[92:95], v[208:211]
    ds_read_b64_tr_b16 a[198:199], v243 offset:20480
    v_mul_f32 v204, s44, v204
    v_mfma_f32_16x16x32_bf16 v[212:215], a[124:127], a[92:95], v[236:239]
    ds_read_b128 a[156:159], v241 offset:21504
    v_mul_f32 v205, s44, v205
    v_mfma_f32_16x16x32_bf16 v[212:215], a[120:123], a[88:91], v[212:215]
    v_exp_f32 v203, v203
    v_mfma_f32_16x16x32_bf16 v[212:215], a[116:119], a[84:87], v[212:215]
    v_exp_f32 v204, v204
    v_mfma_f32_16x16x32_bf16 v[212:215], a[112:115], a[80:83], v[212:215]
    ds_read_b64_tr_b16 a[200:201], v244 offset:16384
    v_cvt_pk_bf16_f32 v201, v202, v203
    v_mfma_f32_16x16x32_bf16 a[228:231], a[240:243], v[192:195], a[228:231]
    v_exp_f32 v205, v205
    v_mfma_f32_16x16x32_bf16 v[96:99], a[160:163], v[192:195], v[96:99]
    ds_read_b64_tr_b16 a[202:203], v244 offset:20480
    v_mul_f32 v206, s44, v206
    v_mfma_f32_16x16x32_bf16 v[100:103], a[164:167], v[192:195], v[100:103]
    v_exp_f32 v206, v206
    v_mfma_f32_16x16x32_bf16 v[104:107], a[168:171], v[192:195], v[104:107]
    v_mul_f32 v207, s44, v207
    v_cvt_pk_bf16_f32 v202, v204, v205
    v_mfma_f32_16x16x32_bf16 v[108:111], a[172:175], v[192:195], v[108:111]
    v_exp_f32 v207, v207
    v_mfma_f32_16x16x32_bf16 v[112:115], a[176:179], v[192:195], v[112:115]
    ds_read_b64_tr_b16 a[204:205], v245 offset:16384
    v_mul_f32 v208, s44, v208
    v_mfma_f32_16x16x32_bf16 v[116:119], a[180:183], v[192:195], v[116:119]
    v_cvt_pk_bf16_f32 v203, v206, v207
    v_mul_f32 v209, s44, v209
    v_mfma_f32_16x16x32_bf16 v[120:123], a[184:187], v[192:195], v[120:123]
    v_exp_f32 v208, v208
    v_mfma_f32_16x16x32_bf16 v[124:127], a[188:191], v[192:195], v[124:127]
    s_waitcnt lgkmcnt(2)
    v_exp_f32 v209, v209
    v_mfma_f32_16x16x32_bf16 v[192:195], a[128:131], a[48:51], v[228:231]
    s_barrier
    v_mul_f32 v210, s44, v210
    v_mfma_f32_16x16x32_bf16 v[192:195], a[132:135], a[52:55], v[192:195]
    buffer_load_dwordx4 v248, s[8:11], s30 offen sc1 nt lds
    v_mfma_f32_16x16x32_bf16 v[192:195], a[136:139], a[56:59], v[192:195]
    s_addk_i32 m0, 896
    ds_read_b64_tr_b16 a[206:207], v245 offset:20480
    v_mul_f32 v211, s44, v211
    v_mfma_f32_16x16x32_bf16 v[192:195], a[140:143], a[60:63], v[192:195]
    v_exp_f32 v210, v210
    v_mfma_f32_16x16x32_bf16 v[196:199], a[156:159], a[60:63], v[228:231]
    v_cvt_pk_bf16_f32 v204, v208, v209
    v_mul_f32 v212, s44, v212
    v_mfma_f32_16x16x32_bf16 v[196:199], a[152:155], a[56:59], v[196:199]
    v_exp_f32 v211, v211
    v_mfma_f32_16x16x32_bf16 v[196:199], a[148:151], a[52:55], v[196:199]
    ds_read_b64_tr_b16 a[208:209], v242 offset:17408
    v_mul_f32 v213, s44, v213
    v_mfma_f32_16x16x32_bf16 v[196:199], a[144:147], a[48:51], v[196:199]
    v_exp_f32 v212, v212
    v_mfma_f32_16x16x32_bf16 v[128:131], a[160:163], v[200:203], v[128:131]
    ds_read_b64_tr_b16 a[210:211], v242 offset:21504
    v_cvt_pk_bf16_f32 v205, v210, v211
    v_mfma_f32_16x16x32_bf16 v[132:135], a[164:167], v[200:203], v[132:135]
    v_exp_f32 v213, v213
    v_mfma_f32_16x16x32_bf16 v[136:139], a[168:171], v[200:203], v[136:139]
    v_mul_f32 v214, s44, v214
    v_mul_f32 v215, s44, v215
    v_mfma_f32_16x16x32_bf16 v[140:143], a[172:175], v[200:203], v[140:143]
    v_exp_f32 v214, v214
    v_mfma_f32_16x16x32_bf16 v[144:147], a[176:179], v[200:203], v[144:147]
    ds_read_b64_tr_b16 a[212:213], v243 offset:17408
    v_cvt_pk_bf16_f32 v206, v212, v213
    v_mfma_f32_16x16x32_bf16 v[148:151], a[180:183], v[200:203], v[148:151]
    v_exp_f32 v215, v215
    v_mfma_f32_16x16x32_bf16 v[152:155], a[184:187], v[200:203], v[152:155]
    buffer_load_dwordx4 v248, s[8:11], s30 offen offset:128 sc1 nt lds
    v_mfma_f32_16x16x32_bf16 v[156:159], a[188:191], v[200:203], v[156:159]
    s_addk_i32 m0, 7296
    ds_read_b64_tr_b16 a[214:215], v243 offset:21504
    v_cvt_pk_bf16_f32 v207, v214, v215
    v_mfma_f32_16x16x32_bf16 v[208:211], a[128:131], a[64:67], v[232:235]
    s_addk_i32 s30, 8192
    v_exp_f32 v192, v192
    v_mfma_f32_16x16x32_bf16 v[208:211], a[132:135], a[68:71], v[208:211]
    v_exp_f32 v193, v193
    v_mfma_f32_16x16x32_bf16 v[208:211], a[136:139], a[72:75], v[208:211]
    v_exp_f32 v194, v194
    v_mfma_f32_16x16x32_bf16 v[208:211], a[140:143], a[76:79], v[208:211]
    ds_read_b64_tr_b16 a[216:217], v244 offset:17408
    v_cvt_pk_bf16_f32 v192, v192, v193
    v_mfma_f32_16x16x32_bf16 v[212:215], a[156:159], a[76:79], v[232:235]
    v_exp_f32 v195, v195
    v_mfma_f32_16x16x32_bf16 v[212:215], a[152:155], a[72:75], v[212:215]
    v_exp_f32 v196, v196
    v_mfma_f32_16x16x32_bf16 v[212:215], a[148:151], a[68:71], v[212:215]
    ds_read_b64_tr_b16 a[218:219], v244 offset:21504
    v_cvt_pk_bf16_f32 v193, v194, v195
    v_mfma_f32_16x16x32_bf16 v[212:215], a[144:147], a[64:67], v[212:215]
    v_exp_f32 v197, v197
    v_smfmac_f32_16x16x64_bf16 a[232:235], a[244:247], v[200:207], v253
    v_cvt_pk_bf16_f32 v194, v196, v197
    v_mfma_f32_16x16x32_bf16 v[160:163], a[160:163], v[204:207], v[160:163]
    v_exp_f32 v198, v198
    v_mfma_f32_16x16x32_bf16 v[164:167], a[164:167], v[204:207], v[164:167]
    v_exp_f32 v199, v199
    v_mfma_f32_16x16x32_bf16 v[168:171], a[168:171], v[204:207], v[168:171]
    ds_read_b64_tr_b16 a[220:221], v245 offset:17408
    v_mul_f32 v208, s44, v208
    v_mfma_f32_16x16x32_bf16 v[172:175], a[172:175], v[204:207], v[172:175]
    ds_read_b64_tr_b16 a[222:223], v245 offset:21504
    v_cvt_pk_bf16_f32 v195, v198, v199
    v_mfma_f32_16x16x32_bf16 v[176:179], a[176:179], v[204:207], v[176:179]
    v_exp_f32 v208, v208
    v_mfma_f32_16x16x32_bf16 v[180:183], a[180:183], v[204:207], v[180:183]
    s_waitcnt vmcnt(12)
    v_mul_f32 v209, s44, v209
    v_mul_f32 v210, s44, v210
    v_mfma_f32_16x16x32_bf16 v[184:187], a[184:187], v[204:207], v[184:187]
    s_barrier
    v_mul_f32 v211, s44, v211
    v_mfma_f32_16x16x32_bf16 v[188:191], a[188:191], v[204:207], v[188:191]
    ds_read_b128 a[96:99], v240 offset:24576
    v_mul_f32 v212, s44, v212
    v_mfma_f32_16x16x32_bf16 v[200:203], a[128:131], a[80:83], v[236:239]
    ds_read_b128 a[100:103], v241 offset:24576
    v_mul_f32 v213, s44, v213
    v_mfma_f32_16x16x32_bf16 v[200:203], a[132:135], a[84:87], v[200:203]
    v_exp_f32 v209, v209
    v_mfma_f32_16x16x32_bf16 v[200:203], a[136:139], a[88:91], v[200:203]
    ds_read_b128 a[104:107], v240 offset:25600
    v_cvt_pk_bf16_f32 v208, v208, v209
    v_mfma_f32_16x16x32_bf16 v[200:203], a[140:143], a[92:95], v[200:203]
    ds_read_b128 a[108:111], v241 offset:25600
    v_mul_f32 v214, s44, v214
    v_mfma_f32_16x16x32_bf16 v[204:207], a[156:159], a[92:95], v[236:239]
    v_exp_f32 v210, v210
    v_mfma_f32_16x16x32_bf16 v[204:207], a[152:155], a[88:91], v[204:207]
    ds_read_b128 a[112:115], v240 offset:28672
    v_mul_f32 v215, s44, v215
    v_mfma_f32_16x16x32_bf16 v[204:207], a[148:151], a[84:87], v[204:207]
    v_exp_f32 v211, v211
    v_mfma_f32_16x16x32_bf16 v[204:207], a[144:147], a[80:83], v[204:207]
    ds_read_b128 a[116:119], v241 offset:28672
    v_cvt_pk_bf16_f32 v209, v210, v211
    v_mfma_f32_16x16x32_bf16 a[228:231], a[240:243], v[192:195], a[228:231]
    v_exp_f32 v212, v212
    v_mfma_f32_16x16x32_bf16 v[96:99], a[192:195], v[192:195], v[96:99]
    v_exp_f32 v213, v213
    v_mfma_f32_16x16x32_bf16 v[100:103], a[196:199], v[192:195], v[100:103]
    s_waitcnt lgkmcnt(3)
    ds_read_b128 a[120:123], v240 offset:29696
    v_cvt_pk_bf16_f32 v210, v212, v213
    v_mfma_f32_16x16x32_bf16 v[104:107], a[200:203], v[192:195], v[104:107]
    ds_read_b128 a[124:127], v241 offset:29696
    v_mul_f32 v200, s44, v200
    v_mfma_f32_16x16x32_bf16 v[108:111], a[204:207], v[192:195], v[108:111]
    v_exp_f32 v214, v214
    v_mfma_f32_16x16x32_bf16 v[112:115], a[208:211], v[192:195], v[112:115]
    v_exp_f32 v215, v215
    v_mfma_f32_16x16x32_bf16 v[116:119], a[212:215], v[192:195], v[116:119]
    v_cvt_pk_bf16_f32 v211, v214, v215
    v_mul_f32 v201, s44, v201
    v_mfma_f32_16x16x32_bf16 v[120:123], a[216:219], v[192:195], v[120:123]
    v_exp_f32 v200, v200
    v_mfma_f32_16x16x32_bf16 v[124:127], a[220:223], v[192:195], v[124:127]
    v_exp_f32 v201, v201
    v_mfma_f32_16x16x32_bf16 v[192:195], a[96:99], a[0:3], v[216:219]
    s_waitcnt vmcnt(4) lgkmcnt(0)
    v_mul_f32 v202, s44, v202
    v_mul_f32 v203, s44, v203
    v_mfma_f32_16x16x32_bf16 v[192:195], a[100:103], a[4:7], v[192:195]
L_pad1:
    s_cbranch_execz L_pad5
    s_barrier
    v_cvt_pk_bf16_f32 v212, v200, v201
    v_mfma_f32_16x16x32_bf16 v[192:195], a[104:107], a[8:11], v[192:195]
    ds_read_b128 a[128:131], v240 offset:0
    v_mul_f32 v204, s44, v204
    v_mfma_f32_16x16x32_bf16 v[192:195], a[108:111], a[12:15], v[192:195]
    buffer_load_dwordx4 v248, s[8:11], s30 offen sc1 nt lds
    v_mfma_f32_16x16x32_bf16 v[196:199], a[124:127], a[12:15], v[216:219]
    s_addk_i32 m0, 896
    v_exp_f32 v202, v202
    v_mfma_f32_16x16x32_bf16 v[196:199], a[120:123], a[8:11], v[196:199]
    ds_read_b128 a[132:135], v241 offset:0
    v_mul_f32 v205, s44, v205
    v_mfma_f32_16x16x32_bf16 v[196:199], a[116:119], a[4:7], v[196:199]
    buffer_load_dwordx4 v248, s[8:11], s30 offen offset:128 sc1 nt lds
    v_mfma_f32_16x16x32_bf16 v[196:199], a[112:115], a[0:3], v[196:199]
    s_mov_b32 m0, s28
    v_exp_f32 v203, v203
    v_mfma_f32_16x16x32_bf16 v[128:131], a[192:195], v[208:211], v[128:131]
    s_mov_b32 s30, s22
    v_exp_f32 v204, v204
    v_mfma_f32_16x16x32_bf16 v[132:135], a[196:199], v[208:211], v[132:135]
    ds_read_b128 a[136:139], v240 offset:1024
    v_cvt_pk_bf16_f32 v213, v202, v203
    v_mfma_f32_16x16x32_bf16 v[136:139], a[200:203], v[208:211], v[136:139]
    buffer_load_dwordx4 v248, s[4:7], s30 offen sc1 nt lds
    v_mfma_f32_16x16x32_bf16 v[140:143], a[204:207], v[208:211], v[140:143]
    s_barrier
    v_mul_f32 v206, s44, v206
    v_mfma_f32_16x16x32_bf16 v[144:147], a[208:211], v[208:211], v[144:147]
    s_addk_i32 m0, 896
    v_exp_f32 v205, v205
    v_mfma_f32_16x16x32_bf16 v[148:151], a[212:215], v[208:211], v[148:151]
    ds_read_b128 a[140:143], v241 offset:1024
    v_mul_f32 v207, s44, v207
    v_mfma_f32_16x16x32_bf16 v[152:155], a[216:219], v[208:211], v[152:155]
    v_exp_f32 v206, v206
    v_cvt_pk_bf16_f32 v214, v204, v205
    v_mfma_f32_16x16x32_bf16 v[156:159], a[220:223], v[208:211], v[156:159]
    v_exp_f32 v207, v207
    v_mfma_f32_16x16x32_bf16 v[200:203], a[96:99], a[16:19], v[220:223]
    ds_read_b64_tr_b16 a[160:161], v242 offset:24576
    v_cvt_pk_bf16_f32 v215, v206, v207
    v_mfma_f32_16x16x32_bf16 v[200:203], a[100:103], a[20:23], v[200:203]
    ds_read_b64_tr_b16 a[162:163], v242 offset:28672
    ds_read_b128 a[144:147], v240 offset:4096
    v_exp_f32 v192, v192
    v_mfma_f32_16x16x32_bf16 v[200:203], a[104:107], a[24:27], v[200:203]
    ds_read_b64_tr_b16 a[164:165], v243 offset:24576
    v_exp_f32 v193, v193
    v_mfma_f32_16x16x32_bf16 v[200:203], a[108:111], a[28:31], v[200:203]
    ds_read_b64_tr_b16 a[166:167], v243 offset:28672
    v_cvt_pk_bf16_f32 v192, v192, v193
    v_mfma_f32_16x16x32_bf16 v[204:207], a[124:127], a[28:31], v[220:223]
    ds_read_b128 a[148:151], v241 offset:4096
    v_exp_f32 v194, v194
    v_mfma_f32_16x16x32_bf16 v[204:207], a[120:123], a[24:27], v[204:207]
    buffer_load_dwordx4 v248, s[4:7], s30 offen offset:128 sc1 nt lds
    ds_read_b64_tr_b16 a[168:169], v244 offset:24576
    v_mfma_f32_16x16x32_bf16 v[204:207], a[116:119], a[20:23], v[204:207]
    s_add_u32 m0, s27, 49152
    ds_read_b64_tr_b16 a[170:171], v244 offset:28672
    v_exp_f32 v195, v195
    v_mfma_f32_16x16x32_bf16 v[204:207], a[112:115], a[16:19], v[204:207]
    s_add_u32 s30, s24, 49152
    ds_read_b128 a[152:155], v240 offset:5120
    v_cvt_pk_bf16_f32 v193, v194, v195
    v_smfmac_f32_16x16x64_bf16 a[232:235], a[244:247], v[208:215], v253
    ds_read_b64_tr_b16 a[172:173], v245 offset:24576
    v_mfma_f32_16x16x32_bf16 v[160:163], a[192:195], v[212:215], v[160:163]
    ds_read_b64_tr_b16 a[174:175], v245 offset:28672
    v_exp_f32 v196, v196
    v_mfma_f32_16x16x32_bf16 v[164:167], a[196:199], v[212:215], v[164:167]
    ds_read_b128 a[156:159], v241 offset:5120
    v_exp_f32 v197, v197
    v_mfma_f32_16x16x32_bf16 v[168:171], a[200:203], v[212:215], v[168:171]
    ds_read_b64_tr_b16 a[176:177], v242 offset:25600
    v_cvt_pk_bf16_f32 v194, v196, v197
    v_mfma_f32_16x16x32_bf16 v[172:175], a[204:207], v[212:215], v[172:175]
    ds_read_b64_tr_b16 a[178:179], v242 offset:29696
    v_exp_f32 v198, v198
    v_mfma_f32_16x16x32_bf16 v[176:179], a[208:211], v[212:215], v[176:179]
    ds_read_b64_tr_b16 a[180:181], v243 offset:25600
    ds_read_b64_tr_b16 a[192:193], v242 offset:0
    v_exp_f32 v199, v199
    v_mfma_f32_16x16x32_bf16 v[180:183], a[212:215], v[212:215], v[180:183]
    ds_read_b64_tr_b16 a[182:183], v243 offset:29696
    v_cvt_pk_bf16_f32 v195, v198, v199
    v_mfma_f32_16x16x32_bf16 v[184:187], a[216:219], v[212:215], v[184:187]
    v_exp_f32 v200, v200
    v_mfma_f32_16x16x32_bf16 v[188:191], a[220:223], v[212:215], v[188:191]
    ds_read_b64_tr_b16 a[184:185], v244 offset:25600
    v_exp_f32 v201, v201
    v_mfma_f32_16x16x32_bf16 v[208:211], a[96:99], a[32:35], v[224:227]
    ds_read_b64_tr_b16 a[186:187], v244 offset:29696
    ds_read_b64_tr_b16 a[194:195], v242 offset:4096
    v_mfma_f32_16x16x32_bf16 v[208:211], a[100:103], a[36:39], v[208:211]
    ds_read_b64_tr_b16 a[188:189], v245 offset:25600
    v_cvt_pk_bf16_f32 v196, v200, v201
    v_mfma_f32_16x16x32_bf16 v[208:211], a[104:107], a[40:43], v[208:211]
    v_exp_f32 v202, v202
    v_mfma_f32_16x16x32_bf16 v[208:211], a[108:111], a[44:47], v[208:211]
    ds_read_b64_tr_b16 a[190:191], v245 offset:29696
    v_exp_f32 v203, v203
    v_mfma_f32_16x16x32_bf16 v[212:215], a[124:127], a[44:47], v[224:227]
    ds_read_b64_tr_b16 a[196:197], v243 offset:0
    v_cvt_pk_bf16_f32 v197, v202, v203
    v_mfma_f32_16x16x32_bf16 v[212:215], a[120:123], a[40:43], v[212:215]
    v_exp_f32 v204, v204
    v_mfma_f32_16x16x32_bf16 v[212:215], a[116:119], a[36:39], v[212:215]
    v_exp_f32 v205, v205
    v_mfma_f32_16x16x32_bf16 v[212:215], a[112:115], a[32:35], v[212:215]
    s_waitcnt lgkmcnt(5)
    ds_read_b64_tr_b16 a[198:199], v243 offset:4096
    v_cvt_pk_bf16_f32 v198, v204, v205
    v_mfma_f32_16x16x32_bf16 v[0:3], a[160:163], v[192:195], v[0:3]
    v_exp_f32 v206, v206
    v_mfma_f32_16x16x32_bf16 v[4:7], a[164:167], v[192:195], v[4:7]
    v_exp_f32 v207, v207
    v_mfma_f32_16x16x32_bf16 v[8:11], a[168:171], v[192:195], v[8:11]
    ds_read_b64_tr_b16 a[200:201], v244 offset:0
    v_cvt_pk_bf16_f32 v199, v206, v207
    v_mfma_f32_16x16x32_bf16 v[12:15], a[172:175], v[192:195], v[12:15]
    ds_read_b64_tr_b16 a[202:203], v244 offset:4096
    v_mul_f32 v208, s44, v208
    v_mfma_f32_16x16x32_bf16 v[16:19], a[176:179], v[192:195], v[16:19]
    v_exp_f32 v208, v208
    v_mfma_f32_16x16x32_bf16 v[20:23], a[180:183], v[192:195], v[20:23]
    s_waitcnt lgkmcnt(3)
    v_mul_f32 v209, s44, v209
    v_mul_f32 v210, s44, v210
    v_mfma_f32_16x16x32_bf16 v[24:27], a[184:187], v[192:195], v[24:27]
    buffer_load_dwordx4 v248, s[12:15], s30 offen sc1 nt lds
    v_mfma_f32_16x16x32_bf16 v[28:31], a[188:191], v[192:195], v[28:31]
    s_addk_i32 m0, 896
    v_exp_f32 v209, v209
    v_mfma_f32_16x16x32_bf16 v[200:203], a[96:99], a[48:51], v[228:231]
    ds_read_b64_tr_b16 a[204:205], v245 offset:0
    v_mul_f32 v211, s44, v211
    v_mfma_f32_16x16x32_bf16 v[200:203], a[100:103], a[52:55], v[200:203]
    v_exp_f32 v210, v210
    v_mfma_f32_16x16x32_bf16 v[200:203], a[104:107], a[56:59], v[200:203]
    v_cvt_pk_bf16_f32 v208, v208, v209
    v_mul_f32 v212, s44, v212
    v_mfma_f32_16x16x32_bf16 v[200:203], a[108:111], a[60:63], v[200:203]
    v_exp_f32 v211, v211
    v_mfma_f32_16x16x32_bf16 v[204:207], a[124:127], a[60:63], v[228:231]
    ds_read_b64_tr_b16 a[206:207], v245 offset:4096
    v_mul_f32 v213, s44, v213
    v_mfma_f32_16x16x32_bf16 v[204:207], a[120:123], a[56:59], v[204:207]
    v_exp_f32 v212, v212
    v_mfma_f32_16x16x32_bf16 v[204:207], a[116:119], a[52:55], v[204:207]
    v_cvt_pk_bf16_f32 v209, v210, v211
    v_mul_f32 v214, s44, v214
    v_mfma_f32_16x16x32_bf16 v[204:207], a[112:115], a[48:51], v[204:207]
    v_exp_f32 v213, v213
    v_smfmac_f32_16x16x64_bf16 a[224:227], a[244:247], v[192:199], v253
    v_mul_f32 v215, s44, v215
    v_mfma_f32_16x16x32_bf16 v[32:35], a[160:163], v[196:199], v[32:35]
    v_exp_f32 v214, v214
    v_mfma_f32_16x16x32_bf16 v[36:39], a[164:167], v[196:199], v[36:39]
    ds_read_b64_tr_b16 a[208:209], v242 offset:1024
    v_cvt_pk_bf16_f32 v210, v212, v213
    v_mfma_f32_16x16x32_bf16 v[40:43], a[168:171], v[196:199], v[40:43]
    buffer_load_dwordx4 v248, s[12:15], s30 offen offset:128 sc1 nt lds
    v_mfma_f32_16x16x32_bf16 v[44:47], a[172:175], v[196:199], v[44:47]
    s_add_u32 m0, s28, 2048
    v_exp_f32 v215, v215
    v_mfma_f32_16x16x32_bf16 v[48:51], a[176:179], v[196:199], v[48:51]
    s_add_u32 s30, s22, 2048
    ds_read_b64_tr_b16 a[210:211], v242 offset:5120
    v_cvt_pk_bf16_f32 v211, v214, v215
    v_mfma_f32_16x16x32_bf16 v[52:55], a[180:183], v[196:199], v[52:55]
    v_exp_f32 v200, v200
    v_mfma_f32_16x16x32_bf16 v[56:59], a[184:187], v[196:199], v[56:59]
    v_exp_f32 v201, v201
    v_mfma_f32_16x16x32_bf16 v[60:63], a[188:191], v[196:199], v[60:63]
    ds_read_b64_tr_b16 a[212:213], v243 offset:1024
    v_cvt_pk_bf16_f32 v212, v200, v201
    v_mfma_f32_16x16x32_bf16 v[192:195], a[96:99], a[64:67], v[232:235]
    v_exp_f32 v202, v202
    v_mfma_f32_16x16x32_bf16 v[192:195], a[100:103], a[68:71], v[192:195]
    v_exp_f32 v203, v203
    v_mfma_f32_16x16x32_bf16 v[192:195], a[104:107], a[72:75], v[192:195]
    v_exp_f32 v204, v204
    v_mfma_f32_16x16x32_bf16 v[192:195], a[108:111], a[76:79], v[192:195]
    v_exp_f32 v205, v205
    v_mfma_f32_16x16x32_bf16 v[196:199], a[124:127], a[76:79], v[232:235]
    ds_read_b64_tr_b16 a[214:215], v243 offset:5120
    v_cvt_pk_bf16_f32 v213, v202, v203
    v_mfma_f32_16x16x32_bf16 v[196:199], a[120:123], a[72:75], v[196:199]
    v_exp_f32 v206, v206
    v_mfma_f32_16x16x32_bf16 v[196:199], a[116:119], a[68:71], v[196:199]
    v_exp_f32 v207, v207
    v_mfma_f32_16x16x32_bf16 v[196:199], a[112:115], a[64:67], v[196:199]
    v_cvt_pk_bf16_f32 v214, v204, v205
    v_cvt_pk_bf16_f32 v215, v206, v207
    v_mfma_f32_16x16x32_bf16 v[64:67], a[160:163], v[208:211], v[64:67]
    ds_read_b64_tr_b16 a[216:217], v244 offset:1024
    v_mfma_f32_16x16x32_bf16 v[68:71], a[164:167], v[208:211], v[68:71]
    v_mfma_f32_16x16x32_bf16 v[72:75], a[168:171], v[208:211], v[72:75]
    v_mfma_f32_16x16x32_bf16 v[76:79], a[172:175], v[208:211], v[76:79]
    v_mul_f32 v192, s44, v192
    v_mul_f32 v193, s44, v193
    v_mfma_f32_16x16x32_bf16 v[80:83], a[176:179], v[208:211], v[80:83]
    v_exp_f32 v192, v192
    v_mfma_f32_16x16x32_bf16 v[84:87], a[180:183], v[208:211], v[84:87]
    ds_read_b64_tr_b16 a[218:219], v244 offset:5120
    v_mul_f32 v194, s44, v194
    v_mfma_f32_16x16x32_bf16 v[88:91], a[184:187], v[208:211], v[88:91]
    v_exp_f32 v193, v193
    v_mfma_f32_16x16x32_bf16 v[92:95], a[188:191], v[208:211], v[92:95]
    v_exp_f32 v194, v194
    v_mfma_f32_16x16x32_bf16 v[200:203], a[96:99], a[80:83], v[236:239]
    v_mul_f32 v195, s44, v195
    v_cvt_pk_bf16_f32 v192, v192, v193
    v_mfma_f32_16x16x32_bf16 v[200:203], a[100:103], a[84:87], v[200:203]
    ds_read_b64_tr_b16 a[220:221], v245 offset:1024
    v_mul_f32 v196, s44, v196
    v_mfma_f32_16x16x32_bf16 v[200:203], a[104:107], a[88:91], v[200:203]
    v_exp_f32 v195, v195
    v_mfma_f32_16x16x32_bf16 v[200:203], a[108:111], a[92:95], v[200:203]
    v_exp_f32 v196, v196
    v_mfma_f32_16x16x32_bf16 v[204:207], a[124:127], a[92:95], v[236:239]
    v_mul_f32 v197, s44, v197
    v_cvt_pk_bf16_f32 v193, v194, v195
    v_mfma_f32_16x16x32_bf16 v[204:207], a[120:123], a[88:91], v[204:207]
    ds_read_b64_tr_b16 a[222:223], v245 offset:5120
    v_mul_f32 v198, s44, v198
    v_mfma_f32_16x16x32_bf16 v[204:207], a[116:119], a[84:87], v[204:207]
    v_exp_f32 v197, v197
    v_mfma_f32_16x16x32_bf16 v[204:207], a[112:115], a[80:83], v[204:207]
    v_exp_f32 v198, v198
    v_smfmac_f32_16x16x64_bf16 a[228:231], a[244:247], v[208:215], v253
    v_mul_f32 v199, s44, v199
    v_mfma_f32_16x16x32_bf16 v[96:99], a[160:163], v[212:215], v[96:99]
    v_exp_f32 v199, v199
    v_mfma_f32_16x16x32_bf16 v[100:103], a[164:167], v[212:215], v[100:103]
    v_cvt_pk_bf16_f32 v194, v196, v197
    v_cvt_pk_bf16_f32 v195, v198, v199
    v_mfma_f32_16x16x32_bf16 v[104:107], a[168:171], v[212:215], v[104:107]
    v_mul_f32 v200, s44, v200
    v_mul_f32 v201, s44, v201
    v_mfma_f32_16x16x32_bf16 v[108:111], a[172:175], v[212:215], v[108:111]
    buffer_load_dwordx4 v248, s[4:7], s30 offen sc1 nt lds
    v_mfma_f32_16x16x32_bf16 v[112:115], a[176:179], v[212:215], v[112:115]
    s_addk_i32 m0, 896
    v_exp_f32 v200, v200
    v_mfma_f32_16x16x32_bf16 v[116:119], a[180:183], v[212:215], v[116:119]
    v_exp_f32 v201, v201
    v_mfma_f32_16x16x32_bf16 v[120:123], a[184:187], v[212:215], v[120:123]
    v_mul_f32 v202, s44, v202
    v_mul_f32 v203, s44, v203
    v_mfma_f32_16x16x32_bf16 v[124:127], a[188:191], v[212:215], v[124:127]
    v_exp_f32 v202, v202
    v_mfma_f32_16x16x32_bf16 v[208:211], a[128:131], a[0:3], v[216:219]
    s_waitcnt vmcnt(9) lgkmcnt(0)
    v_cvt_pk_bf16_f32 v196, v200, v201
    v_mul_f32 v204, s44, v204
    v_mfma_f32_16x16x32_bf16 v[208:211], a[132:135], a[4:7], v[208:211]
    s_barrier
    v_mul_f32 v205, s44, v205
    v_mfma_f32_16x16x32_bf16 v[208:211], a[136:139], a[8:11], v[208:211]
    buffer_load_dwordx4 v248, s[4:7], s30 offen offset:128 sc1 nt lds
    v_mfma_f32_16x16x32_bf16 v[208:211], a[140:143], a[12:15], v[208:211]
    s_mov_b32 m0, s27
    ds_read_b128 a[96:99], v240 offset:8192
    v_mul_f32 v206, s44, v206
    v_mfma_f32_16x16x32_bf16 v[212:215], a[156:159], a[12:15], v[216:219]
    s_add_u32 s30, s24, 65536
    ds_read_b128 a[100:103], v241 offset:8192
    v_mul_f32 v207, s44, v207
    v_mfma_f32_16x16x32_bf16 v[212:215], a[152:155], a[8:11], v[212:215]
    buffer_load_dwordx4 v248, s[8:11], s30 offen sc1 nt lds
    v_mfma_f32_16x16x32_bf16 v[212:215], a[148:151], a[4:7], v[212:215]
    s_addk_i32 m0, 896
    v_exp_f32 v203, v203
    v_mfma_f32_16x16x32_bf16 v[212:215], a[144:147], a[0:3], v[212:215]
    v_exp_f32 v204, v204
    v_mfma_f32_16x16x32_bf16 v[128:131], a[160:163], v[192:195], v[128:131]
    ds_read_b128 a[104:107], v240 offset:9216
    v_cvt_pk_bf16_f32 v197, v202, v203
    v_mfma_f32_16x16x32_bf16 v[132:135], a[164:167], v[192:195], v[132:135]
    v_exp_f32 v205, v205
    v_mfma_f32_16x16x32_bf16 v[136:139], a[168:171], v[192:195], v[136:139]
    ds_read_b128 a[108:111], v241 offset:9216
    v_cvt_pk_bf16_f32 v198, v204, v205
    v_mfma_f32_16x16x32_bf16 v[140:143], a[172:175], v[192:195], v[140:143]
    v_exp_f32 v206, v206
    v_mfma_f32_16x16x32_bf16 v[144:147], a[176:179], v[192:195], v[144:147]
    v_exp_f32 v207, v207
    v_mfma_f32_16x16x32_bf16 v[148:151], a[180:183], v[192:195], v[148:151]
    ds_read_b128 a[112:115], v240 offset:12288
    v_cvt_pk_bf16_f32 v199, v206, v207
    v_mfma_f32_16x16x32_bf16 v[152:155], a[184:187], v[192:195], v[152:155]
    buffer_load_dwordx4 v248, s[8:11], s30 offen offset:128 sc1 nt lds
    v_mfma_f32_16x16x32_bf16 v[156:159], a[188:191], v[192:195], v[156:159]
    s_add_u32 m0, s27, 57344
    v_exp_f32 v208, v208
    v_mfma_f32_16x16x32_bf16 v[200:203], a[128:131], a[16:19], v[220:223]
    s_addk_i32 s30, -8192
    v_exp_f32 v209, v209
    v_mfma_f32_16x16x32_bf16 v[200:203], a[132:135], a[20:23], v[200:203]
    ds_read_b128 a[116:119], v241 offset:12288
    v_cvt_pk_bf16_f32 v208, v208, v209
    v_mfma_f32_16x16x32_bf16 v[200:203], a[136:139], a[24:27], v[200:203]
    v_exp_f32 v210, v210
    v_mfma_f32_16x16x32_bf16 v[200:203], a[140:143], a[28:31], v[200:203]
    v_exp_f32 v211, v211
    v_mfma_f32_16x16x32_bf16 v[204:207], a[156:159], a[28:31], v[220:223]
    ds_read_b128 a[120:123], v240 offset:13312
    v_cvt_pk_bf16_f32 v209, v210, v211
    v_mfma_f32_16x16x32_bf16 v[204:207], a[152:155], a[24:27], v[204:207]
    v_exp_f32 v212, v212
    v_mfma_f32_16x16x32_bf16 v[204:207], a[148:151], a[20:23], v[204:207]
    v_exp_f32 v213, v213
    v_mfma_f32_16x16x32_bf16 v[204:207], a[144:147], a[16:19], v[204:207]
    ds_read_b128 a[124:127], v241 offset:13312
    v_cvt_pk_bf16_f32 v210, v212, v213
    v_smfmac_f32_16x16x64_bf16 a[232:235], a[244:247], v[192:199], v253
    v_mfma_f32_16x16x32_bf16 v[160:163], a[160:163], v[196:199], v[160:163]
    v_exp_f32 v214, v214
    v_mfma_f32_16x16x32_bf16 v[164:167], a[164:167], v[196:199], v[164:167]
    v_exp_f32 v215, v215
    v_mfma_f32_16x16x32_bf16 v[168:171], a[168:171], v[196:199], v[168:171]
    ds_read_b64_tr_b16 a[160:161], v242 offset:8192
    v_cvt_pk_bf16_f32 v211, v214, v215
    v_mfma_f32_16x16x32_bf16 v[172:175], a[172:175], v[196:199], v[172:175]
    v_exp_f32 v200, v200
    v_mfma_f32_16x16x32_bf16 v[176:179], a[176:179], v[196:199], v[176:179]
    v_exp_f32 v201, v201
    v_mfma_f32_16x16x32_bf16 v[180:183], a[180:183], v[196:199], v[180:183]
    ds_read_b64_tr_b16 a[162:163], v242 offset:12288
    v_cvt_pk_bf16_f32 v212, v200, v201
    v_mfma_f32_16x16x32_bf16 v[184:187], a[184:187], v[196:199], v[184:187]
    v_exp_f32 v202, v202
    v_mfma_f32_16x16x32_bf16 v[188:191], a[188:191], v[196:199], v[188:191]
    v_exp_f32 v203, v203
    v_mfma_f32_16x16x32_bf16 v[192:195], a[128:131], a[32:35], v[224:227]
    ds_read_b64_tr_b16 a[164:165], v243 offset:8192
    v_cvt_pk_bf16_f32 v213, v202, v203
    v_mfma_f32_16x16x32_bf16 v[192:195], a[132:135], a[36:39], v[192:195]
    v_exp_f32 v204, v204
    v_mfma_f32_16x16x32_bf16 v[192:195], a[136:139], a[40:43], v[192:195]
    v_exp_f32 v205, v205
    v_mfma_f32_16x16x32_bf16 v[192:195], a[140:143], a[44:47], v[192:195]
    ds_read_b64_tr_b16 a[166:167], v243 offset:12288
    v_cvt_pk_bf16_f32 v214, v204, v205
    v_mfma_f32_16x16x32_bf16 v[196:199], a[156:159], a[44:47], v[224:227]
    v_exp_f32 v206, v206
    v_mfma_f32_16x16x32_bf16 v[196:199], a[152:155], a[40:43], v[196:199]
    v_exp_f32 v207, v207
    v_mfma_f32_16x16x32_bf16 v[196:199], a[148:151], a[36:39], v[196:199]
    ds_read_b64_tr_b16 a[168:169], v244 offset:8192
    v_cvt_pk_bf16_f32 v215, v206, v207
    v_mfma_f32_16x16x32_bf16 v[196:199], a[144:147], a[32:35], v[196:199]
    v_mfma_f32_16x16x32_bf16 v[0:3], a[192:195], v[208:211], v[0:3]
    buffer_load_dwordx4 v248, s[12:15], s30 offen sc1 nt lds
    v_mfma_f32_16x16x32_bf16 v[4:7], a[196:199], v[208:211], v[4:7]
    s_addk_i32 m0, 896
    v_mfma_f32_16x16x32_bf16 v[8:11], a[200:203], v[208:211], v[8:11]
    ds_read_b64_tr_b16 a[170:171], v244 offset:12288
    v_mfma_f32_16x16x32_bf16 v[12:15], a[204:207], v[208:211], v[12:15]
    v_mul_f32 v192, s44, v192
    v_mul_f32 v193, s44, v193
    v_mfma_f32_16x16x32_bf16 v[16:19], a[208:211], v[208:211], v[16:19]
    v_exp_f32 v192, v192
    v_mfma_f32_16x16x32_bf16 v[20:23], a[212:215], v[208:211], v[20:23]
    v_exp_f32 v193, v193
    v_mfma_f32_16x16x32_bf16 v[24:27], a[216:219], v[208:211], v[24:27]
    v_mul_f32 v194, s44, v194
    v_mul_f32 v195, s44, v195
    v_mfma_f32_16x16x32_bf16 v[28:31], a[220:223], v[208:211], v[28:31]
    ds_read_b64_tr_b16 a[172:173], v245 offset:8192
    v_cvt_pk_bf16_f32 v192, v192, v193
    v_mfma_f32_16x16x32_bf16 v[200:203], a[128:131], a[48:51], v[228:231]
    v_exp_f32 v194, v194
    v_mfma_f32_16x16x32_bf16 v[200:203], a[132:135], a[52:55], v[200:203]
    v_exp_f32 v195, v195
    v_mfma_f32_16x16x32_bf16 v[200:203], a[136:139], a[56:59], v[200:203]
    v_mul_f32 v196, s44, v196
    v_mul_f32 v197, s44, v197
    v_mfma_f32_16x16x32_bf16 v[200:203], a[140:143], a[60:63], v[200:203]
    ds_read_b64_tr_b16 a[174:175], v245 offset:12288
    v_cvt_pk_bf16_f32 v193, v194, v195
    v_mfma_f32_16x16x32_bf16 v[204:207], a[156:159], a[60:63], v[228:231]
    buffer_load_dwordx4 v248, s[12:15], s30 offen offset:128 sc1 nt lds
    v_mfma_f32_16x16x32_bf16 v[204:207], a[152:155], a[56:59], v[204:207]
    s_addk_i32 m0, -25472
    v_exp_f32 v196, v196
    v_mfma_f32_16x16x32_bf16 v[204:207], a[148:151], a[52:55], v[204:207]
    s_addk_i32 s30, 8192
    v_exp_f32 v197, v197
    v_mfma_f32_16x16x32_bf16 v[204:207], a[144:147], a[48:51], v[204:207]
    buffer_load_dwordx4 v248, s[12:15], s30 offen sc1 nt lds
    v_smfmac_f32_16x16x64_bf16 a[224:227], a[244:247], v[208:215], v253
    s_addk_i32 m0, 896
    v_mul_f32 v198, s44, v198
    v_mfma_f32_16x16x32_bf16 v[32:35], a[192:195], v[212:215], v[32:35]
    v_exp_f32 v198, v198
    v_mfma_f32_16x16x32_bf16 v[36:39], a[196:199], v[212:215], v[36:39]
    v_mul_f32 v199, s44, v199
    v_cvt_pk_bf16_f32 v194, v196, v197
    v_mfma_f32_16x16x32_bf16 v[40:43], a[200:203], v[212:215], v[40:43]
    buffer_load_dwordx4 v248, s[12:15], s30 offen offset:128 sc1 nt lds
    v_mfma_f32_16x16x32_bf16 v[44:47], a[204:207], v[212:215], v[44:47]
    s_add_u32 m0, s28, 4096
    v_exp_f32 v199, v199
    v_mfma_f32_16x16x32_bf16 v[48:51], a[208:211], v[212:215], v[48:51]
    s_add_u32 s30, s22, 4096
    ds_read_b64_tr_b16 a[176:177], v242 offset:9216
    v_cvt_pk_bf16_f32 v195, v198, v199
    v_mfma_f32_16x16x32_bf16 v[52:55], a[212:215], v[212:215], v[52:55]
    v_exp_f32 v200, v200
    v_mfma_f32_16x16x32_bf16 v[56:59], a[216:219], v[212:215], v[56:59]
    v_exp_f32 v201, v201
    v_mfma_f32_16x16x32_bf16 v[60:63], a[220:223], v[212:215], v[60:63]
    ds_read_b64_tr_b16 a[178:179], v242 offset:13312
    v_cvt_pk_bf16_f32 v196, v200, v201
    v_mfma_f32_16x16x32_bf16 v[208:211], a[128:131], a[64:67], v[232:235]
    v_exp_f32 v202, v202
    v_mfma_f32_16x16x32_bf16 v[208:211], a[132:135], a[68:71], v[208:211]
    v_exp_f32 v203, v203
    v_mfma_f32_16x16x32_bf16 v[208:211], a[136:139], a[72:75], v[208:211]
    ds_read_b64_tr_b16 a[180:181], v243 offset:9216
    v_cvt_pk_bf16_f32 v197, v202, v203
    v_mfma_f32_16x16x32_bf16 v[208:211], a[140:143], a[76:79], v[208:211]
    v_exp_f32 v204, v204
    v_mfma_f32_16x16x32_bf16 v[212:215], a[156:159], a[76:79], v[232:235]
    v_exp_f32 v205, v205
    v_mfma_f32_16x16x32_bf16 v[212:215], a[152:155], a[72:75], v[212:215]
    ds_read_b64_tr_b16 a[182:183], v243 offset:13312
    v_cvt_pk_bf16_f32 v198, v204, v205
    v_mfma_f32_16x16x32_bf16 v[212:215], a[148:151], a[68:71], v[212:215]
    v_exp_f32 v206, v206
    v_mfma_f32_16x16x32_bf16 v[212:215], a[144:147], a[64:67], v[212:215]
    v_exp_f32 v207, v207
    v_mfma_f32_16x16x32_bf16 v[64:67], a[192:195], v[192:195], v[64:67]
    ds_read_b64_tr_b16 a[184:185], v244 offset:9216
    v_cvt_pk_bf16_f32 v199, v206, v207
    v_mfma_f32_16x16x32_bf16 v[68:71], a[196:199], v[192:195], v[68:71]
    v_mfma_f32_16x16x32_bf16 v[72:75], a[200:203], v[192:195], v[72:75]
    v_mfma_f32_16x16x32_bf16 v[76:79], a[204:207], v[192:195], v[76:79]
    v_mul_f32 v208, s44, v208
    v_mul_f32 v209, s44, v209
    v_mfma_f32_16x16x32_bf16 v[80:83], a[208:211], v[192:195], v[80:83]
    v_exp_f32 v208, v208
    v_mfma_f32_16x16x32_bf16 v[84:87], a[212:215], v[192:195], v[84:87]
    ds_read_b64_tr_b16 a[186:187], v244 offset:13312
    v_mul_f32 v210, s44, v210
    v_mfma_f32_16x16x32_bf16 v[88:91], a[216:219], v[192:195], v[88:91]
    v_exp_f32 v209, v209
    v_mfma_f32_16x16x32_bf16 v[92:95], a[220:223], v[192:195], v[92:95]
    v_exp_f32 v210, v210
    v_mfma_f32_16x16x32_bf16 v[200:203], a[128:131], a[80:83], v[236:239]
    v_mul_f32 v211, s44, v211
    v_cvt_pk_bf16_f32 v208, v208, v209
    v_mfma_f32_16x16x32_bf16 v[200:203], a[132:135], a[84:87], v[200:203]
    ds_read_b64_tr_b16 a[188:189], v245 offset:9216
    v_mul_f32 v212, s44, v212
    v_mfma_f32_16x16x32_bf16 v[200:203], a[136:139], a[88:91], v[200:203]
    v_exp_f32 v211, v211
    v_mfma_f32_16x16x32_bf16 v[200:203], a[140:143], a[92:95], v[200:203]
    v_exp_f32 v212, v212
    v_mfma_f32_16x16x32_bf16 v[204:207], a[156:159], a[92:95], v[236:239]
    v_mul_f32 v213, s44, v213
    v_cvt_pk_bf16_f32 v209, v210, v211
    v_mfma_f32_16x16x32_bf16 v[204:207], a[152:155], a[88:91], v[204:207]
    buffer_load_dwordx4 v248, s[4:7], s30 offen sc1 nt lds
    v_mfma_f32_16x16x32_bf16 v[204:207], a[148:151], a[84:87], v[204:207]
    s_addk_i32 m0, 896
    ds_read_b64_tr_b16 a[190:191], v245 offset:13312
    v_mul_f32 v214, s44, v214
    v_mfma_f32_16x16x32_bf16 v[204:207], a[144:147], a[80:83], v[204:207]
    v_exp_f32 v213, v213
    v_smfmac_f32_16x16x64_bf16 a[228:231], a[244:247], v[192:199], v253
    v_mul_f32 v215, s44, v215
    v_mfma_f32_16x16x32_bf16 v[96:99], a[192:195], v[196:199], v[96:99]
    v_exp_f32 v214, v214
    v_mfma_f32_16x16x32_bf16 v[100:103], a[196:199], v[196:199], v[100:103]
    v_exp_f32 v215, v215
    v_mfma_f32_16x16x32_bf16 v[104:107], a[200:203], v[196:199], v[104:107]
    v_cvt_pk_bf16_f32 v210, v212, v213
    v_mul_f32 v200, s44, v200
    v_mfma_f32_16x16x32_bf16 v[108:111], a[204:207], v[196:199], v[108:111]
    v_cvt_pk_bf16_f32 v211, v214, v215
    v_mul_f32 v201, s44, v201
    v_mfma_f32_16x16x32_bf16 v[112:115], a[208:211], v[196:199], v[112:115]
    v_exp_f32 v200, v200
    v_mfma_f32_16x16x32_bf16 v[116:119], a[212:215], v[196:199], v[116:119]
    buffer_load_dwordx4 v248, s[4:7], s30 offen offset:128 sc1 nt lds
    v_mfma_f32_16x16x32_bf16 v[120:123], a[216:219], v[196:199], v[120:123]
    s_add_u32 m0, s27, 8192
    v_exp_f32 v201, v201
    v_mfma_f32_16x16x32_bf16 v[124:127], a[220:223], v[196:199], v[124:127]
    s_waitcnt lgkmcnt(0)
    v_mul_f32 v202, s44, v202
    v_mul_f32 v203, s44, v203
    v_mfma_f32_16x16x32_bf16 v[192:195], a[96:99], a[0:3], v[216:219]
    s_waitcnt vmcnt(10)
    v_exp_f32 v202, v202
    v_mfma_f32_16x16x32_bf16 v[192:195], a[100:103], a[4:7], v[192:195]
    s_barrier
    v_cvt_pk_bf16_f32 v212, v200, v201
    v_mfma_f32_16x16x32_bf16 v[192:195], a[104:107], a[8:11], v[192:195]
    s_add_u32 s30, s24, 73728
    ds_read_b128 a[128:131], v240 offset:16384
    v_mul_f32 v204, s44, v204
    v_mfma_f32_16x16x32_bf16 v[192:195], a[108:111], a[12:15], v[192:195]
    buffer_load_dwordx4 v248, s[8:11], s30 offen sc1 nt lds
    v_mfma_f32_16x16x32_bf16 v[196:199], a[124:127], a[12:15], v[216:219]
    s_addk_i32 m0, 896
    ds_read_b128 a[132:135], v241 offset:16384
    v_mul_f32 v205, s44, v205
    v_mfma_f32_16x16x32_bf16 v[196:199], a[120:123], a[8:11], v[196:199]
    v_exp_f32 v203, v203
    v_mfma_f32_16x16x32_bf16 v[196:199], a[116:119], a[4:7], v[196:199]
    v_exp_f32 v204, v204
    v_mfma_f32_16x16x32_bf16 v[196:199], a[112:115], a[0:3], v[196:199]
    ds_read_b128 a[136:139], v240 offset:17408
    v_cvt_pk_bf16_f32 v213, v202, v203
    v_mfma_f32_16x16x32_bf16 v[128:131], a[192:195], v[208:211], v[128:131]
    v_exp_f32 v205, v205
    v_mfma_f32_16x16x32_bf16 v[132:135], a[196:199], v[208:211], v[132:135]
    ds_read_b128 a[140:143], v241 offset:17408
    v_mul_f32 v206, s44, v206
    v_mfma_f32_16x16x32_bf16 v[136:139], a[200:203], v[208:211], v[136:139]
    v_exp_f32 v206, v206
    v_mfma_f32_16x16x32_bf16 v[140:143], a[204:207], v[208:211], v[140:143]
    v_mul_f32 v207, s44, v207
    v_cvt_pk_bf16_f32 v214, v204, v205
    v_mfma_f32_16x16x32_bf16 v[144:147], a[208:211], v[208:211], v[144:147]
    v_exp_f32 v207, v207
    v_mfma_f32_16x16x32_bf16 v[148:151], a[212:215], v[208:211], v[148:151]
    ds_read_b128 a[144:147], v240 offset:20480
    v_cvt_pk_bf16_f32 v215, v206, v207
    v_mfma_f32_16x16x32_bf16 v[152:155], a[216:219], v[208:211], v[152:155]
    buffer_load_dwordx4 v248, s[8:11], s30 offen offset:128 sc1 nt lds
    v_mfma_f32_16x16x32_bf16 v[156:159], a[220:223], v[208:211], v[156:159]
    s_addk_i32 m0, 31872
    v_exp_f32 v192, v192
    v_mfma_f32_16x16x32_bf16 v[200:203], a[96:99], a[16:19], v[220:223]
    v_exp_f32 v193, v193
    v_mfma_f32_16x16x32_bf16 v[200:203], a[100:103], a[20:23], v[200:203]
    ds_read_b128 a[148:151], v241 offset:20480
    v_cvt_pk_bf16_f32 v192, v192, v193
    v_mfma_f32_16x16x32_bf16 v[200:203], a[104:107], a[24:27], v[200:203]
    v_exp_f32 v194, v194
    v_mfma_f32_16x16x32_bf16 v[200:203], a[108:111], a[28:31], v[200:203]
    v_exp_f32 v195, v195
    v_mfma_f32_16x16x32_bf16 v[204:207], a[124:127], a[28:31], v[220:223]
    ds_read_b128 a[152:155], v240 offset:21504
    v_cvt_pk_bf16_f32 v193, v194, v195
    v_mfma_f32_16x16x32_bf16 v[204:207], a[120:123], a[24:27], v[204:207]
    v_exp_f32 v196, v196
    v_mfma_f32_16x16x32_bf16 v[204:207], a[116:119], a[20:23], v[204:207]
    v_exp_f32 v197, v197
    v_mfma_f32_16x16x32_bf16 v[204:207], a[112:115], a[16:19], v[204:207]
    ds_read_b128 a[156:159], v241 offset:21504
    v_cvt_pk_bf16_f32 v194, v196, v197
    v_smfmac_f32_16x16x64_bf16 a[232:235], a[244:247], v[208:215], v253
    v_mfma_f32_16x16x32_bf16 v[160:163], a[192:195], v[212:215], v[160:163]
    v_exp_f32 v198, v198
    v_mfma_f32_16x16x32_bf16 v[164:167], a[196:199], v[212:215], v[164:167]
    v_exp_f32 v199, v199
    v_mfma_f32_16x16x32_bf16 v[168:171], a[200:203], v[212:215], v[168:171]
    ds_read_b64_tr_b16 a[192:193], v242 offset:16384
    v_cvt_pk_bf16_f32 v195, v198, v199
    v_mfma_f32_16x16x32_bf16 v[172:175], a[204:207], v[212:215], v[172:175]
    v_exp_f32 v200, v200
    v_mfma_f32_16x16x32_bf16 v[176:179], a[208:211], v[212:215], v[176:179]
    v_exp_f32 v201, v201
    v_mfma_f32_16x16x32_bf16 v[180:183], a[212:215], v[212:215], v[180:183]
    ds_read_b64_tr_b16 a[194:195], v242 offset:20480
    v_cvt_pk_bf16_f32 v196, v200, v201
    v_mfma_f32_16x16x32_bf16 v[184:187], a[216:219], v[212:215], v[184:187]
    v_exp_f32 v202, v202
    v_mfma_f32_16x16x32_bf16 v[188:191], a[220:223], v[212:215], v[188:191]
    v_exp_f32 v203, v203
    v_mfma_f32_16x16x32_bf16 v[208:211], a[96:99], a[32:35], v[224:227]
    ds_read_b64_tr_b16 a[196:197], v243 offset:16384
    v_cvt_pk_bf16_f32 v197, v202, v203
    v_mfma_f32_16x16x32_bf16 v[208:211], a[100:103], a[36:39], v[208:211]
    v_exp_f32 v204, v204
    v_mfma_f32_16x16x32_bf16 v[208:211], a[104:107], a[40:43], v[208:211]
    v_exp_f32 v205, v205
    v_mfma_f32_16x16x32_bf16 v[208:211], a[108:111], a[44:47], v[208:211]
    ds_read_b64_tr_b16 a[198:199], v243 offset:20480
    v_cvt_pk_bf16_f32 v198, v204, v205
    v_mfma_f32_16x16x32_bf16 v[212:215], a[124:127], a[44:47], v[224:227]
    v_exp_f32 v206, v206
    v_mfma_f32_16x16x32_bf16 v[212:215], a[120:123], a[40:43], v[212:215]
    v_exp_f32 v207, v207
    v_mfma_f32_16x16x32_bf16 v[212:215], a[116:119], a[36:39], v[212:215]
    ds_read_b64_tr_b16 a[200:201], v244 offset:16384
    v_cvt_pk_bf16_f32 v199, v206, v207
    v_mfma_f32_16x16x32_bf16 v[212:215], a[112:115], a[32:35], v[212:215]
    v_mfma_f32_16x16x32_bf16 v[0:3], a[160:163], v[192:195], v[0:3]
    buffer_load_dwordx4 v248, s[12:15], s30 offen sc1 nt lds
    v_mfma_f32_16x16x32_bf16 v[4:7], a[164:167], v[192:195], v[4:7]
    s_addk_i32 m0, 896
    v_mfma_f32_16x16x32_bf16 v[8:11], a[168:171], v[192:195], v[8:11]
    ds_read_b64_tr_b16 a[202:203], v244 offset:20480
    v_mfma_f32_16x16x32_bf16 v[12:15], a[172:175], v[192:195], v[12:15]
    v_mul_f32 v208, s44, v208
    v_mul_f32 v209, s44, v209
    v_mfma_f32_16x16x32_bf16 v[16:19], a[176:179], v[192:195], v[16:19]
    v_exp_f32 v208, v208
    v_mfma_f32_16x16x32_bf16 v[20:23], a[180:183], v[192:195], v[20:23]
    v_exp_f32 v209, v209
    v_mfma_f32_16x16x32_bf16 v[24:27], a[184:187], v[192:195], v[24:27]
    v_mul_f32 v210, s44, v210
    v_mul_f32 v211, s44, v211
    v_mfma_f32_16x16x32_bf16 v[28:31], a[188:191], v[192:195], v[28:31]
L_pad2:
    s_cbranch_execz L_pad6
    ds_read_b64_tr_b16 a[204:205], v245 offset:16384
    v_cvt_pk_bf16_f32 v208, v208, v209
    v_mfma_f32_16x16x32_bf16 v[200:203], a[96:99], a[48:51], v[228:231]
    v_exp_f32 v210, v210
    v_mfma_f32_16x16x32_bf16 v[200:203], a[100:103], a[52:55], v[200:203]
    v_exp_f32 v211, v211
    v_mfma_f32_16x16x32_bf16 v[200:203], a[104:107], a[56:59], v[200:203]
    v_mul_f32 v212, s44, v212
    v_mul_f32 v213, s44, v213
    v_mfma_f32_16x16x32_bf16 v[200:203], a[108:111], a[60:63], v[200:203]
    ds_read_b64_tr_b16 a[206:207], v245 offset:20480
    v_cvt_pk_bf16_f32 v209, v210, v211
    v_mfma_f32_16x16x32_bf16 v[204:207], a[124:127], a[60:63], v[228:231]
    v_exp_f32 v212, v212
    v_mfma_f32_16x16x32_bf16 v[204:207], a[120:123], a[56:59], v[204:207]
    v_exp_f32 v213, v213
    v_mfma_f32_16x16x32_bf16 v[204:207], a[116:119], a[52:55], v[204:207]
    v_mul_f32 v214, s44, v214
    v_mul_f32 v215, s44, v215
    v_mfma_f32_16x16x32_bf16 v[204:207], a[112:115], a[48:51], v[204:207]
    v_exp_f32 v214, v214
    v_smfmac_f32_16x16x64_bf16 a[224:227], a[244:247], v[192:199], v253
    v_cvt_pk_bf16_f32 v210, v212, v213
    v_mfma_f32_16x16x32_bf16 v[32:35], a[160:163], v[196:199], v[32:35]
    buffer_load_dwordx4 v248, s[12:15], s30 offen offset:128 sc1 nt lds
    v_mfma_f32_16x16x32_bf16 v[36:39], a[164:167], v[196:199], v[36:39]
    s_add_u32 m0, s28, 6144
    v_exp_f32 v215, v215
    v_mfma_f32_16x16x32_bf16 v[40:43], a[168:171], v[196:199], v[40:43]
    s_add_u32 s30, s22, 6144
    ds_read_b64_tr_b16 a[208:209], v242 offset:17408
    v_cvt_pk_bf16_f32 v211, v214, v215
    v_mfma_f32_16x16x32_bf16 v[44:47], a[172:175], v[196:199], v[44:47]
    v_exp_f32 v200, v200
    v_mfma_f32_16x16x32_bf16 v[48:51], a[176:179], v[196:199], v[48:51]
    v_exp_f32 v201, v201
    v_mfma_f32_16x16x32_bf16 v[52:55], a[180:183], v[196:199], v[52:55]
    ds_read_b64_tr_b16 a[210:211], v242 offset:21504
    v_cvt_pk_bf16_f32 v212, v200, v201
    v_mfma_f32_16x16x32_bf16 v[56:59], a[184:187], v[196:199], v[56:59]
    v_exp_f32 v202, v202
    v_mfma_f32_16x16x32_bf16 v[60:63], a[188:191], v[196:199], v[60:63]
    v_exp_f32 v203, v203
    v_mfma_f32_16x16x32_bf16 v[192:195], a[96:99], a[64:67], v[232:235]
    ds_read_b64_tr_b16 a[212:213], v243 offset:17408
    v_cvt_pk_bf16_f32 v213, v202, v203
    v_mfma_f32_16x16x32_bf16 v[192:195], a[100:103], a[68:71], v[192:195]
    v_exp_f32 v204, v204
    v_mfma_f32_16x16x32_bf16 v[192:195], a[104:107], a[72:75], v[192:195]
    v_exp_f32 v205, v205
    v_mfma_f32_16x16x32_bf16 v[192:195], a[108:111], a[76:79], v[192:195]
    v_exp_f32 v206, v206
    v_mfma_f32_16x16x32_bf16 v[196:199], a[124:127], a[76:79], v[232:235]
    ds_read_b64_tr_b16 a[214:215], v243 offset:21504
    v_cvt_pk_bf16_f32 v214, v204, v205
    v_mfma_f32_16x16x32_bf16 v[196:199], a[120:123], a[72:75], v[196:199]
    v_exp_f32 v207, v207
    v_mfma_f32_16x16x32_bf16 v[196:199], a[116:119], a[68:71], v[196:199]
    v_cvt_pk_bf16_f32 v215, v206, v207
    v_mfma_f32_16x16x32_bf16 v[196:199], a[112:115], a[64:67], v[196:199]
    buffer_load_dwordx4 v248, s[4:7], s30 offen sc1 nt lds
    v_mfma_f32_16x16x32_bf16 v[64:67], a[160:163], v[208:211], v[64:67]
    s_addk_i32 m0, 896
    ds_read_b64_tr_b16 a[216:217], v244 offset:17408
    v_mfma_f32_16x16x32_bf16 v[68:71], a[164:167], v[208:211], v[68:71]
    v_mfma_f32_16x16x32_bf16 v[72:75], a[168:171], v[208:211], v[72:75]
    v_mfma_f32_16x16x32_bf16 v[76:79], a[172:175], v[208:211], v[76:79]
    v_mul_f32 v192, s44, v192
    v_mul_f32 v193, s44, v193
    v_mfma_f32_16x16x32_bf16 v[80:83], a[176:179], v[208:211], v[80:83]
    v_exp_f32 v192, v192
    v_mfma_f32_16x16x32_bf16 v[84:87], a[180:183], v[208:211], v[84:87]
    ds_read_b64_tr_b16 a[218:219], v244 offset:21504
    v_mul_f32 v194, s44, v194
    v_mfma_f32_16x16x32_bf16 v[88:91], a[184:187], v[208:211], v[88:91]
    v_exp_f32 v193, v193
    v_mfma_f32_16x16x32_bf16 v[92:95], a[188:191], v[208:211], v[92:95]
    v_exp_f32 v194, v194
    v_mfma_f32_16x16x32_bf16 v[200:203], a[96:99], a[80:83], v[236:239]
    v_mul_f32 v195, s44, v195
    v_cvt_pk_bf16_f32 v192, v192, v193
    v_mfma_f32_16x16x32_bf16 v[200:203], a[100:103], a[84:87], v[200:203]
    ds_read_b64_tr_b16 a[220:221], v245 offset:17408
    v_mul_f32 v196, s44, v196
    v_mfma_f32_16x16x32_bf16 v[200:203], a[104:107], a[88:91], v[200:203]
    v_exp_f32 v195, v195
    v_mfma_f32_16x16x32_bf16 v[200:203], a[108:111], a[92:95], v[200:203]
    v_exp_f32 v196, v196
    v_mfma_f32_16x16x32_bf16 v[204:207], a[124:127], a[92:95], v[236:239]
    v_mul_f32 v197, s44, v197
    v_cvt_pk_bf16_f32 v193, v194, v195
    v_mfma_f32_16x16x32_bf16 v[204:207], a[120:123], a[88:91], v[204:207]
    ds_read_b64_tr_b16 a[222:223], v245 offset:21504
    v_mul_f32 v198, s44, v198
    v_mfma_f32_16x16x32_bf16 v[204:207], a[116:119], a[84:87], v[204:207]
    v_exp_f32 v197, v197
    v_mfma_f32_16x16x32_bf16 v[204:207], a[112:115], a[80:83], v[204:207]
    v_exp_f32 v198, v198
    v_smfmac_f32_16x16x64_bf16 a[228:231], a[244:247], v[208:215], v253
    v_mul_f32 v199, s44, v199
    v_mfma_f32_16x16x32_bf16 v[96:99], a[160:163], v[212:215], v[96:99]
    buffer_load_dwordx4 v248, s[4:7], s30 offen offset:128 sc1 nt lds
    v_mfma_f32_16x16x32_bf16 v[100:103], a[164:167], v[212:215], v[100:103]
    s_add_u32 m0, s27, 16384
    v_exp_f32 v199, v199
    v_mfma_f32_16x16x32_bf16 v[104:107], a[168:171], v[212:215], v[104:107]
    s_add_u32 s30, s24, 81920
    v_cvt_pk_bf16_f32 v194, v196, v197
    v_mul_f32 v200, s44, v200
    v_mfma_f32_16x16x32_bf16 v[108:111], a[172:175], v[212:215], v[108:111]
    v_cvt_pk_bf16_f32 v195, v198, v199
    v_mul_f32 v201, s44, v201
    v_mfma_f32_16x16x32_bf16 v[112:115], a[176:179], v[212:215], v[112:115]
    v_exp_f32 v200, v200
    v_mfma_f32_16x16x32_bf16 v[116:119], a[180:183], v[212:215], v[116:119]
    v_exp_f32 v201, v201
    v_mfma_f32_16x16x32_bf16 v[120:123], a[184:187], v[212:215], v[120:123]
    v_mul_f32 v202, s44, v202
    v_mul_f32 v203, s44, v203
    v_mfma_f32_16x16x32_bf16 v[124:127], a[188:191], v[212:215], v[124:127]
    s_waitcnt lgkmcnt(0)
    v_exp_f32 v202, v202
    v_mfma_f32_16x16x32_bf16 v[208:211], a[128:131], a[0:3], v[216:219]
    s_waitcnt vmcnt(10)
    v_cvt_pk_bf16_f32 v196, v200, v201
    v_mul_f32 v204, s44, v204
    v_mfma_f32_16x16x32_bf16 v[208:211], a[132:135], a[4:7], v[208:211]
    s_barrier
    v_mul_f32 v205, s44, v205
    v_mfma_f32_16x16x32_bf16 v[208:211], a[136:139], a[8:11], v[208:211]
    ds_read_b128 a[96:99], v240 offset:24576
    v_mul_f32 v206, s44, v206
    v_mfma_f32_16x16x32_bf16 v[208:211], a[140:143], a[12:15], v[208:211]
    buffer_load_dwordx4 v248, s[8:11], s30 offen sc1 nt lds
    v_mfma_f32_16x16x32_bf16 v[212:215], a[156:159], a[12:15], v[216:219]
    s_addk_i32 m0, 896
    ds_read_b128 a[100:103], v241 offset:24576
    v_mul_f32 v207, s44, v207
    v_mfma_f32_16x16x32_bf16 v[212:215], a[152:155], a[8:11], v[212:215]
    v_exp_f32 v203, v203
    v_mfma_f32_16x16x32_bf16 v[212:215], a[148:151], a[4:7], v[212:215]
    v_exp_f32 v204, v204
    v_mfma_f32_16x16x32_bf16 v[212:215], a[144:147], a[0:3], v[212:215]
    ds_read_b128 a[104:107], v240 offset:25600
    v_cvt_pk_bf16_f32 v197, v202, v203
    v_mfma_f32_16x16x32_bf16 v[128:131], a[160:163], v[192:195], v[128:131]
    v_exp_f32 v205, v205
    v_mfma_f32_16x16x32_bf16 v[132:135], a[164:167], v[192:195], v[132:135]
    ds_read_b128 a[108:111], v241 offset:25600
    v_cvt_pk_bf16_f32 v198, v204, v205
    v_mfma_f32_16x16x32_bf16 v[136:139], a[168:171], v[192:195], v[136:139]
    v_exp_f32 v206, v206
    v_mfma_f32_16x16x32_bf16 v[140:143], a[172:175], v[192:195], v[140:143]
    v_exp_f32 v207, v207
    v_mfma_f32_16x16x32_bf16 v[144:147], a[176:179], v[192:195], v[144:147]
    ds_read_b128 a[112:115], v240 offset:28672
    v_cvt_pk_bf16_f32 v199, v206, v207
    v_mfma_f32_16x16x32_bf16 v[148:151], a[180:183], v[192:195], v[148:151]
    buffer_load_dwordx4 v248, s[8:11], s30 offen offset:128 sc1 nt lds
    v_mfma_f32_16x16x32_bf16 v[152:155], a[184:187], v[192:195], v[152:155]
    s_addk_i32 m0, 31872
    v_exp_f32 v208, v208
    v_mfma_f32_16x16x32_bf16 v[156:159], a[188:191], v[192:195], v[156:159]
    v_exp_f32 v209, v209
    v_mfma_f32_16x16x32_bf16 v[200:203], a[128:131], a[16:19], v[220:223]
    ds_read_b128 a[116:119], v241 offset:28672
    v_cvt_pk_bf16_f32 v208, v208, v209
    v_mfma_f32_16x16x32_bf16 v[200:203], a[132:135], a[20:23], v[200:203]
    v_exp_f32 v210, v210
    v_mfma_f32_16x16x32_bf16 v[200:203], a[136:139], a[24:27], v[200:203]
    v_exp_f32 v211, v211
    v_mfma_f32_16x16x32_bf16 v[200:203], a[140:143], a[28:31], v[200:203]
    ds_read_b128 a[120:123], v240 offset:29696
    v_cvt_pk_bf16_f32 v209, v210, v211
    v_mfma_f32_16x16x32_bf16 v[204:207], a[156:159], a[28:31], v[220:223]
    v_exp_f32 v212, v212
    v_mfma_f32_16x16x32_bf16 v[204:207], a[152:155], a[24:27], v[204:207]
    v_exp_f32 v213, v213
    v_mfma_f32_16x16x32_bf16 v[204:207], a[148:151], a[20:23], v[204:207]
    ds_read_b128 a[124:127], v241 offset:29696
    v_cvt_pk_bf16_f32 v210, v212, v213
    v_mfma_f32_16x16x32_bf16 v[204:207], a[144:147], a[16:19], v[204:207]
    v_exp_f32 v214, v214
    v_smfmac_f32_16x16x64_bf16 a[232:235], a[244:247], v[192:199], v253
    v_mfma_f32_16x16x32_bf16 v[160:163], a[160:163], v[196:199], v[160:163]
    v_exp_f32 v215, v215
    v_mfma_f32_16x16x32_bf16 v[164:167], a[164:167], v[196:199], v[164:167]
    ds_read_b64_tr_b16 a[160:161], v242 offset:24576
    v_cvt_pk_bf16_f32 v211, v214, v215
    v_mfma_f32_16x16x32_bf16 v[168:171], a[168:171], v[196:199], v[168:171]
    v_exp_f32 v200, v200
    v_mfma_f32_16x16x32_bf16 v[172:175], a[172:175], v[196:199], v[172:175]
    v_exp_f32 v201, v201
    v_mfma_f32_16x16x32_bf16 v[176:179], a[176:179], v[196:199], v[176:179]
    ds_read_b64_tr_b16 a[162:163], v242 offset:28672
    v_cvt_pk_bf16_f32 v212, v200, v201
    v_mfma_f32_16x16x32_bf16 v[180:183], a[180:183], v[196:199], v[180:183]
    v_exp_f32 v202, v202
    v_mfma_f32_16x16x32_bf16 v[184:187], a[184:187], v[196:199], v[184:187]
    v_exp_f32 v203, v203
    v_mfma_f32_16x16x32_bf16 v[188:191], a[188:191], v[196:199], v[188:191]
    ds_read_b64_tr_b16 a[164:165], v243 offset:24576
    v_cvt_pk_bf16_f32 v213, v202, v203
    v_mfma_f32_16x16x32_bf16 v[192:195], a[128:131], a[32:35], v[224:227]
    v_exp_f32 v204, v204
    v_mfma_f32_16x16x32_bf16 v[192:195], a[132:135], a[36:39], v[192:195]
    v_exp_f32 v205, v205
    v_mfma_f32_16x16x32_bf16 v[192:195], a[136:139], a[40:43], v[192:195]
    ds_read_b64_tr_b16 a[166:167], v243 offset:28672
    v_cvt_pk_bf16_f32 v214, v204, v205
    v_mfma_f32_16x16x32_bf16 v[192:195], a[140:143], a[44:47], v[192:195]
    v_exp_f32 v206, v206
    v_mfma_f32_16x16x32_bf16 v[196:199], a[156:159], a[44:47], v[224:227]
    v_exp_f32 v207, v207
    v_mfma_f32_16x16x32_bf16 v[196:199], a[152:155], a[40:43], v[196:199]
    v_cvt_pk_bf16_f32 v215, v206, v207
    v_mfma_f32_16x16x32_bf16 v[196:199], a[148:151], a[36:39], v[196:199]
    ds_read_b64_tr_b16 a[168:169], v244 offset:24576
    v_mfma_f32_16x16x32_bf16 v[196:199], a[144:147], a[32:35], v[196:199]
    v_mfma_f32_16x16x32_bf16 v[0:3], a[192:195], v[208:211], v[0:3]
    buffer_load_dwordx4 v248, s[12:15], s30 offen sc1 nt lds
    v_mfma_f32_16x16x32_bf16 v[4:7], a[196:199], v[208:211], v[4:7]
    s_addk_i32 m0, 896
    v_mfma_f32_16x16x32_bf16 v[8:11], a[200:203], v[208:211], v[8:11]
    ds_read_b64_tr_b16 a[170:171], v244 offset:28672
    v_mfma_f32_16x16x32_bf16 v[12:15], a[204:207], v[208:211], v[12:15]
    v_mul_f32 v192, s44, v192
    v_mul_f32 v193, s44, v193
    v_mfma_f32_16x16x32_bf16 v[16:19], a[208:211], v[208:211], v[16:19]
    v_exp_f32 v192, v192
    v_mfma_f32_16x16x32_bf16 v[20:23], a[212:215], v[208:211], v[20:23]
    v_exp_f32 v193, v193
    v_mfma_f32_16x16x32_bf16 v[24:27], a[216:219], v[208:211], v[24:27]
    v_mul_f32 v194, s44, v194
    v_mul_f32 v195, s44, v195
    v_mfma_f32_16x16x32_bf16 v[28:31], a[220:223], v[208:211], v[28:31]
    ds_read_b64_tr_b16 a[172:173], v245 offset:24576
    v_cvt_pk_bf16_f32 v192, v192, v193
    v_mfma_f32_16x16x32_bf16 v[200:203], a[128:131], a[48:51], v[228:231]
    v_exp_f32 v194, v194
    v_mfma_f32_16x16x32_bf16 v[200:203], a[132:135], a[52:55], v[200:203]
    v_exp_f32 v195, v195
    v_mfma_f32_16x16x32_bf16 v[200:203], a[136:139], a[56:59], v[200:203]
    v_mul_f32 v196, s44, v196
    v_mul_f32 v197, s44, v197
    v_mfma_f32_16x16x32_bf16 v[200:203], a[140:143], a[60:63], v[200:203]
    ds_read_b64_tr_b16 a[174:175], v245 offset:28672
    v_cvt_pk_bf16_f32 v193, v194, v195
    v_mfma_f32_16x16x32_bf16 v[204:207], a[156:159], a[60:63], v[228:231]
    v_exp_f32 v196, v196
    v_mfma_f32_16x16x32_bf16 v[204:207], a[152:155], a[56:59], v[204:207]
    v_exp_f32 v197, v197
    v_mfma_f32_16x16x32_bf16 v[204:207], a[148:151], a[52:55], v[204:207]
    v_mul_f32 v198, s44, v198
    v_mul_f32 v199, s44, v199
    v_mfma_f32_16x16x32_bf16 v[204:207], a[144:147], a[48:51], v[204:207]
    v_exp_f32 v198, v198
    v_smfmac_f32_16x16x64_bf16 a[224:227], a[244:247], v[208:215], v253
    v_cvt_pk_bf16_f32 v194, v196, v197
    v_mfma_f32_16x16x32_bf16 v[32:35], a[192:195], v[212:215], v[32:35]
    buffer_load_dwordx4 v248, s[12:15], s30 offen offset:128 sc1 nt lds
    v_mfma_f32_16x16x32_bf16 v[36:39], a[196:199], v[212:215], v[36:39]
    s_add_u32 m0, s28, 8192
    v_exp_f32 v199, v199
    v_mfma_f32_16x16x32_bf16 v[40:43], a[200:203], v[212:215], v[40:43]
    s_add_u32 s30, s22, 8192
    ds_read_b64_tr_b16 a[176:177], v242 offset:25600
    v_cvt_pk_bf16_f32 v195, v198, v199
    v_mfma_f32_16x16x32_bf16 v[44:47], a[204:207], v[212:215], v[44:47]
    v_exp_f32 v200, v200
    v_mfma_f32_16x16x32_bf16 v[48:51], a[208:211], v[212:215], v[48:51]
    v_exp_f32 v201, v201
    v_mfma_f32_16x16x32_bf16 v[52:55], a[212:215], v[212:215], v[52:55]
    ds_read_b64_tr_b16 a[178:179], v242 offset:29696
    v_cvt_pk_bf16_f32 v196, v200, v201
    v_mfma_f32_16x16x32_bf16 v[56:59], a[216:219], v[212:215], v[56:59]
    v_exp_f32 v202, v202
    v_mfma_f32_16x16x32_bf16 v[60:63], a[220:223], v[212:215], v[60:63]
    v_exp_f32 v203, v203
    v_mfma_f32_16x16x32_bf16 v[208:211], a[128:131], a[64:67], v[232:235]
    ds_read_b64_tr_b16 a[180:181], v243 offset:25600
    v_cvt_pk_bf16_f32 v197, v202, v203
    v_mfma_f32_16x16x32_bf16 v[208:211], a[132:135], a[68:71], v[208:211]
    v_exp_f32 v204, v204
    v_mfma_f32_16x16x32_bf16 v[208:211], a[136:139], a[72:75], v[208:211]
    buffer_load_dwordx4 v248, s[4:7], s30 offen sc1 nt lds
    v_mfma_f32_16x16x32_bf16 v[208:211], a[140:143], a[76:79], v[208:211]
    s_addk_i32 m0, 896
    v_exp_f32 v205, v205
    v_mfma_f32_16x16x32_bf16 v[212:215], a[156:159], a[76:79], v[232:235]
    ds_read_b64_tr_b16 a[182:183], v243 offset:29696
    v_cvt_pk_bf16_f32 v198, v204, v205
    v_mfma_f32_16x16x32_bf16 v[212:215], a[152:155], a[72:75], v[212:215]
    v_exp_f32 v206, v206
    v_mfma_f32_16x16x32_bf16 v[212:215], a[148:151], a[68:71], v[212:215]
    v_exp_f32 v207, v207
    v_mfma_f32_16x16x32_bf16 v[212:215], a[144:147], a[64:67], v[212:215]
    v_cvt_pk_bf16_f32 v199, v206, v207
    v_mfma_f32_16x16x32_bf16 v[64:67], a[192:195], v[192:195], v[64:67]
    ds_read_b64_tr_b16 a[184:185], v244 offset:25600
    v_mfma_f32_16x16x32_bf16 v[68:71], a[196:199], v[192:195], v[68:71]
    v_mfma_f32_16x16x32_bf16 v[72:75], a[200:203], v[192:195], v[72:75]
    v_mfma_f32_16x16x32_bf16 v[76:79], a[204:207], v[192:195], v[76:79]
    v_mul_f32 v208, s44, v208
    v_mul_f32 v209, s44, v209
    v_mfma_f32_16x16x32_bf16 v[80:83], a[208:211], v[192:195], v[80:83]
    v_exp_f32 v208, v208
    v_mfma_f32_16x16x32_bf16 v[84:87], a[212:215], v[192:195], v[84:87]
    ds_read_b64_tr_b16 a[186:187], v244 offset:29696
    v_mul_f32 v210, s44, v210
    v_mfma_f32_16x16x32_bf16 v[88:91], a[216:219], v[192:195], v[88:91]
    v_exp_f32 v209, v209
    v_mfma_f32_16x16x32_bf16 v[92:95], a[220:223], v[192:195], v[92:95]
    v_exp_f32 v210, v210
    v_mfma_f32_16x16x32_bf16 v[200:203], a[128:131], a[80:83], v[236:239]
    v_mul_f32 v211, s44, v211
    v_cvt_pk_bf16_f32 v208, v208, v209
    v_mfma_f32_16x16x32_bf16 v[200:203], a[132:135], a[84:87], v[200:203]
    buffer_load_dwordx4 v248, s[4:7], s30 offen offset:128 sc1 nt lds
    v_mfma_f32_16x16x32_bf16 v[200:203], a[136:139], a[88:91], v[200:203]
    s_add_u32 m0, s27, 24576
    ds_read_b64_tr_b16 a[188:189], v245 offset:25600
    v_mul_f32 v212, s44, v212
    v_mfma_f32_16x16x32_bf16 v[200:203], a[140:143], a[92:95], v[200:203]
    s_add_u32 s30, s24, 90112
    v_exp_f32 v211, v211
    v_mfma_f32_16x16x32_bf16 v[204:207], a[156:159], a[92:95], v[236:239]
    v_exp_f32 v212, v212
    v_mfma_f32_16x16x32_bf16 v[204:207], a[152:155], a[88:91], v[204:207]
    v_mul_f32 v213, s44, v213
    v_cvt_pk_bf16_f32 v209, v210, v211
    v_mfma_f32_16x16x32_bf16 v[204:207], a[148:151], a[84:87], v[204:207]
    ds_read_b64_tr_b16 a[190:191], v245 offset:29696
    v_mul_f32 v214, s44, v214
    v_mfma_f32_16x16x32_bf16 v[204:207], a[144:147], a[80:83], v[204:207]
    v_exp_f32 v213, v213
    v_smfmac_f32_16x16x64_bf16 a[228:231], a[244:247], v[192:199], v253
    v_mul_f32 v215, s44, v215
    v_mfma_f32_16x16x32_bf16 v[96:99], a[192:195], v[196:199], v[96:99]
    v_exp_f32 v214, v214
    v_mfma_f32_16x16x32_bf16 v[100:103], a[196:199], v[196:199], v[100:103]
    v_exp_f32 v215, v215
    v_mfma_f32_16x16x32_bf16 v[104:107], a[200:203], v[196:199], v[104:107]
    v_cvt_pk_bf16_f32 v210, v212, v213
    v_mul_f32 v200, s44, v200
    v_mfma_f32_16x16x32_bf16 v[108:111], a[204:207], v[196:199], v[108:111]
    v_cvt_pk_bf16_f32 v211, v214, v215
    v_mul_f32 v201, s44, v201
    v_mfma_f32_16x16x32_bf16 v[112:115], a[208:211], v[196:199], v[112:115]
    v_exp_f32 v200, v200
    v_mfma_f32_16x16x32_bf16 v[116:119], a[212:215], v[196:199], v[116:119]
    v_exp_f32 v201, v201
    v_mfma_f32_16x16x32_bf16 v[120:123], a[216:219], v[196:199], v[120:123]
    v_mul_f32 v202, s44, v202
    v_mul_f32 v203, s44, v203
    v_mfma_f32_16x16x32_bf16 v[124:127], a[220:223], v[196:199], v[124:127]
    s_waitcnt lgkmcnt(0)
    v_exp_f32 v202, v202
    v_mfma_f32_16x16x32_bf16 v[192:195], a[96:99], a[0:3], v[216:219]
    s_waitcnt vmcnt(14)
    v_cvt_pk_bf16_f32 v212, v200, v201
    v_mul_f32 v204, s44, v204
    v_mfma_f32_16x16x32_bf16 v[192:195], a[100:103], a[4:7], v[192:195]
    s_barrier
    v_mul_f32 v205, s44, v205
    v_mfma_f32_16x16x32_bf16 v[192:195], a[104:107], a[8:11], v[192:195]
    ds_read_b128 a[128:131], v240 offset:0
    v_mul_f32 v206, s44, v206
    v_mfma_f32_16x16x32_bf16 v[192:195], a[108:111], a[12:15], v[192:195]
    buffer_load_dwordx4 v248, s[8:11], s30 offen sc1 nt lds
    v_mfma_f32_16x16x32_bf16 v[196:199], a[124:127], a[12:15], v[216:219]
    s_addk_i32 m0, 896
    ds_read_b128 a[132:135], v241 offset:0
    v_mul_f32 v207, s44, v207
    v_mfma_f32_16x16x32_bf16 v[196:199], a[120:123], a[8:11], v[196:199]
    v_exp_f32 v203, v203
    v_mfma_f32_16x16x32_bf16 v[196:199], a[116:119], a[4:7], v[196:199]
    v_exp_f32 v204, v204
    v_mfma_f32_16x16x32_bf16 v[196:199], a[112:115], a[0:3], v[196:199]
    ds_read_b128 a[136:139], v240 offset:1024
    v_cvt_pk_bf16_f32 v213, v202, v203
    v_mfma_f32_16x16x32_bf16 v[128:131], a[192:195], v[208:211], v[128:131]
    v_exp_f32 v205, v205
    v_mfma_f32_16x16x32_bf16 v[132:135], a[196:199], v[208:211], v[132:135]
    ds_read_b128 a[140:143], v241 offset:1024
    v_cvt_pk_bf16_f32 v214, v204, v205
    v_mfma_f32_16x16x32_bf16 v[136:139], a[200:203], v[208:211], v[136:139]
    v_exp_f32 v206, v206
    v_mfma_f32_16x16x32_bf16 v[140:143], a[204:207], v[208:211], v[140:143]
    v_exp_f32 v207, v207
    v_mfma_f32_16x16x32_bf16 v[144:147], a[208:211], v[208:211], v[144:147]
    ds_read_b128 a[144:147], v240 offset:4096
    v_cvt_pk_bf16_f32 v215, v206, v207
    v_mfma_f32_16x16x32_bf16 v[148:151], a[212:215], v[208:211], v[148:151]
    buffer_load_dwordx4 v248, s[8:11], s30 offen offset:128 sc1 nt lds
    v_mfma_f32_16x16x32_bf16 v[152:155], a[216:219], v[208:211], v[152:155]
    s_addk_i32 m0, 31872
    v_exp_f32 v192, v192
    v_mfma_f32_16x16x32_bf16 v[156:159], a[220:223], v[208:211], v[156:159]
    v_exp_f32 v193, v193
    v_mfma_f32_16x16x32_bf16 v[200:203], a[96:99], a[16:19], v[220:223]
    ds_read_b128 a[148:151], v241 offset:4096
    v_cvt_pk_bf16_f32 v192, v192, v193
    v_mfma_f32_16x16x32_bf16 v[200:203], a[100:103], a[20:23], v[200:203]
    v_exp_f32 v194, v194
    v_mfma_f32_16x16x32_bf16 v[200:203], a[104:107], a[24:27], v[200:203]
    v_exp_f32 v195, v195
    v_mfma_f32_16x16x32_bf16 v[200:203], a[108:111], a[28:31], v[200:203]
    ds_read_b128 a[152:155], v240 offset:5120
    v_cvt_pk_bf16_f32 v193, v194, v195
    v_mfma_f32_16x16x32_bf16 v[204:207], a[124:127], a[28:31], v[220:223]
    v_exp_f32 v196, v196
    v_mfma_f32_16x16x32_bf16 v[204:207], a[120:123], a[24:27], v[204:207]
    v_exp_f32 v197, v197
    v_mfma_f32_16x16x32_bf16 v[204:207], a[116:119], a[20:23], v[204:207]
    ds_read_b128 a[156:159], v241 offset:5120
    v_cvt_pk_bf16_f32 v194, v196, v197
    v_mfma_f32_16x16x32_bf16 v[204:207], a[112:115], a[16:19], v[204:207]
    v_exp_f32 v198, v198
    v_smfmac_f32_16x16x64_bf16 a[232:235], a[244:247], v[208:215], v253
    v_mfma_f32_16x16x32_bf16 v[160:163], a[192:195], v[212:215], v[160:163]
    v_exp_f32 v199, v199
    v_mfma_f32_16x16x32_bf16 v[164:167], a[196:199], v[212:215], v[164:167]
    ds_read_b64_tr_b16 a[192:193], v242 offset:0
    v_cvt_pk_bf16_f32 v195, v198, v199
    v_mfma_f32_16x16x32_bf16 v[168:171], a[200:203], v[212:215], v[168:171]
    v_exp_f32 v200, v200
    v_mfma_f32_16x16x32_bf16 v[172:175], a[204:207], v[212:215], v[172:175]
    v_exp_f32 v201, v201
    v_mfma_f32_16x16x32_bf16 v[176:179], a[208:211], v[212:215], v[176:179]
    ds_read_b64_tr_b16 a[194:195], v242 offset:4096
    v_cvt_pk_bf16_f32 v196, v200, v201
    v_mfma_f32_16x16x32_bf16 v[180:183], a[212:215], v[212:215], v[180:183]
    v_exp_f32 v202, v202
    v_mfma_f32_16x16x32_bf16 v[184:187], a[216:219], v[212:215], v[184:187]
    v_exp_f32 v203, v203
    v_mfma_f32_16x16x32_bf16 v[188:191], a[220:223], v[212:215], v[188:191]
    ds_read_b64_tr_b16 a[196:197], v243 offset:0
    v_cvt_pk_bf16_f32 v197, v202, v203
    v_mfma_f32_16x16x32_bf16 v[208:211], a[96:99], a[32:35], v[224:227]
    v_exp_f32 v204, v204
    v_mfma_f32_16x16x32_bf16 v[208:211], a[100:103], a[36:39], v[208:211]
    v_exp_f32 v205, v205
    v_mfma_f32_16x16x32_bf16 v[208:211], a[104:107], a[40:43], v[208:211]
    ds_read_b64_tr_b16 a[198:199], v243 offset:4096
    v_cvt_pk_bf16_f32 v198, v204, v205
    v_mfma_f32_16x16x32_bf16 v[208:211], a[108:111], a[44:47], v[208:211]
    v_exp_f32 v206, v206
    v_mfma_f32_16x16x32_bf16 v[212:215], a[124:127], a[44:47], v[224:227]
    v_exp_f32 v207, v207
    v_mfma_f32_16x16x32_bf16 v[212:215], a[120:123], a[40:43], v[212:215]
    v_cvt_pk_bf16_f32 v199, v206, v207
    v_mfma_f32_16x16x32_bf16 v[212:215], a[116:119], a[36:39], v[212:215]
    ds_read_b64_tr_b16 a[200:201], v244 offset:0
    v_mfma_f32_16x16x32_bf16 v[212:215], a[112:115], a[32:35], v[212:215]
    v_mfma_f32_16x16x32_bf16 v[0:3], a[160:163], v[192:195], v[0:3]
    buffer_load_dwordx4 v248, s[12:15], s30 offen sc1 nt lds
    v_mfma_f32_16x16x32_bf16 v[4:7], a[164:167], v[192:195], v[4:7]
    s_addk_i32 m0, 896
    v_mfma_f32_16x16x32_bf16 v[8:11], a[168:171], v[192:195], v[8:11]
    ds_read_b64_tr_b16 a[202:203], v244 offset:4096
    v_mfma_f32_16x16x32_bf16 v[12:15], a[172:175], v[192:195], v[12:15]
    v_mul_f32 v208, s44, v208
    v_mul_f32 v209, s44, v209
    v_mfma_f32_16x16x32_bf16 v[16:19], a[176:179], v[192:195], v[16:19]
    v_exp_f32 v208, v208
    v_mfma_f32_16x16x32_bf16 v[20:23], a[180:183], v[192:195], v[20:23]
    v_exp_f32 v209, v209
    v_mfma_f32_16x16x32_bf16 v[24:27], a[184:187], v[192:195], v[24:27]
    v_mul_f32 v210, s44, v210
    v_mul_f32 v211, s44, v211
    v_mfma_f32_16x16x32_bf16 v[28:31], a[188:191], v[192:195], v[28:31]
    ds_read_b64_tr_b16 a[204:205], v245 offset:0
    v_cvt_pk_bf16_f32 v208, v208, v209
    v_mfma_f32_16x16x32_bf16 v[200:203], a[96:99], a[48:51], v[228:231]
    v_exp_f32 v210, v210
    v_mfma_f32_16x16x32_bf16 v[200:203], a[100:103], a[52:55], v[200:203]
    v_exp_f32 v211, v211
    v_mfma_f32_16x16x32_bf16 v[200:203], a[104:107], a[56:59], v[200:203]
    v_mul_f32 v212, s44, v212
    v_mul_f32 v213, s44, v213
    v_mfma_f32_16x16x32_bf16 v[200:203], a[108:111], a[60:63], v[200:203]
    ds_read_b64_tr_b16 a[206:207], v245 offset:4096
    v_cvt_pk_bf16_f32 v209, v210, v211
    v_mfma_f32_16x16x32_bf16 v[204:207], a[124:127], a[60:63], v[228:231]
    v_exp_f32 v212, v212
    v_mfma_f32_16x16x32_bf16 v[204:207], a[120:123], a[56:59], v[204:207]
    v_exp_f32 v213, v213
    v_mfma_f32_16x16x32_bf16 v[204:207], a[116:119], a[52:55], v[204:207]
    v_mul_f32 v214, s44, v214
    v_mul_f32 v215, s44, v215
    v_mfma_f32_16x16x32_bf16 v[204:207], a[112:115], a[48:51], v[204:207]
    v_exp_f32 v214, v214
    v_smfmac_f32_16x16x64_bf16 a[224:227], a[244:247], v[192:199], v253
    v_cvt_pk_bf16_f32 v210, v212, v213
    v_mfma_f32_16x16x32_bf16 v[32:35], a[160:163], v[196:199], v[32:35]
    buffer_load_dwordx4 v248, s[12:15], s30 offen offset:128 sc1 nt lds
    v_mfma_f32_16x16x32_bf16 v[36:39], a[164:167], v[196:199], v[36:39]
    s_add_u32 m0, s28, 10240
    v_exp_f32 v215, v215
    v_mfma_f32_16x16x32_bf16 v[40:43], a[168:171], v[196:199], v[40:43]
    s_add_u32 s30, s22, 10240
    ds_read_b64_tr_b16 a[208:209], v242 offset:1024
    v_cvt_pk_bf16_f32 v211, v214, v215
    v_mfma_f32_16x16x32_bf16 v[44:47], a[172:175], v[196:199], v[44:47]
    buffer_load_dwordx4 v248, s[4:7], s30 offen sc1 nt lds
    v_mfma_f32_16x16x32_bf16 v[48:51], a[176:179], v[196:199], v[48:51]
    s_addk_i32 m0, 896
    v_exp_f32 v200, v200
    v_mfma_f32_16x16x32_bf16 v[52:55], a[180:183], v[196:199], v[52:55]
    v_exp_f32 v201, v201
    v_mfma_f32_16x16x32_bf16 v[56:59], a[184:187], v[196:199], v[56:59]
    ds_read_b64_tr_b16 a[210:211], v242 offset:5120
    v_cvt_pk_bf16_f32 v212, v200, v201
    v_mfma_f32_16x16x32_bf16 v[60:63], a[188:191], v[196:199], v[60:63]
    v_exp_f32 v202, v202
    v_mfma_f32_16x16x32_bf16 v[192:195], a[96:99], a[64:67], v[232:235]
    v_exp_f32 v203, v203
    v_mfma_f32_16x16x32_bf16 v[192:195], a[100:103], a[68:71], v[192:195]
    ds_read_b64_tr_b16 a[212:213], v243 offset:1024
    v_cvt_pk_bf16_f32 v213, v202, v203
    v_mfma_f32_16x16x32_bf16 v[192:195], a[104:107], a[72:75], v[192:195]
    v_exp_f32 v204, v204
    v_mfma_f32_16x16x32_bf16 v[192:195], a[108:111], a[76:79], v[192:195]
    v_exp_f32 v205, v205
    v_mfma_f32_16x16x32_bf16 v[196:199], a[124:127], a[76:79], v[232:235]
    ds_read_b64_tr_b16 a[214:215], v243 offset:5120
    v_cvt_pk_bf16_f32 v214, v204, v205
    v_mfma_f32_16x16x32_bf16 v[196:199], a[120:123], a[72:75], v[196:199]
    buffer_load_dwordx4 v248, s[4:7], s30 offen offset:128 sc1 nt lds
    v_mfma_f32_16x16x32_bf16 v[196:199], a[116:119], a[68:71], v[196:199]
    s_mov_b32 m0, s27
    v_exp_f32 v206, v206
    v_mfma_f32_16x16x32_bf16 v[196:199], a[112:115], a[64:67], v[196:199]
    s_add_u32 s30, s24, 98304
    v_exp_f32 v207, v207
    v_mfma_f32_16x16x32_bf16 v[64:67], a[160:163], v[208:211], v[64:67]
    ds_read_b64_tr_b16 a[216:217], v244 offset:1024
    v_cvt_pk_bf16_f32 v215, v206, v207
    v_mfma_f32_16x16x32_bf16 v[68:71], a[164:167], v[208:211], v[68:71]
    v_mfma_f32_16x16x32_bf16 v[72:75], a[168:171], v[208:211], v[72:75]
    v_mfma_f32_16x16x32_bf16 v[76:79], a[172:175], v[208:211], v[76:79]
    v_mul_f32 v192, s44, v192
    v_mul_f32 v193, s44, v193
    v_mfma_f32_16x16x32_bf16 v[80:83], a[176:179], v[208:211], v[80:83]
    v_exp_f32 v192, v192
    v_mfma_f32_16x16x32_bf16 v[84:87], a[180:183], v[208:211], v[84:87]
    ds_read_b64_tr_b16 a[218:219], v244 offset:5120
    v_mul_f32 v194, s44, v194
    v_mfma_f32_16x16x32_bf16 v[88:91], a[184:187], v[208:211], v[88:91]
    v_exp_f32 v193, v193
    v_mfma_f32_16x16x32_bf16 v[92:95], a[188:191], v[208:211], v[92:95]
    v_exp_f32 v194, v194
    v_mfma_f32_16x16x32_bf16 v[200:203], a[96:99], a[80:83], v[236:239]
    v_mul_f32 v195, s44, v195
    v_cvt_pk_bf16_f32 v192, v192, v193
    v_mfma_f32_16x16x32_bf16 v[200:203], a[100:103], a[84:87], v[200:203]
    ds_read_b64_tr_b16 a[220:221], v245 offset:1024
    v_mul_f32 v196, s44, v196
    v_mfma_f32_16x16x32_bf16 v[200:203], a[104:107], a[88:91], v[200:203]
    v_exp_f32 v195, v195
    v_mfma_f32_16x16x32_bf16 v[200:203], a[108:111], a[92:95], v[200:203]
    v_exp_f32 v196, v196
    v_mfma_f32_16x16x32_bf16 v[204:207], a[124:127], a[92:95], v[236:239]
    v_mul_f32 v197, s44, v197
    v_cvt_pk_bf16_f32 v193, v194, v195
    v_mfma_f32_16x16x32_bf16 v[204:207], a[120:123], a[88:91], v[204:207]
    ds_read_b64_tr_b16 a[222:223], v245 offset:5120
    v_mul_f32 v198, s44, v198
    v_mfma_f32_16x16x32_bf16 v[204:207], a[116:119], a[84:87], v[204:207]
    v_exp_f32 v197, v197
    v_mfma_f32_16x16x32_bf16 v[204:207], a[112:115], a[80:83], v[204:207]
    v_exp_f32 v198, v198
    v_smfmac_f32_16x16x64_bf16 a[228:231], a[244:247], v[208:215], v253
    v_mul_f32 v199, s44, v199
    v_mfma_f32_16x16x32_bf16 v[96:99], a[160:163], v[212:215], v[96:99]
    v_exp_f32 v199, v199
    v_mfma_f32_16x16x32_bf16 v[100:103], a[164:167], v[212:215], v[100:103]
    v_cvt_pk_bf16_f32 v194, v196, v197
    v_cvt_pk_bf16_f32 v195, v198, v199
    v_mfma_f32_16x16x32_bf16 v[104:107], a[168:171], v[212:215], v[104:107]
    v_mul_f32 v200, s44, v200
    v_mul_f32 v201, s44, v201
    v_mfma_f32_16x16x32_bf16 v[108:111], a[172:175], v[212:215], v[108:111]
    v_exp_f32 v200, v200
    v_mfma_f32_16x16x32_bf16 v[112:115], a[176:179], v[212:215], v[112:115]
    v_exp_f32 v201, v201
    v_mfma_f32_16x16x32_bf16 v[116:119], a[180:183], v[212:215], v[116:119]
    v_mul_f32 v202, s44, v202
    v_mul_f32 v203, s44, v203
    v_mfma_f32_16x16x32_bf16 v[120:123], a[184:187], v[212:215], v[120:123]
    v_exp_f32 v202, v202
    v_mfma_f32_16x16x32_bf16 v[124:127], a[188:191], v[212:215], v[124:127]
    s_waitcnt lgkmcnt(0)
    v_cvt_pk_bf16_f32 v196, v200, v201
    v_mul_f32 v204, s44, v204
    v_mfma_f32_16x16x32_bf16 v[208:211], a[128:131], a[0:3], v[216:219]
    s_waitcnt vmcnt(14)
    v_exp_f32 v203, v203
    v_mfma_f32_16x16x32_bf16 v[208:211], a[132:135], a[4:7], v[208:211]
    s_barrier
    v_mul_f32 v205, s44, v205
    v_mfma_f32_16x16x32_bf16 v[208:211], a[136:139], a[8:11], v[208:211]
    ds_read_b128 a[96:99], v240 offset:8192
    v_cvt_pk_bf16_f32 v197, v202, v203
    v_mfma_f32_16x16x32_bf16 v[208:211], a[140:143], a[12:15], v[208:211]
    buffer_load_dwordx4 v248, s[8:11], s30 offen sc1 nt lds
    v_mfma_f32_16x16x32_bf16 v[212:215], a[156:159], a[12:15], v[216:219]
    s_addk_i32 m0, 896
    ds_read_b128 a[100:103], v241 offset:8192
    v_mul_f32 v206, s44, v206
    v_mfma_f32_16x16x32_bf16 v[212:215], a[152:155], a[8:11], v[212:215]
    v_exp_f32 v204, v204
    v_mfma_f32_16x16x32_bf16 v[212:215], a[148:151], a[4:7], v[212:215]
    ds_read_b128 a[104:107], v240 offset:9216
    v_mul_f32 v207, s44, v207
    v_mfma_f32_16x16x32_bf16 v[212:215], a[144:147], a[0:3], v[212:215]
L_pad3:
    s_cbranch_execz L_pad7
    v_exp_f32 v205, v205
    v_mfma_f32_16x16x32_bf16 v[128:131], a[160:163], v[192:195], v[128:131]
    ds_read_b128 a[108:111], v241 offset:9216
    v_cvt_pk_bf16_f32 v198, v204, v205
    v_mfma_f32_16x16x32_bf16 v[132:135], a[164:167], v[192:195], v[132:135]
    v_exp_f32 v206, v206
    v_mfma_f32_16x16x32_bf16 v[136:139], a[168:171], v[192:195], v[136:139]
    v_exp_f32 v207, v207
    v_mfma_f32_16x16x32_bf16 v[140:143], a[172:175], v[192:195], v[140:143]
    ds_read_b128 a[112:115], v240 offset:12288
    v_cvt_pk_bf16_f32 v199, v206, v207
    v_mfma_f32_16x16x32_bf16 v[144:147], a[176:179], v[192:195], v[144:147]
    buffer_load_dwordx4 v248, s[8:11], s30 offen offset:128 sc1 nt lds
    v_mfma_f32_16x16x32_bf16 v[148:151], a[180:183], v[192:195], v[148:151]
    s_addk_i32 m0, 31872
    v_exp_f32 v208, v208
    v_mfma_f32_16x16x32_bf16 v[152:155], a[184:187], v[192:195], v[152:155]
    v_exp_f32 v209, v209
    v_mfma_f32_16x16x32_bf16 v[156:159], a[188:191], v[192:195], v[156:159]
    ds_read_b128 a[116:119], v241 offset:12288
    v_cvt_pk_bf16_f32 v208, v208, v209
    v_mfma_f32_16x16x32_bf16 v[200:203], a[128:131], a[16:19], v[220:223]
    v_exp_f32 v210, v210
    v_mfma_f32_16x16x32_bf16 v[200:203], a[132:135], a[20:23], v[200:203]
    v_exp_f32 v211, v211
    v_mfma_f32_16x16x32_bf16 v[200:203], a[136:139], a[24:27], v[200:203]
    ds_read_b128 a[120:123], v240 offset:13312
    v_cvt_pk_bf16_f32 v209, v210, v211
    v_mfma_f32_16x16x32_bf16 v[200:203], a[140:143], a[28:31], v[200:203]
    v_exp_f32 v212, v212
    v_mfma_f32_16x16x32_bf16 v[204:207], a[156:159], a[28:31], v[220:223]
    v_exp_f32 v213, v213
    v_mfma_f32_16x16x32_bf16 v[204:207], a[152:155], a[24:27], v[204:207]
    ds_read_b128 a[124:127], v241 offset:13312
    v_cvt_pk_bf16_f32 v210, v212, v213
    v_mfma_f32_16x16x32_bf16 v[204:207], a[148:151], a[20:23], v[204:207]
    v_exp_f32 v214, v214
    v_mfma_f32_16x16x32_bf16 v[204:207], a[144:147], a[16:19], v[204:207]
    v_exp_f32 v215, v215
    v_smfmac_f32_16x16x64_bf16 a[232:235], a[244:247], v[192:199], v253
    v_cvt_pk_bf16_f32 v211, v214, v215
    v_mfma_f32_16x16x32_bf16 v[160:163], a[160:163], v[196:199], v[160:163]
    ds_read_b64_tr_b16 a[160:161], v242 offset:8192
    v_mfma_f32_16x16x32_bf16 v[164:167], a[164:167], v[196:199], v[164:167]
    ds_read_b64_tr_b16 a[162:163], v242 offset:12288
    v_mfma_f32_16x16x32_bf16 v[168:171], a[168:171], v[196:199], v[168:171]
    v_exp_f32 v200, v200
    v_mfma_f32_16x16x32_bf16 v[172:175], a[172:175], v[196:199], v[172:175]
    v_exp_f32 v201, v201
    v_mfma_f32_16x16x32_bf16 v[176:179], a[176:179], v[196:199], v[176:179]
    v_exp_f32 v202, v202
    v_mfma_f32_16x16x32_bf16 v[180:183], a[180:183], v[196:199], v[180:183]
    ds_read_b64_tr_b16 a[164:165], v243 offset:8192
    v_cvt_pk_bf16_f32 v212, v200, v201
    v_mfma_f32_16x16x32_bf16 v[184:187], a[184:187], v[196:199], v[184:187]
    v_exp_f32 v203, v203
    v_mfma_f32_16x16x32_bf16 v[188:191], a[188:191], v[196:199], v[188:191]
    v_exp_f32 v204, v204
    v_mfma_f32_16x16x32_bf16 v[192:195], a[128:131], a[32:35], v[224:227]
    v_exp_f32 v205, v205
    v_mfma_f32_16x16x32_bf16 v[192:195], a[132:135], a[36:39], v[192:195]
    v_cvt_pk_bf16_f32 v213, v202, v203
    v_cvt_pk_bf16_f32 v214, v204, v205
    v_mfma_f32_16x16x32_bf16 v[192:195], a[136:139], a[40:43], v[192:195]
    v_exp_f32 v206, v206
    v_mfma_f32_16x16x32_bf16 v[192:195], a[140:143], a[44:47], v[192:195]
    v_exp_f32 v207, v207
    v_mfma_f32_16x16x32_bf16 v[196:199], a[156:159], a[44:47], v[224:227]
    ds_read_b64_tr_b16 a[166:167], v243 offset:12288
    v_cvt_pk_bf16_f32 v215, v206, v207
    v_mfma_f32_16x16x32_bf16 v[196:199], a[152:155], a[40:43], v[196:199]
    v_mfma_f32_16x16x32_bf16 v[196:199], a[148:151], a[36:39], v[196:199]
    ds_read_b64_tr_b16 a[168:169], v244 offset:8192
    v_mfma_f32_16x16x32_bf16 v[196:199], a[144:147], a[32:35], v[196:199]
    v_mfma_f32_16x16x32_bf16 v[0:3], a[192:195], v[208:211], v[0:3]
    buffer_load_dwordx4 v248, s[12:15], s30 offen sc1 nt lds
    v_mfma_f32_16x16x32_bf16 v[4:7], a[196:199], v[208:211], v[4:7]
    s_addk_i32 m0, 896
    v_mfma_f32_16x16x32_bf16 v[8:11], a[200:203], v[208:211], v[8:11]
    ds_read_b64_tr_b16 a[170:171], v244 offset:12288
    v_mfma_f32_16x16x32_bf16 v[12:15], a[204:207], v[208:211], v[12:15]
    v_mul_f32 v192, s44, v192
    v_mul_f32 v193, s44, v193
    v_mfma_f32_16x16x32_bf16 v[16:19], a[208:211], v[208:211], v[16:19]
    v_exp_f32 v192, v192
    v_mfma_f32_16x16x32_bf16 v[20:23], a[212:215], v[208:211], v[20:23]
    v_exp_f32 v193, v193
    v_mfma_f32_16x16x32_bf16 v[24:27], a[216:219], v[208:211], v[24:27]
    v_mul_f32 v194, s44, v194
    v_mul_f32 v195, s44, v195
    v_mfma_f32_16x16x32_bf16 v[28:31], a[220:223], v[208:211], v[28:31]
    ds_read_b64_tr_b16 a[172:173], v245 offset:8192
    v_cvt_pk_bf16_f32 v192, v192, v193
    v_mfma_f32_16x16x32_bf16 v[200:203], a[128:131], a[48:51], v[228:231]
    v_exp_f32 v194, v194
    v_mfma_f32_16x16x32_bf16 v[200:203], a[132:135], a[52:55], v[200:203]
    v_exp_f32 v195, v195
    v_mfma_f32_16x16x32_bf16 v[200:203], a[136:139], a[56:59], v[200:203]
    v_mul_f32 v196, s44, v196
    v_mul_f32 v197, s44, v197
    v_mfma_f32_16x16x32_bf16 v[200:203], a[140:143], a[60:63], v[200:203]
    ds_read_b64_tr_b16 a[174:175], v245 offset:12288
    v_cvt_pk_bf16_f32 v193, v194, v195
    v_mfma_f32_16x16x32_bf16 v[204:207], a[156:159], a[60:63], v[228:231]
    buffer_load_dwordx4 v248, s[12:15], s30 offen offset:128 sc1 nt lds
    v_mfma_f32_16x16x32_bf16 v[204:207], a[152:155], a[56:59], v[204:207]
    s_add_u32 m0, s28, 12288
    v_exp_f32 v196, v196
    v_mfma_f32_16x16x32_bf16 v[204:207], a[148:151], a[52:55], v[204:207]
    s_add_u32 s30, s22, 12288
    v_exp_f32 v197, v197
    v_mfma_f32_16x16x32_bf16 v[204:207], a[144:147], a[48:51], v[204:207]
    buffer_load_dwordx4 v248, s[4:7], s30 offen sc1 nt lds
    v_smfmac_f32_16x16x64_bf16 a[224:227], a[244:247], v[208:215], v253
    s_addk_i32 m0, 896
    v_mul_f32 v198, s44, v198
    v_mfma_f32_16x16x32_bf16 v[32:35], a[192:195], v[212:215], v[32:35]
    v_exp_f32 v198, v198
    v_mfma_f32_16x16x32_bf16 v[36:39], a[196:199], v[212:215], v[36:39]
    v_mul_f32 v199, s44, v199
    v_cvt_pk_bf16_f32 v194, v196, v197
    v_mfma_f32_16x16x32_bf16 v[40:43], a[200:203], v[212:215], v[40:43]
    v_exp_f32 v199, v199
    v_mfma_f32_16x16x32_bf16 v[44:47], a[204:207], v[212:215], v[44:47]
    ds_read_b64_tr_b16 a[176:177], v242 offset:9216
    v_cvt_pk_bf16_f32 v195, v198, v199
    v_mfma_f32_16x16x32_bf16 v[48:51], a[208:211], v[212:215], v[48:51]
    v_exp_f32 v200, v200
    v_mfma_f32_16x16x32_bf16 v[52:55], a[212:215], v[212:215], v[52:55]
    v_exp_f32 v201, v201
    v_mfma_f32_16x16x32_bf16 v[56:59], a[216:219], v[212:215], v[56:59]
    ds_read_b64_tr_b16 a[178:179], v242 offset:13312
    v_cvt_pk_bf16_f32 v196, v200, v201
    v_mfma_f32_16x16x32_bf16 v[60:63], a[220:223], v[212:215], v[60:63]
    buffer_load_dwordx4 v248, s[4:7], s30 offen offset:128 sc1 nt lds
    v_mfma_f32_16x16x32_bf16 v[208:211], a[128:131], a[64:67], v[232:235]
    s_add_u32 m0, s27, 8192
    v_exp_f32 v202, v202
    v_mfma_f32_16x16x32_bf16 v[208:211], a[132:135], a[68:71], v[208:211]
    s_add_u32 s30, s24, 106496
    v_exp_f32 v203, v203
    v_mfma_f32_16x16x32_bf16 v[208:211], a[136:139], a[72:75], v[208:211]
    ds_read_b64_tr_b16 a[180:181], v243 offset:9216
    v_cvt_pk_bf16_f32 v197, v202, v203
    v_mfma_f32_16x16x32_bf16 v[208:211], a[140:143], a[76:79], v[208:211]
    v_exp_f32 v204, v204
    v_mfma_f32_16x16x32_bf16 v[212:215], a[156:159], a[76:79], v[232:235]
    v_exp_f32 v205, v205
    v_mfma_f32_16x16x32_bf16 v[212:215], a[152:155], a[72:75], v[212:215]
    ds_read_b64_tr_b16 a[182:183], v243 offset:13312
    v_cvt_pk_bf16_f32 v198, v204, v205
    v_mfma_f32_16x16x32_bf16 v[212:215], a[148:151], a[68:71], v[212:215]
    v_exp_f32 v206, v206
    v_mfma_f32_16x16x32_bf16 v[212:215], a[144:147], a[64:67], v[212:215]
    v_exp_f32 v207, v207
    v_mfma_f32_16x16x32_bf16 v[64:67], a[192:195], v[192:195], v[64:67]
    ds_read_b64_tr_b16 a[184:185], v244 offset:9216
    v_cvt_pk_bf16_f32 v199, v206, v207
    v_mfma_f32_16x16x32_bf16 v[68:71], a[196:199], v[192:195], v[68:71]
    v_mfma_f32_16x16x32_bf16 v[72:75], a[200:203], v[192:195], v[72:75]
    v_mfma_f32_16x16x32_bf16 v[76:79], a[204:207], v[192:195], v[76:79]
    v_mul_f32 v208, s44, v208
    v_mul_f32 v209, s44, v209
    v_mfma_f32_16x16x32_bf16 v[80:83], a[208:211], v[192:195], v[80:83]
    v_exp_f32 v208, v208
    v_mfma_f32_16x16x32_bf16 v[84:87], a[212:215], v[192:195], v[84:87]
    ds_read_b64_tr_b16 a[186:187], v244 offset:13312
    v_mul_f32 v210, s44, v210
    v_mfma_f32_16x16x32_bf16 v[88:91], a[216:219], v[192:195], v[88:91]
    v_exp_f32 v209, v209
    v_mfma_f32_16x16x32_bf16 v[92:95], a[220:223], v[192:195], v[92:95]
    v_exp_f32 v210, v210
    v_mfma_f32_16x16x32_bf16 v[200:203], a[128:131], a[80:83], v[236:239]
    v_mul_f32 v211, s44, v211
    v_cvt_pk_bf16_f32 v208, v208, v209
    v_mfma_f32_16x16x32_bf16 v[200:203], a[132:135], a[84:87], v[200:203]
    ds_read_b64_tr_b16 a[188:189], v245 offset:9216
    v_mul_f32 v212, s44, v212
    v_mfma_f32_16x16x32_bf16 v[200:203], a[136:139], a[88:91], v[200:203]
    v_exp_f32 v211, v211
    v_mfma_f32_16x16x32_bf16 v[200:203], a[140:143], a[92:95], v[200:203]
    v_exp_f32 v212, v212
    v_mfma_f32_16x16x32_bf16 v[204:207], a[156:159], a[92:95], v[236:239]
    v_mul_f32 v213, s44, v213
    v_cvt_pk_bf16_f32 v209, v210, v211
    v_mfma_f32_16x16x32_bf16 v[204:207], a[152:155], a[88:91], v[204:207]
    ds_read_b64_tr_b16 a[190:191], v245 offset:13312
    v_mul_f32 v214, s44, v214
    v_mfma_f32_16x16x32_bf16 v[204:207], a[148:151], a[84:87], v[204:207]
    v_exp_f32 v213, v213
    v_mfma_f32_16x16x32_bf16 v[204:207], a[144:147], a[80:83], v[204:207]
    v_exp_f32 v214, v214
    v_smfmac_f32_16x16x64_bf16 a[228:231], a[244:247], v[192:199], v253
    v_mul_f32 v215, s44, v215
    v_mfma_f32_16x16x32_bf16 v[96:99], a[192:195], v[196:199], v[96:99]
    v_exp_f32 v215, v215
    v_mfma_f32_16x16x32_bf16 v[100:103], a[196:199], v[196:199], v[100:103]
    v_cvt_pk_bf16_f32 v210, v212, v213
    v_cvt_pk_bf16_f32 v211, v214, v215
    v_mfma_f32_16x16x32_bf16 v[104:107], a[200:203], v[196:199], v[104:107]
    v_mul_f32 v200, s44, v200
    v_mul_f32 v201, s44, v201
    v_mfma_f32_16x16x32_bf16 v[108:111], a[204:207], v[196:199], v[108:111]
    v_exp_f32 v200, v200
    v_mfma_f32_16x16x32_bf16 v[112:115], a[208:211], v[196:199], v[112:115]
    v_exp_f32 v201, v201
    v_mfma_f32_16x16x32_bf16 v[116:119], a[212:215], v[196:199], v[116:119]
    v_mul_f32 v202, s44, v202
    v_mul_f32 v203, s44, v203
    v_mfma_f32_16x16x32_bf16 v[120:123], a[216:219], v[196:199], v[120:123]
    v_exp_f32 v202, v202
    v_mfma_f32_16x16x32_bf16 v[124:127], a[220:223], v[196:199], v[124:127]
    s_waitcnt lgkmcnt(0)
    v_cvt_pk_bf16_f32 v212, v200, v201
    v_mul_f32 v204, s44, v204
    v_mfma_f32_16x16x32_bf16 v[192:195], a[96:99], a[0:3], v[216:219]
    s_waitcnt vmcnt(14)
    v_exp_f32 v203, v203
    v_mfma_f32_16x16x32_bf16 v[192:195], a[100:103], a[4:7], v[192:195]
    s_barrier
    v_mul_f32 v205, s44, v205
    v_mfma_f32_16x16x32_bf16 v[192:195], a[104:107], a[8:11], v[192:195]
    ds_read_b128 a[128:131], v240 offset:16384
    v_cvt_pk_bf16_f32 v213, v202, v203
    v_mfma_f32_16x16x32_bf16 v[192:195], a[108:111], a[12:15], v[192:195]
    buffer_load_dwordx4 v248, s[8:11], s30 offen sc1 nt lds
    v_mfma_f32_16x16x32_bf16 v[196:199], a[124:127], a[12:15], v[216:219]
    s_addk_i32 m0, 896
    ds_read_b128 a[132:135], v241 offset:16384
    v_mul_f32 v206, s44, v206
    v_mfma_f32_16x16x32_bf16 v[196:199], a[120:123], a[8:11], v[196:199]
    v_exp_f32 v204, v204
    v_mfma_f32_16x16x32_bf16 v[196:199], a[116:119], a[4:7], v[196:199]
    ds_read_b128 a[136:139], v240 offset:17408
    v_mul_f32 v207, s44, v207
    v_mfma_f32_16x16x32_bf16 v[196:199], a[112:115], a[0:3], v[196:199]
    v_exp_f32 v205, v205
    v_mfma_f32_16x16x32_bf16 v[128:131], a[192:195], v[208:211], v[128:131]
    ds_read_b128 a[140:143], v241 offset:17408
    v_cvt_pk_bf16_f32 v214, v204, v205
    v_mfma_f32_16x16x32_bf16 v[132:135], a[196:199], v[208:211], v[132:135]
    v_exp_f32 v206, v206
    v_mfma_f32_16x16x32_bf16 v[136:139], a[200:203], v[208:211], v[136:139]
    v_exp_f32 v207, v207
    v_mfma_f32_16x16x32_bf16 v[140:143], a[204:207], v[208:211], v[140:143]
    ds_read_b128 a[144:147], v240 offset:20480
    v_cvt_pk_bf16_f32 v215, v206, v207
    v_mfma_f32_16x16x32_bf16 v[144:147], a[208:211], v[208:211], v[144:147]
    buffer_load_dwordx4 v248, s[8:11], s30 offen offset:128 sc1 nt lds
    v_mfma_f32_16x16x32_bf16 v[148:151], a[212:215], v[208:211], v[148:151]
    s_add_u32 m0, s28, 14336
    v_exp_f32 v192, v192
    v_mfma_f32_16x16x32_bf16 v[152:155], a[216:219], v[208:211], v[152:155]
    s_add_u32 s30, s22, 14336
    v_exp_f32 v193, v193
    v_mfma_f32_16x16x32_bf16 v[156:159], a[220:223], v[208:211], v[156:159]
    ds_read_b128 a[148:151], v241 offset:20480
    v_cvt_pk_bf16_f32 v192, v192, v193
    v_mfma_f32_16x16x32_bf16 v[200:203], a[96:99], a[16:19], v[220:223]
    v_exp_f32 v194, v194
    v_mfma_f32_16x16x32_bf16 v[200:203], a[100:103], a[20:23], v[200:203]
    v_exp_f32 v195, v195
    v_mfma_f32_16x16x32_bf16 v[200:203], a[104:107], a[24:27], v[200:203]
    ds_read_b128 a[152:155], v240 offset:21504
    v_cvt_pk_bf16_f32 v193, v194, v195
    v_mfma_f32_16x16x32_bf16 v[200:203], a[108:111], a[28:31], v[200:203]
    v_exp_f32 v196, v196
    v_mfma_f32_16x16x32_bf16 v[204:207], a[124:127], a[28:31], v[220:223]
    v_exp_f32 v197, v197
    v_mfma_f32_16x16x32_bf16 v[204:207], a[120:123], a[24:27], v[204:207]
    ds_read_b128 a[156:159], v241 offset:21504
    v_cvt_pk_bf16_f32 v194, v196, v197
    v_mfma_f32_16x16x32_bf16 v[204:207], a[116:119], a[20:23], v[204:207]
    v_exp_f32 v198, v198
    v_mfma_f32_16x16x32_bf16 v[204:207], a[112:115], a[16:19], v[204:207]
    v_exp_f32 v199, v199
    v_smfmac_f32_16x16x64_bf16 a[232:235], a[244:247], v[208:215], v253
    v_cvt_pk_bf16_f32 v195, v198, v199
    v_mfma_f32_16x16x32_bf16 v[160:163], a[192:195], v[212:215], v[160:163]
    ds_read_b64_tr_b16 a[192:193], v242 offset:16384
    v_mfma_f32_16x16x32_bf16 v[164:167], a[196:199], v[212:215], v[164:167]
    ds_read_b64_tr_b16 a[194:195], v242 offset:20480
    v_mfma_f32_16x16x32_bf16 v[168:171], a[200:203], v[212:215], v[168:171]
    v_exp_f32 v200, v200
    v_mfma_f32_16x16x32_bf16 v[172:175], a[204:207], v[212:215], v[172:175]
    v_exp_f32 v201, v201
    v_mfma_f32_16x16x32_bf16 v[176:179], a[208:211], v[212:215], v[176:179]
    v_exp_f32 v202, v202
    v_mfma_f32_16x16x32_bf16 v[180:183], a[212:215], v[212:215], v[180:183]
    ds_read_b64_tr_b16 a[196:197], v243 offset:16384
    v_cvt_pk_bf16_f32 v196, v200, v201
    v_mfma_f32_16x16x32_bf16 v[184:187], a[216:219], v[212:215], v[184:187]
    v_exp_f32 v203, v203
    v_mfma_f32_16x16x32_bf16 v[188:191], a[220:223], v[212:215], v[188:191]
    v_exp_f32 v204, v204
    v_mfma_f32_16x16x32_bf16 v[208:211], a[96:99], a[32:35], v[224:227]
    v_exp_f32 v205, v205
    v_mfma_f32_16x16x32_bf16 v[208:211], a[100:103], a[36:39], v[208:211]
    v_cvt_pk_bf16_f32 v197, v202, v203
    v_cvt_pk_bf16_f32 v198, v204, v205
    v_mfma_f32_16x16x32_bf16 v[208:211], a[104:107], a[40:43], v[208:211]
    v_exp_f32 v206, v206
    v_mfma_f32_16x16x32_bf16 v[208:211], a[108:111], a[44:47], v[208:211]
    v_exp_f32 v207, v207
    v_mfma_f32_16x16x32_bf16 v[212:215], a[124:127], a[44:47], v[224:227]
    ds_read_b64_tr_b16 a[198:199], v243 offset:20480
    v_cvt_pk_bf16_f32 v199, v206, v207
    v_mfma_f32_16x16x32_bf16 v[212:215], a[120:123], a[40:43], v[212:215]
    v_mfma_f32_16x16x32_bf16 v[212:215], a[116:119], a[36:39], v[212:215]
    ds_read_b64_tr_b16 a[200:201], v244 offset:16384
    v_mfma_f32_16x16x32_bf16 v[212:215], a[112:115], a[32:35], v[212:215]
    buffer_load_dwordx4 v248, s[4:7], s30 offen sc1 nt lds
    v_mfma_f32_16x16x32_bf16 v[0:3], a[160:163], v[192:195], v[0:3]
    s_addk_i32 m0, 896
    v_mfma_f32_16x16x32_bf16 v[4:7], a[164:167], v[192:195], v[4:7]
    v_mfma_f32_16x16x32_bf16 v[8:11], a[168:171], v[192:195], v[8:11]
    ds_read_b64_tr_b16 a[202:203], v244 offset:20480
    v_mfma_f32_16x16x32_bf16 v[12:15], a[172:175], v[192:195], v[12:15]
    v_mul_f32 v208, s44, v208
    v_mul_f32 v209, s44, v209
    v_mfma_f32_16x16x32_bf16 v[16:19], a[176:179], v[192:195], v[16:19]
    v_exp_f32 v208, v208
    v_mfma_f32_16x16x32_bf16 v[20:23], a[180:183], v[192:195], v[20:23]
    v_exp_f32 v209, v209
    v_mfma_f32_16x16x32_bf16 v[24:27], a[184:187], v[192:195], v[24:27]
    v_mul_f32 v210, s44, v210
    v_mul_f32 v211, s44, v211
    v_mfma_f32_16x16x32_bf16 v[28:31], a[188:191], v[192:195], v[28:31]
    ds_read_b64_tr_b16 a[204:205], v245 offset:16384
    v_cvt_pk_bf16_f32 v208, v208, v209
    v_mfma_f32_16x16x32_bf16 v[200:203], a[96:99], a[48:51], v[228:231]
    v_exp_f32 v210, v210
    v_mfma_f32_16x16x32_bf16 v[200:203], a[100:103], a[52:55], v[200:203]
    v_exp_f32 v211, v211
    v_mfma_f32_16x16x32_bf16 v[200:203], a[104:107], a[56:59], v[200:203]
    v_mul_f32 v212, s44, v212
    v_mul_f32 v213, s44, v213
    v_mfma_f32_16x16x32_bf16 v[200:203], a[108:111], a[60:63], v[200:203]
    buffer_load_dwordx4 v248, s[4:7], s30 offen offset:128 sc1 nt lds
    v_mfma_f32_16x16x32_bf16 v[204:207], a[124:127], a[60:63], v[228:231]
    s_add_u32 m0, s27, 40960
    ds_read_b64_tr_b16 a[206:207], v245 offset:20480
    v_cvt_pk_bf16_f32 v209, v210, v211
    v_mfma_f32_16x16x32_bf16 v[204:207], a[120:123], a[56:59], v[204:207]
    s_add_u32 s30, s24, 106496
    v_exp_f32 v212, v212
    v_mfma_f32_16x16x32_bf16 v[204:207], a[116:119], a[52:55], v[204:207]
    buffer_load_dwordx4 v248, s[12:15], s30 offen sc1 nt lds
    v_mfma_f32_16x16x32_bf16 v[204:207], a[112:115], a[48:51], v[204:207]
    s_addk_i32 m0, 896
    v_exp_f32 v213, v213
    v_smfmac_f32_16x16x64_bf16 a[224:227], a[244:247], v[192:199], v253
    v_mul_f32 v214, s44, v214
    v_mfma_f32_16x16x32_bf16 v[32:35], a[160:163], v[196:199], v[32:35]
    v_exp_f32 v214, v214
    v_mfma_f32_16x16x32_bf16 v[36:39], a[164:167], v[196:199], v[36:39]
    v_mul_f32 v215, s44, v215
    v_cvt_pk_bf16_f32 v210, v212, v213
    v_mfma_f32_16x16x32_bf16 v[40:43], a[168:171], v[196:199], v[40:43]
    buffer_load_dwordx4 v248, s[12:15], s30 offen offset:128 sc1 nt lds
    v_mfma_f32_16x16x32_bf16 v[44:47], a[172:175], v[196:199], v[44:47]
    s_addk_i32 m0, -25472
    v_exp_f32 v215, v215
    v_mfma_f32_16x16x32_bf16 v[48:51], a[176:179], v[196:199], v[48:51]
    s_addk_i32 s30, 8192
    ds_read_b64_tr_b16 a[208:209], v242 offset:17408
    v_cvt_pk_bf16_f32 v211, v214, v215
    v_mfma_f32_16x16x32_bf16 v[52:55], a[180:183], v[196:199], v[52:55]
    v_exp_f32 v200, v200
    v_mfma_f32_16x16x32_bf16 v[56:59], a[184:187], v[196:199], v[56:59]
    v_exp_f32 v201, v201
    v_mfma_f32_16x16x32_bf16 v[60:63], a[188:191], v[196:199], v[60:63]
    ds_read_b64_tr_b16 a[210:211], v242 offset:21504
    v_cvt_pk_bf16_f32 v212, v200, v201
    v_mfma_f32_16x16x32_bf16 v[192:195], a[96:99], a[64:67], v[232:235]
    v_exp_f32 v202, v202
    v_mfma_f32_16x16x32_bf16 v[192:195], a[100:103], a[68:71], v[192:195]
    v_exp_f32 v203, v203
    v_mfma_f32_16x16x32_bf16 v[192:195], a[104:107], a[72:75], v[192:195]
    ds_read_b64_tr_b16 a[212:213], v243 offset:17408
    v_cvt_pk_bf16_f32 v213, v202, v203
    v_mfma_f32_16x16x32_bf16 v[192:195], a[108:111], a[76:79], v[192:195]
    v_exp_f32 v204, v204
    v_mfma_f32_16x16x32_bf16 v[196:199], a[124:127], a[76:79], v[232:235]
    v_exp_f32 v205, v205
    v_mfma_f32_16x16x32_bf16 v[196:199], a[120:123], a[72:75], v[196:199]
    ds_read_b64_tr_b16 a[214:215], v243 offset:21504
    v_cvt_pk_bf16_f32 v214, v204, v205
    v_mfma_f32_16x16x32_bf16 v[196:199], a[116:119], a[68:71], v[196:199]
    v_exp_f32 v206, v206
    v_mfma_f32_16x16x32_bf16 v[196:199], a[112:115], a[64:67], v[196:199]
    v_exp_f32 v207, v207
    v_mfma_f32_16x16x32_bf16 v[64:67], a[160:163], v[208:211], v[64:67]
    ds_read_b64_tr_b16 a[216:217], v244 offset:17408
    v_cvt_pk_bf16_f32 v215, v206, v207
    v_mfma_f32_16x16x32_bf16 v[68:71], a[164:167], v[208:211], v[68:71]
    v_mfma_f32_16x16x32_bf16 v[72:75], a[168:171], v[208:211], v[72:75]
    v_mfma_f32_16x16x32_bf16 v[76:79], a[172:175], v[208:211], v[76:79]
    v_mul_f32 v192, s44, v192
    v_mul_f32 v193, s44, v193
    v_mfma_f32_16x16x32_bf16 v[80:83], a[176:179], v[208:211], v[80:83]
    v_exp_f32 v192, v192
    v_mfma_f32_16x16x32_bf16 v[84:87], a[180:183], v[208:211], v[84:87]
    ds_read_b64_tr_b16 a[218:219], v244 offset:21504
    v_mul_f32 v194, s44, v194
    v_mfma_f32_16x16x32_bf16 v[88:91], a[184:187], v[208:211], v[88:91]
    v_exp_f32 v193, v193
    v_mfma_f32_16x16x32_bf16 v[92:95], a[188:191], v[208:211], v[92:95]
    v_exp_f32 v194, v194
    v_mfma_f32_16x16x32_bf16 v[200:203], a[96:99], a[80:83], v[236:239]
    v_mul_f32 v195, s44, v195
    v_cvt_pk_bf16_f32 v192, v192, v193
    v_mfma_f32_16x16x32_bf16 v[200:203], a[100:103], a[84:87], v[200:203]
    ds_read_b64_tr_b16 a[220:221], v245 offset:17408
    v_mul_f32 v196, s44, v196
    v_mfma_f32_16x16x32_bf16 v[200:203], a[104:107], a[88:91], v[200:203]
    v_exp_f32 v195, v195
    v_mfma_f32_16x16x32_bf16 v[200:203], a[108:111], a[92:95], v[200:203]
    v_exp_f32 v196, v196
    v_mfma_f32_16x16x32_bf16 v[204:207], a[124:127], a[92:95], v[236:239]
    v_mul_f32 v197, s44, v197
    v_cvt_pk_bf16_f32 v193, v194, v195
    v_mfma_f32_16x16x32_bf16 v[204:207], a[120:123], a[88:91], v[204:207]
    ds_read_b64_tr_b16 a[222:223], v245 offset:21504
    v_mul_f32 v198, s44, v198
    v_mfma_f32_16x16x32_bf16 v[204:207], a[116:119], a[84:87], v[204:207]
    v_exp_f32 v197, v197
    v_mfma_f32_16x16x32_bf16 v[204:207], a[112:115], a[80:83], v[204:207]
    v_exp_f32 v198, v198
    v_smfmac_f32_16x16x64_bf16 a[228:231], a[244:247], v[208:215], v253
    v_mul_f32 v199, s44, v199
    v_mfma_f32_16x16x32_bf16 v[96:99], a[160:163], v[212:215], v[96:99]
    v_exp_f32 v199, v199
    v_mfma_f32_16x16x32_bf16 v[100:103], a[164:167], v[212:215], v[100:103]
    v_cvt_pk_bf16_f32 v194, v196, v197
    v_cvt_pk_bf16_f32 v195, v198, v199
    v_mfma_f32_16x16x32_bf16 v[104:107], a[168:171], v[212:215], v[104:107]
    v_mul_f32 v200, s44, v200
    v_mul_f32 v201, s44, v201
    v_mfma_f32_16x16x32_bf16 v[108:111], a[172:175], v[212:215], v[108:111]
    v_exp_f32 v200, v200
    v_mfma_f32_16x16x32_bf16 v[112:115], a[176:179], v[212:215], v[112:115]
    v_exp_f32 v201, v201
    v_mfma_f32_16x16x32_bf16 v[116:119], a[180:183], v[212:215], v[116:119]
    v_mul_f32 v202, s44, v202
    v_mul_f32 v203, s44, v203
    v_mfma_f32_16x16x32_bf16 v[120:123], a[184:187], v[212:215], v[120:123]
    v_exp_f32 v202, v202
    v_mfma_f32_16x16x32_bf16 v[124:127], a[188:191], v[212:215], v[124:127]
    s_waitcnt lgkmcnt(0)
    v_cvt_pk_bf16_f32 v196, v200, v201
    v_mul_f32 v204, s44, v204
    v_mfma_f32_16x16x32_bf16 v[208:211], a[128:131], a[0:3], v[216:219]
    s_waitcnt vmcnt(14)
    v_exp_f32 v203, v203
    v_mfma_f32_16x16x32_bf16 v[208:211], a[132:135], a[4:7], v[208:211]
    s_barrier
    v_mul_f32 v205, s44, v205
    v_mfma_f32_16x16x32_bf16 v[208:211], a[136:139], a[8:11], v[208:211]
    ds_read_b128 a[96:99], v240 offset:24576
    v_cvt_pk_bf16_f32 v197, v202, v203
    v_mfma_f32_16x16x32_bf16 v[208:211], a[140:143], a[12:15], v[208:211]
    buffer_load_dwordx4 v248, s[8:11], s30 offen sc1 nt lds
    v_mfma_f32_16x16x32_bf16 v[212:215], a[156:159], a[12:15], v[216:219]
    s_addk_i32 m0, 896
    ds_read_b128 a[100:103], v241 offset:24576
    v_mul_f32 v206, s44, v206
    v_mfma_f32_16x16x32_bf16 v[212:215], a[152:155], a[8:11], v[212:215]
    v_exp_f32 v204, v204
    v_mfma_f32_16x16x32_bf16 v[212:215], a[148:151], a[4:7], v[212:215]
    ds_read_b128 a[104:107], v240 offset:25600
    v_mul_f32 v207, s44, v207
    v_mfma_f32_16x16x32_bf16 v[212:215], a[144:147], a[0:3], v[212:215]
    v_exp_f32 v205, v205
    v_mfma_f32_16x16x32_bf16 v[128:131], a[160:163], v[192:195], v[128:131]
    ds_read_b128 a[108:111], v241 offset:25600
    v_cvt_pk_bf16_f32 v198, v204, v205
    v_mfma_f32_16x16x32_bf16 v[132:135], a[164:167], v[192:195], v[132:135]
    v_exp_f32 v206, v206
    v_mfma_f32_16x16x32_bf16 v[136:139], a[168:171], v[192:195], v[136:139]
    v_exp_f32 v207, v207
    v_mfma_f32_16x16x32_bf16 v[140:143], a[172:175], v[192:195], v[140:143]
    ds_read_b128 a[112:115], v240 offset:28672
    v_cvt_pk_bf16_f32 v199, v206, v207
    v_mfma_f32_16x16x32_bf16 v[144:147], a[176:179], v[192:195], v[144:147]
    buffer_load_dwordx4 v248, s[8:11], s30 offen offset:128 sc1 nt lds
    v_mfma_f32_16x16x32_bf16 v[148:151], a[180:183], v[192:195], v[148:151]
    s_add_u32 m0, s28, 16384
    v_exp_f32 v208, v208
    v_mfma_f32_16x16x32_bf16 v[152:155], a[184:187], v[192:195], v[152:155]
    s_add_u32 s30, s22, 16384
    v_exp_f32 v209, v209
    v_mfma_f32_16x16x32_bf16 v[156:159], a[188:191], v[192:195], v[156:159]
    ds_read_b128 a[116:119], v241 offset:28672
    v_cvt_pk_bf16_f32 v208, v208, v209
    v_mfma_f32_16x16x32_bf16 v[200:203], a[128:131], a[16:19], v[220:223]
    v_exp_f32 v210, v210
    v_mfma_f32_16x16x32_bf16 v[200:203], a[132:135], a[20:23], v[200:203]
    v_exp_f32 v211, v211
    v_mfma_f32_16x16x32_bf16 v[200:203], a[136:139], a[24:27], v[200:203]
    ds_read_b128 a[120:123], v240 offset:29696
    v_cvt_pk_bf16_f32 v209, v210, v211
    v_mfma_f32_16x16x32_bf16 v[200:203], a[140:143], a[28:31], v[200:203]
    v_exp_f32 v212, v212
    v_mfma_f32_16x16x32_bf16 v[204:207], a[156:159], a[28:31], v[220:223]
    v_exp_f32 v213, v213
    v_mfma_f32_16x16x32_bf16 v[204:207], a[152:155], a[24:27], v[204:207]
    ds_read_b128 a[124:127], v241 offset:29696
    v_cvt_pk_bf16_f32 v210, v212, v213
    v_mfma_f32_16x16x32_bf16 v[204:207], a[148:151], a[20:23], v[204:207]
    v_exp_f32 v214, v214
    v_mfma_f32_16x16x32_bf16 v[204:207], a[144:147], a[16:19], v[204:207]
    v_exp_f32 v215, v215
    v_smfmac_f32_16x16x64_bf16 a[232:235], a[244:247], v[192:199], v253
    v_cvt_pk_bf16_f32 v211, v214, v215
    v_mfma_f32_16x16x32_bf16 v[160:163], a[160:163], v[196:199], v[160:163]
    ds_read_b64_tr_b16 a[160:161], v242 offset:24576
    v_mfma_f32_16x16x32_bf16 v[164:167], a[164:167], v[196:199], v[164:167]
    ds_read_b64_tr_b16 a[162:163], v242 offset:28672
    v_mfma_f32_16x16x32_bf16 v[168:171], a[168:171], v[196:199], v[168:171]
    v_exp_f32 v200, v200
    v_mfma_f32_16x16x32_bf16 v[172:175], a[172:175], v[196:199], v[172:175]
    v_exp_f32 v201, v201
    v_mfma_f32_16x16x32_bf16 v[176:179], a[176:179], v[196:199], v[176:179]
    v_exp_f32 v202, v202
    v_mfma_f32_16x16x32_bf16 v[180:183], a[180:183], v[196:199], v[180:183]
    ds_read_b64_tr_b16 a[164:165], v243 offset:24576
    v_cvt_pk_bf16_f32 v212, v200, v201
    v_mfma_f32_16x16x32_bf16 v[184:187], a[184:187], v[196:199], v[184:187]
    v_exp_f32 v203, v203
    v_mfma_f32_16x16x32_bf16 v[188:191], a[188:191], v[196:199], v[188:191]
    v_exp_f32 v204, v204
    v_mfma_f32_16x16x32_bf16 v[192:195], a[128:131], a[32:35], v[224:227]
    buffer_load_dwordx4 v248, s[4:7], s30 offen sc1 nt lds
    v_mfma_f32_16x16x32_bf16 v[192:195], a[132:135], a[36:39], v[192:195]
    s_addk_i32 m0, 896
    v_exp_f32 v205, v205
    v_mfma_f32_16x16x32_bf16 v[192:195], a[136:139], a[40:43], v[192:195]
    ds_read_b64_tr_b16 a[166:167], v243 offset:28672
    v_cvt_pk_bf16_f32 v213, v202, v203
    v_mfma_f32_16x16x32_bf16 v[192:195], a[140:143], a[44:47], v[192:195]
    v_exp_f32 v206, v206
    v_mfma_f32_16x16x32_bf16 v[196:199], a[156:159], a[44:47], v[224:227]
    v_exp_f32 v207, v207
    v_mfma_f32_16x16x32_bf16 v[196:199], a[152:155], a[40:43], v[196:199]
    v_cvt_pk_bf16_f32 v214, v204, v205
    v_cvt_pk_bf16_f32 v215, v206, v207
    v_mfma_f32_16x16x32_bf16 v[196:199], a[148:151], a[36:39], v[196:199]
    ds_read_b64_tr_b16 a[168:169], v244 offset:24576
    v_mfma_f32_16x16x32_bf16 v[196:199], a[144:147], a[32:35], v[196:199]
    v_mfma_f32_16x16x32_bf16 v[0:3], a[192:195], v[208:211], v[0:3]
    v_mfma_f32_16x16x32_bf16 v[4:7], a[196:199], v[208:211], v[4:7]
    v_mfma_f32_16x16x32_bf16 v[8:11], a[200:203], v[208:211], v[8:11]
    ds_read_b64_tr_b16 a[170:171], v244 offset:28672
    v_mfma_f32_16x16x32_bf16 v[12:15], a[204:207], v[208:211], v[12:15]
    v_mul_f32 v192, s44, v192
    v_mul_f32 v193, s44, v193
    v_mfma_f32_16x16x32_bf16 v[16:19], a[208:211], v[208:211], v[16:19]
    buffer_load_dwordx4 v248, s[4:7], s30 offen offset:128 sc1 nt lds
    v_mfma_f32_16x16x32_bf16 v[20:23], a[212:215], v[208:211], v[20:23]
    s_add_u32 m0, s27, 49152
    v_exp_f32 v192, v192
    v_mfma_f32_16x16x32_bf16 v[24:27], a[216:219], v[208:211], v[24:27]
    s_add_u32 s30, s24, 114688
    v_exp_f32 v193, v193
    v_mfma_f32_16x16x32_bf16 v[28:31], a[220:223], v[208:211], v[28:31]
    buffer_load_dwordx4 v248, s[12:15], s30 offen sc1 nt lds
    v_mfma_f32_16x16x32_bf16 v[200:203], a[128:131], a[48:51], v[228:231]
    s_addk_i32 m0, 896
    ds_read_b64_tr_b16 a[172:173], v245 offset:24576
    v_mul_f32 v194, s44, v194
    v_mfma_f32_16x16x32_bf16 v[200:203], a[132:135], a[52:55], v[200:203]
    v_exp_f32 v194, v194
    v_mfma_f32_16x16x32_bf16 v[200:203], a[136:139], a[56:59], v[200:203]
    v_mul_f32 v195, s44, v195
    v_cvt_pk_bf16_f32 v192, v192, v193
    v_mfma_f32_16x16x32_bf16 v[200:203], a[140:143], a[60:63], v[200:203]
    v_exp_f32 v195, v195
    v_mfma_f32_16x16x32_bf16 v[204:207], a[156:159], a[60:63], v[228:231]
    ds_read_b64_tr_b16 a[174:175], v245 offset:28672
    v_mul_f32 v196, s44, v196
    v_mfma_f32_16x16x32_bf16 v[204:207], a[152:155], a[56:59], v[204:207]
    v_exp_f32 v196, v196
    v_mfma_f32_16x16x32_bf16 v[204:207], a[148:151], a[52:55], v[204:207]
    v_mul_f32 v197, s44, v197
    v_cvt_pk_bf16_f32 v193, v194, v195
    v_mfma_f32_16x16x32_bf16 v[204:207], a[144:147], a[48:51], v[204:207]
    v_exp_f32 v197, v197
    v_smfmac_f32_16x16x64_bf16 a[224:227], a[244:247], v[208:215], v253
    v_mul_f32 v198, s44, v198
    v_mfma_f32_16x16x32_bf16 v[32:35], a[192:195], v[212:215], v[32:35]
    v_exp_f32 v198, v198
    v_mfma_f32_16x16x32_bf16 v[36:39], a[196:199], v[212:215], v[36:39]
    v_mul_f32 v199, s44, v199
    v_cvt_pk_bf16_f32 v194, v196, v197
    v_mfma_f32_16x16x32_bf16 v[40:43], a[200:203], v[212:215], v[40:43]
    buffer_load_dwordx4 v248, s[12:15], s30 offen offset:128 sc1 nt lds
    v_mfma_f32_16x16x32_bf16 v[44:47], a[204:207], v[212:215], v[44:47]
    s_addk_i32 m0, -25472
    v_exp_f32 v199, v199
    v_mfma_f32_16x16x32_bf16 v[48:51], a[208:211], v[212:215], v[48:51]
    s_addk_i32 s30, 8192
    ds_read_b64_tr_b16 a[176:177], v242 offset:25600
    v_cvt_pk_bf16_f32 v195, v198, v199
    v_mfma_f32_16x16x32_bf16 v[52:55], a[212:215], v[212:215], v[52:55]
    v_exp_f32 v200, v200
    v_mfma_f32_16x16x32_bf16 v[56:59], a[216:219], v[212:215], v[56:59]
    v_exp_f32 v201, v201
    v_mfma_f32_16x16x32_bf16 v[60:63], a[220:223], v[212:215], v[60:63]
    ds_read_b64_tr_b16 a[178:179], v242 offset:29696
    v_cvt_pk_bf16_f32 v196, v200, v201
    v_mfma_f32_16x16x32_bf16 v[208:211], a[128:131], a[64:67], v[232:235]
L_pad4:
    s_cbranch_execz L_pad8
    v_exp_f32 v202, v202
    v_mfma_f32_16x16x32_bf16 v[208:211], a[132:135], a[68:71], v[208:211]
    v_exp_f32 v203, v203
    v_mfma_f32_16x16x32_bf16 v[208:211], a[136:139], a[72:75], v[208:211]
    ds_read_b64_tr_b16 a[180:181], v243 offset:25600
    v_cvt_pk_bf16_f32 v197, v202, v203
    v_mfma_f32_16x16x32_bf16 v[208:211], a[140:143], a[76:79], v[208:211]
    v_exp_f32 v204, v204
    v_mfma_f32_16x16x32_bf16 v[212:215], a[156:159], a[76:79], v[232:235]
    v_exp_f32 v205, v205
    v_mfma_f32_16x16x32_bf16 v[212:215], a[152:155], a[72:75], v[212:215]
    ds_read_b64_tr_b16 a[182:183], v243 offset:29696
    v_cvt_pk_bf16_f32 v198, v204, v205
    v_mfma_f32_16x16x32_bf16 v[212:215], a[148:151], a[68:71], v[212:215]
    v_exp_f32 v206, v206
    v_mfma_f32_16x16x32_bf16 v[212:215], a[144:147], a[64:67], v[212:215]
    v_exp_f32 v207, v207
    v_mfma_f32_16x16x32_bf16 v[64:67], a[192:195], v[192:195], v[64:67]
    ds_read_b64_tr_b16 a[184:185], v244 offset:25600
    v_cvt_pk_bf16_f32 v199, v206, v207
    v_mfma_f32_16x16x32_bf16 v[68:71], a[196:199], v[192:195], v[68:71]
    v_mfma_f32_16x16x32_bf16 v[72:75], a[200:203], v[192:195], v[72:75]
    v_mfma_f32_16x16x32_bf16 v[76:79], a[204:207], v[192:195], v[76:79]
    v_mul_f32 v208, s44, v208
    v_mul_f32 v209, s44, v209
    v_mfma_f32_16x16x32_bf16 v[80:83], a[208:211], v[192:195], v[80:83]
    v_exp_f32 v208, v208
    v_mfma_f32_16x16x32_bf16 v[84:87], a[212:215], v[192:195], v[84:87]
    ds_read_b64_tr_b16 a[186:187], v244 offset:29696
    v_mul_f32 v210, s44, v210
    v_mfma_f32_16x16x32_bf16 v[88:91], a[216:219], v[192:195], v[88:91]
    v_exp_f32 v209, v209
    v_mfma_f32_16x16x32_bf16 v[92:95], a[220:223], v[192:195], v[92:95]
    v_exp_f32 v210, v210
    v_mfma_f32_16x16x32_bf16 v[200:203], a[128:131], a[80:83], v[236:239]
    v_mul_f32 v211, s44, v211
    v_cvt_pk_bf16_f32 v208, v208, v209
    v_mfma_f32_16x16x32_bf16 v[200:203], a[132:135], a[84:87], v[200:203]
    ds_read_b64_tr_b16 a[188:189], v245 offset:25600
    v_mul_f32 v212, s44, v212
    v_mfma_f32_16x16x32_bf16 v[200:203], a[136:139], a[88:91], v[200:203]
    v_exp_f32 v211, v211
    v_mfma_f32_16x16x32_bf16 v[200:203], a[140:143], a[92:95], v[200:203]
    v_exp_f32 v212, v212
    v_mfma_f32_16x16x32_bf16 v[204:207], a[156:159], a[92:95], v[236:239]
    v_mul_f32 v213, s44, v213
    v_cvt_pk_bf16_f32 v209, v210, v211
    v_mfma_f32_16x16x32_bf16 v[204:207], a[152:155], a[88:91], v[204:207]
    ds_read_b64_tr_b16 a[190:191], v245 offset:29696
    v_mul_f32 v214, s44, v214
    v_mfma_f32_16x16x32_bf16 v[204:207], a[148:151], a[84:87], v[204:207]
    v_exp_f32 v213, v213
    v_mfma_f32_16x16x32_bf16 v[204:207], a[144:147], a[80:83], v[204:207]
    v_exp_f32 v214, v214
    v_smfmac_f32_16x16x64_bf16 a[228:231], a[244:247], v[192:199], v253
    v_mul_f32 v215, s44, v215
    v_mfma_f32_16x16x32_bf16 v[96:99], a[192:195], v[196:199], v[96:99]
    v_exp_f32 v215, v215
    v_mfma_f32_16x16x32_bf16 v[100:103], a[196:199], v[196:199], v[100:103]
    v_cvt_pk_bf16_f32 v210, v212, v213
    v_cvt_pk_bf16_f32 v211, v214, v215
    v_mfma_f32_16x16x32_bf16 v[104:107], a[200:203], v[196:199], v[104:107]
    v_mul_f32 v200, s44, v200
    v_mul_f32 v201, s44, v201
    v_mfma_f32_16x16x32_bf16 v[108:111], a[204:207], v[196:199], v[108:111]
    v_exp_f32 v200, v200
    v_mfma_f32_16x16x32_bf16 v[112:115], a[208:211], v[196:199], v[112:115]
    v_exp_f32 v201, v201
    v_mfma_f32_16x16x32_bf16 v[116:119], a[212:215], v[196:199], v[116:119]
    v_mul_f32 v202, s44, v202
    v_mul_f32 v203, s44, v203
    v_mfma_f32_16x16x32_bf16 v[120:123], a[216:219], v[196:199], v[120:123]
    v_exp_f32 v202, v202
    v_mfma_f32_16x16x32_bf16 v[124:127], a[220:223], v[196:199], v[124:127]
    s_waitcnt lgkmcnt(0)
    v_cvt_pk_bf16_f32 v212, v200, v201
    v_mul_f32 v204, s44, v204
    v_mfma_f32_16x16x32_bf16 v[192:195], a[96:99], a[0:3], v[216:219]
    s_waitcnt vmcnt(14)
    v_exp_f32 v203, v203
    v_mfma_f32_16x16x32_bf16 v[192:195], a[100:103], a[4:7], v[192:195]
    s_barrier
    v_mul_f32 v205, s44, v205
    v_mfma_f32_16x16x32_bf16 v[192:195], a[104:107], a[8:11], v[192:195]
    ds_read_b128 a[128:131], v240 offset:0
    v_cvt_pk_bf16_f32 v213, v202, v203
    v_mfma_f32_16x16x32_bf16 v[192:195], a[108:111], a[12:15], v[192:195]
    buffer_load_dwordx4 v248, s[8:11], s30 offen sc1 nt lds
    v_mfma_f32_16x16x32_bf16 v[196:199], a[124:127], a[12:15], v[216:219]
    s_addk_i32 m0, 896
    ds_read_b128 a[132:135], v241 offset:0
    v_mul_f32 v206, s44, v206
    v_mfma_f32_16x16x32_bf16 v[196:199], a[120:123], a[8:11], v[196:199]
    v_exp_f32 v204, v204
    v_mfma_f32_16x16x32_bf16 v[196:199], a[116:119], a[4:7], v[196:199]
    ds_read_b128 a[136:139], v240 offset:1024
    v_mul_f32 v207, s44, v207
    v_mfma_f32_16x16x32_bf16 v[196:199], a[112:115], a[0:3], v[196:199]
    v_exp_f32 v205, v205
    v_mfma_f32_16x16x32_bf16 v[128:131], a[192:195], v[208:211], v[128:131]
    ds_read_b128 a[140:143], v241 offset:1024
    v_cvt_pk_bf16_f32 v214, v204, v205
    v_mfma_f32_16x16x32_bf16 v[132:135], a[196:199], v[208:211], v[132:135]
    v_exp_f32 v206, v206
    v_mfma_f32_16x16x32_bf16 v[136:139], a[200:203], v[208:211], v[136:139]
    v_exp_f32 v207, v207
    v_mfma_f32_16x16x32_bf16 v[140:143], a[204:207], v[208:211], v[140:143]
    ds_read_b128 a[144:147], v240 offset:4096
    v_cvt_pk_bf16_f32 v215, v206, v207
    v_mfma_f32_16x16x32_bf16 v[144:147], a[208:211], v[208:211], v[144:147]
    buffer_load_dwordx4 v248, s[8:11], s30 offen offset:128 sc1 nt lds
    v_mfma_f32_16x16x32_bf16 v[148:151], a[212:215], v[208:211], v[148:151]
    s_add_u32 m0, s28, 18432
    v_exp_f32 v192, v192
    v_mfma_f32_16x16x32_bf16 v[152:155], a[216:219], v[208:211], v[152:155]
    s_add_u32 s30, s22, 18432
    v_exp_f32 v193, v193
    v_mfma_f32_16x16x32_bf16 v[156:159], a[220:223], v[208:211], v[156:159]
    ds_read_b128 a[148:151], v241 offset:4096
    v_cvt_pk_bf16_f32 v192, v192, v193
    v_mfma_f32_16x16x32_bf16 v[200:203], a[96:99], a[16:19], v[220:223]
    v_exp_f32 v194, v194
    v_mfma_f32_16x16x32_bf16 v[200:203], a[100:103], a[20:23], v[200:203]
    v_exp_f32 v195, v195
    v_mfma_f32_16x16x32_bf16 v[200:203], a[104:107], a[24:27], v[200:203]
    ds_read_b128 a[152:155], v240 offset:5120
    v_cvt_pk_bf16_f32 v193, v194, v195
    v_mfma_f32_16x16x32_bf16 v[200:203], a[108:111], a[28:31], v[200:203]
    v_exp_f32 v196, v196
    v_mfma_f32_16x16x32_bf16 v[204:207], a[124:127], a[28:31], v[220:223]
    v_exp_f32 v197, v197
    v_mfma_f32_16x16x32_bf16 v[204:207], a[120:123], a[24:27], v[204:207]
    ds_read_b128 a[156:159], v241 offset:5120
    v_cvt_pk_bf16_f32 v194, v196, v197
    v_mfma_f32_16x16x32_bf16 v[204:207], a[116:119], a[20:23], v[204:207]
    v_exp_f32 v198, v198
    v_mfma_f32_16x16x32_bf16 v[204:207], a[112:115], a[16:19], v[204:207]
    v_exp_f32 v199, v199
    v_smfmac_f32_16x16x64_bf16 a[232:235], a[244:247], v[208:215], v253
    v_cvt_pk_bf16_f32 v195, v198, v199
    v_mfma_f32_16x16x32_bf16 v[160:163], a[192:195], v[212:215], v[160:163]
    buffer_load_dwordx4 v248, s[4:7], s30 offen sc1 nt lds
    v_mfma_f32_16x16x32_bf16 v[164:167], a[196:199], v[212:215], v[164:167]
    s_addk_i32 m0, 896
    ds_read_b64_tr_b16 a[192:193], v242 offset:0
    v_mfma_f32_16x16x32_bf16 v[168:171], a[200:203], v[212:215], v[168:171]
    v_exp_f32 v200, v200
    v_mfma_f32_16x16x32_bf16 v[172:175], a[204:207], v[212:215], v[172:175]
    v_exp_f32 v201, v201
    v_mfma_f32_16x16x32_bf16 v[176:179], a[208:211], v[212:215], v[176:179]
    ds_read_b64_tr_b16 a[194:195], v242 offset:4096
    v_cvt_pk_bf16_f32 v196, v200, v201
    v_mfma_f32_16x16x32_bf16 v[180:183], a[212:215], v[212:215], v[180:183]
    v_exp_f32 v202, v202
    v_mfma_f32_16x16x32_bf16 v[184:187], a[216:219], v[212:215], v[184:187]
    v_exp_f32 v203, v203
    v_mfma_f32_16x16x32_bf16 v[188:191], a[220:223], v[212:215], v[188:191]
    ds_read_b64_tr_b16 a[196:197], v243 offset:0
    v_cvt_pk_bf16_f32 v197, v202, v203
    v_mfma_f32_16x16x32_bf16 v[208:211], a[96:99], a[32:35], v[224:227]
    v_exp_f32 v204, v204
    v_mfma_f32_16x16x32_bf16 v[208:211], a[100:103], a[36:39], v[208:211]
    v_exp_f32 v205, v205
    v_mfma_f32_16x16x32_bf16 v[208:211], a[104:107], a[40:43], v[208:211]
    ds_read_b64_tr_b16 a[198:199], v243 offset:4096
    v_cvt_pk_bf16_f32 v198, v204, v205
    v_mfma_f32_16x16x32_bf16 v[208:211], a[108:111], a[44:47], v[208:211]
    buffer_load_dwordx4 v248, s[4:7], s30 offen offset:128 sc1 nt lds
    v_mfma_f32_16x16x32_bf16 v[212:215], a[124:127], a[44:47], v[224:227]
    s_add_u32 m0, s27, 57344
    v_exp_f32 v206, v206
    v_mfma_f32_16x16x32_bf16 v[212:215], a[120:123], a[40:43], v[212:215]
    s_add_u32 s30, s24, 122880
    v_exp_f32 v207, v207
    v_mfma_f32_16x16x32_bf16 v[212:215], a[116:119], a[36:39], v[212:215]
    ds_read_b64_tr_b16 a[200:201], v244 offset:0
    v_cvt_pk_bf16_f32 v199, v206, v207
    v_mfma_f32_16x16x32_bf16 v[212:215], a[112:115], a[32:35], v[212:215]
    v_mfma_f32_16x16x32_bf16 v[0:3], a[160:163], v[192:195], v[0:3]
    buffer_load_dwordx4 v248, s[12:15], s30 offen sc1 nt lds
    v_mfma_f32_16x16x32_bf16 v[4:7], a[164:167], v[192:195], v[4:7]
    s_addk_i32 m0, 896
    v_mfma_f32_16x16x32_bf16 v[8:11], a[168:171], v[192:195], v[8:11]
    ds_read_b64_tr_b16 a[202:203], v244 offset:4096
    v_mfma_f32_16x16x32_bf16 v[12:15], a[172:175], v[192:195], v[12:15]
    v_mul_f32 v208, s44, v208
    v_mul_f32 v209, s44, v209
    v_mfma_f32_16x16x32_bf16 v[16:19], a[176:179], v[192:195], v[16:19]
    v_exp_f32 v208, v208
    v_mfma_f32_16x16x32_bf16 v[20:23], a[180:183], v[192:195], v[20:23]
    v_exp_f32 v209, v209
    v_mfma_f32_16x16x32_bf16 v[24:27], a[184:187], v[192:195], v[24:27]
    v_mul_f32 v210, s44, v210
    v_mul_f32 v211, s44, v211
    v_mfma_f32_16x16x32_bf16 v[28:31], a[188:191], v[192:195], v[28:31]
    ds_read_b64_tr_b16 a[204:205], v245 offset:0
    v_cvt_pk_bf16_f32 v208, v208, v209
    v_mfma_f32_16x16x32_bf16 v[200:203], a[96:99], a[48:51], v[228:231]
    v_exp_f32 v210, v210
    v_mfma_f32_16x16x32_bf16 v[200:203], a[100:103], a[52:55], v[200:203]
    v_exp_f32 v211, v211
    v_mfma_f32_16x16x32_bf16 v[200:203], a[104:107], a[56:59], v[200:203]
    v_mul_f32 v212, s44, v212
    v_mul_f32 v213, s44, v213
    v_mfma_f32_16x16x32_bf16 v[200:203], a[108:111], a[60:63], v[200:203]
    ds_read_b64_tr_b16 a[206:207], v245 offset:4096
    v_cvt_pk_bf16_f32 v209, v210, v211
    v_mfma_f32_16x16x32_bf16 v[204:207], a[124:127], a[60:63], v[228:231]
    v_exp_f32 v212, v212
    v_mfma_f32_16x16x32_bf16 v[204:207], a[120:123], a[56:59], v[204:207]
    v_exp_f32 v213, v213
    v_mfma_f32_16x16x32_bf16 v[204:207], a[116:119], a[52:55], v[204:207]
    v_mul_f32 v214, s44, v214
    v_mul_f32 v215, s44, v215
    v_mfma_f32_16x16x32_bf16 v[204:207], a[112:115], a[48:51], v[204:207]
    v_exp_f32 v214, v214
    v_smfmac_f32_16x16x64_bf16 a[224:227], a[244:247], v[192:199], v253
    v_cvt_pk_bf16_f32 v210, v212, v213
    v_mfma_f32_16x16x32_bf16 v[32:35], a[160:163], v[196:199], v[32:35]
    buffer_load_dwordx4 v248, s[12:15], s30 offen offset:128 sc1 nt lds
    v_mfma_f32_16x16x32_bf16 v[36:39], a[164:167], v[196:199], v[36:39]
    s_mov_b32 m0, s27
    v_exp_f32 v215, v215
    v_mfma_f32_16x16x32_bf16 v[40:43], a[168:171], v[196:199], v[40:43]
    s_mov_b32 s30, s25
    ds_read_b64_tr_b16 a[208:209], v242 offset:1024
    v_cvt_pk_bf16_f32 v211, v214, v215
    v_mfma_f32_16x16x32_bf16 v[44:47], a[172:175], v[196:199], v[44:47]
    v_exp_f32 v200, v200
    v_mfma_f32_16x16x32_bf16 v[48:51], a[176:179], v[196:199], v[48:51]
    v_exp_f32 v201, v201
    v_mfma_f32_16x16x32_bf16 v[52:55], a[180:183], v[196:199], v[52:55]
    ds_read_b64_tr_b16 a[210:211], v242 offset:5120
    v_cvt_pk_bf16_f32 v212, v200, v201
    v_mfma_f32_16x16x32_bf16 v[56:59], a[184:187], v[196:199], v[56:59]
    v_exp_f32 v202, v202
    v_mfma_f32_16x16x32_bf16 v[60:63], a[188:191], v[196:199], v[60:63]
    v_exp_f32 v203, v203
    v_mfma_f32_16x16x32_bf16 v[192:195], a[96:99], a[64:67], v[232:235]
    ds_read_b64_tr_b16 a[212:213], v243 offset:1024
    v_cvt_pk_bf16_f32 v213, v202, v203
    v_mfma_f32_16x16x32_bf16 v[192:195], a[100:103], a[68:71], v[192:195]
    v_exp_f32 v204, v204
    v_mfma_f32_16x16x32_bf16 v[192:195], a[104:107], a[72:75], v[192:195]
    v_exp_f32 v205, v205
    v_mfma_f32_16x16x32_bf16 v[192:195], a[108:111], a[76:79], v[192:195]
    v_exp_f32 v206, v206
    v_mfma_f32_16x16x32_bf16 v[196:199], a[124:127], a[76:79], v[232:235]
    ds_read_b64_tr_b16 a[214:215], v243 offset:5120
    v_cvt_pk_bf16_f32 v214, v204, v205
    v_mfma_f32_16x16x32_bf16 v[196:199], a[120:123], a[72:75], v[196:199]
    v_exp_f32 v207, v207
    v_mfma_f32_16x16x32_bf16 v[196:199], a[116:119], a[68:71], v[196:199]
    v_cvt_pk_bf16_f32 v215, v206, v207
    v_mfma_f32_16x16x32_bf16 v[196:199], a[112:115], a[64:67], v[196:199]
    v_mfma_f32_16x16x32_bf16 v[64:67], a[160:163], v[208:211], v[64:67]
    ds_read_b64_tr_b16 a[216:217], v244 offset:1024
    v_mfma_f32_16x16x32_bf16 v[68:71], a[164:167], v[208:211], v[68:71]
    v_mfma_f32_16x16x32_bf16 v[72:75], a[168:171], v[208:211], v[72:75]
    v_mfma_f32_16x16x32_bf16 v[76:79], a[172:175], v[208:211], v[76:79]
    v_mul_f32 v192, s44, v192
    v_mul_f32 v193, s44, v193
    v_mfma_f32_16x16x32_bf16 v[80:83], a[176:179], v[208:211], v[80:83]
    v_exp_f32 v192, v192
    v_mfma_f32_16x16x32_bf16 v[84:87], a[180:183], v[208:211], v[84:87]
    ds_read_b64_tr_b16 a[218:219], v244 offset:5120
    v_mul_f32 v194, s44, v194
    v_mfma_f32_16x16x32_bf16 v[88:91], a[184:187], v[208:211], v[88:91]
    v_exp_f32 v193, v193
    v_mfma_f32_16x16x32_bf16 v[92:95], a[188:191], v[208:211], v[92:95]
    v_exp_f32 v194, v194
    v_mfma_f32_16x16x32_bf16 v[200:203], a[96:99], a[80:83], v[236:239]
    v_mul_f32 v195, s44, v195
    v_cvt_pk_bf16_f32 v192, v192, v193
    v_mfma_f32_16x16x32_bf16 v[200:203], a[100:103], a[84:87], v[200:203]
    ds_read_b64_tr_b16 a[220:221], v245 offset:1024
    v_mul_f32 v196, s44, v196
    v_mfma_f32_16x16x32_bf16 v[200:203], a[104:107], a[88:91], v[200:203]
    v_exp_f32 v195, v195
    v_mfma_f32_16x16x32_bf16 v[200:203], a[108:111], a[92:95], v[200:203]
    v_exp_f32 v196, v196
    v_mfma_f32_16x16x32_bf16 v[204:207], a[124:127], a[92:95], v[236:239]
    v_mul_f32 v197, s44, v197
    v_cvt_pk_bf16_f32 v193, v194, v195
    v_mfma_f32_16x16x32_bf16 v[204:207], a[120:123], a[88:91], v[204:207]
    ds_read_b64_tr_b16 a[222:223], v245 offset:5120
    v_mul_f32 v198, s44, v198
    v_mfma_f32_16x16x32_bf16 v[204:207], a[116:119], a[84:87], v[204:207]
    v_exp_f32 v197, v197
    v_mfma_f32_16x16x32_bf16 v[204:207], a[112:115], a[80:83], v[204:207]
    v_exp_f32 v198, v198
    v_smfmac_f32_16x16x64_bf16 a[228:231], a[244:247], v[208:215], v253
    v_mul_f32 v199, s44, v199
    v_mfma_f32_16x16x32_bf16 v[96:99], a[160:163], v[212:215], v[96:99]
    v_exp_f32 v199, v199
    v_mfma_f32_16x16x32_bf16 v[100:103], a[164:167], v[212:215], v[100:103]
    v_cvt_pk_bf16_f32 v194, v196, v197
    v_cvt_pk_bf16_f32 v195, v198, v199
    v_mfma_f32_16x16x32_bf16 v[104:107], a[168:171], v[212:215], v[104:107]
    v_mul_f32 v200, s44, v200
    v_mul_f32 v201, s44, v201
    v_mfma_f32_16x16x32_bf16 v[108:111], a[172:175], v[212:215], v[108:111]
    v_exp_f32 v200, v200
    v_mfma_f32_16x16x32_bf16 v[112:115], a[176:179], v[212:215], v[112:115]
    v_exp_f32 v201, v201
    v_mfma_f32_16x16x32_bf16 v[116:119], a[180:183], v[212:215], v[116:119]
    v_mul_f32 v202, s44, v202
    v_mul_f32 v203, s44, v203
    v_mfma_f32_16x16x32_bf16 v[120:123], a[184:187], v[212:215], v[120:123]
    v_exp_f32 v202, v202
    v_mfma_f32_16x16x32_bf16 v[124:127], a[188:191], v[212:215], v[124:127]
    s_waitcnt lgkmcnt(0)
    v_cvt_pk_bf16_f32 v196, v200, v201
    v_mul_f32 v204, s44, v204
    v_mfma_f32_16x16x32_bf16 v[208:211], a[128:131], a[0:3], v[216:219]
    s_waitcnt vmcnt(12)
    v_exp_f32 v203, v203
    v_mfma_f32_16x16x32_bf16 v[208:211], a[132:135], a[4:7], v[208:211]
    s_barrier
    v_mul_f32 v205, s44, v205
    v_mfma_f32_16x16x32_bf16 v[208:211], a[136:139], a[8:11], v[208:211]
    ds_read_b128 a[96:99], v240 offset:8192
    v_cvt_pk_bf16_f32 v197, v202, v203
    v_mfma_f32_16x16x32_bf16 v[208:211], a[140:143], a[12:15], v[208:211]
    buffer_load_dwordx4 v248, s[8:11], s30 offen sc1 nt lds
    v_mfma_f32_16x16x32_bf16 v[212:215], a[156:159], a[12:15], v[216:219]
    s_addk_i32 m0, 896
    ds_read_b128 a[100:103], v241 offset:8192
    v_mul_f32 v206, s44, v206
    v_mfma_f32_16x16x32_bf16 v[212:215], a[152:155], a[8:11], v[212:215]
    v_exp_f32 v204, v204
    v_mfma_f32_16x16x32_bf16 v[212:215], a[148:151], a[4:7], v[212:215]
    ds_read_b128 a[104:107], v240 offset:9216
    v_mul_f32 v207, s44, v207
    v_mfma_f32_16x16x32_bf16 v[212:215], a[144:147], a[0:3], v[212:215]
    v_exp_f32 v205, v205
    v_mfma_f32_16x16x32_bf16 v[128:131], a[160:163], v[192:195], v[128:131]
    ds_read_b128 a[108:111], v241 offset:9216
    v_cvt_pk_bf16_f32 v198, v204, v205
    v_mfma_f32_16x16x32_bf16 v[132:135], a[164:167], v[192:195], v[132:135]
    v_exp_f32 v206, v206
    v_mfma_f32_16x16x32_bf16 v[136:139], a[168:171], v[192:195], v[136:139]
    v_exp_f32 v207, v207
    v_mfma_f32_16x16x32_bf16 v[140:143], a[172:175], v[192:195], v[140:143]
    ds_read_b128 a[112:115], v240 offset:12288
    v_cvt_pk_bf16_f32 v199, v206, v207
    v_mfma_f32_16x16x32_bf16 v[144:147], a[176:179], v[192:195], v[144:147]
    buffer_load_dwordx4 v248, s[8:11], s30 offen offset:128 sc1 nt lds
    v_mfma_f32_16x16x32_bf16 v[148:151], a[180:183], v[192:195], v[148:151]
    s_add_u32 m0, s28, 20480
    v_exp_f32 v208, v208
    v_mfma_f32_16x16x32_bf16 v[152:155], a[184:187], v[192:195], v[152:155]
    s_add_u32 s30, s22, 20480
    v_exp_f32 v209, v209
    v_mfma_f32_16x16x32_bf16 v[156:159], a[188:191], v[192:195], v[156:159]
    ds_read_b128 a[116:119], v241 offset:12288
    v_cvt_pk_bf16_f32 v208, v208, v209
    v_mfma_f32_16x16x32_bf16 v[200:203], a[128:131], a[16:19], v[220:223]
    v_exp_f32 v210, v210
    v_mfma_f32_16x16x32_bf16 v[200:203], a[132:135], a[20:23], v[200:203]
    v_exp_f32 v211, v211
    v_mfma_f32_16x16x32_bf16 v[200:203], a[136:139], a[24:27], v[200:203]
    ds_read_b128 a[120:123], v240 offset:13312
    v_cvt_pk_bf16_f32 v209, v210, v211
    v_mfma_f32_16x16x32_bf16 v[200:203], a[140:143], a[28:31], v[200:203]
    v_exp_f32 v212, v212
    v_mfma_f32_16x16x32_bf16 v[204:207], a[156:159], a[28:31], v[220:223]
    buffer_load_dwordx4 v248, s[4:7], s30 offen sc1 nt lds
    v_mfma_f32_16x16x32_bf16 v[204:207], a[152:155], a[24:27], v[204:207]
    s_addk_i32 m0, 896
    v_exp_f32 v213, v213
    v_mfma_f32_16x16x32_bf16 v[204:207], a[148:151], a[20:23], v[204:207]
    ds_read_b128 a[124:127], v241 offset:13312
    v_cvt_pk_bf16_f32 v210, v212, v213
    v_mfma_f32_16x16x32_bf16 v[204:207], a[144:147], a[16:19], v[204:207]
    v_exp_f32 v214, v214
    v_smfmac_f32_16x16x64_bf16 a[232:235], a[244:247], v[192:199], v253
    v_mfma_f32_16x16x32_bf16 v[160:163], a[160:163], v[196:199], v[160:163]
    v_exp_f32 v215, v215
    v_mfma_f32_16x16x32_bf16 v[164:167], a[164:167], v[196:199], v[164:167]
    ds_read_b64_tr_b16 a[160:161], v242 offset:8192
    v_cvt_pk_bf16_f32 v211, v214, v215
    v_mfma_f32_16x16x32_bf16 v[168:171], a[168:171], v[196:199], v[168:171]
    v_exp_f32 v200, v200
    v_mfma_f32_16x16x32_bf16 v[172:175], a[172:175], v[196:199], v[172:175]
    v_exp_f32 v201, v201
    v_mfma_f32_16x16x32_bf16 v[176:179], a[176:179], v[196:199], v[176:179]
    ds_read_b64_tr_b16 a[162:163], v242 offset:12288
    v_cvt_pk_bf16_f32 v212, v200, v201
    v_mfma_f32_16x16x32_bf16 v[180:183], a[180:183], v[196:199], v[180:183]
    buffer_load_dwordx4 v248, s[4:7], s30 offen offset:128 sc1 nt lds
    v_mfma_f32_16x16x32_bf16 v[184:187], a[184:187], v[196:199], v[184:187]
    s_add_u32 m0, s27, 32768
    v_exp_f32 v202, v202
    v_mfma_f32_16x16x32_bf16 v[188:191], a[188:191], v[196:199], v[188:191]
    s_mov_b32 s30, s25
    v_exp_f32 v203, v203
    v_mfma_f32_16x16x32_bf16 v[192:195], a[128:131], a[32:35], v[224:227]
    ds_read_b64_tr_b16 a[164:165], v243 offset:8192
    v_cvt_pk_bf16_f32 v213, v202, v203
    v_mfma_f32_16x16x32_bf16 v[192:195], a[132:135], a[36:39], v[192:195]
    v_exp_f32 v204, v204
    v_mfma_f32_16x16x32_bf16 v[192:195], a[136:139], a[40:43], v[192:195]
    v_exp_f32 v205, v205
    v_mfma_f32_16x16x32_bf16 v[192:195], a[140:143], a[44:47], v[192:195]
    ds_read_b64_tr_b16 a[166:167], v243 offset:12288
    v_cvt_pk_bf16_f32 v214, v204, v205
    v_mfma_f32_16x16x32_bf16 v[196:199], a[156:159], a[44:47], v[224:227]
    v_exp_f32 v206, v206
    v_mfma_f32_16x16x32_bf16 v[196:199], a[152:155], a[40:43], v[196:199]
    v_exp_f32 v207, v207
    v_mfma_f32_16x16x32_bf16 v[196:199], a[148:151], a[36:39], v[196:199]
    ds_read_b64_tr_b16 a[168:169], v244 offset:8192
    v_cvt_pk_bf16_f32 v215, v206, v207
    v_mfma_f32_16x16x32_bf16 v[196:199], a[144:147], a[32:35], v[196:199]
    v_mfma_f32_16x16x32_bf16 v[0:3], a[192:195], v[208:211], v[0:3]
    buffer_load_dwordx4 v248, s[12:15], s30 offen sc1 nt lds
    v_mfma_f32_16x16x32_bf16 v[4:7], a[196:199], v[208:211], v[4:7]
    s_addk_i32 m0, 896
    v_mfma_f32_16x16x32_bf16 v[8:11], a[200:203], v[208:211], v[8:11]
    ds_read_b64_tr_b16 a[170:171], v244 offset:12288
    v_mfma_f32_16x16x32_bf16 v[12:15], a[204:207], v[208:211], v[12:15]
    v_mul_f32 v192, s44, v192
    v_mul_f32 v193, s44, v193
    v_mfma_f32_16x16x32_bf16 v[16:19], a[208:211], v[208:211], v[16:19]
    v_exp_f32 v192, v192
    v_mfma_f32_16x16x32_bf16 v[20:23], a[212:215], v[208:211], v[20:23]
    v_exp_f32 v193, v193
    v_mfma_f32_16x16x32_bf16 v[24:27], a[216:219], v[208:211], v[24:27]
    v_mul_f32 v194, s44, v194
    v_mul_f32 v195, s44, v195
    v_mfma_f32_16x16x32_bf16 v[28:31], a[220:223], v[208:211], v[28:31]
    ds_read_b64_tr_b16 a[172:173], v245 offset:8192
    v_cvt_pk_bf16_f32 v192, v192, v193
    v_mfma_f32_16x16x32_bf16 v[200:203], a[128:131], a[48:51], v[228:231]
    v_exp_f32 v194, v194
    v_mfma_f32_16x16x32_bf16 v[200:203], a[132:135], a[52:55], v[200:203]
    v_exp_f32 v195, v195
    v_mfma_f32_16x16x32_bf16 v[200:203], a[136:139], a[56:59], v[200:203]
    v_mul_f32 v196, s44, v196
    v_mul_f32 v197, s44, v197
    v_mfma_f32_16x16x32_bf16 v[200:203], a[140:143], a[60:63], v[200:203]
    ds_read_b64_tr_b16 a[174:175], v245 offset:12288
    v_cvt_pk_bf16_f32 v193, v194, v195
    v_mfma_f32_16x16x32_bf16 v[204:207], a[156:159], a[60:63], v[228:231]
    v_exp_f32 v196, v196
    v_mfma_f32_16x16x32_bf16 v[204:207], a[152:155], a[56:59], v[204:207]
    v_exp_f32 v197, v197
    v_mfma_f32_16x16x32_bf16 v[204:207], a[148:151], a[52:55], v[204:207]
    v_mul_f32 v198, s44, v198
    v_mul_f32 v199, s44, v199
    v_mfma_f32_16x16x32_bf16 v[204:207], a[144:147], a[48:51], v[204:207]
    v_exp_f32 v198, v198
    v_smfmac_f32_16x16x64_bf16 a[224:227], a[244:247], v[208:215], v253
    v_cvt_pk_bf16_f32 v194, v196, v197
    v_mfma_f32_16x16x32_bf16 v[32:35], a[192:195], v[212:215], v[32:35]
    buffer_load_dwordx4 v248, s[12:15], s30 offen offset:128 sc1 nt lds
    v_mfma_f32_16x16x32_bf16 v[36:39], a[196:199], v[212:215], v[36:39]
    s_addk_i32 m0, -25472
    v_exp_f32 v199, v199
    v_mfma_f32_16x16x32_bf16 v[40:43], a[200:203], v[212:215], v[40:43]
    s_addk_i32 s30, 8192
    ds_read_b64_tr_b16 a[176:177], v242 offset:9216
    v_cvt_pk_bf16_f32 v195, v198, v199
    v_mfma_f32_16x16x32_bf16 v[44:47], a[204:207], v[212:215], v[44:47]
    v_exp_f32 v200, v200
    v_mfma_f32_16x16x32_bf16 v[48:51], a[208:211], v[212:215], v[48:51]
    v_exp_f32 v201, v201
    v_mfma_f32_16x16x32_bf16 v[52:55], a[212:215], v[212:215], v[52:55]
    ds_read_b64_tr_b16 a[178:179], v242 offset:13312
    v_cvt_pk_bf16_f32 v196, v200, v201
    v_mfma_f32_16x16x32_bf16 v[56:59], a[216:219], v[212:215], v[56:59]
    v_exp_f32 v202, v202
    v_mfma_f32_16x16x32_bf16 v[60:63], a[220:223], v[212:215], v[60:63]
    v_exp_f32 v203, v203
    v_mfma_f32_16x16x32_bf16 v[208:211], a[128:131], a[64:67], v[232:235]
    ds_read_b64_tr_b16 a[180:181], v243 offset:9216
    v_cvt_pk_bf16_f32 v197, v202, v203
    v_mfma_f32_16x16x32_bf16 v[208:211], a[132:135], a[68:71], v[208:211]
    v_exp_f32 v204, v204
    v_mfma_f32_16x16x32_bf16 v[208:211], a[136:139], a[72:75], v[208:211]
    v_exp_f32 v205, v205
    v_mfma_f32_16x16x32_bf16 v[208:211], a[140:143], a[76:79], v[208:211]
    v_exp_f32 v206, v206
    v_mfma_f32_16x16x32_bf16 v[212:215], a[156:159], a[76:79], v[232:235]
    ds_read_b64_tr_b16 a[182:183], v243 offset:13312
    v_cvt_pk_bf16_f32 v198, v204, v205
    v_mfma_f32_16x16x32_bf16 v[212:215], a[152:155], a[72:75], v[212:215]
    v_exp_f32 v207, v207
    v_mfma_f32_16x16x32_bf16 v[212:215], a[148:151], a[68:71], v[212:215]
    v_cvt_pk_bf16_f32 v199, v206, v207
    v_mfma_f32_16x16x32_bf16 v[212:215], a[144:147], a[64:67], v[212:215]
    v_mfma_f32_16x16x32_bf16 v[64:67], a[192:195], v[192:195], v[64:67]
    ds_read_b64_tr_b16 a[184:185], v244 offset:9216
    v_mfma_f32_16x16x32_bf16 v[68:71], a[196:199], v[192:195], v[68:71]
    v_mfma_f32_16x16x32_bf16 v[72:75], a[200:203], v[192:195], v[72:75]
    v_mfma_f32_16x16x32_bf16 v[76:79], a[204:207], v[192:195], v[76:79]
    v_mul_f32 v208, s44, v208
    v_mul_f32 v209, s44, v209
    v_mfma_f32_16x16x32_bf16 v[80:83], a[208:211], v[192:195], v[80:83]
    v_exp_f32 v208, v208
    v_mfma_f32_16x16x32_bf16 v[84:87], a[212:215], v[192:195], v[84:87]
    ds_read_b64_tr_b16 a[186:187], v244 offset:13312
    v_mul_f32 v210, s44, v210
    v_mfma_f32_16x16x32_bf16 v[88:91], a[216:219], v[192:195], v[88:91]
    v_exp_f32 v209, v209
    v_mfma_f32_16x16x32_bf16 v[92:95], a[220:223], v[192:195], v[92:95]
    v_exp_f32 v210, v210
    v_mfma_f32_16x16x32_bf16 v[200:203], a[128:131], a[80:83], v[236:239]
    v_mul_f32 v211, s44, v211
    v_cvt_pk_bf16_f32 v208, v208, v209
    v_mfma_f32_16x16x32_bf16 v[200:203], a[132:135], a[84:87], v[200:203]
    ds_read_b64_tr_b16 a[188:189], v245 offset:9216
    v_mul_f32 v212, s44, v212
    v_mfma_f32_16x16x32_bf16 v[200:203], a[136:139], a[88:91], v[200:203]
    v_exp_f32 v211, v211
    v_mfma_f32_16x16x32_bf16 v[200:203], a[140:143], a[92:95], v[200:203]
    v_exp_f32 v212, v212
    v_mfma_f32_16x16x32_bf16 v[204:207], a[156:159], a[92:95], v[236:239]
    v_mul_f32 v213, s44, v213
    v_cvt_pk_bf16_f32 v209, v210, v211
    v_mfma_f32_16x16x32_bf16 v[204:207], a[152:155], a[88:91], v[204:207]
    ds_read_b64_tr_b16 a[190:191], v245 offset:13312
    v_mul_f32 v214, s44, v214
    v_mfma_f32_16x16x32_bf16 v[204:207], a[148:151], a[84:87], v[204:207]
    v_exp_f32 v213, v213
    v_mfma_f32_16x16x32_bf16 v[204:207], a[144:147], a[80:83], v[204:207]
    v_exp_f32 v214, v214
    v_smfmac_f32_16x16x64_bf16 a[228:231], a[244:247], v[192:199], v253
    v_mul_f32 v215, s44, v215
    v_mfma_f32_16x16x32_bf16 v[96:99], a[192:195], v[196:199], v[96:99]
    v_exp_f32 v215, v215
    v_mfma_f32_16x16x32_bf16 v[100:103], a[196:199], v[196:199], v[100:103]
    v_cvt_pk_bf16_f32 v210, v212, v213
    v_cvt_pk_bf16_f32 v211, v214, v215
    v_mfma_f32_16x16x32_bf16 v[104:107], a[200:203], v[196:199], v[104:107]
    v_mul_f32 v200, s44, v200
    v_mul_f32 v201, s44, v201
    v_mfma_f32_16x16x32_bf16 v[108:111], a[204:207], v[196:199], v[108:111]
    v_exp_f32 v200, v200
    v_mfma_f32_16x16x32_bf16 v[112:115], a[208:211], v[196:199], v[112:115]
    v_exp_f32 v201, v201
    v_mfma_f32_16x16x32_bf16 v[116:119], a[212:215], v[196:199], v[116:119]
    v_mul_f32 v202, s44, v202
    v_mul_f32 v203, s44, v203
    v_mfma_f32_16x16x32_bf16 v[120:123], a[216:219], v[196:199], v[120:123]
    v_exp_f32 v202, v202
    v_mfma_f32_16x16x32_bf16 v[124:127], a[220:223], v[196:199], v[124:127]
    s_waitcnt lgkmcnt(0)
    v_cvt_pk_bf16_f32 v212, v200, v201
    v_mul_f32 v204, s44, v204
    v_mfma_f32_16x16x32_bf16 v[192:195], a[96:99], a[0:3], v[216:219]
    s_waitcnt vmcnt(12)
    v_exp_f32 v203, v203
    v_mfma_f32_16x16x32_bf16 v[192:195], a[100:103], a[4:7], v[192:195]
    s_barrier
    v_mul_f32 v205, s44, v205
    v_mfma_f32_16x16x32_bf16 v[192:195], a[104:107], a[8:11], v[192:195]
    ds_read_b128 a[128:131], v240 offset:16384
    v_cvt_pk_bf16_f32 v213, v202, v203
    v_mfma_f32_16x16x32_bf16 v[192:195], a[108:111], a[12:15], v[192:195]
    buffer_load_dwordx4 v248, s[8:11], s30 offen sc1 nt lds
    v_mfma_f32_16x16x32_bf16 v[196:199], a[124:127], a[12:15], v[216:219]
    s_addk_i32 m0, 896
    ds_read_b128 a[132:135], v241 offset:16384
    v_mul_f32 v206, s44, v206
    v_mfma_f32_16x16x32_bf16 v[196:199], a[120:123], a[8:11], v[196:199]
    v_exp_f32 v204, v204
    v_mfma_f32_16x16x32_bf16 v[196:199], a[116:119], a[4:7], v[196:199]
    ds_read_b128 a[136:139], v240 offset:17408
    v_mul_f32 v207, s44, v207
    v_mfma_f32_16x16x32_bf16 v[196:199], a[112:115], a[0:3], v[196:199]
    v_exp_f32 v205, v205
    v_mfma_f32_16x16x32_bf16 v[128:131], a[192:195], v[208:211], v[128:131]
    ds_read_b128 a[140:143], v241 offset:17408
    v_cvt_pk_bf16_f32 v214, v204, v205
    v_mfma_f32_16x16x32_bf16 v[132:135], a[196:199], v[208:211], v[132:135]
    v_exp_f32 v206, v206
    v_mfma_f32_16x16x32_bf16 v[136:139], a[200:203], v[208:211], v[136:139]
    buffer_load_dwordx4 v248, s[8:11], s30 offen offset:128 sc1 nt lds
    v_mfma_f32_16x16x32_bf16 v[140:143], a[204:207], v[208:211], v[140:143]
    s_add_u32 m0, s28, 22528
    v_exp_f32 v207, v207
    v_mfma_f32_16x16x32_bf16 v[144:147], a[208:211], v[208:211], v[144:147]
    s_add_u32 s30, s22, 22528
    ds_read_b128 a[144:147], v240 offset:20480
    v_cvt_pk_bf16_f32 v215, v206, v207
    v_mfma_f32_16x16x32_bf16 v[148:151], a[212:215], v[208:211], v[148:151]
    v_exp_f32 v192, v192
    v_mfma_f32_16x16x32_bf16 v[152:155], a[216:219], v[208:211], v[152:155]
    buffer_load_dwordx4 v248, s[4:7], s30 offen sc1 nt lds
    v_mfma_f32_16x16x32_bf16 v[156:159], a[220:223], v[208:211], v[156:159]
    s_addk_i32 m0, 896
    v_exp_f32 v193, v193
    v_mfma_f32_16x16x32_bf16 v[200:203], a[96:99], a[16:19], v[220:223]
    ds_read_b128 a[148:151], v241 offset:20480
    v_cvt_pk_bf16_f32 v192, v192, v193
    v_mfma_f32_16x16x32_bf16 v[200:203], a[100:103], a[20:23], v[200:203]
    v_exp_f32 v194, v194
    v_mfma_f32_16x16x32_bf16 v[200:203], a[104:107], a[24:27], v[200:203]
    v_exp_f32 v195, v195
    v_mfma_f32_16x16x32_bf16 v[200:203], a[108:111], a[28:31], v[200:203]
    ds_read_b128 a[152:155], v240 offset:21504
    v_cvt_pk_bf16_f32 v193, v194, v195
    v_mfma_f32_16x16x32_bf16 v[204:207], a[124:127], a[28:31], v[220:223]
    v_exp_f32 v196, v196
    v_mfma_f32_16x16x32_bf16 v[204:207], a[120:123], a[24:27], v[204:207]
    v_exp_f32 v197, v197
    v_mfma_f32_16x16x32_bf16 v[204:207], a[116:119], a[20:23], v[204:207]
    ds_read_b128 a[156:159], v241 offset:21504
    v_cvt_pk_bf16_f32 v194, v196, v197
    v_mfma_f32_16x16x32_bf16 v[204:207], a[112:115], a[16:19], v[204:207]
    v_exp_f32 v198, v198
    v_smfmac_f32_16x16x64_bf16 a[232:235], a[244:247], v[208:215], v253
    v_mfma_f32_16x16x32_bf16 v[160:163], a[192:195], v[212:215], v[160:163]
L_pad5:
    s_cbranch_execz L_pad9
    buffer_load_dwordx4 v248, s[4:7], s30 offen offset:128 sc1 nt lds
    v_mfma_f32_16x16x32_bf16 v[164:167], a[196:199], v[212:215], v[164:167]
    s_add_u32 m0, s27, 40960
    v_exp_f32 v199, v199
    v_mfma_f32_16x16x32_bf16 v[168:171], a[200:203], v[212:215], v[168:171]
    s_add_u32 s30, s25, 8192
    ds_read_b64_tr_b16 a[192:193], v242 offset:16384
    v_cvt_pk_bf16_f32 v195, v198, v199
    v_mfma_f32_16x16x32_bf16 v[172:175], a[204:207], v[212:215], v[172:175]
    v_exp_f32 v200, v200
    v_mfma_f32_16x16x32_bf16 v[176:179], a[208:211], v[212:215], v[176:179]
    v_exp_f32 v201, v201
    v_mfma_f32_16x16x32_bf16 v[180:183], a[212:215], v[212:215], v[180:183]
    ds_read_b64_tr_b16 a[194:195], v242 offset:20480
    v_cvt_pk_bf16_f32 v196, v200, v201
    v_mfma_f32_16x16x32_bf16 v[184:187], a[216:219], v[212:215], v[184:187]
    v_exp_f32 v202, v202
    v_mfma_f32_16x16x32_bf16 v[188:191], a[220:223], v[212:215], v[188:191]
    v_exp_f32 v203, v203
    v_mfma_f32_16x16x32_bf16 v[208:211], a[96:99], a[32:35], v[224:227]
    ds_read_b64_tr_b16 a[196:197], v243 offset:16384
    v_cvt_pk_bf16_f32 v197, v202, v203
    v_mfma_f32_16x16x32_bf16 v[208:211], a[100:103], a[36:39], v[208:211]
    v_exp_f32 v204, v204
    v_mfma_f32_16x16x32_bf16 v[208:211], a[104:107], a[40:43], v[208:211]
    v_exp_f32 v205, v205
    v_mfma_f32_16x16x32_bf16 v[208:211], a[108:111], a[44:47], v[208:211]
    ds_read_b64_tr_b16 a[198:199], v243 offset:20480
    v_cvt_pk_bf16_f32 v198, v204, v205
    v_mfma_f32_16x16x32_bf16 v[212:215], a[124:127], a[44:47], v[224:227]
    v_exp_f32 v206, v206
    v_mfma_f32_16x16x32_bf16 v[212:215], a[120:123], a[40:43], v[212:215]
    v_exp_f32 v207, v207
    v_mfma_f32_16x16x32_bf16 v[212:215], a[116:119], a[36:39], v[212:215]
    ds_read_b64_tr_b16 a[200:201], v244 offset:16384
    v_cvt_pk_bf16_f32 v199, v206, v207
    v_mfma_f32_16x16x32_bf16 v[212:215], a[112:115], a[32:35], v[212:215]
    v_mfma_f32_16x16x32_bf16 v[0:3], a[160:163], v[192:195], v[0:3]
    buffer_load_dwordx4 v248, s[12:15], s30 offen sc1 nt lds
    v_mfma_f32_16x16x32_bf16 v[4:7], a[164:167], v[192:195], v[4:7]
    s_addk_i32 m0, 896
    v_mfma_f32_16x16x32_bf16 v[8:11], a[168:171], v[192:195], v[8:11]
    ds_read_b64_tr_b16 a[202:203], v244 offset:20480
    v_mfma_f32_16x16x32_bf16 v[12:15], a[172:175], v[192:195], v[12:15]
    v_mul_f32 v208, s44, v208
    v_mul_f32 v209, s44, v209
    v_mfma_f32_16x16x32_bf16 v[16:19], a[176:179], v[192:195], v[16:19]
    v_exp_f32 v208, v208
    v_mfma_f32_16x16x32_bf16 v[20:23], a[180:183], v[192:195], v[20:23]
    v_exp_f32 v209, v209
    v_mfma_f32_16x16x32_bf16 v[24:27], a[184:187], v[192:195], v[24:27]
    v_mul_f32 v210, s44, v210
    v_mul_f32 v211, s44, v211
    v_mfma_f32_16x16x32_bf16 v[28:31], a[188:191], v[192:195], v[28:31]
    ds_read_b64_tr_b16 a[204:205], v245 offset:16384
    v_cvt_pk_bf16_f32 v208, v208, v209
    v_mfma_f32_16x16x32_bf16 v[200:203], a[96:99], a[48:51], v[228:231]
    v_exp_f32 v210, v210
    v_mfma_f32_16x16x32_bf16 v[200:203], a[100:103], a[52:55], v[200:203]
    v_exp_f32 v211, v211
    v_mfma_f32_16x16x32_bf16 v[200:203], a[104:107], a[56:59], v[200:203]
    v_mul_f32 v212, s44, v212
    v_mul_f32 v213, s44, v213
    v_mfma_f32_16x16x32_bf16 v[200:203], a[108:111], a[60:63], v[200:203]
    ds_read_b64_tr_b16 a[206:207], v245 offset:20480
    v_cvt_pk_bf16_f32 v209, v210, v211
    v_mfma_f32_16x16x32_bf16 v[204:207], a[124:127], a[60:63], v[228:231]
    v_exp_f32 v212, v212
    v_mfma_f32_16x16x32_bf16 v[204:207], a[120:123], a[56:59], v[204:207]
    v_exp_f32 v213, v213
    v_mfma_f32_16x16x32_bf16 v[204:207], a[116:119], a[52:55], v[204:207]
    v_mul_f32 v214, s44, v214
    v_mul_f32 v215, s44, v215
    v_mfma_f32_16x16x32_bf16 v[204:207], a[112:115], a[48:51], v[204:207]
    v_exp_f32 v214, v214
    v_smfmac_f32_16x16x64_bf16 a[224:227], a[244:247], v[192:199], v253
    v_cvt_pk_bf16_f32 v210, v212, v213
    v_mfma_f32_16x16x32_bf16 v[32:35], a[160:163], v[196:199], v[32:35]
    buffer_load_dwordx4 v248, s[12:15], s30 offen offset:128 sc1 nt lds
    v_mfma_f32_16x16x32_bf16 v[36:39], a[164:167], v[196:199], v[36:39]
    s_addk_i32 m0, -25472
    v_exp_f32 v215, v215
    v_mfma_f32_16x16x32_bf16 v[40:43], a[168:171], v[196:199], v[40:43]
    s_addk_i32 s30, 8192
    ds_read_b64_tr_b16 a[208:209], v242 offset:17408
    v_cvt_pk_bf16_f32 v211, v214, v215
    v_mfma_f32_16x16x32_bf16 v[44:47], a[172:175], v[196:199], v[44:47]
    v_exp_f32 v200, v200
    v_mfma_f32_16x16x32_bf16 v[48:51], a[176:179], v[196:199], v[48:51]
    v_exp_f32 v201, v201
    v_mfma_f32_16x16x32_bf16 v[52:55], a[180:183], v[196:199], v[52:55]
    ds_read_b64_tr_b16 a[210:211], v242 offset:21504
    v_cvt_pk_bf16_f32 v212, v200, v201
    v_mfma_f32_16x16x32_bf16 v[56:59], a[184:187], v[196:199], v[56:59]
    v_exp_f32 v202, v202
    v_mfma_f32_16x16x32_bf16 v[60:63], a[188:191], v[196:199], v[60:63]
    v_exp_f32 v203, v203
    v_mfma_f32_16x16x32_bf16 v[192:195], a[96:99], a[64:67], v[232:235]
    ds_read_b64_tr_b16 a[212:213], v243 offset:17408
    v_cvt_pk_bf16_f32 v213, v202, v203
    v_mfma_f32_16x16x32_bf16 v[192:195], a[100:103], a[68:71], v[192:195]
    v_exp_f32 v204, v204
    v_mfma_f32_16x16x32_bf16 v[192:195], a[104:107], a[72:75], v[192:195]
    v_exp_f32 v205, v205
    v_mfma_f32_16x16x32_bf16 v[192:195], a[108:111], a[76:79], v[192:195]
    v_exp_f32 v206, v206
    v_mfma_f32_16x16x32_bf16 v[196:199], a[124:127], a[76:79], v[232:235]
    ds_read_b64_tr_b16 a[214:215], v243 offset:21504
    v_cvt_pk_bf16_f32 v214, v204, v205
    v_mfma_f32_16x16x32_bf16 v[196:199], a[120:123], a[72:75], v[196:199]
    v_exp_f32 v207, v207
    v_mfma_f32_16x16x32_bf16 v[196:199], a[116:119], a[68:71], v[196:199]
    v_cvt_pk_bf16_f32 v215, v206, v207
    v_mfma_f32_16x16x32_bf16 v[196:199], a[112:115], a[64:67], v[196:199]
    v_mfma_f32_16x16x32_bf16 v[64:67], a[160:163], v[208:211], v[64:67]
    ds_read_b64_tr_b16 a[216:217], v244 offset:17408
    v_mfma_f32_16x16x32_bf16 v[68:71], a[164:167], v[208:211], v[68:71]
    v_mfma_f32_16x16x32_bf16 v[72:75], a[168:171], v[208:211], v[72:75]
    v_mfma_f32_16x16x32_bf16 v[76:79], a[172:175], v[208:211], v[76:79]
    v_mul_f32 v192, s44, v192
    v_mul_f32 v193, s44, v193
    v_mfma_f32_16x16x32_bf16 v[80:83], a[176:179], v[208:211], v[80:83]
    v_exp_f32 v192, v192
    v_mfma_f32_16x16x32_bf16 v[84:87], a[180:183], v[208:211], v[84:87]
    ds_read_b64_tr_b16 a[218:219], v244 offset:21504
    v_mul_f32 v194, s44, v194
    v_mfma_f32_16x16x32_bf16 v[88:91], a[184:187], v[208:211], v[88:91]
    v_exp_f32 v193, v193
    v_mfma_f32_16x16x32_bf16 v[92:95], a[188:191], v[208:211], v[92:95]
    v_exp_f32 v194, v194
    v_mfma_f32_16x16x32_bf16 v[200:203], a[96:99], a[80:83], v[236:239]
    v_mul_f32 v195, s44, v195
    v_cvt_pk_bf16_f32 v192, v192, v193
    v_mfma_f32_16x16x32_bf16 v[200:203], a[100:103], a[84:87], v[200:203]
    ds_read_b64_tr_b16 a[220:221], v245 offset:17408
    v_mul_f32 v196, s44, v196
    v_mfma_f32_16x16x32_bf16 v[200:203], a[104:107], a[88:91], v[200:203]
    v_exp_f32 v195, v195
    v_mfma_f32_16x16x32_bf16 v[200:203], a[108:111], a[92:95], v[200:203]
    v_exp_f32 v196, v196
    v_mfma_f32_16x16x32_bf16 v[204:207], a[124:127], a[92:95], v[236:239]
    v_mul_f32 v197, s44, v197
    v_cvt_pk_bf16_f32 v193, v194, v195
    v_mfma_f32_16x16x32_bf16 v[204:207], a[120:123], a[88:91], v[204:207]
    ds_read_b64_tr_b16 a[222:223], v245 offset:21504
    v_mul_f32 v198, s44, v198
    v_mfma_f32_16x16x32_bf16 v[204:207], a[116:119], a[84:87], v[204:207]
    v_exp_f32 v197, v197
    v_mfma_f32_16x16x32_bf16 v[204:207], a[112:115], a[80:83], v[204:207]
    v_exp_f32 v198, v198
    v_smfmac_f32_16x16x64_bf16 a[228:231], a[244:247], v[208:215], v253
    v_mul_f32 v199, s44, v199
    v_mfma_f32_16x16x32_bf16 v[96:99], a[160:163], v[212:215], v[96:99]
    v_exp_f32 v199, v199
    v_mfma_f32_16x16x32_bf16 v[100:103], a[164:167], v[212:215], v[100:103]
    v_cvt_pk_bf16_f32 v194, v196, v197
    v_cvt_pk_bf16_f32 v195, v198, v199
    v_mfma_f32_16x16x32_bf16 v[104:107], a[168:171], v[212:215], v[104:107]
    v_mul_f32 v200, s44, v200
    v_mul_f32 v201, s44, v201
    v_mfma_f32_16x16x32_bf16 v[108:111], a[172:175], v[212:215], v[108:111]
    v_exp_f32 v200, v200
    v_mfma_f32_16x16x32_bf16 v[112:115], a[176:179], v[212:215], v[112:115]
    v_exp_f32 v201, v201
    v_mfma_f32_16x16x32_bf16 v[116:119], a[180:183], v[212:215], v[116:119]
    v_mul_f32 v202, s44, v202
    v_mul_f32 v203, s44, v203
    v_mfma_f32_16x16x32_bf16 v[120:123], a[184:187], v[212:215], v[120:123]
    v_exp_f32 v202, v202
    v_mfma_f32_16x16x32_bf16 v[124:127], a[188:191], v[212:215], v[124:127]
    s_waitcnt lgkmcnt(0)
    v_cvt_pk_bf16_f32 v196, v200, v201
    v_mul_f32 v204, s44, v204
    v_mfma_f32_16x16x32_bf16 v[208:211], a[128:131], a[0:3], v[216:219]
    s_waitcnt vmcnt(12)
    v_exp_f32 v203, v203
    v_mfma_f32_16x16x32_bf16 v[208:211], a[132:135], a[4:7], v[208:211]
    s_barrier
    v_mul_f32 v205, s44, v205
    v_mfma_f32_16x16x32_bf16 v[208:211], a[136:139], a[8:11], v[208:211]
    ds_read_b128 a[96:99], v240 offset:24576
    v_cvt_pk_bf16_f32 v197, v202, v203
    v_mfma_f32_16x16x32_bf16 v[208:211], a[140:143], a[12:15], v[208:211]
    buffer_load_dwordx4 v248, s[8:11], s30 offen sc1 nt lds
    v_mfma_f32_16x16x32_bf16 v[212:215], a[156:159], a[12:15], v[216:219]
    s_addk_i32 m0, 896
    ds_read_b128 a[100:103], v241 offset:24576
    v_mul_f32 v206, s44, v206
    v_mfma_f32_16x16x32_bf16 v[212:215], a[152:155], a[8:11], v[212:215]
    v_exp_f32 v204, v204
    v_mfma_f32_16x16x32_bf16 v[212:215], a[148:151], a[4:7], v[212:215]
    ds_read_b128 a[104:107], v240 offset:25600
    v_mul_f32 v207, s44, v207
    v_mfma_f32_16x16x32_bf16 v[212:215], a[144:147], a[0:3], v[212:215]
    v_exp_f32 v205, v205
    v_mfma_f32_16x16x32_bf16 v[128:131], a[160:163], v[192:195], v[128:131]
    ds_read_b128 a[108:111], v241 offset:25600
    v_cvt_pk_bf16_f32 v198, v204, v205
    v_mfma_f32_16x16x32_bf16 v[132:135], a[164:167], v[192:195], v[132:135]
    v_exp_f32 v206, v206
    v_mfma_f32_16x16x32_bf16 v[136:139], a[168:171], v[192:195], v[136:139]
    v_exp_f32 v207, v207
    v_mfma_f32_16x16x32_bf16 v[140:143], a[172:175], v[192:195], v[140:143]
    ds_read_b128 a[112:115], v240 offset:28672
    v_cvt_pk_bf16_f32 v199, v206, v207
    v_mfma_f32_16x16x32_bf16 v[144:147], a[176:179], v[192:195], v[144:147]
    buffer_load_dwordx4 v248, s[8:11], s30 offen offset:128 sc1 nt lds
    v_mfma_f32_16x16x32_bf16 v[148:151], a[180:183], v[192:195], v[148:151]
    s_addk_i32 m0, 31872
    v_exp_f32 v208, v208
    v_mfma_f32_16x16x32_bf16 v[152:155], a[184:187], v[192:195], v[152:155]
    v_exp_f32 v209, v209
    v_mfma_f32_16x16x32_bf16 v[156:159], a[188:191], v[192:195], v[156:159]
    ds_read_b128 a[116:119], v241 offset:28672
    v_cvt_pk_bf16_f32 v208, v208, v209
    v_mfma_f32_16x16x32_bf16 v[200:203], a[128:131], a[16:19], v[220:223]
    v_exp_f32 v210, v210
    v_mfma_f32_16x16x32_bf16 v[200:203], a[132:135], a[20:23], v[200:203]
    v_exp_f32 v211, v211
    v_mfma_f32_16x16x32_bf16 v[200:203], a[136:139], a[24:27], v[200:203]
    ds_read_b128 a[120:123], v240 offset:29696
    v_cvt_pk_bf16_f32 v209, v210, v211
    v_mfma_f32_16x16x32_bf16 v[200:203], a[140:143], a[28:31], v[200:203]
    v_exp_f32 v212, v212
    v_mfma_f32_16x16x32_bf16 v[204:207], a[156:159], a[28:31], v[220:223]
    v_exp_f32 v213, v213
    v_mfma_f32_16x16x32_bf16 v[204:207], a[152:155], a[24:27], v[204:207]
    ds_read_b128 a[124:127], v241 offset:29696
    v_cvt_pk_bf16_f32 v210, v212, v213
    v_mfma_f32_16x16x32_bf16 v[204:207], a[148:151], a[20:23], v[204:207]
    v_exp_f32 v214, v214
    v_mfma_f32_16x16x32_bf16 v[204:207], a[144:147], a[16:19], v[204:207]
    v_exp_f32 v215, v215
    v_smfmac_f32_16x16x64_bf16 a[232:235], a[244:247], v[192:199], v253
    v_cvt_pk_bf16_f32 v211, v214, v215
    v_mfma_f32_16x16x32_bf16 v[160:163], a[160:163], v[196:199], v[160:163]
    ds_read_b64_tr_b16 a[160:161], v242 offset:24576
    v_mfma_f32_16x16x32_bf16 v[164:167], a[164:167], v[196:199], v[164:167]
    ds_read_b64_tr_b16 a[162:163], v242 offset:28672
    v_mfma_f32_16x16x32_bf16 v[168:171], a[168:171], v[196:199], v[168:171]
    v_exp_f32 v200, v200
    v_mfma_f32_16x16x32_bf16 v[172:175], a[172:175], v[196:199], v[172:175]
    v_exp_f32 v201, v201
    v_mfma_f32_16x16x32_bf16 v[176:179], a[176:179], v[196:199], v[176:179]
    v_exp_f32 v202, v202
    v_mfma_f32_16x16x32_bf16 v[180:183], a[180:183], v[196:199], v[180:183]
    ds_read_b64_tr_b16 a[164:165], v243 offset:24576
    v_cvt_pk_bf16_f32 v212, v200, v201
    v_mfma_f32_16x16x32_bf16 v[184:187], a[184:187], v[196:199], v[184:187]
    v_exp_f32 v203, v203
    v_mfma_f32_16x16x32_bf16 v[188:191], a[188:191], v[196:199], v[188:191]
    v_exp_f32 v204, v204
    v_mfma_f32_16x16x32_bf16 v[192:195], a[128:131], a[32:35], v[224:227]
    v_exp_f32 v205, v205
    v_mfma_f32_16x16x32_bf16 v[192:195], a[132:135], a[36:39], v[192:195]
    v_cvt_pk_bf16_f32 v213, v202, v203
    v_cvt_pk_bf16_f32 v214, v204, v205
    v_mfma_f32_16x16x32_bf16 v[192:195], a[136:139], a[40:43], v[192:195]
    v_exp_f32 v206, v206
    v_mfma_f32_16x16x32_bf16 v[192:195], a[140:143], a[44:47], v[192:195]
    v_exp_f32 v207, v207
    v_mfma_f32_16x16x32_bf16 v[196:199], a[156:159], a[44:47], v[224:227]
    ds_read_b64_tr_b16 a[166:167], v243 offset:28672
    v_cvt_pk_bf16_f32 v215, v206, v207
    v_mfma_f32_16x16x32_bf16 v[196:199], a[152:155], a[40:43], v[196:199]
    v_mfma_f32_16x16x32_bf16 v[196:199], a[148:151], a[36:39], v[196:199]
    ds_read_b64_tr_b16 a[168:169], v244 offset:24576
    v_mfma_f32_16x16x32_bf16 v[196:199], a[144:147], a[32:35], v[196:199]
    v_mfma_f32_16x16x32_bf16 v[0:3], a[192:195], v[208:211], v[0:3]
    buffer_load_dwordx4 v248, s[12:15], s30 offen sc1 nt lds
    v_mfma_f32_16x16x32_bf16 v[4:7], a[196:199], v[208:211], v[4:7]
    s_addk_i32 m0, 896
    v_mfma_f32_16x16x32_bf16 v[8:11], a[200:203], v[208:211], v[8:11]
    ds_read_b64_tr_b16 a[170:171], v244 offset:28672
    v_mfma_f32_16x16x32_bf16 v[12:15], a[204:207], v[208:211], v[12:15]
    v_mul_f32 v192, s44, v192
    v_mul_f32 v193, s44, v193
    v_mfma_f32_16x16x32_bf16 v[16:19], a[208:211], v[208:211], v[16:19]
    v_exp_f32 v192, v192
    v_mfma_f32_16x16x32_bf16 v[20:23], a[212:215], v[208:211], v[20:23]
    v_exp_f32 v193, v193
    v_mfma_f32_16x16x32_bf16 v[24:27], a[216:219], v[208:211], v[24:27]
    v_mul_f32 v194, s44, v194
    v_mul_f32 v195, s44, v195
    v_mfma_f32_16x16x32_bf16 v[28:31], a[220:223], v[208:211], v[28:31]
    ds_read_b64_tr_b16 a[172:173], v245 offset:24576
    v_cvt_pk_bf16_f32 v192, v192, v193
    v_mfma_f32_16x16x32_bf16 v[200:203], a[128:131], a[48:51], v[228:231]
    v_exp_f32 v194, v194
    v_mfma_f32_16x16x32_bf16 v[200:203], a[132:135], a[52:55], v[200:203]
    v_exp_f32 v195, v195
    v_mfma_f32_16x16x32_bf16 v[200:203], a[136:139], a[56:59], v[200:203]
    v_mul_f32 v196, s44, v196
    v_mul_f32 v197, s44, v197
    v_mfma_f32_16x16x32_bf16 v[200:203], a[140:143], a[60:63], v[200:203]
    ds_read_b64_tr_b16 a[174:175], v245 offset:28672
    v_cvt_pk_bf16_f32 v193, v194, v195
    v_mfma_f32_16x16x32_bf16 v[204:207], a[156:159], a[60:63], v[228:231]
    v_exp_f32 v196, v196
    v_mfma_f32_16x16x32_bf16 v[204:207], a[152:155], a[56:59], v[204:207]
    v_exp_f32 v197, v197
    v_mfma_f32_16x16x32_bf16 v[204:207], a[148:151], a[52:55], v[204:207]
    v_mul_f32 v198, s44, v198
    v_mul_f32 v199, s44, v199
    v_mfma_f32_16x16x32_bf16 v[204:207], a[144:147], a[48:51], v[204:207]
    v_exp_f32 v198, v198
    v_smfmac_f32_16x16x64_bf16 a[224:227], a[244:247], v[208:215], v253
    v_cvt_pk_bf16_f32 v194, v196, v197
    v_mfma_f32_16x16x32_bf16 v[32:35], a[192:195], v[212:215], v[32:35]
    buffer_load_dwordx4 v248, s[12:15], s30 offen offset:128 sc1 nt lds
    v_mfma_f32_16x16x32_bf16 v[36:39], a[196:199], v[212:215], v[36:39]
    s_addk_i32 m0, -25472
    v_exp_f32 v199, v199
    v_mfma_f32_16x16x32_bf16 v[40:43], a[200:203], v[212:215], v[40:43]
    s_addk_i32 s30, 8192
    ds_read_b64_tr_b16 a[176:177], v242 offset:25600
    v_cvt_pk_bf16_f32 v195, v198, v199
    v_mfma_f32_16x16x32_bf16 v[44:47], a[204:207], v[212:215], v[44:47]
    v_exp_f32 v200, v200
    v_mfma_f32_16x16x32_bf16 v[48:51], a[208:211], v[212:215], v[48:51]
    v_exp_f32 v201, v201
    v_mfma_f32_16x16x32_bf16 v[52:55], a[212:215], v[212:215], v[52:55]
    ds_read_b64_tr_b16 a[178:179], v242 offset:29696
    v_cvt_pk_bf16_f32 v196, v200, v201
    v_mfma_f32_16x16x32_bf16 v[56:59], a[216:219], v[212:215], v[56:59]
    v_exp_f32 v202, v202
    v_mfma_f32_16x16x32_bf16 v[60:63], a[220:223], v[212:215], v[60:63]
    v_exp_f32 v203, v203
    v_mfma_f32_16x16x32_bf16 v[208:211], a[128:131], a[64:67], v[232:235]
    ds_read_b64_tr_b16 a[180:181], v243 offset:25600
    v_cvt_pk_bf16_f32 v197, v202, v203
    v_mfma_f32_16x16x32_bf16 v[208:211], a[132:135], a[68:71], v[208:211]
    v_exp_f32 v204, v204
    v_mfma_f32_16x16x32_bf16 v[208:211], a[136:139], a[72:75], v[208:211]
    v_exp_f32 v205, v205
    v_mfma_f32_16x16x32_bf16 v[208:211], a[140:143], a[76:79], v[208:211]
    v_exp_f32 v206, v206
    v_mfma_f32_16x16x32_bf16 v[212:215], a[156:159], a[76:79], v[232:235]
    ds_read_b64_tr_b16 a[182:183], v243 offset:29696
    v_cvt_pk_bf16_f32 v198, v204, v205
    v_mfma_f32_16x16x32_bf16 v[212:215], a[152:155], a[72:75], v[212:215]
    v_exp_f32 v207, v207
    v_mfma_f32_16x16x32_bf16 v[212:215], a[148:151], a[68:71], v[212:215]
    v_cvt_pk_bf16_f32 v199, v206, v207
    v_mfma_f32_16x16x32_bf16 v[212:215], a[144:147], a[64:67], v[212:215]
    v_mfma_f32_16x16x32_bf16 v[64:67], a[192:195], v[192:195], v[64:67]
    ds_read_b64_tr_b16 a[184:185], v244 offset:25600
    v_mfma_f32_16x16x32_bf16 v[68:71], a[196:199], v[192:195], v[68:71]
    v_mfma_f32_16x16x32_bf16 v[72:75], a[200:203], v[192:195], v[72:75]
    v_mfma_f32_16x16x32_bf16 v[76:79], a[204:207], v[192:195], v[76:79]
    v_mul_f32 v208, s44, v208
    v_mul_f32 v209, s44, v209
    v_mfma_f32_16x16x32_bf16 v[80:83], a[208:211], v[192:195], v[80:83]
    v_exp_f32 v208, v208
    v_mfma_f32_16x16x32_bf16 v[84:87], a[212:215], v[192:195], v[84:87]
    ds_read_b64_tr_b16 a[186:187], v244 offset:29696
    v_mul_f32 v210, s44, v210
    v_mfma_f32_16x16x32_bf16 v[88:91], a[216:219], v[192:195], v[88:91]
    v_exp_f32 v209, v209
    v_mfma_f32_16x16x32_bf16 v[92:95], a[220:223], v[192:195], v[92:95]
    v_exp_f32 v210, v210
    v_mfma_f32_16x16x32_bf16 v[200:203], a[128:131], a[80:83], v[236:239]
    v_mul_f32 v211, s44, v211
    v_cvt_pk_bf16_f32 v208, v208, v209
    v_mfma_f32_16x16x32_bf16 v[200:203], a[132:135], a[84:87], v[200:203]
    ds_read_b64_tr_b16 a[188:189], v245 offset:25600
    v_mul_f32 v212, s44, v212
    v_mfma_f32_16x16x32_bf16 v[200:203], a[136:139], a[88:91], v[200:203]
    v_exp_f32 v211, v211
    v_mfma_f32_16x16x32_bf16 v[200:203], a[140:143], a[92:95], v[200:203]
    v_exp_f32 v212, v212
    v_mfma_f32_16x16x32_bf16 v[204:207], a[156:159], a[92:95], v[236:239]
    v_mul_f32 v213, s44, v213
    v_cvt_pk_bf16_f32 v209, v210, v211
    v_mfma_f32_16x16x32_bf16 v[204:207], a[152:155], a[88:91], v[204:207]
    ds_read_b64_tr_b16 a[190:191], v245 offset:29696
    v_mul_f32 v214, s44, v214
    v_mfma_f32_16x16x32_bf16 v[204:207], a[148:151], a[84:87], v[204:207]
    v_exp_f32 v213, v213
    v_mfma_f32_16x16x32_bf16 v[204:207], a[144:147], a[80:83], v[204:207]
    v_exp_f32 v214, v214
    v_smfmac_f32_16x16x64_bf16 a[228:231], a[244:247], v[192:199], v253
    v_mul_f32 v215, s44, v215
    v_mfma_f32_16x16x32_bf16 v[96:99], a[192:195], v[196:199], v[96:99]
    v_exp_f32 v215, v215
    v_mfma_f32_16x16x32_bf16 v[100:103], a[196:199], v[196:199], v[100:103]
    v_cvt_pk_bf16_f32 v210, v212, v213
    v_cvt_pk_bf16_f32 v211, v214, v215
    v_mfma_f32_16x16x32_bf16 v[104:107], a[200:203], v[196:199], v[104:107]
    v_mul_f32 v200, s44, v200
    v_mul_f32 v201, s44, v201
    v_mfma_f32_16x16x32_bf16 v[108:111], a[204:207], v[196:199], v[108:111]
    v_exp_f32 v200, v200
    v_mfma_f32_16x16x32_bf16 v[112:115], a[208:211], v[196:199], v[112:115]
    v_exp_f32 v201, v201
    v_mfma_f32_16x16x32_bf16 v[116:119], a[212:215], v[196:199], v[116:119]
    v_mul_f32 v202, s44, v202
    v_mul_f32 v203, s44, v203
    v_mfma_f32_16x16x32_bf16 v[120:123], a[216:219], v[196:199], v[120:123]
    v_exp_f32 v202, v202
    v_mfma_f32_16x16x32_bf16 v[124:127], a[220:223], v[196:199], v[124:127]
    s_waitcnt lgkmcnt(0)
    v_cvt_pk_bf16_f32 v212, v200, v201
    v_mul_f32 v204, s44, v204
    v_mfma_f32_16x16x32_bf16 v[192:195], a[96:99], a[0:3], v[216:219]
    s_waitcnt vmcnt(10)
    v_exp_f32 v203, v203
    v_mfma_f32_16x16x32_bf16 v[192:195], a[100:103], a[4:7], v[192:195]
    s_barrier
    v_mul_f32 v205, s44, v205
    v_mfma_f32_16x16x32_bf16 v[192:195], a[104:107], a[8:11], v[192:195]
    ds_read_b128 a[128:131], v240 offset:0
    v_cvt_pk_bf16_f32 v213, v202, v203
    v_mfma_f32_16x16x32_bf16 v[192:195], a[108:111], a[12:15], v[192:195]
    buffer_load_dwordx4 v248, s[8:11], s30 offen sc1 nt lds
    v_mfma_f32_16x16x32_bf16 v[196:199], a[124:127], a[12:15], v[216:219]
    s_addk_i32 m0, 896
    ds_read_b128 a[132:135], v241 offset:0
    v_mul_f32 v206, s44, v206
    v_mfma_f32_16x16x32_bf16 v[196:199], a[120:123], a[8:11], v[196:199]
    ds_read_b128 a[12:15], v247 offset:1024
    v_mul_f32 v207, s44, v207
    v_mfma_f32_16x16x32_bf16 v[196:199], a[116:119], a[4:7], v[196:199]
    v_exp_f32 v204, v204
    v_mfma_f32_16x16x32_bf16 v[196:199], a[112:115], a[0:3], v[196:199]
    v_exp_f32 v205, v205
    v_mfma_f32_16x16x32_bf16 v[128:131], a[192:195], v[208:211], v[128:131]
    ds_read_b128 a[8:11], v246 offset:1024
    v_cvt_pk_bf16_f32 v214, v204, v205
    v_mfma_f32_16x16x32_bf16 v[132:135], a[196:199], v[208:211], v[132:135]
    v_exp_f32 v206, v206
    v_mfma_f32_16x16x32_bf16 v[136:139], a[200:203], v[208:211], v[136:139]
    v_exp_f32 v207, v207
    v_mfma_f32_16x16x32_bf16 v[140:143], a[204:207], v[208:211], v[140:143]
    s_add_u32 s31, s21, 0
    ds_read_b128 a[136:139], v240 offset:1024
    v_cvt_pk_bf16_f32 v215, v206, v207
    v_mfma_f32_16x16x32_bf16 v[144:147], a[208:211], v[208:211], v[144:147]
    ds_read_b128 a[4:7], v247 offset:0
    v_exp_f32 v192, v192
    v_mfma_f32_16x16x32_bf16 v[148:151], a[212:215], v[208:211], v[148:151]
    buffer_load_dwordx4 v248, s[8:11], s30 offen offset:128 sc1 nt lds
    ds_read_b128 a[0:3], v246 offset:0
    v_mfma_f32_16x16x32_bf16 v[152:155], a[216:219], v[208:211], v[152:155]
    s_addk_i32 m0, 31872
    ds_read_b128 a[140:143], v241 offset:1024
    v_exp_f32 v193, v193
    v_mfma_f32_16x16x32_bf16 v[156:159], a[220:223], v[208:211], v[156:159]
    ds_read_b128 a[144:147], v240 offset:4096
    v_cvt_pk_bf16_f32 v192, v192, v193
    v_mfma_f32_16x16x32_bf16 v[200:203], a[96:99], a[16:19], v[220:223]
    v_exp_f32 v194, v194
    v_mfma_f32_16x16x32_bf16 v[200:203], a[100:103], a[20:23], v[200:203]
    v_exp_f32 v195, v195
    v_mfma_f32_16x16x32_bf16 v[200:203], a[104:107], a[24:27], v[200:203]
    ds_read_b128 a[148:151], v241 offset:4096
    v_cvt_pk_bf16_f32 v193, v194, v195
    v_mfma_f32_16x16x32_bf16 v[200:203], a[108:111], a[28:31], v[200:203]
    v_exp_f32 v196, v196
    v_mfma_f32_16x16x32_bf16 v[204:207], a[124:127], a[28:31], v[220:223]
    v_exp_f32 v197, v197
    v_mfma_f32_16x16x32_bf16 v[204:207], a[120:123], a[24:27], v[204:207]
    ds_read_b128 a[152:155], v240 offset:5120
    v_cvt_pk_bf16_f32 v194, v196, v197
    v_mfma_f32_16x16x32_bf16 v[204:207], a[116:119], a[20:23], v[204:207]
    v_exp_f32 v198, v198
    v_mfma_f32_16x16x32_bf16 v[204:207], a[112:115], a[16:19], v[204:207]
    v_exp_f32 v199, v199
    v_smfmac_f32_16x16x64_bf16 a[232:235], a[244:247], v[208:215], v253
    ds_read_b128 a[28:31], v247 offset:5120
    v_mfma_f32_16x16x32_bf16 v[160:163], a[192:195], v[212:215], v[160:163]
    ds_read_b128 a[156:159], v241 offset:5120
    v_cvt_pk_bf16_f32 v195, v198, v199
    v_mfma_f32_16x16x32_bf16 v[164:167], a[196:199], v[212:215], v[164:167]
    ds_read_b128 a[24:27], v246 offset:5120
    v_mfma_f32_16x16x32_bf16 v[168:171], a[200:203], v[212:215], v[168:171]
    v_exp_f32 v200, v200
    v_mfma_f32_16x16x32_bf16 v[172:175], a[204:207], v[212:215], v[172:175]
    ds_read_b128 a[20:23], v247 offset:4096
    v_exp_f32 v201, v201
    v_mfma_f32_16x16x32_bf16 v[176:179], a[208:211], v[212:215], v[176:179]
    ds_read_b128 a[16:19], v246 offset:4096
    ds_read_b64_tr_b16 a[192:193], v242 offset:0
    v_mfma_f32_16x16x32_bf16 v[180:183], a[212:215], v[212:215], v[180:183]
    ds_read_b64_tr_b16 a[194:195], v242 offset:4096
    v_cvt_pk_bf16_f32 v200, v200, v201
    v_mfma_f32_16x16x32_bf16 v[184:187], a[216:219], v[212:215], v[184:187]
    v_exp_f32 v202, v202
    v_mfma_f32_16x16x32_bf16 v[188:191], a[220:223], v[212:215], v[188:191]
    v_exp_f32 v203, v203
    v_mfma_f32_16x16x32_bf16 v[208:211], a[96:99], a[32:35], v[224:227]
    ds_read_b64_tr_b16 a[196:197], v243 offset:0
    v_cvt_pk_bf16_f32 v201, v202, v203
    v_mfma_f32_16x16x32_bf16 v[208:211], a[100:103], a[36:39], v[208:211]
    v_exp_f32 v204, v204
    v_mfma_f32_16x16x32_bf16 v[208:211], a[104:107], a[40:43], v[208:211]
    v_exp_f32 v205, v205
    v_mfma_f32_16x16x32_bf16 v[208:211], a[108:111], a[44:47], v[208:211]
    ds_read_b64_tr_b16 a[198:199], v243 offset:4096
    v_cvt_pk_bf16_f32 v202, v204, v205
    v_mfma_f32_16x16x32_bf16 v[212:215], a[124:127], a[44:47], v[224:227]
    v_exp_f32 v206, v206
    v_mfma_f32_16x16x32_bf16 v[212:215], a[120:123], a[40:43], v[212:215]
    v_exp_f32 v207, v207
    v_mfma_f32_16x16x32_bf16 v[212:215], a[116:119], a[36:39], v[212:215]
    ds_read_b128 a[44:47], v247 offset:9216
    v_cvt_pk_bf16_f32 v203, v206, v207
    v_mfma_f32_16x16x32_bf16 v[212:215], a[112:115], a[32:35], v[212:215]
    ds_read_b128 a[40:43], v246 offset:9216
    v_mfma_f32_16x16x32_bf16 a[224:227], a[236:239], v[192:195], a[224:227]
    ds_read_b128 a[36:39], v247 offset:8192
    v_mfma_f32_16x16x32_bf16 v[0:3], a[160:163], v[192:195], v[0:3]
    buffer_load_dwordx4 v248, s[12:15], s30 offen sc1 nt lds
    v_mfma_f32_16x16x32_bf16 v[4:7], a[164:167], v[192:195], v[4:7]
    s_addk_i32 m0, 896
    ds_read_b128 a[32:35], v246 offset:8192
    v_mfma_f32_16x16x32_bf16 v[8:11], a[168:171], v[192:195], v[8:11]
    ds_read_b64_tr_b16 a[200:201], v244 offset:0
    v_mul_f32 v208, s44, v208
    v_mfma_f32_16x16x32_bf16 v[12:15], a[172:175], v[192:195], v[12:15]
    v_accvgpr_read_b32 v217, a225
    v_accvgpr_read_b32 v252, a224
    v_mfma_f32_16x16x32_bf16 v[16:19], a[176:179], v[192:195], v[16:19]
    v_add_f32 v252, v252, v217
    v_cmp_nge_f32 vcc, s46, v252
    v_mfma_f32_16x16x32_bf16 v[20:23], a[180:183], v[192:195], v[20:23]
    v_rcp_f32 v252, v252
    v_mfma_f32_16x16x32_bf16 v[24:27], a[184:187], v[192:195], v[24:27]
    s_or_b64 s[32:33], s[32:33], vcc
    ds_read_b64_tr_b16 a[202:203], v244 offset:4096
    v_mul_f32 v209, s44, v209
    v_mfma_f32_16x16x32_bf16 v[28:31], a[188:191], v[192:195], v[28:31]
    v_exp_f32 v208, v208
    v_exp_f32 v209, v209
    v_mul_f32 v210, s44, v210
    v_pk_mul_f32 v[0:1], v[0:1], v[252:253] op_sel_hi:[1,0]
    v_pk_mul_f32 v[2:3], v[2:3], v[252:253] op_sel_hi:[1,0]
    v_pk_mul_f32 v[4:5], v[4:5], v[252:253] op_sel_hi:[1,0]
    v_pk_mul_f32 v[6:7], v[6:7], v[252:253] op_sel_hi:[1,0]
    v_cvt_pk_bf16_f32 v0, v0, v1
    v_cvt_pk_bf16_f32 v1, v2, v3
    v_cvt_pk_bf16_f32 v4, v4, v5
    v_cvt_pk_bf16_f32 v5, v6, v7
    v_mfma_f32_16x16x32_bf16 v[192:195], a[96:99], a[48:51], v[228:231]
    ds_write_b64 v249, v[0:1] offset:0
    v_mfma_f32_16x16x32_bf16 v[192:195], a[100:103], a[52:55], v[192:195]
    ds_read_b64_tr_b16 a[204:205], v245 offset:0
    v_mul_f32 v211, s44, v211
    v_mfma_f32_16x16x32_bf16 v[192:195], a[104:107], a[56:59], v[192:195]
    v_exp_f32 v210, v210
    v_mfma_f32_16x16x32_bf16 v[192:195], a[108:111], a[60:63], v[192:195]
    ds_write_b64 v249, v[4:5] offset:32
    v_cvt_pk_bf16_f32 v208, v208, v209
    v_mul_f32 v212, s44, v212
    v_pk_mul_f32 v[8:9], v[8:9], v[252:253] op_sel_hi:[1,0]
    v_pk_mul_f32 v[10:11], v[10:11], v[252:253] op_sel_hi:[1,0]
    v_pk_mul_f32 v[12:13], v[12:13], v[252:253] op_sel_hi:[1,0]
    v_pk_mul_f32 v[14:15], v[14:15], v[252:253] op_sel_hi:[1,0]
    v_cvt_pk_bf16_f32 v8, v8, v9
    v_cvt_pk_bf16_f32 v9, v10, v11
    v_cvt_pk_bf16_f32 v12, v12, v13
    v_cvt_pk_bf16_f32 v13, v14, v15
    v_mfma_f32_16x16x32_bf16 v[196:199], a[124:127], a[60:63], v[228:231]
    v_exp_f32 v211, v211
    v_mfma_f32_16x16x32_bf16 v[196:199], a[120:123], a[56:59], v[196:199]
    ds_write_b64 v249, v[8:9] offset:64
    v_mfma_f32_16x16x32_bf16 v[196:199], a[116:119], a[52:55], v[196:199]
    ds_read_b128 a[60:63], v247 offset:13312
    v_mul_f32 v213, s44, v213
    v_mfma_f32_16x16x32_bf16 v[196:199], a[112:115], a[48:51], v[196:199]
    ds_read_b64_tr_b16 a[206:207], v245 offset:4096
    ds_write_b64 v249, v[12:13] offset:96
    v_cvt_pk_bf16_f32 v209, v210, v211
    v_pk_mul_f32 v[16:17], v[16:17], v[252:253] op_sel_hi:[1,0]
    v_pk_mul_f32 v[18:19], v[18:19], v[252:253] op_sel_hi:[1,0]
    v_pk_mul_f32 v[20:21], v[20:21], v[252:253] op_sel_hi:[1,0]
    v_pk_mul_f32 v[22:23], v[22:23], v[252:253] op_sel_hi:[1,0]
    v_cvt_pk_bf16_f32 v16, v16, v17
    v_cvt_pk_bf16_f32 v17, v18, v19
    v_cvt_pk_bf16_f32 v20, v20, v21
    v_cvt_pk_bf16_f32 v21, v22, v23
    v_mfma_f32_16x16x32_bf16 a[224:227], a[240:243], v[200:203], a[224:227]
    v_exp_f32 v212, v212
    v_mfma_f32_16x16x32_bf16 v[32:35], a[160:163], v[200:203], v[32:35]
    ds_read_b128 a[56:59], v246 offset:13312
    v_mul_f32 v214, s44, v214
    v_mfma_f32_16x16x32_bf16 v[36:39], a[164:167], v[200:203], v[36:39]
    ds_read_b128 a[52:55], v247 offset:12288
    v_mul_f32 v215, s44, v215
    v_mfma_f32_16x16x32_bf16 v[40:43], a[168:171], v[200:203], v[40:43]
    ds_write_b64 v249, v[16:17] offset:128
    v_exp_f32 v213, v213
    v_pk_mul_f32 v[24:25], v[24:25], v[252:253] op_sel_hi:[1,0]
    v_pk_mul_f32 v[26:27], v[26:27], v[252:253] op_sel_hi:[1,0]
    v_pk_mul_f32 v[28:29], v[28:29], v[252:253] op_sel_hi:[1,0]
    v_pk_mul_f32 v[30:31], v[30:31], v[252:253] op_sel_hi:[1,0]
    v_cvt_pk_bf16_f32 v24, v24, v25
    v_cvt_pk_bf16_f32 v25, v26, v27
    v_cvt_pk_bf16_f32 v28, v28, v29
    v_cvt_pk_bf16_f32 v29, v30, v31
    v_mfma_f32_16x16x32_bf16 v[44:47], a[172:175], v[200:203], v[44:47]
    ds_read_b128 a[48:51], v246 offset:12288
    v_accvgpr_read_b32 v221, a227
    v_mfma_f32_16x16x32_bf16 v[48:51], a[176:179], v[200:203], v[48:51]
    v_accvgpr_read_b32 v254, a226
    v_cvt_pk_bf16_f32 v210, v212, v213
    v_mfma_f32_16x16x32_bf16 v[52:55], a[180:183], v[200:203], v[52:55]
L_pad6:
    s_cbranch_execz L_pad10
    v_exp_f32 v214, v214
    v_add_f32 v254, v254, v221
    v_mfma_f32_16x16x32_bf16 v[56:59], a[184:187], v[200:203], v[56:59]
    ds_read_b64_tr_b16 a[208:209], v242 offset:1024
    ds_write_b64 v249, v[20:21] offset:160
    v_cmp_nge_f32 vcc, s46, v254
    v_mfma_f32_16x16x32_bf16 v[60:63], a[188:191], v[200:203], v[60:63]
    buffer_load_dwordx4 v248, s[12:15], s30 offen offset:128 sc1 nt lds
    v_exp_f32 v215, v215
    v_rcp_f32 v254, v254
    v_mfma_f32_16x16x32_bf16 v[200:203], a[96:99], a[64:67], v[232:235]
    s_or_b64 s[32:33], s[32:33], vcc
    ds_write_b64 v249, v[24:25] offset:192
    ds_read_b64_tr_b16 a[210:211], v242 offset:5120
    v_cvt_pk_bf16_f32 v211, v214, v215
    v_pk_mul_f32 v[32:33], v[32:33], v[254:255] op_sel_hi:[1,0]
    v_pk_mul_f32 v[34:35], v[34:35], v[254:255] op_sel_hi:[1,0]
    v_pk_mul_f32 v[36:37], v[36:37], v[254:255] op_sel_hi:[1,0]
    v_pk_mul_f32 v[38:39], v[38:39], v[254:255] op_sel_hi:[1,0]
    v_cvt_pk_bf16_f32 v32, v32, v33
    v_cvt_pk_bf16_f32 v33, v34, v35
    v_cvt_pk_bf16_f32 v36, v36, v37
    v_cvt_pk_bf16_f32 v37, v38, v39
    v_mfma_f32_16x16x32_bf16 v[200:203], a[100:103], a[68:71], v[200:203]
    s_mov_b32 m0, s27
    v_exp_f32 v192, v192
    v_mfma_f32_16x16x32_bf16 v[200:203], a[104:107], a[72:75], v[200:203]
    s_addk_i32 s30, 8192
    ds_write_b64 v249, v[28:29] offset:224
    v_mfma_f32_16x16x32_bf16 v[200:203], a[108:111], a[76:79], v[200:203]
    ds_read_b128 a[248:251], v250 offset:0
    v_exp_f32 v193, v193
    v_exp_f32 v194, v194
    v_pk_mul_f32 v[40:41], v[40:41], v[254:255] op_sel_hi:[1,0]
    v_pk_mul_f32 v[42:43], v[42:43], v[254:255] op_sel_hi:[1,0]
    v_pk_mul_f32 v[44:45], v[44:45], v[254:255] op_sel_hi:[1,0]
    v_pk_mul_f32 v[46:47], v[46:47], v[254:255] op_sel_hi:[1,0]
    v_cvt_pk_bf16_f32 v40, v40, v41
    v_cvt_pk_bf16_f32 v41, v42, v43
    v_cvt_pk_bf16_f32 v44, v44, v45
    v_cvt_pk_bf16_f32 v45, v46, v47
    v_mfma_f32_16x16x32_bf16 v[204:207], a[124:127], a[76:79], v[232:235]
    ds_write_b64 v249, v[32:33] offset:4352
    v_mfma_f32_16x16x32_bf16 v[204:207], a[120:123], a[72:75], v[204:207]
    ds_read_b64_tr_b16 a[212:213], v243 offset:1024
    v_cvt_pk_bf16_f32 v192, v192, v193
    v_mfma_f32_16x16x32_bf16 v[204:207], a[116:119], a[68:71], v[204:207]
    ds_write_b64 v249, v[36:37] offset:4384
    v_mfma_f32_16x16x32_bf16 v[204:207], a[112:115], a[64:67], v[204:207]
    ds_read_b128 a[76:79], v247 offset:17408
    v_exp_f32 v195, v195
    v_exp_f32 v196, v196
    v_pk_mul_f32 v[48:49], v[48:49], v[254:255] op_sel_hi:[1,0]
    v_pk_mul_f32 v[50:51], v[50:51], v[254:255] op_sel_hi:[1,0]
    v_pk_mul_f32 v[52:53], v[52:53], v[254:255] op_sel_hi:[1,0]
    v_pk_mul_f32 v[54:55], v[54:55], v[254:255] op_sel_hi:[1,0]
    v_cvt_pk_bf16_f32 v48, v48, v49
    v_cvt_pk_bf16_f32 v49, v50, v51
    v_cvt_pk_bf16_f32 v52, v52, v53
    v_cvt_pk_bf16_f32 v53, v54, v55
    v_mfma_f32_16x16x32_bf16 a[228:231], a[236:239], v[208:211], a[228:231]
    ds_write_b64 v249, v[40:41] offset:4416
    v_mfma_f32_16x16x32_bf16 v[64:67], a[160:163], v[208:211], v[64:67]
    ds_read_b128 a[72:75], v246 offset:17408
    v_cvt_pk_bf16_f32 v193, v194, v195
    v_mfma_f32_16x16x32_bf16 v[68:71], a[164:167], v[208:211], v[68:71]
    s_waitcnt lgkmcnt(6)
    ds_write_b64 v249, v[44:45] offset:4448
    v_mfma_f32_16x16x32_bf16 v[72:75], a[168:171], v[208:211], v[72:75]
    ds_read_b64_tr_b16 a[214:215], v243 offset:5120
    buffer_store_dwordx4 a[248:251], v248, s[16:19], s31 offen offset:0 sc1
    v_mul_f32 v200, s44, v200
    v_pk_mul_f32 v[56:57], v[56:57], v[254:255] op_sel_hi:[1,0]
    v_pk_mul_f32 v[58:59], v[58:59], v[254:255] op_sel_hi:[1,0]
    v_pk_mul_f32 v[60:61], v[60:61], v[254:255] op_sel_hi:[1,0]
    v_pk_mul_f32 v[62:63], v[62:63], v[254:255] op_sel_hi:[1,0]
    v_cvt_pk_bf16_f32 v56, v56, v57
    v_cvt_pk_bf16_f32 v57, v58, v59
    v_cvt_pk_bf16_f32 v60, v60, v61
    v_cvt_pk_bf16_f32 v61, v62, v63
    v_mfma_f32_16x16x32_bf16 v[76:79], a[172:175], v[208:211], v[76:79]
    ds_read_b128 a[68:71], v247 offset:16384
    v_accvgpr_read_b32 v225, a229
    v_exp_f32 v197, v197
    v_mfma_f32_16x16x32_bf16 v[80:83], a[176:179], v[208:211], v[80:83]
    ds_read_b128 a[64:67], v246 offset:16384
    ds_write_b64 v249, v[48:49] offset:4480
    v_accvgpr_read_b32 v252, a228
    v_mfma_f32_16x16x32_bf16 v[84:87], a[180:183], v[208:211], v[84:87]
    v_exp_f32 v198, v198
    v_cvt_pk_bf16_f32 v194, v196, v197
    v_add_f32 v252, v252, v225
    v_mfma_f32_16x16x32_bf16 v[88:91], a[184:187], v[208:211], v[88:91]
    ds_write_b64 v249, v[52:53] offset:4512
    v_cmp_nge_f32 vcc, s46, v252
    v_mfma_f32_16x16x32_bf16 v[92:95], a[188:191], v[208:211], v[92:95]
    ds_read_b64_tr_b16 a[216:217], v244 offset:1024
    ds_read_b128 a[252:255], v250 offset:2176
    v_exp_f32 v199, v199
    v_rcp_f32 v252, v252
    v_mfma_f32_16x16x32_bf16 v[208:211], a[96:99], a[80:83], v[236:239]
    s_or_b64 s[32:33], s[32:33], vcc
    ds_write_b64 v249, v[56:57] offset:4544
    v_cvt_pk_bf16_f32 v195, v198, v199
    v_exp_f32 v200, v200
    v_pk_mul_f32 v[64:65], v[64:65], v[252:253] op_sel_hi:[1,0]
    v_pk_mul_f32 v[66:67], v[66:67], v[252:253] op_sel_hi:[1,0]
    v_pk_mul_f32 v[68:69], v[68:69], v[252:253] op_sel_hi:[1,0]
    v_pk_mul_f32 v[70:71], v[70:71], v[252:253] op_sel_hi:[1,0]
    v_cvt_pk_bf16_f32 v64, v64, v65
    v_cvt_pk_bf16_f32 v65, v66, v67
    v_cvt_pk_bf16_f32 v68, v68, v69
    v_cvt_pk_bf16_f32 v69, v70, v71
    v_mfma_f32_16x16x32_bf16 v[208:211], a[100:103], a[84:87], v[208:211]
    ds_read_b64_tr_b16 a[218:219], v244 offset:5120
    v_mul_f32 v201, s44, v201
    v_mfma_f32_16x16x32_bf16 v[208:211], a[104:107], a[88:91], v[208:211]
    ds_write_b64 v249, v[60:61] offset:4576
    v_mfma_f32_16x16x32_bf16 v[208:211], a[108:111], a[92:95], v[208:211]
    v_cmp_nge_f32 vcc, s46, v252
    v_mul_f32 v202, s44, v202
    v_exp_f32 v201, v201
    v_exp_f32 v202, v202
    v_pk_mul_f32 v[72:73], v[72:73], v[252:253] op_sel_hi:[1,0]
    v_pk_mul_f32 v[74:75], v[74:75], v[252:253] op_sel_hi:[1,0]
    v_pk_mul_f32 v[76:77], v[76:77], v[252:253] op_sel_hi:[1,0]
    v_pk_mul_f32 v[78:79], v[78:79], v[252:253] op_sel_hi:[1,0]
    v_cvt_pk_bf16_f32 v72, v72, v73
    v_cvt_pk_bf16_f32 v73, v74, v75
    v_cvt_pk_bf16_f32 v76, v76, v77
    v_cvt_pk_bf16_f32 v77, v78, v79
    v_mfma_f32_16x16x32_bf16 v[212:215], a[124:127], a[92:95], v[236:239]
    ds_write_b64 v249, v[64:65] offset:8704
    v_mfma_f32_16x16x32_bf16 v[212:215], a[120:123], a[88:91], v[212:215]
    s_or_b64 s[32:33], s[32:33], vcc
    v_mul_f32 v203, s44, v203
    v_cvt_pk_bf16_f32 v200, v200, v201
    v_mfma_f32_16x16x32_bf16 v[212:215], a[116:119], a[84:87], v[212:215]
    s_waitcnt lgkmcnt(4)
    ds_write_b64 v249, v[68:69] offset:8736
    v_mfma_f32_16x16x32_bf16 v[212:215], a[112:115], a[80:83], v[212:215]
    buffer_store_dwordx4 a[252:255], v248, s[16:19], s31 offen offset:2048 sc1
    v_mul_f32 v204, s44, v204
    v_mul_f32 v205, s44, v205
    v_pk_mul_f32 v[80:81], v[80:81], v[252:253] op_sel_hi:[1,0]
    v_pk_mul_f32 v[82:83], v[82:83], v[252:253] op_sel_hi:[1,0]
    v_pk_mul_f32 v[84:85], v[84:85], v[252:253] op_sel_hi:[1,0]
    v_pk_mul_f32 v[86:87], v[86:87], v[252:253] op_sel_hi:[1,0]
    v_cvt_pk_bf16_f32 v80, v80, v81
    v_cvt_pk_bf16_f32 v81, v82, v83
    v_cvt_pk_bf16_f32 v84, v84, v85
    v_cvt_pk_bf16_f32 v85, v86, v87
    v_mfma_f32_16x16x32_bf16 a[228:231], a[240:243], v[192:195], a[228:231]
    ds_read_b64_tr_b16 a[220:221], v245 offset:1024
    v_mul_f32 v206, s44, v206
    v_exp_f32 v203, v203
    v_mfma_f32_16x16x32_bf16 v[96:99], a[160:163], v[192:195], v[96:99]
    ds_write_b64 v249, v[72:73] offset:8768
    v_mfma_f32_16x16x32_bf16 v[100:103], a[164:167], v[192:195], v[100:103]
    s_waitcnt vmcnt(12)
    ds_read_b128 a[92:95], v247 offset:21504
    v_cvt_pk_bf16_f32 v201, v202, v203
    v_exp_f32 v204, v204
    v_mfma_f32_16x16x32_bf16 v[104:107], a[168:171], v[192:195], v[104:107]
    ds_read_b128 a[88:91], v246 offset:21504
    ds_read_b128 a[248:251], v250 offset:128
    ds_write_b64 v249, v[76:77] offset:8800
    v_pk_mul_f32 v[88:89], v[88:89], v[252:253] op_sel_hi:[1,0]
    v_pk_mul_f32 v[90:91], v[90:91], v[252:253] op_sel_hi:[1,0]
    v_pk_mul_f32 v[92:93], v[92:93], v[252:253] op_sel_hi:[1,0]
    v_pk_mul_f32 v[94:95], v[94:95], v[252:253] op_sel_hi:[1,0]
    v_cvt_pk_bf16_f32 v88, v88, v89
    v_cvt_pk_bf16_f32 v89, v90, v91
    v_cvt_pk_bf16_f32 v92, v92, v93
    v_cvt_pk_bf16_f32 v93, v94, v95
    v_mfma_f32_16x16x32_bf16 v[108:111], a[172:175], v[192:195], v[108:111]
    ds_read_b128 a[84:87], v247 offset:20480
    ds_read_b64_tr_b16 a[222:223], v245 offset:5120
    v_exp_f32 v205, v205
    v_mfma_f32_16x16x32_bf16 v[112:115], a[176:179], v[192:195], v[112:115]
    ds_read_b128 a[80:83], v246 offset:20480
    ds_write_b64 v249, v[80:81] offset:8832
    v_accvgpr_read_b32 v229, a231
    v_accvgpr_read_b32 v254, a230
    v_mfma_f32_16x16x32_bf16 v[116:119], a[180:183], v[192:195], v[116:119]
    v_exp_f32 v206, v206
    v_mul_f32 v207, s44, v207
    v_cvt_pk_bf16_f32 v202, v204, v205
    v_add_f32 v254, v254, v229
    v_mfma_f32_16x16x32_bf16 v[120:123], a[184:187], v[192:195], v[120:123]
    ds_write_b64 v249, v[84:85] offset:8864
    v_cmp_nge_f32 vcc, s46, v254
    v_mfma_f32_16x16x32_bf16 v[124:127], a[188:191], v[192:195], v[124:127]
    v_exp_f32 v207, v207
    v_rcp_f32 v254, v254
    v_mfma_f32_16x16x32_bf16 v[192:195], a[128:131], a[0:3], 0
    s_waitcnt vmcnt(10) lgkmcnt(3)
    ds_write_b64 v249, v[88:89] offset:8896
    v_mul_f32 v208, s44, v208
    v_cvt_pk_bf16_f32 v203, v206, v207
    v_pk_mul_f32 v[96:97], v[96:97], v[254:255] op_sel_hi:[1,0]
    v_pk_mul_f32 v[98:99], v[98:99], v[254:255] op_sel_hi:[1,0]
    v_pk_mul_f32 v[100:101], v[100:101], v[254:255] op_sel_hi:[1,0]
    v_pk_mul_f32 v[102:103], v[102:103], v[254:255] op_sel_hi:[1,0]
    v_cvt_pk_bf16_f32 v96, v96, v97
    v_cvt_pk_bf16_f32 v97, v98, v99
    v_cvt_pk_bf16_f32 v100, v100, v101
    v_cvt_pk_bf16_f32 v101, v102, v103
    v_mfma_f32_16x16x32_bf16 v[192:195], a[132:135], a[4:7], v[192:195]
    s_barrier
    buffer_store_dwordx4 a[248:251], v248, s[16:19], s31 offen offset:128 sc1
    v_mul_f32 v209, s44, v209
    v_mfma_f32_16x16x32_bf16 v[192:195], a[136:139], a[8:11], v[192:195]
    s_or_b64 s[32:33], s[32:33], vcc
    ds_write_b64 v249, v[92:93] offset:8928
    v_exp_f32 v208, v208
    v_mfma_f32_16x16x32_bf16 v[192:195], a[140:143], a[12:15], v[192:195]
    ds_read_b128 a[96:99], v240 offset:8192
    v_exp_f32 v209, v209
    v_mul_f32 v210, s44, v210
    v_exp_f32 v210, v210
    v_pk_mul_f32 v[104:105], v[104:105], v[254:255] op_sel_hi:[1,0]
    v_pk_mul_f32 v[106:107], v[106:107], v[254:255] op_sel_hi:[1,0]
    v_pk_mul_f32 v[108:109], v[108:109], v[254:255] op_sel_hi:[1,0]
    v_pk_mul_f32 v[110:111], v[110:111], v[254:255] op_sel_hi:[1,0]
    v_cvt_pk_bf16_f32 v104, v104, v105
    v_cvt_pk_bf16_f32 v105, v106, v107
    v_cvt_pk_bf16_f32 v108, v108, v109
    v_cvt_pk_bf16_f32 v109, v110, v111
    v_mfma_f32_16x16x32_bf16 v[196:199], a[156:159], a[12:15], 0
    ds_write_b64 v249, v[96:97] offset:13056
    v_mfma_f32_16x16x32_bf16 v[196:199], a[152:155], a[8:11], v[196:199]
    v_mul_f32 v211, s44, v211
    v_cvt_pk_bf16_f32 v208, v208, v209
    v_mfma_f32_16x16x32_bf16 v[196:199], a[148:151], a[4:7], v[196:199]
    ds_read_b128 a[252:255], v250 offset:2304
    v_mul_f32 v212, s44, v212
    v_mfma_f32_16x16x32_bf16 v[196:199], a[144:147], a[0:3], v[196:199]
    buffer_load_dwordx4 v248, s[8:11], s30 offen sc1 nt lds
    ds_write_b64 v249, v[100:101] offset:13088
    v_pk_mul_f32 v[112:113], v[112:113], v[254:255] op_sel_hi:[1,0]
    v_pk_mul_f32 v[114:115], v[114:115], v[254:255] op_sel_hi:[1,0]
    v_pk_mul_f32 v[116:117], v[116:117], v[254:255] op_sel_hi:[1,0]
    v_pk_mul_f32 v[118:119], v[118:119], v[254:255] op_sel_hi:[1,0]
    v_cvt_pk_bf16_f32 v112, v112, v113
    v_cvt_pk_bf16_f32 v113, v114, v115
    v_cvt_pk_bf16_f32 v116, v116, v117
    v_cvt_pk_bf16_f32 v117, v118, v119
    v_mfma_f32_16x16x32_bf16 a[232:235], a[236:239], v[200:203], a[232:235]
    s_addk_i32 m0, 896
    ds_read_b128 a[100:103], v241 offset:8192
    v_mul_f32 v213, s44, v213
    v_exp_f32 v211, v211
    v_mfma_f32_16x16x32_bf16 v[128:131], a[160:163], v[200:203], v[128:131]
    ds_write_b64 v249, v[104:105] offset:13120
    v_mfma_f32_16x16x32_bf16 v[132:135], a[164:167], v[200:203], v[132:135]
    v_exp_f32 v212, v212
    v_cvt_pk_bf16_f32 v209, v210, v211
    v_mfma_f32_16x16x32_bf16 v[136:139], a[168:171], v[200:203], v[136:139]
    ds_write_b64 v249, v[108:109] offset:13152
    v_max3_f32 v217, v192, v193, v194
    v_max3_f32 v218, v195, v196, v197
    v_pk_mul_f32 v[120:121], v[120:121], v[254:255] op_sel_hi:[1,0]
    v_pk_mul_f32 v[122:123], v[122:123], v[254:255] op_sel_hi:[1,0]
    v_pk_mul_f32 v[124:125], v[124:125], v[254:255] op_sel_hi:[1,0]
    v_pk_mul_f32 v[126:127], v[126:127], v[254:255] op_sel_hi:[1,0]
    v_cvt_pk_bf16_f32 v120, v120, v121
    v_cvt_pk_bf16_f32 v121, v122, v123
    v_cvt_pk_bf16_f32 v124, v124, v125
    v_cvt_pk_bf16_f32 v125, v126, v127
    v_mfma_f32_16x16x32_bf16 v[140:143], a[172:175], v[200:203], v[140:143]
    ds_read_b128 a[104:107], v240 offset:9216
    v_max3_f32 v217, v217, v198, v199
    v_max_f32 v217, v217, v218
    v_mov_b32 v218, v217
    v_exp_f32 v213, v213
    v_mul_f32 v214, s44, v214
    v_mfma_f32_16x16x32_bf16 v[144:147], a[176:179], v[200:203], v[144:147]
    s_waitcnt lgkmcnt(5)
    ds_write_b64 v249, v[112:113] offset:13184
    v_accvgpr_read_b32 v233, a233
    v_accvgpr_read_b32 v252, a232
    v_mfma_f32_16x16x32_bf16 v[148:151], a[180:183], v[200:203], v[148:151]
    buffer_store_dwordx4 a[252:255], v248, s[16:19], s31 offen offset:2176 sc1
    ds_read_b128 a[108:111], v241 offset:9216
    v_permlane32_swap_b32 v217, v218
    v_exp_f32 v214, v214
    v_mul_f32 v215, s44, v215
    v_mfma_f32_16x16x32_bf16 v[152:155], a[184:187], v[200:203], v[152:155]
    ds_write_b64 v249, v[116:117] offset:13216
    v_max_f32 v217, v217, v218
    v_mov_b32 v218, v217
    v_cvt_pk_bf16_f32 v210, v212, v213
    v_add_f32 v252, v252, v233
    v_cmp_nge_f32 vcc, s46, v252
    v_mfma_f32_16x16x32_bf16 v[156:159], a[188:191], v[200:203], v[156:159]
    v_exp_f32 v215, v215
    v_rcp_f32 v252, v252
    v_mfma_f32_16x16x32_bf16 v[200:203], a[128:131], a[16:19], 0
    s_or_b64 s[32:33], s[32:33], vcc
    ds_write_b64 v249, v[120:121] offset:13248
    v_permlane16_swap_b32 v217, v218
    v_pk_mul_f32 v[128:129], v[128:129], v[252:253] op_sel_hi:[1,0]
    v_pk_mul_f32 v[130:131], v[130:131], v[252:253] op_sel_hi:[1,0]
    v_pk_mul_f32 v[132:133], v[132:133], v[252:253] op_sel_hi:[1,0]
    v_pk_mul_f32 v[134:135], v[134:135], v[252:253] op_sel_hi:[1,0]
    v_cvt_pk_bf16_f32 v128, v128, v129
    v_cvt_pk_bf16_f32 v129, v130, v131
    v_cvt_pk_bf16_f32 v132, v132, v133
    v_cvt_pk_bf16_f32 v133, v134, v135
    v_mfma_f32_16x16x32_bf16 v[200:203], a[132:135], a[20:23], v[200:203]
    ds_read_b128 a[112:115], v240 offset:12288
    v_min_f32 v216, -v217, -v218
    v_mul_f32 v255, s44, v216
    v_fma_f32 v192, v192, s44, v255
    v_cvt_pk_bf16_f32 v211, v214, v215
    v_mfma_f32_16x16x32_bf16 v[200:203], a[136:139], a[24:27], v[200:203]
    buffer_load_dwordx4 v248, s[8:11], s30 offen offset:128 sc1 nt lds
    ds_write_b64 v249, v[124:125] offset:13280
    v_exp_f32 v192, v192
    v_fma_f32 v193, v193, s44, v255
    v_mfma_f32_16x16x32_bf16 v[200:203], a[140:143], a[28:31], v[200:203]
    s_addk_i32 m0, 31872
    ds_read_b128 a[116:119], v241 offset:12288
    v_cmp_nge_f32 vcc, s46, v252
    v_exp_f32 v193, v193
    v_fma_f32 v194, v194, s44, v255
    v_pk_mul_f32 v[136:137], v[136:137], v[252:253] op_sel_hi:[1,0]
    v_pk_mul_f32 v[138:139], v[138:139], v[252:253] op_sel_hi:[1,0]
    v_pk_mul_f32 v[140:141], v[140:141], v[252:253] op_sel_hi:[1,0]
    v_pk_mul_f32 v[142:143], v[142:143], v[252:253] op_sel_hi:[1,0]
    v_cvt_pk_bf16_f32 v136, v136, v137
    v_cvt_pk_bf16_f32 v137, v138, v139
    v_cvt_pk_bf16_f32 v140, v140, v141
    v_cvt_pk_bf16_f32 v141, v142, v143
    v_mfma_f32_16x16x32_bf16 v[204:207], a[156:159], a[28:31], 0
    ds_write_b64 v249, v[128:129] offset:17408
    v_mfma_f32_16x16x32_bf16 v[204:207], a[152:155], a[24:27], v[204:207]
    s_or_b64 s[32:33], s[32:33], vcc
    ds_read_b128 a[120:123], v240 offset:13312
    v_fma_f32 v195, v195, s44, v255
    v_mfma_f32_16x16x32_bf16 v[204:207], a[148:151], a[20:23], v[204:207]
    v_exp_f32 v194, v194
    v_cvt_pk_bf16_f32 v192, v192, v193
    v_mfma_f32_16x16x32_bf16 v[204:207], a[144:147], a[16:19], v[204:207]
    ds_write_b64 v249, v[132:133] offset:17440
    v_exp_f32 v195, v195
    v_pk_mul_f32 v[144:145], v[144:145], v[252:253] op_sel_hi:[1,0]
    v_pk_mul_f32 v[146:147], v[146:147], v[252:253] op_sel_hi:[1,0]
    v_pk_mul_f32 v[148:149], v[148:149], v[252:253] op_sel_hi:[1,0]
    v_pk_mul_f32 v[150:151], v[150:151], v[252:253] op_sel_hi:[1,0]
    v_cvt_pk_bf16_f32 v144, v144, v145
    v_cvt_pk_bf16_f32 v145, v146, v147
    v_cvt_pk_bf16_f32 v148, v148, v149
    v_cvt_pk_bf16_f32 v149, v150, v151
    v_mfma_f32_16x16x32_bf16 a[232:235], a[240:243], v[208:211], a[232:235]
    ds_read_b128 a[124:127], v241 offset:13312
    v_fma_f32 v196, v196, s44, v255
    v_mfma_f32_16x16x32_bf16 v[160:163], a[160:163], v[208:211], v[160:163]
    ds_write_b64 v249, v[136:137] offset:17472
    v_mfma_f32_16x16x32_bf16 v[164:167], a[164:167], v[208:211], v[164:167]
    v_exp_f32 v196, v196
    v_fma_f32 v197, v197, s44, v255
    v_cvt_pk_bf16_f32 v193, v194, v195
    v_mfma_f32_16x16x32_bf16 v[168:171], a[168:171], v[208:211], v[168:171]
    ds_write_b64 v249, v[140:141] offset:17504
    v_max3_f32 v221, v200, v201, v202
    v_max3_f32 v222, v203, v204, v205
    v_pk_mul_f32 v[152:153], v[152:153], v[252:253] op_sel_hi:[1,0]
    v_pk_mul_f32 v[154:155], v[154:155], v[252:253] op_sel_hi:[1,0]
    v_pk_mul_f32 v[156:157], v[156:157], v[252:253] op_sel_hi:[1,0]
    v_pk_mul_f32 v[158:159], v[158:159], v[252:253] op_sel_hi:[1,0]
    v_cvt_pk_bf16_f32 v152, v152, v153
    v_cvt_pk_bf16_f32 v153, v154, v155
    v_cvt_pk_bf16_f32 v156, v156, v157
    v_cvt_pk_bf16_f32 v157, v158, v159
    v_mfma_f32_16x16x32_bf16 v[172:175], a[172:175], v[208:211], v[172:175]
    v_max3_f32 v221, v221, v206, v207
    v_max_f32 v221, v221, v222
    v_mov_b32 v222, v221
    v_exp_f32 v197, v197
    v_fma_f32 v198, v198, s44, v255
    v_mfma_f32_16x16x32_bf16 v[176:179], a[176:179], v[208:211], v[176:179]
    ds_read_b64_tr_b16 a[160:161], v242 offset:8192
    ds_write_b64 v249, v[144:145] offset:17536
    v_accvgpr_read_b32 v237, a235
    v_accvgpr_read_b32 v254, a234
    v_mfma_f32_16x16x32_bf16 v[180:183], a[180:183], v[208:211], v[180:183]
    v_permlane32_swap_b32 v221, v222
    v_exp_f32 v198, v198
    v_fma_f32 v199, v199, s44, v255
    v_cvt_pk_bf16_f32 v194, v196, v197
    v_add_f32 v254, v254, v237
    v_mfma_f32_16x16x32_bf16 v[184:187], a[184:187], v[208:211], v[184:187]
    ds_write_b64 v249, v[148:149] offset:17568
    v_max_f32 v221, v221, v222
    v_mov_b32 v222, v221
    v_cmp_nge_f32 vcc, s46, v254
    v_mfma_f32_16x16x32_bf16 v[188:191], a[188:191], v[208:211], v[188:191]
    v_exp_f32 v199, v199
    v_rcp_f32 v254, v254
    v_mfma_f32_16x16x32_bf16 v[208:211], a[128:131], a[32:35], 0
    s_or_b64 s[32:33], s[32:33], vcc
    ds_write_b64 v249, v[152:153] offset:17600
    v_permlane16_swap_b32 v221, v222
    v_pk_mul_f32 v[160:161], v[160:161], v[254:255] op_sel_hi:[1,0]
    v_pk_mul_f32 v[162:163], v[162:163], v[254:255] op_sel_hi:[1,0]
    v_pk_mul_f32 v[164:165], v[164:165], v[254:255] op_sel_hi:[1,0]
    v_pk_mul_f32 v[166:167], v[166:167], v[254:255] op_sel_hi:[1,0]
    v_cvt_pk_bf16_f32 v160, v160, v161
    v_cvt_pk_bf16_f32 v161, v162, v163
    v_cvt_pk_bf16_f32 v164, v164, v165
    v_cvt_pk_bf16_f32 v165, v166, v167
    v_mfma_f32_16x16x32_bf16 v[208:211], a[132:135], a[36:39], v[208:211]
    ds_read_b64_tr_b16 a[162:163], v242 offset:12288
    v_min_f32 v220, -v221, -v222
    v_mul_f32 v251, s44, v220
    v_fma_f32 v200, v200, s44, v251
    v_mov_b32 v217, v216
    v_mov_b32 v218, v216
    v_mov_b32 v219, v216
    v_cvt_pk_bf16_f32 v195, v198, v199
    v_mfma_f32_16x16x32_bf16 v[208:211], a[136:139], a[40:43], v[208:211]
    ds_write_b64 v249, v[156:157] offset:17632
    v_exp_f32 v200, v200
    v_fma_f32 v201, v201, s44, v251
    v_mfma_f32_16x16x32_bf16 v[208:211], a[140:143], a[44:47], v[208:211]
    ds_read_b64_tr_b16 a[164:165], v243 offset:8192
    v_cmp_nge_f32 vcc, s46, v254
    v_fma_f32 v202, v202, s44, v251
    v_exp_f32 v201, v201
    v_pk_mul_f32 v[168:169], v[168:169], v[254:255] op_sel_hi:[1,0]
    v_pk_mul_f32 v[170:171], v[170:171], v[254:255] op_sel_hi:[1,0]
    v_pk_mul_f32 v[172:173], v[172:173], v[254:255] op_sel_hi:[1,0]
    v_pk_mul_f32 v[174:175], v[174:175], v[254:255] op_sel_hi:[1,0]
    v_cvt_pk_bf16_f32 v168, v168, v169
    v_cvt_pk_bf16_f32 v169, v170, v171
    v_cvt_pk_bf16_f32 v172, v172, v173
    v_cvt_pk_bf16_f32 v173, v174, v175
    v_mfma_f32_16x16x32_bf16 v[212:215], a[156:159], a[44:47], 0
    ds_write_b64 v249, v[160:161] offset:0
    v_mfma_f32_16x16x32_bf16 v[212:215], a[152:155], a[40:43], v[212:215]
    s_or_b64 s[32:33], s[32:33], vcc
    v_exp_f32 v202, v202
    v_mfma_f32_16x16x32_bf16 v[212:215], a[148:151], a[36:39], v[212:215]
    v_fma_f32 v203, v203, s44, v251
    v_cvt_pk_bf16_f32 v200, v200, v201
    v_mfma_f32_16x16x32_bf16 v[212:215], a[144:147], a[32:35], v[212:215]
    ds_write_b64 v249, v[164:165] offset:32
    v_exp_f32 v203, v203
    v_pk_mul_f32 v[176:177], v[176:177], v[254:255] op_sel_hi:[1,0]
    v_pk_mul_f32 v[178:179], v[178:179], v[254:255] op_sel_hi:[1,0]
    v_pk_mul_f32 v[180:181], v[180:181], v[254:255] op_sel_hi:[1,0]
    v_pk_mul_f32 v[182:183], v[182:183], v[254:255] op_sel_hi:[1,0]
    v_cvt_pk_bf16_f32 v176, v176, v177
    v_cvt_pk_bf16_f32 v177, v178, v179
    v_cvt_pk_bf16_f32 v180, v180, v181
    v_cvt_pk_bf16_f32 v181, v182, v183
    v_mfma_f32_16x16x32_bf16 a[224:227], a[236:239], v[192:195], 0
    ds_read_b64_tr_b16 a[166:167], v243 offset:12288
    v_fma_f32 v204, v204, s44, v251
    v_mfma_f32_16x16x32_bf16 v[0:3], a[192:195], v[192:195], 0
    ds_write_b64 v249, v[168:169] offset:64
    v_mfma_f32_16x16x32_bf16 v[4:7], a[196:199], v[192:195], 0
    v_exp_f32 v204, v204
    v_fma_f32 v205, v205, s44, v251
    v_cvt_pk_bf16_f32 v201, v202, v203
    v_mfma_f32_16x16x32_bf16 v[8:11], a[200:203], v[192:195], 0
    ds_write_b64 v249, v[172:173] offset:96
    v_max3_f32 v225, v208, v209, v210
    v_max3_f32 v226, v211, v212, v213
    v_pk_mul_f32 v[184:185], v[184:185], v[254:255] op_sel_hi:[1,0]
    v_pk_mul_f32 v[186:187], v[186:187], v[254:255] op_sel_hi:[1,0]
    v_pk_mul_f32 v[188:189], v[188:189], v[254:255] op_sel_hi:[1,0]
    v_pk_mul_f32 v[190:191], v[190:191], v[254:255] op_sel_hi:[1,0]
    v_cvt_pk_bf16_f32 v184, v184, v185
    v_cvt_pk_bf16_f32 v185, v186, v187
    v_cvt_pk_bf16_f32 v188, v188, v189
    v_cvt_pk_bf16_f32 v189, v190, v191
    v_mfma_f32_16x16x32_bf16 v[12:15], a[204:207], v[192:195], 0
    v_max3_f32 v225, v225, v214, v215
    v_max_f32 v225, v225, v226
    v_mov_b32 v226, v225
    v_exp_f32 v205, v205
    v_fma_f32 v206, v206, s44, v251
    v_mfma_f32_16x16x32_bf16 v[16:19], a[208:211], v[192:195], 0
    ds_write_b64 v249, v[176:177] offset:128
    v_mfma_f32_16x16x32_bf16 v[20:23], a[212:215], v[192:195], 0
    s_add_u32 s31, s21, 4096
    ds_read_b64_tr_b16 a[168:169], v244 offset:8192
    v_permlane32_swap_b32 v225, v226
    v_exp_f32 v206, v206
    v_fma_f32 v207, v207, s44, v251
    v_cvt_pk_bf16_f32 v202, v204, v205
    v_mfma_f32_16x16x32_bf16 v[24:27], a[216:219], v[192:195], 0
    ds_write_b64 v249, v[180:181] offset:160
    v_max_f32 v225, v225, v226
    v_mov_b32 v226, v225
    v_mfma_f32_16x16x32_bf16 v[28:31], a[220:223], v[192:195], 0
    v_exp_f32 v207, v207
    v_mfma_f32_16x16x32_bf16 v[192:195], a[128:131], a[48:51], 0
    ds_write_b64 v249, v[184:185] offset:192
    v_permlane16_swap_b32 v225, v226
    v_mfma_f32_16x16x32_bf16 v[192:195], a[132:135], a[52:55], v[192:195]
    ds_read_b64_tr_b16 a[170:171], v244 offset:12288
    v_min_f32 v224, -v225, -v226
    v_mul_f32 v255, s44, v224
    v_fma_f32 v208, v208, s44, v255
    v_mov_b32 v221, v220
    v_mov_b32 v222, v220
    v_mov_b32 v223, v220
    v_cvt_pk_bf16_f32 v203, v206, v207
    v_mfma_f32_16x16x32_bf16 v[192:195], a[136:139], a[56:59], v[192:195]
    ds_write_b64 v249, v[188:189] offset:224
    v_exp_f32 v208, v208
    v_fma_f32 v209, v209, s44, v255
    v_mfma_f32_16x16x32_bf16 v[192:195], a[140:143], a[60:63], v[192:195]
    buffer_load_dwordx4 v248, s[12:15], s30 offen sc1 nt lds
    v_mfma_f32_16x16x32_bf16 v[196:199], a[156:159], a[60:63], 0
    s_addk_i32 m0, 896
    v_exp_f32 v209, v209
    v_fma_f32 v210, v210, s44, v255
    v_mfma_f32_16x16x32_bf16 v[196:199], a[152:155], a[56:59], v[196:199]
    ds_read_b64_tr_b16 a[172:173], v245 offset:8192
    v_fma_f32 v211, v211, s44, v255
    v_mfma_f32_16x16x32_bf16 v[196:199], a[148:151], a[52:55], v[196:199]
    v_exp_f32 v210, v210
    v_cvt_pk_bf16_f32 v208, v208, v209
    v_mfma_f32_16x16x32_bf16 v[196:199], a[144:147], a[48:51], v[196:199]
    v_exp_f32 v211, v211
    v_mfma_f32_16x16x32_bf16 a[224:227], a[240:243], v[200:203], a[224:227]
    ds_read_b64_tr_b16 a[174:175], v245 offset:12288
    v_fma_f32 v212, v212, s44, v255
    v_mfma_f32_16x16x32_bf16 v[32:35], a[192:195], v[200:203], 0
    v_exp_f32 v212, v212
    v_mfma_f32_16x16x32_bf16 v[36:39], a[196:199], v[200:203], 0
    v_fma_f32 v213, v213, s44, v255
    v_cvt_pk_bf16_f32 v209, v210, v211
    v_mfma_f32_16x16x32_bf16 v[40:43], a[200:203], v[200:203], 0
    v_max3_f32 v229, v192, v193, v194
    v_max3_f32 v230, v195, v196, v197
    v_max3_f32 v229, v229, v198, v199
    v_max_f32 v229, v229, v230
    v_mov_b32 v230, v229
    v_mfma_f32_16x16x32_bf16 v[44:47], a[204:207], v[200:203], 0
    v_exp_f32 v213, v213
    v_fma_f32 v214, v214, s44, v255
    v_mfma_f32_16x16x32_bf16 v[48:51], a[208:211], v[200:203], 0
    v_permlane32_swap_b32 v229, v230
    v_mfma_f32_16x16x32_bf16 v[52:55], a[212:215], v[200:203], 0
    v_max_f32 v229, v229, v230
    v_mov_b32 v230, v229
    v_exp_f32 v214, v214
    v_fma_f32 v215, v215, s44, v255
    v_cvt_pk_bf16_f32 v210, v212, v213
    v_mfma_f32_16x16x32_bf16 v[56:59], a[216:219], v[200:203], 0
    ds_read_b64_tr_b16 a[176:177], v242 offset:9216
    v_mov_b32 v225, v224
    v_mfma_f32_16x16x32_bf16 v[60:63], a[220:223], v[200:203], 0
    buffer_load_dwordx4 v248, s[12:15], s30 offen offset:128 sc1 nt lds
    v_permlane16_swap_b32 v229, v230
    v_exp_f32 v215, v215
    v_mfma_f32_16x16x32_bf16 v[200:203], a[128:131], a[64:67], 0
    s_addk_i32 m0, -25472
    v_min_f32 v228, -v229, -v230
    v_mul_f32 v251, s44, v228
    v_fma_f32 v192, v192, s44, v251
    v_mfma_f32_16x16x32_bf16 v[200:203], a[132:135], a[68:71], v[200:203]
    s_addk_i32 s30, 8192
    v_mov_b32 v226, v224
    v_mov_b32 v227, v224
    v_cvt_pk_bf16_f32 v211, v214, v215
    v_mfma_f32_16x16x32_bf16 v[200:203], a[136:139], a[72:75], v[200:203]
    ds_read_b64_tr_b16 a[178:179], v242 offset:13312
    v_fma_f32 v193, v193, s44, v251
    v_exp_f32 v192, v192
    v_mfma_f32_16x16x32_bf16 v[200:203], a[140:143], a[76:79], v[200:203]
    v_exp_f32 v193, v193
    v_mfma_f32_16x16x32_bf16 v[204:207], a[156:159], a[76:79], 0
    v_fma_f32 v194, v194, s44, v251
    v_fma_f32 v195, v195, s44, v251
    v_mfma_f32_16x16x32_bf16 v[204:207], a[152:155], a[72:75], v[204:207]
    v_exp_f32 v194, v194
    v_mfma_f32_16x16x32_bf16 v[204:207], a[148:151], a[68:71], v[204:207]
L_pad7:
    s_cbranch_execz L_pad11
    ds_read_b64_tr_b16 a[180:181], v243 offset:9216
    v_cvt_pk_bf16_f32 v192, v192, v193
    v_mfma_f32_16x16x32_bf16 v[204:207], a[144:147], a[64:67], v[204:207]
    v_exp_f32 v195, v195
    v_mfma_f32_16x16x32_bf16 a[228:231], a[236:239], v[208:211], 0
    v_fma_f32 v196, v196, s44, v251
    v_fma_f32 v197, v197, s44, v251
    v_mfma_f32_16x16x32_bf16 v[64:67], a[192:195], v[208:211], 0
    v_exp_f32 v196, v196
    v_mfma_f32_16x16x32_bf16 v[68:71], a[196:199], v[208:211], 0
    ds_read_b64_tr_b16 a[182:183], v243 offset:13312
    v_cvt_pk_bf16_f32 v193, v194, v195
    v_mfma_f32_16x16x32_bf16 v[72:75], a[200:203], v[208:211], 0
    v_max3_f32 v233, v200, v201, v202
    v_max3_f32 v234, v203, v204, v205
    v_max3_f32 v233, v233, v206, v207
    v_max_f32 v233, v233, v234
    v_mov_b32 v234, v233
    v_mfma_f32_16x16x32_bf16 v[76:79], a[204:207], v[208:211], 0
    v_exp_f32 v197, v197
    v_fma_f32 v198, v198, s44, v251
    v_mfma_f32_16x16x32_bf16 v[80:83], a[208:211], v[208:211], 0
    v_permlane32_swap_b32 v233, v234
    v_mfma_f32_16x16x32_bf16 v[84:87], a[212:215], v[208:211], 0
    v_max_f32 v233, v233, v234
    v_mov_b32 v234, v233
    v_exp_f32 v198, v198
    v_fma_f32 v199, v199, s44, v251
    v_cvt_pk_bf16_f32 v194, v196, v197
    v_mfma_f32_16x16x32_bf16 v[88:91], a[216:219], v[208:211], 0
    ds_read_b64_tr_b16 a[184:185], v244 offset:9216
    v_mov_b32 v229, v228
    v_mfma_f32_16x16x32_bf16 v[92:95], a[220:223], v[208:211], 0
    v_permlane16_swap_b32 v233, v234
    v_exp_f32 v199, v199
    v_mfma_f32_16x16x32_bf16 v[208:211], a[128:131], a[80:83], 0
    v_min_f32 v232, -v233, -v234
    v_mul_f32 v255, s44, v232
    v_fma_f32 v200, v200, s44, v255
    v_mfma_f32_16x16x32_bf16 v[208:211], a[132:135], a[84:87], v[208:211]
    v_mov_b32 v230, v228
    v_mov_b32 v231, v228
    v_cvt_pk_bf16_f32 v195, v198, v199
    v_mfma_f32_16x16x32_bf16 v[208:211], a[136:139], a[88:91], v[208:211]
    v_exp_f32 v200, v200
    v_fma_f32 v201, v201, s44, v255
    v_mfma_f32_16x16x32_bf16 v[208:211], a[140:143], a[92:95], v[208:211]
    ds_read_b64_tr_b16 a[186:187], v244 offset:13312
    v_fma_f32 v202, v202, s44, v255
    v_mfma_f32_16x16x32_bf16 v[212:215], a[156:159], a[92:95], 0
    v_exp_f32 v201, v201
    v_mfma_f32_16x16x32_bf16 v[212:215], a[152:155], a[88:91], v[212:215]
    v_exp_f32 v202, v202
    v_mfma_f32_16x16x32_bf16 v[212:215], a[148:151], a[84:87], v[212:215]
    v_fma_f32 v203, v203, s44, v255
    v_cvt_pk_bf16_f32 v200, v200, v201
    v_mfma_f32_16x16x32_bf16 v[212:215], a[144:147], a[80:83], v[212:215]
    ds_read_b64_tr_b16 a[188:189], v245 offset:9216
    v_fma_f32 v204, v204, s44, v255
    v_mfma_f32_16x16x32_bf16 a[228:231], a[240:243], v[192:195], a[228:231]
    v_exp_f32 v203, v203
    v_mfma_f32_16x16x32_bf16 v[96:99], a[192:195], v[192:195], 0
    v_exp_f32 v204, v204
    v_mfma_f32_16x16x32_bf16 v[100:103], a[196:199], v[192:195], 0
    v_fma_f32 v205, v205, s44, v255
    v_cvt_pk_bf16_f32 v201, v202, v203
    v_mfma_f32_16x16x32_bf16 v[104:107], a[200:203], v[192:195], 0
    v_max3_f32 v237, v208, v209, v210
    v_max3_f32 v238, v211, v212, v213
    v_max3_f32 v237, v237, v214, v215
    v_max_f32 v237, v237, v238
    v_mov_b32 v238, v237
    v_mfma_f32_16x16x32_bf16 v[108:111], a[204:207], v[192:195], 0
    ds_read_b64_tr_b16 a[190:191], v245 offset:13312
    v_fma_f32 v206, v206, s44, v255
    v_exp_f32 v205, v205
    v_mfma_f32_16x16x32_bf16 v[112:115], a[208:211], v[192:195], 0
    v_permlane32_swap_b32 v237, v238
    v_mfma_f32_16x16x32_bf16 v[116:119], a[212:215], v[192:195], 0
    v_max_f32 v237, v237, v238
    v_mov_b32 v238, v237
    v_exp_f32 v206, v206
    v_fma_f32 v207, v207, s44, v255
    v_cvt_pk_bf16_f32 v202, v204, v205
    v_mfma_f32_16x16x32_bf16 v[120:123], a[216:219], v[192:195], 0
    v_exp_f32 v207, v207
    v_mfma_f32_16x16x32_bf16 v[124:127], a[220:223], v[192:195], 0
    v_permlane16_swap_b32 v237, v238
    v_mfma_f32_16x16x32_bf16 v[192:195], a[96:99], a[0:3], v[216:219]
    s_waitcnt vmcnt(12) lgkmcnt(0)
    v_min_f32 v236, -v237, -v238
    v_mul_f32 v251, s44, v236
    v_fma_f32 v208, v208, s44, v251
    v_mfma_f32_16x16x32_bf16 v[192:195], a[100:103], a[4:7], v[192:195]
    s_barrier
    v_mov_b32 v233, v232
    v_mov_b32 v234, v232
    v_mov_b32 v235, v232
    v_cvt_pk_bf16_f32 v203, v206, v207
    v_mfma_f32_16x16x32_bf16 v[192:195], a[104:107], a[8:11], v[192:195]
    v_exp_f32 v208, v208
    v_fma_f32 v209, v209, s44, v251
    v_mfma_f32_16x16x32_bf16 v[192:195], a[108:111], a[12:15], v[192:195]
    v_exp_f32 v209, v209
    v_mfma_f32_16x16x32_bf16 v[196:199], a[124:127], a[12:15], v[216:219]
    ds_read_b128 a[128:131], v240 offset:16384
    v_fma_f32 v210, v210, s44, v251
    v_mfma_f32_16x16x32_bf16 v[196:199], a[120:123], a[8:11], v[196:199]
    v_exp_f32 v210, v210
    v_mfma_f32_16x16x32_bf16 v[196:199], a[116:119], a[4:7], v[196:199]
    ds_read_b128 a[248:251], v250 offset:4352
    v_fma_f32 v211, v211, s44, v251
    v_cvt_pk_bf16_f32 v208, v208, v209
    v_mfma_f32_16x16x32_bf16 v[196:199], a[112:115], a[0:3], v[196:199]
    buffer_load_dwordx4 v248, s[8:11], s30 offen sc1 nt lds
    v_mfma_f32_16x16x32_bf16 a[232:235], a[236:239], v[200:203], 0
    s_addk_i32 m0, 896
    ds_read_b128 a[132:135], v241 offset:16384
    v_fma_f32 v212, v212, s44, v251
    v_exp_f32 v211, v211
    v_mfma_f32_16x16x32_bf16 v[128:131], a[192:195], v[200:203], 0
    v_exp_f32 v212, v212
    v_mfma_f32_16x16x32_bf16 v[132:135], a[196:199], v[200:203], 0
    v_fma_f32 v213, v213, s44, v251
    v_cvt_pk_bf16_f32 v209, v210, v211
    v_mfma_f32_16x16x32_bf16 v[136:139], a[200:203], v[200:203], 0
    ds_read_b128 a[136:139], v240 offset:17408
    v_fma_f32 v214, v214, s44, v251
    v_mfma_f32_16x16x32_bf16 v[140:143], a[204:207], v[200:203], 0
    v_exp_f32 v213, v213
    v_mfma_f32_16x16x32_bf16 v[144:147], a[208:211], v[200:203], 0
    s_waitcnt lgkmcnt(2)
    ds_read_b128 a[140:143], v241 offset:17408
    buffer_store_dwordx4 a[248:251], v248, s[16:19], s31 offen offset:0 sc1
    v_fma_f32 v215, v215, s44, v251
    v_mfma_f32_16x16x32_bf16 v[148:151], a[212:215], v[200:203], 0
    v_exp_f32 v214, v214
    v_cvt_pk_bf16_f32 v210, v212, v213
    v_mfma_f32_16x16x32_bf16 v[152:155], a[216:219], v[200:203], 0
    ds_read_b128 a[252:255], v250 offset:6528
    v_mul_f32 v192, s44, v192
    v_mfma_f32_16x16x32_bf16 v[156:159], a[220:223], v[200:203], 0
    v_exp_f32 v215, v215
    v_mfma_f32_16x16x32_bf16 v[200:203], a[96:99], a[16:19], v[220:223]
    ds_read_b128 a[144:147], v240 offset:20480
    v_mov_b32 v237, v236
    v_mfma_f32_16x16x32_bf16 v[200:203], a[100:103], a[20:23], v[200:203]
    v_mov_b32 v238, v236
    v_mov_b32 v239, v236
    v_cvt_pk_bf16_f32 v211, v214, v215
    v_mfma_f32_16x16x32_bf16 v[200:203], a[104:107], a[24:27], v[200:203]
    buffer_load_dwordx4 v248, s[8:11], s30 offen offset:128 sc1 nt lds
    v_exp_f32 v192, v192
    v_mul_f32 v193, s44, v193
    v_mfma_f32_16x16x32_bf16 v[200:203], a[108:111], a[28:31], v[200:203]
    s_addk_i32 m0, 31872
    ds_read_b128 a[148:151], v241 offset:20480
    v_mul_f32 v194, s44, v194
    v_mfma_f32_16x16x32_bf16 v[204:207], a[124:127], a[28:31], v[220:223]
    v_exp_f32 v193, v193
    v_mfma_f32_16x16x32_bf16 v[204:207], a[120:123], a[24:27], v[204:207]
    s_waitcnt lgkmcnt(2)
    ds_read_b128 a[152:155], v240 offset:21504
    buffer_store_dwordx4 a[252:255], v248, s[16:19], s31 offen offset:2048 sc1
    v_mul_f32 v195, s44, v195
    v_mfma_f32_16x16x32_bf16 v[204:207], a[116:119], a[20:23], v[204:207]
    v_exp_f32 v194, v194
    v_cvt_pk_bf16_f32 v192, v192, v193
    v_mfma_f32_16x16x32_bf16 v[204:207], a[112:115], a[16:19], v[204:207]
    ds_read_b128 a[248:251], v250 offset:4480
    v_mul_f32 v196, s44, v196
    v_mfma_f32_16x16x32_bf16 a[232:235], a[240:243], v[208:211], a[232:235]
    v_exp_f32 v195, v195
    v_mfma_f32_16x16x32_bf16 v[160:163], a[192:195], v[208:211], 0
    ds_read_b128 a[156:159], v241 offset:21504
    v_mul_f32 v197, s44, v197
    v_mfma_f32_16x16x32_bf16 v[164:167], a[196:199], v[208:211], 0
    v_exp_f32 v196, v196
    v_cvt_pk_bf16_f32 v193, v194, v195
    v_mfma_f32_16x16x32_bf16 v[168:171], a[200:203], v[208:211], 0
    v_exp_f32 v197, v197
    v_mfma_f32_16x16x32_bf16 v[172:175], a[204:207], v[208:211], 0
    ds_read_b64_tr_b16 a[192:193], v242 offset:16384
    v_mul_f32 v198, s44, v198
    v_mfma_f32_16x16x32_bf16 v[176:179], a[208:211], v[208:211], 0
    v_exp_f32 v198, v198
    v_mfma_f32_16x16x32_bf16 v[180:183], a[212:215], v[208:211], 0
    s_waitcnt lgkmcnt(2)
    buffer_store_dwordx4 a[248:251], v248, s[16:19], s31 offen offset:128 sc1
    v_mul_f32 v199, s44, v199
    v_cvt_pk_bf16_f32 v194, v196, v197
    v_mfma_f32_16x16x32_bf16 v[184:187], a[216:219], v[208:211], 0
    v_exp_f32 v199, v199
    v_mfma_f32_16x16x32_bf16 v[188:191], a[220:223], v[208:211], 0
    ds_read_b128 a[252:255], v250 offset:6656
    v_mul_f32 v200, s44, v200
    v_mfma_f32_16x16x32_bf16 v[208:211], a[96:99], a[32:35], v[224:227]
    ds_read_b64_tr_b16 a[194:195], v242 offset:20480
    v_cvt_pk_bf16_f32 v195, v198, v199
    v_mfma_f32_16x16x32_bf16 v[208:211], a[100:103], a[36:39], v[208:211]
    v_exp_f32 v200, v200
    v_mfma_f32_16x16x32_bf16 v[208:211], a[104:107], a[40:43], v[208:211]
    ds_read_b64_tr_b16 a[196:197], v243 offset:16384
    v_mul_f32 v201, s44, v201
    v_mfma_f32_16x16x32_bf16 v[208:211], a[108:111], a[44:47], v[208:211]
    v_exp_f32 v201, v201
    v_mfma_f32_16x16x32_bf16 v[212:215], a[124:127], a[44:47], v[224:227]
    v_mul_f32 v202, s44, v202
    v_mul_f32 v203, s44, v203
    v_mfma_f32_16x16x32_bf16 v[212:215], a[120:123], a[40:43], v[212:215]
    v_exp_f32 v202, v202
    v_mfma_f32_16x16x32_bf16 v[212:215], a[116:119], a[36:39], v[212:215]
    s_waitcnt lgkmcnt(2)
    buffer_store_dwordx4 a[252:255], v248, s[16:19], s31 offen offset:2176 sc1
    v_cvt_pk_bf16_f32 v196, v200, v201
    v_mul_f32 v204, s44, v204
    v_mfma_f32_16x16x32_bf16 v[212:215], a[112:115], a[32:35], v[212:215]
    v_exp_f32 v203, v203
    v_mfma_f32_16x16x32_bf16 v[0:3], a[160:163], v[192:195], v[0:3]
    ds_read_b64_tr_b16 a[198:199], v243 offset:20480
    v_mul_f32 v205, s44, v205
    v_mfma_f32_16x16x32_bf16 v[4:7], a[164:167], v[192:195], v[4:7]
    v_exp_f32 v204, v204
    v_mfma_f32_16x16x32_bf16 v[8:11], a[168:171], v[192:195], v[8:11]
    v_cvt_pk_bf16_f32 v197, v202, v203
    v_mul_f32 v206, s44, v206
    v_mfma_f32_16x16x32_bf16 v[12:15], a[172:175], v[192:195], v[12:15]
    v_exp_f32 v205, v205
    v_mfma_f32_16x16x32_bf16 v[16:19], a[176:179], v[192:195], v[16:19]
    ds_read_b64_tr_b16 a[200:201], v244 offset:16384
    v_mul_f32 v207, s44, v207
    v_mfma_f32_16x16x32_bf16 v[20:23], a[180:183], v[192:195], v[20:23]
    v_exp_f32 v206, v206
    v_mfma_f32_16x16x32_bf16 v[24:27], a[184:187], v[192:195], v[24:27]
    v_cvt_pk_bf16_f32 v198, v204, v205
    v_mul_f32 v208, s44, v208
    v_mfma_f32_16x16x32_bf16 v[28:31], a[188:191], v[192:195], v[28:31]
    v_exp_f32 v207, v207
    v_mfma_f32_16x16x32_bf16 v[200:203], a[96:99], a[48:51], v[228:231]
    ds_read_b64_tr_b16 a[202:203], v244 offset:20480
    v_cvt_pk_bf16_f32 v199, v206, v207
    v_mfma_f32_16x16x32_bf16 v[200:203], a[100:103], a[52:55], v[200:203]
    v_exp_f32 v208, v208
    v_mfma_f32_16x16x32_bf16 v[200:203], a[104:107], a[56:59], v[200:203]
    v_mul_f32 v209, s44, v209
    v_mul_f32 v210, s44, v210
    v_mfma_f32_16x16x32_bf16 v[200:203], a[108:111], a[60:63], v[200:203]
    buffer_load_dwordx4 v248, s[12:15], s30 offen sc1 nt lds
    v_mfma_f32_16x16x32_bf16 v[204:207], a[124:127], a[60:63], v[228:231]
    s_addk_i32 m0, 896
    v_exp_f32 v209, v209
    v_mfma_f32_16x16x32_bf16 v[204:207], a[120:123], a[56:59], v[204:207]
    ds_read_b64_tr_b16 a[204:205], v245 offset:16384
    v_mul_f32 v211, s44, v211
    v_mfma_f32_16x16x32_bf16 v[204:207], a[116:119], a[52:55], v[204:207]
    v_exp_f32 v210, v210
    v_cvt_pk_bf16_f32 v208, v208, v209
    v_mfma_f32_16x16x32_bf16 v[204:207], a[112:115], a[48:51], v[204:207]
    v_exp_f32 v211, v211
    v_smfmac_f32_16x16x64_bf16 a[224:227], a[244:247], v[192:199], v253
    v_mul_f32 v212, s44, v212
    v_mfma_f32_16x16x32_bf16 v[32:35], a[160:163], v[196:199], v[32:35]
    ds_read_b64_tr_b16 a[206:207], v245 offset:20480
    v_mul_f32 v213, s44, v213
    v_mfma_f32_16x16x32_bf16 v[36:39], a[164:167], v[196:199], v[36:39]
    v_exp_f32 v212, v212
    v_cvt_pk_bf16_f32 v209, v210, v211
    v_mfma_f32_16x16x32_bf16 v[40:43], a[168:171], v[196:199], v[40:43]
    v_exp_f32 v213, v213
    v_mfma_f32_16x16x32_bf16 v[44:47], a[172:175], v[196:199], v[44:47]
    v_mul_f32 v214, s44, v214
    v_mul_f32 v215, s44, v215
    v_mfma_f32_16x16x32_bf16 v[48:51], a[176:179], v[196:199], v[48:51]
    v_exp_f32 v214, v214
    v_mfma_f32_16x16x32_bf16 v[52:55], a[180:183], v[196:199], v[52:55]
    ds_read_b64_tr_b16 a[208:209], v242 offset:17408
    v_cvt_pk_bf16_f32 v210, v212, v213
    v_mfma_f32_16x16x32_bf16 v[56:59], a[184:187], v[196:199], v[56:59]
    buffer_load_dwordx4 v248, s[12:15], s30 offen offset:128 sc1 nt lds
    v_mfma_f32_16x16x32_bf16 v[60:63], a[188:191], v[196:199], v[60:63]
    s_addk_i32 m0, -25472
    v_exp_f32 v215, v215
    v_mfma_f32_16x16x32_bf16 v[192:195], a[96:99], a[64:67], v[232:235]
    s_addk_i32 s30, 8192
    v_mul_f32 v200, s44, v200
    v_cvt_pk_bf16_f32 v211, v214, v215
    v_mfma_f32_16x16x32_bf16 v[192:195], a[100:103], a[68:71], v[192:195]
    ds_read_b64_tr_b16 a[210:211], v242 offset:21504
    v_mul_f32 v201, s44, v201
    v_mfma_f32_16x16x32_bf16 v[192:195], a[104:107], a[72:75], v[192:195]
    v_exp_f32 v200, v200
    v_mfma_f32_16x16x32_bf16 v[192:195], a[108:111], a[76:79], v[192:195]
    v_exp_f32 v201, v201
    v_mfma_f32_16x16x32_bf16 v[196:199], a[124:127], a[76:79], v[232:235]
    ds_read_b64_tr_b16 a[212:213], v243 offset:17408
    v_mul_f32 v202, s44, v202
    v_mfma_f32_16x16x32_bf16 v[196:199], a[120:123], a[72:75], v[196:199]
    v_exp_f32 v202, v202
    v_mfma_f32_16x16x32_bf16 v[196:199], a[116:119], a[68:71], v[196:199]
    v_mul_f32 v203, s44, v203
    v_cvt_pk_bf16_f32 v212, v200, v201
    v_mfma_f32_16x16x32_bf16 v[196:199], a[112:115], a[64:67], v[196:199]
    v_exp_f32 v203, v203
    v_mfma_f32_16x16x32_bf16 v[64:67], a[160:163], v[208:211], v[64:67]
    v_mul_f32 v204, s44, v204
    v_mul_f32 v205, s44, v205
    v_mfma_f32_16x16x32_bf16 v[68:71], a[164:167], v[208:211], v[68:71]
    v_exp_f32 v204, v204
    v_mfma_f32_16x16x32_bf16 v[72:75], a[168:171], v[208:211], v[72:75]
    ds_read_b64_tr_b16 a[214:215], v243 offset:21504
    v_cvt_pk_bf16_f32 v213, v202, v203
    v_mfma_f32_16x16x32_bf16 v[76:79], a[172:175], v[208:211], v[76:79]
    v_exp_f32 v205, v205
    v_mfma_f32_16x16x32_bf16 v[80:83], a[176:179], v[208:211], v[80:83]
    v_mul_f32 v206, s44, v206
    v_mul_f32 v207, s44, v207
    v_mfma_f32_16x16x32_bf16 v[84:87], a[180:183], v[208:211], v[84:87]
    v_exp_f32 v206, v206
    v_mfma_f32_16x16x32_bf16 v[88:91], a[184:187], v[208:211], v[88:91]
    ds_read_b64_tr_b16 a[216:217], v244 offset:17408
    v_cvt_pk_bf16_f32 v214, v204, v205
    v_mfma_f32_16x16x32_bf16 v[92:95], a[188:191], v[208:211], v[92:95]
    v_exp_f32 v207, v207
    v_mfma_f32_16x16x32_bf16 v[200:203], a[96:99], a[80:83], v[236:239]
    v_mul_f32 v192, s44, v192
    v_cvt_pk_bf16_f32 v215, v206, v207
    v_mfma_f32_16x16x32_bf16 v[200:203], a[100:103], a[84:87], v[200:203]
    v_exp_f32 v192, v192
    v_mfma_f32_16x16x32_bf16 v[200:203], a[104:107], a[88:91], v[200:203]
    ds_read_b64_tr_b16 a[218:219], v244 offset:21504
    v_mul_f32 v193, s44, v193
    v_mfma_f32_16x16x32_bf16 v[200:203], a[108:111], a[92:95], v[200:203]
    v_exp_f32 v193, v193
    v_mfma_f32_16x16x32_bf16 v[204:207], a[124:127], a[92:95], v[236:239]
    v_mul_f32 v194, s44, v194
    v_mul_f32 v195, s44, v195
    v_mfma_f32_16x16x32_bf16 v[204:207], a[120:123], a[88:91], v[204:207]
    v_exp_f32 v194, v194
    v_mfma_f32_16x16x32_bf16 v[204:207], a[116:119], a[84:87], v[204:207]
    ds_read_b64_tr_b16 a[220:221], v245 offset:17408
    v_cvt_pk_bf16_f32 v192, v192, v193
    v_mfma_f32_16x16x32_bf16 v[204:207], a[112:115], a[80:83], v[204:207]
    v_exp_f32 v195, v195
    v_smfmac_f32_16x16x64_bf16 a[228:231], a[244:247], v[208:215], v253
    v_mul_f32 v196, s44, v196
    v_mfma_f32_16x16x32_bf16 v[96:99], a[160:163], v[212:215], v[96:99]
    v_exp_f32 v196, v196
    v_mfma_f32_16x16x32_bf16 v[100:103], a[164:167], v[212:215], v[100:103]
    v_mul_f32 v197, s44, v197
    v_cvt_pk_bf16_f32 v193, v194, v195
    v_mfma_f32_16x16x32_bf16 v[104:107], a[168:171], v[212:215], v[104:107]
    ds_read_b64_tr_b16 a[222:223], v245 offset:21504
    v_mul_f32 v198, s44, v198
    v_mfma_f32_16x16x32_bf16 v[108:111], a[172:175], v[212:215], v[108:111]
    v_exp_f32 v197, v197
    v_mfma_f32_16x16x32_bf16 v[112:115], a[176:179], v[212:215], v[112:115]
    v_exp_f32 v198, v198
    v_mfma_f32_16x16x32_bf16 v[116:119], a[180:183], v[212:215], v[116:119]
    v_mul_f32 v199, s44, v199
    v_cvt_pk_bf16_f32 v194, v196, v197
    v_mfma_f32_16x16x32_bf16 v[120:123], a[184:187], v[212:215], v[120:123]
    v_exp_f32 v199, v199
    v_mfma_f32_16x16x32_bf16 v[124:127], a[188:191], v[212:215], v[124:127]
    v_mul_f32 v200, s44, v200
    v_cvt_pk_bf16_f32 v195, v198, v199
    v_mfma_f32_16x16x32_bf16 v[208:211], a[128:131], a[0:3], v[216:219]
    s_waitcnt vmcnt(16) lgkmcnt(0)
    v_exp_f32 v200, v200
    v_mfma_f32_16x16x32_bf16 v[208:211], a[132:135], a[4:7], v[208:211]
    s_barrier
    v_mul_f32 v201, s44, v201
    v_mfma_f32_16x16x32_bf16 v[208:211], a[136:139], a[8:11], v[208:211]
    v_exp_f32 v201, v201
    v_mfma_f32_16x16x32_bf16 v[208:211], a[140:143], a[12:15], v[208:211]
    ds_read_b128 a[96:99], v240 offset:24576
    v_mul_f32 v202, s44, v202
    v_mfma_f32_16x16x32_bf16 v[212:215], a[156:159], a[12:15], v[216:219]
    buffer_load_dwordx4 v248, s[8:11], s30 offen sc1 nt lds
    v_mfma_f32_16x16x32_bf16 v[212:215], a[152:155], a[8:11], v[212:215]
    s_addk_i32 m0, 896
    v_exp_f32 v202, v202
    v_mfma_f32_16x16x32_bf16 v[212:215], a[148:151], a[4:7], v[212:215]
    v_mul_f32 v203, s44, v203
    v_cvt_pk_bf16_f32 v196, v200, v201
    v_mfma_f32_16x16x32_bf16 v[212:215], a[144:147], a[0:3], v[212:215]
    ds_read_b128 a[100:103], v241 offset:24576
    v_mul_f32 v204, s44, v204
    v_mfma_f32_16x16x32_bf16 v[128:131], a[160:163], v[192:195], v[128:131]
    v_exp_f32 v203, v203
    v_mfma_f32_16x16x32_bf16 v[132:135], a[164:167], v[192:195], v[132:135]
    v_exp_f32 v204, v204
    v_mfma_f32_16x16x32_bf16 v[136:139], a[168:171], v[192:195], v[136:139]
    v_mul_f32 v205, s44, v205
    v_cvt_pk_bf16_f32 v197, v202, v203
    v_mfma_f32_16x16x32_bf16 v[140:143], a[172:175], v[192:195], v[140:143]
    ds_read_b128 a[104:107], v240 offset:25600
    v_mul_f32 v206, s44, v206
    v_mfma_f32_16x16x32_bf16 v[144:147], a[176:179], v[192:195], v[144:147]
    v_exp_f32 v205, v205
    v_mfma_f32_16x16x32_bf16 v[148:151], a[180:183], v[192:195], v[148:151]
    ds_read_b128 a[108:111], v241 offset:25600
    v_mul_f32 v207, s44, v207
    v_mfma_f32_16x16x32_bf16 v[152:155], a[184:187], v[192:195], v[152:155]
    v_exp_f32 v206, v206
    v_cvt_pk_bf16_f32 v198, v204, v205
    v_mfma_f32_16x16x32_bf16 v[156:159], a[188:191], v[192:195], v[156:159]
    v_exp_f32 v207, v207
    v_mfma_f32_16x16x32_bf16 v[200:203], a[128:131], a[16:19], v[220:223]
    ds_read_b128 a[112:115], v240 offset:28672
    v_mul_f32 v208, s44, v208
    v_mfma_f32_16x16x32_bf16 v[200:203], a[132:135], a[20:23], v[200:203]
    buffer_load_dwordx4 v248, s[8:11], s30 offen offset:128 sc1 nt lds
    v_mfma_f32_16x16x32_bf16 v[200:203], a[136:139], a[24:27], v[200:203]
    s_addk_i32 m0, 31872
    v_cvt_pk_bf16_f32 v199, v206, v207
    v_mul_f32 v209, s44, v209
    v_exp_f32 v208, v208
    v_mfma_f32_16x16x32_bf16 v[200:203], a[140:143], a[28:31], v[200:203]
    ds_read_b128 a[116:119], v241 offset:28672
    v_mul_f32 v210, s44, v210
    v_mfma_f32_16x16x32_bf16 v[204:207], a[156:159], a[28:31], v[220:223]
    v_exp_f32 v209, v209
    v_mfma_f32_16x16x32_bf16 v[204:207], a[152:155], a[24:27], v[204:207]
    v_exp_f32 v210, v210
    v_mfma_f32_16x16x32_bf16 v[204:207], a[148:151], a[20:23], v[204:207]
    v_mul_f32 v211, s44, v211
    v_cvt_pk_bf16_f32 v208, v208, v209
    v_mfma_f32_16x16x32_bf16 v[204:207], a[144:147], a[16:19], v[204:207]
    ds_read_b128 a[120:123], v240 offset:29696
    v_mul_f32 v212, s44, v212
    v_smfmac_f32_16x16x64_bf16 a[232:235], a[244:247], v[192:199], v253
    ds_read_b128 a[124:127], v241 offset:29696
    v_exp_f32 v211, v211
    v_mfma_f32_16x16x32_bf16 v[160:163], a[160:163], v[196:199], v[160:163]
    v_exp_f32 v212, v212
    v_mfma_f32_16x16x32_bf16 v[164:167], a[164:167], v[196:199], v[164:167]
    v_mul_f32 v213, s44, v213
    v_cvt_pk_bf16_f32 v209, v210, v211
    v_mfma_f32_16x16x32_bf16 v[168:171], a[168:171], v[196:199], v[168:171]
    v_exp_f32 v213, v213
    v_mfma_f32_16x16x32_bf16 v[172:175], a[172:175], v[196:199], v[172:175]
    ds_read_b64_tr_b16 a[160:161], v242 offset:24576
    v_mul_f32 v214, s44, v214
    v_mfma_f32_16x16x32_bf16 v[176:179], a[176:179], v[196:199], v[176:179]
    v_exp_f32 v214, v214
    v_mfma_f32_16x16x32_bf16 v[180:183], a[180:183], v[196:199], v[180:183]
    v_mul_f32 v215, s44, v215
    v_cvt_pk_bf16_f32 v210, v212, v213
    v_mfma_f32_16x16x32_bf16 v[184:187], a[184:187], v[196:199], v[184:187]
    v_exp_f32 v215, v215
    v_mfma_f32_16x16x32_bf16 v[188:191], a[188:191], v[196:199], v[188:191]
    ds_read_b64_tr_b16 a[162:163], v242 offset:28672
    v_mul_f32 v200, s44, v200
    v_mfma_f32_16x16x32_bf16 v[192:195], a[128:131], a[32:35], v[224:227]
    v_cvt_pk_bf16_f32 v211, v214, v215
    v_mul_f32 v201, s44, v201
    v_mfma_f32_16x16x32_bf16 v[192:195], a[132:135], a[36:39], v[192:195]
    v_exp_f32 v200, v200
    v_mfma_f32_16x16x32_bf16 v[192:195], a[136:139], a[40:43], v[192:195]
    ds_read_b64_tr_b16 a[164:165], v243 offset:24576
    v_mul_f32 v202, s44, v202
    v_mfma_f32_16x16x32_bf16 v[192:195], a[140:143], a[44:47], v[192:195]
    v_exp_f32 v201, v201
    v_mfma_f32_16x16x32_bf16 v[196:199], a[156:159], a[44:47], v[224:227]
    v_exp_f32 v202, v202
    v_mfma_f32_16x16x32_bf16 v[196:199], a[152:155], a[40:43], v[196:199]
    v_mul_f32 v203, s44, v203
    v_cvt_pk_bf16_f32 v212, v200, v201
    v_mfma_f32_16x16x32_bf16 v[196:199], a[148:151], a[36:39], v[196:199]
    v_exp_f32 v203, v203
    v_mfma_f32_16x16x32_bf16 v[196:199], a[144:147], a[32:35], v[196:199]
    ds_read_b64_tr_b16 a[166:167], v243 offset:28672
    v_mul_f32 v204, s44, v204
    v_mfma_f32_16x16x32_bf16 v[0:3], a[192:195], v[208:211], v[0:3]
    v_exp_f32 v204, v204
    v_mfma_f32_16x16x32_bf16 v[4:7], a[196:199], v[208:211], v[4:7]
    v_mul_f32 v205, s44, v205
    v_cvt_pk_bf16_f32 v213, v202, v203
    v_mfma_f32_16x16x32_bf16 v[8:11], a[200:203], v[208:211], v[8:11]
    v_exp_f32 v205, v205
    v_mfma_f32_16x16x32_bf16 v[12:15], a[204:207], v[208:211], v[12:15]
    ds_read_b64_tr_b16 a[168:169], v244 offset:24576
    v_mul_f32 v206, s44, v206
    v_mfma_f32_16x16x32_bf16 v[16:19], a[208:211], v[208:211], v[16:19]
    s_add_u32 s31, s21, 8192
    v_exp_f32 v206, v206
    v_mfma_f32_16x16x32_bf16 v[20:23], a[212:215], v[208:211], v[20:23]
    v_mul_f32 v207, s44, v207
    v_cvt_pk_bf16_f32 v214, v204, v205
    v_mfma_f32_16x16x32_bf16 v[24:27], a[216:219], v[208:211], v[24:27]
    v_exp_f32 v207, v207
    v_mfma_f32_16x16x32_bf16 v[28:31], a[220:223], v[208:211], v[28:31]
    ds_read_b64_tr_b16 a[170:171], v244 offset:28672
    v_mul_f32 v192, s44, v192
    v_mfma_f32_16x16x32_bf16 v[200:203], a[128:131], a[48:51], v[228:231]
    v_cvt_pk_bf16_f32 v215, v206, v207
    v_mul_f32 v193, s44, v193
    v_mfma_f32_16x16x32_bf16 v[200:203], a[132:135], a[52:55], v[200:203]
    v_exp_f32 v192, v192
    v_mfma_f32_16x16x32_bf16 v[200:203], a[136:139], a[56:59], v[200:203]
    buffer_load_dwordx4 v248, s[12:15], s30 offen sc1 nt lds
    v_mfma_f32_16x16x32_bf16 v[200:203], a[140:143], a[60:63], v[200:203]
    s_addk_i32 m0, 896
    v_exp_f32 v193, v193
    v_mfma_f32_16x16x32_bf16 v[204:207], a[156:159], a[60:63], v[228:231]
    ds_read_b64_tr_b16 a[172:173], v245 offset:24576
    v_mul_f32 v194, s44, v194
    v_mfma_f32_16x16x32_bf16 v[204:207], a[152:155], a[56:59], v[204:207]
    v_exp_f32 v194, v194
    v_mfma_f32_16x16x32_bf16 v[204:207], a[148:151], a[52:55], v[204:207]
    v_mul_f32 v195, s44, v195
    v_cvt_pk_bf16_f32 v192, v192, v193
    v_mfma_f32_16x16x32_bf16 v[204:207], a[144:147], a[48:51], v[204:207]
    v_exp_f32 v195, v195
    v_smfmac_f32_16x16x64_bf16 a[224:227], a[244:247], v[208:215], v253
    v_mul_f32 v196, s44, v196
    v_mfma_f32_16x16x32_bf16 v[32:35], a[192:195], v[212:215], v[32:35]
    ds_read_b64_tr_b16 a[174:175], v245 offset:28672
    v_mul_f32 v197, s44, v197
    v_mfma_f32_16x16x32_bf16 v[36:39], a[196:199], v[212:215], v[36:39]
    v_exp_f32 v196, v196
    v_cvt_pk_bf16_f32 v193, v194, v195
    v_mfma_f32_16x16x32_bf16 v[40:43], a[200:203], v[212:215], v[40:43]
    v_exp_f32 v197, v197
    v_mfma_f32_16x16x32_bf16 v[44:47], a[204:207], v[212:215], v[44:47]
    v_mul_f32 v198, s44, v198
    v_mul_f32 v199, s44, v199
    v_mfma_f32_16x16x32_bf16 v[48:51], a[208:211], v[212:215], v[48:51]
    v_exp_f32 v198, v198
    v_mfma_f32_16x16x32_bf16 v[52:55], a[212:215], v[212:215], v[52:55]
    ds_read_b64_tr_b16 a[176:177], v242 offset:25600
    v_cvt_pk_bf16_f32 v194, v196, v197
    v_mfma_f32_16x16x32_bf16 v[56:59], a[216:219], v[212:215], v[56:59]
    buffer_load_dwordx4 v248, s[12:15], s30 offen offset:128 sc1 nt lds
    v_mfma_f32_16x16x32_bf16 v[60:63], a[220:223], v[212:215], v[60:63]
    s_addk_i32 m0, -25472
    v_exp_f32 v199, v199
    v_mfma_f32_16x16x32_bf16 v[208:211], a[128:131], a[64:67], v[232:235]
    s_addk_i32 s30, 8192
    v_mul_f32 v200, s44, v200
    v_cvt_pk_bf16_f32 v195, v198, v199
    v_mfma_f32_16x16x32_bf16 v[208:211], a[132:135], a[68:71], v[208:211]
    ds_read_b64_tr_b16 a[178:179], v242 offset:29696
    v_mul_f32 v201, s44, v201
    v_mfma_f32_16x16x32_bf16 v[208:211], a[136:139], a[72:75], v[208:211]
    v_exp_f32 v200, v200
    v_mfma_f32_16x16x32_bf16 v[208:211], a[140:143], a[76:79], v[208:211]
    v_exp_f32 v201, v201
    v_mfma_f32_16x16x32_bf16 v[212:215], a[156:159], a[76:79], v[232:235]
    ds_read_b64_tr_b16 a[180:181], v243 offset:25600
    v_mul_f32 v202, s44, v202
    v_mfma_f32_16x16x32_bf16 v[212:215], a[152:155], a[72:75], v[212:215]
    v_exp_f32 v202, v202
    v_mfma_f32_16x16x32_bf16 v[212:215], a[148:151], a[68:71], v[212:215]
    v_mul_f32 v203, s44, v203
    v_cvt_pk_bf16_f32 v196, v200, v201
    v_mfma_f32_16x16x32_bf16 v[212:215], a[144:147], a[64:67], v[212:215]
    v_exp_f32 v203, v203
    v_mfma_f32_16x16x32_bf16 v[64:67], a[192:195], v[192:195], v[64:67]
    v_mul_f32 v204, s44, v204
    v_mul_f32 v205, s44, v205
    v_mfma_f32_16x16x32_bf16 v[68:71], a[196:199], v[192:195], v[68:71]
    v_exp_f32 v204, v204
    v_mfma_f32_16x16x32_bf16 v[72:75], a[200:203], v[192:195], v[72:75]
    ds_read_b64_tr_b16 a[182:183], v243 offset:29696
    v_cvt_pk_bf16_f32 v197, v202, v203
    v_mfma_f32_16x16x32_bf16 v[76:79], a[204:207], v[192:195], v[76:79]
    v_exp_f32 v205, v205
    v_mfma_f32_16x16x32_bf16 v[80:83], a[208:211], v[192:195], v[80:83]
    v_mul_f32 v206, s44, v206
    v_mul_f32 v207, s44, v207
    v_mfma_f32_16x16x32_bf16 v[84:87], a[212:215], v[192:195], v[84:87]
    v_exp_f32 v206, v206
    v_mfma_f32_16x16x32_bf16 v[88:91], a[216:219], v[192:195], v[88:91]
    ds_read_b64_tr_b16 a[184:185], v244 offset:25600
    v_cvt_pk_bf16_f32 v198, v204, v205
    v_mfma_f32_16x16x32_bf16 v[92:95], a[220:223], v[192:195], v[92:95]
    v_exp_f32 v207, v207
    v_mfma_f32_16x16x32_bf16 v[200:203], a[128:131], a[80:83], v[236:239]
    v_mul_f32 v208, s44, v208
    v_cvt_pk_bf16_f32 v199, v206, v207
    v_mfma_f32_16x16x32_bf16 v[200:203], a[132:135], a[84:87], v[200:203]
    v_exp_f32 v208, v208
    v_mfma_f32_16x16x32_bf16 v[200:203], a[136:139], a[88:91], v[200:203]
    ds_read_b64_tr_b16 a[186:187], v244 offset:29696
    v_mul_f32 v209, s44, v209
    v_mfma_f32_16x16x32_bf16 v[200:203], a[140:143], a[92:95], v[200:203]
    v_exp_f32 v209, v209
    v_mfma_f32_16x16x32_bf16 v[204:207], a[156:159], a[92:95], v[236:239]
    v_mul_f32 v210, s44, v210
    v_mul_f32 v211, s44, v211
    v_mfma_f32_16x16x32_bf16 v[204:207], a[152:155], a[88:91], v[204:207]
    v_exp_f32 v210, v210
    v_mfma_f32_16x16x32_bf16 v[204:207], a[148:151], a[84:87], v[204:207]
    ds_read_b64_tr_b16 a[188:189], v245 offset:25600
    v_cvt_pk_bf16_f32 v208, v208, v209
    v_mfma_f32_16x16x32_bf16 v[204:207], a[144:147], a[80:83], v[204:207]
    v_exp_f32 v211, v211
    v_smfmac_f32_16x16x64_bf16 a[228:231], a[244:247], v[192:199], v253
    v_mul_f32 v212, s44, v212
    v_mfma_f32_16x16x32_bf16 v[96:99], a[192:195], v[196:199], v[96:99]
    v_exp_f32 v212, v212
    v_mfma_f32_16x16x32_bf16 v[100:103], a[196:199], v[196:199], v[100:103]
    v_mul_f32 v213, s44, v213
    v_cvt_pk_bf16_f32 v209, v210, v211
    v_mfma_f32_16x16x32_bf16 v[104:107], a[200:203], v[196:199], v[104:107]
    ds_read_b64_tr_b16 a[190:191], v245 offset:29696
    v_mul_f32 v214, s44, v214
    v_mfma_f32_16x16x32_bf16 v[108:111], a[204:207], v[196:199], v[108:111]
    v_exp_f32 v213, v213
    v_mfma_f32_16x16x32_bf16 v[112:115], a[208:211], v[196:199], v[112:115]
    v_exp_f32 v214, v214
    v_mfma_f32_16x16x32_bf16 v[116:119], a[212:215], v[196:199], v[116:119]
    v_mul_f32 v215, s44, v215
    v_cvt_pk_bf16_f32 v210, v212, v213
    v_mfma_f32_16x16x32_bf16 v[120:123], a[216:219], v[196:199], v[120:123]
    v_exp_f32 v215, v215
    v_mfma_f32_16x16x32_bf16 v[124:127], a[220:223], v[196:199], v[124:127]
    s_waitcnt lgkmcnt(1)
    v_mul_f32 v200, s44, v200
    v_cvt_pk_bf16_f32 v211, v214, v215
    v_mfma_f32_16x16x32_bf16 v[192:195], a[96:99], a[0:3], v[216:219]
    s_waitcnt vmcnt(12) lgkmcnt(0)
    v_exp_f32 v200, v200
    v_mfma_f32_16x16x32_bf16 v[192:195], a[100:103], a[4:7], v[192:195]
    s_barrier
    v_mul_f32 v201, s44, v201
    v_mfma_f32_16x16x32_bf16 v[192:195], a[104:107], a[8:11], v[192:195]
    v_exp_f32 v201, v201
    v_mfma_f32_16x16x32_bf16 v[192:195], a[108:111], a[12:15], v[192:195]
    ds_read_b128 a[128:131], v240 offset:0
    v_mul_f32 v202, s44, v202
    v_mfma_f32_16x16x32_bf16 v[196:199], a[124:127], a[12:15], v[216:219]
    buffer_load_dwordx4 v248, s[8:11], s30 offen sc1 nt lds
    v_mfma_f32_16x16x32_bf16 v[196:199], a[120:123], a[8:11], v[196:199]
    s_addk_i32 m0, 896
    v_exp_f32 v202, v202
    v_mfma_f32_16x16x32_bf16 v[196:199], a[116:119], a[4:7], v[196:199]
L_pad8:
    s_cbranch_execz L_pad12
    ds_read_b128 a[248:251], v250 offset:8704
    v_mul_f32 v203, s44, v203
    v_cvt_pk_bf16_f32 v212, v200, v201
    v_mfma_f32_16x16x32_bf16 v[196:199], a[112:115], a[0:3], v[196:199]
    ds_read_b128 a[132:135], v241 offset:0
    v_mul_f32 v204, s44, v204
    v_mfma_f32_16x16x32_bf16 v[128:131], a[192:195], v[208:211], v[128:131]
    v_exp_f32 v203, v203
    v_mfma_f32_16x16x32_bf16 v[132:135], a[196:199], v[208:211], v[132:135]
    v_exp_f32 v204, v204
    v_mfma_f32_16x16x32_bf16 v[136:139], a[200:203], v[208:211], v[136:139]
    v_mul_f32 v205, s44, v205
    v_cvt_pk_bf16_f32 v213, v202, v203
    v_mfma_f32_16x16x32_bf16 v[140:143], a[204:207], v[208:211], v[140:143]
    ds_read_b128 a[136:139], v240 offset:1024
    v_mul_f32 v206, s44, v206
    v_mfma_f32_16x16x32_bf16 v[144:147], a[208:211], v[208:211], v[144:147]
    v_exp_f32 v205, v205
    v_mfma_f32_16x16x32_bf16 v[148:151], a[212:215], v[208:211], v[148:151]
    s_waitcnt lgkmcnt(2)
    ds_read_b128 a[140:143], v241 offset:1024
    buffer_store_dwordx4 a[248:251], v248, s[16:19], s31 offen offset:0 sc1
    v_mul_f32 v207, s44, v207
    v_mfma_f32_16x16x32_bf16 v[152:155], a[216:219], v[208:211], v[152:155]
    v_exp_f32 v206, v206
    v_cvt_pk_bf16_f32 v214, v204, v205
    v_mfma_f32_16x16x32_bf16 v[156:159], a[220:223], v[208:211], v[156:159]
    ds_read_b128 a[252:255], v250 offset:10880
    v_mul_f32 v192, s44, v192
    v_mfma_f32_16x16x32_bf16 v[200:203], a[96:99], a[16:19], v[220:223]
    v_exp_f32 v207, v207
    v_mfma_f32_16x16x32_bf16 v[200:203], a[100:103], a[20:23], v[200:203]
    ds_read_b128 a[144:147], v240 offset:4096
    v_cvt_pk_bf16_f32 v215, v206, v207
    v_mfma_f32_16x16x32_bf16 v[200:203], a[104:107], a[24:27], v[200:203]
    buffer_load_dwordx4 v248, s[8:11], s30 offen offset:128 sc1 nt lds
    v_exp_f32 v192, v192
    v_mul_f32 v193, s44, v193
    v_mfma_f32_16x16x32_bf16 v[200:203], a[108:111], a[28:31], v[200:203]
    s_addk_i32 m0, 31872
    ds_read_b128 a[148:151], v241 offset:4096
    v_mul_f32 v194, s44, v194
    v_mfma_f32_16x16x32_bf16 v[204:207], a[124:127], a[28:31], v[220:223]
    v_exp_f32 v193, v193
    v_mfma_f32_16x16x32_bf16 v[204:207], a[120:123], a[24:27], v[204:207]
    v_exp_f32 v194, v194
    v_mfma_f32_16x16x32_bf16 v[204:207], a[116:119], a[20:23], v[204:207]
    s_waitcnt lgkmcnt(2)
    buffer_store_dwordx4 a[252:255], v248, s[16:19], s31 offen offset:2048 sc1
    v_mul_f32 v195, s44, v195
    v_cvt_pk_bf16_f32 v192, v192, v193
    v_mfma_f32_16x16x32_bf16 v[204:207], a[112:115], a[16:19], v[204:207]
    ds_read_b128 a[152:155], v240 offset:5120
    v_mul_f32 v196, s44, v196
    v_smfmac_f32_16x16x64_bf16 a[232:235], a[244:247], v[208:215], v253
    ds_read_b128 a[248:251], v250 offset:8832
    v_exp_f32 v195, v195
    v_mfma_f32_16x16x32_bf16 v[160:163], a[192:195], v[212:215], v[160:163]
    ds_read_b128 a[156:159], v241 offset:5120
    v_mul_f32 v197, s44, v197
    v_mfma_f32_16x16x32_bf16 v[164:167], a[196:199], v[212:215], v[164:167]
    v_exp_f32 v196, v196
    v_cvt_pk_bf16_f32 v193, v194, v195
    v_mfma_f32_16x16x32_bf16 v[168:171], a[200:203], v[212:215], v[168:171]
    v_exp_f32 v197, v197
    v_mfma_f32_16x16x32_bf16 v[172:175], a[204:207], v[212:215], v[172:175]
    ds_read_b64_tr_b16 a[192:193], v242 offset:0
    v_mul_f32 v198, s44, v198
    v_mfma_f32_16x16x32_bf16 v[176:179], a[208:211], v[212:215], v[176:179]
    v_exp_f32 v198, v198
    v_mfma_f32_16x16x32_bf16 v[180:183], a[212:215], v[212:215], v[180:183]
    v_mul_f32 v199, s44, v199
    v_cvt_pk_bf16_f32 v194, v196, v197
    v_mfma_f32_16x16x32_bf16 v[184:187], a[216:219], v[212:215], v[184:187]
    s_waitcnt lgkmcnt(2)
    buffer_store_dwordx4 a[248:251], v248, s[16:19], s31 offen offset:128 sc1
    v_exp_f32 v199, v199
    v_mfma_f32_16x16x32_bf16 v[188:191], a[220:223], v[212:215], v[188:191]
    ds_read_b64_tr_b16 a[194:195], v242 offset:4096
    v_mul_f32 v200, s44, v200
    v_mfma_f32_16x16x32_bf16 v[208:211], a[96:99], a[32:35], v[224:227]
    ds_read_b128 a[252:255], v250 offset:11008
    v_cvt_pk_bf16_f32 v195, v198, v199
    v_mfma_f32_16x16x32_bf16 v[208:211], a[100:103], a[36:39], v[208:211]
    v_exp_f32 v200, v200
    v_mfma_f32_16x16x32_bf16 v[208:211], a[104:107], a[40:43], v[208:211]
    ds_read_b64_tr_b16 a[196:197], v243 offset:0
    v_mul_f32 v201, s44, v201
    v_mfma_f32_16x16x32_bf16 v[208:211], a[108:111], a[44:47], v[208:211]
    v_exp_f32 v201, v201
    v_mfma_f32_16x16x32_bf16 v[212:215], a[124:127], a[44:47], v[224:227]
    v_mul_f32 v202, s44, v202
    v_mul_f32 v203, s44, v203
    v_mfma_f32_16x16x32_bf16 v[212:215], a[120:123], a[40:43], v[212:215]
    v_exp_f32 v202, v202
    v_mfma_f32_16x16x32_bf16 v[212:215], a[116:119], a[36:39], v[212:215]
    v_cvt_pk_bf16_f32 v196, v200, v201
    v_mul_f32 v204, s44, v204
    v_mfma_f32_16x16x32_bf16 v[212:215], a[112:115], a[32:35], v[212:215]
    s_waitcnt lgkmcnt(1)
    buffer_store_dwordx4 a[252:255], v248, s[16:19], s31 offen offset:2176 sc1
    v_exp_f32 v203, v203
    v_mfma_f32_16x16x32_bf16 v[0:3], a[160:163], v[192:195], v[0:3]
    ds_read_b64_tr_b16 a[198:199], v243 offset:4096
    v_mul_f32 v205, s44, v205
    v_mfma_f32_16x16x32_bf16 v[4:7], a[164:167], v[192:195], v[4:7]
    v_exp_f32 v204, v204
    v_mfma_f32_16x16x32_bf16 v[8:11], a[168:171], v[192:195], v[8:11]
    v_cvt_pk_bf16_f32 v197, v202, v203
    v_mul_f32 v206, s44, v206
    v_mfma_f32_16x16x32_bf16 v[12:15], a[172:175], v[192:195], v[12:15]
    v_exp_f32 v205, v205
    v_mfma_f32_16x16x32_bf16 v[16:19], a[176:179], v[192:195], v[16:19]
    ds_read_b64_tr_b16 a[200:201], v244 offset:0
    v_mul_f32 v207, s44, v207
    v_mfma_f32_16x16x32_bf16 v[20:23], a[180:183], v[192:195], v[20:23]
    v_exp_f32 v206, v206
    v_mfma_f32_16x16x32_bf16 v[24:27], a[184:187], v[192:195], v[24:27]
    v_cvt_pk_bf16_f32 v198, v204, v205
    v_mul_f32 v208, s44, v208
    v_mfma_f32_16x16x32_bf16 v[28:31], a[188:191], v[192:195], v[28:31]
    v_exp_f32 v207, v207
    v_mfma_f32_16x16x32_bf16 v[200:203], a[96:99], a[48:51], v[228:231]
    ds_read_b64_tr_b16 a[202:203], v244 offset:4096
    v_cvt_pk_bf16_f32 v199, v206, v207
    v_mfma_f32_16x16x32_bf16 v[200:203], a[100:103], a[52:55], v[200:203]
    v_exp_f32 v208, v208
    v_mfma_f32_16x16x32_bf16 v[200:203], a[104:107], a[56:59], v[200:203]
    v_mul_f32 v209, s44, v209
    v_mul_f32 v210, s44, v210
    v_mfma_f32_16x16x32_bf16 v[200:203], a[108:111], a[60:63], v[200:203]
    buffer_load_dwordx4 v248, s[12:15], s30 offen sc1 nt lds
    v_mfma_f32_16x16x32_bf16 v[204:207], a[124:127], a[60:63], v[228:231]
    s_addk_i32 m0, 896
    v_exp_f32 v209, v209
    v_mfma_f32_16x16x32_bf16 v[204:207], a[120:123], a[56:59], v[204:207]
    ds_read_b64_tr_b16 a[204:205], v245 offset:0
    v_mul_f32 v211, s44, v211
    v_mfma_f32_16x16x32_bf16 v[204:207], a[116:119], a[52:55], v[204:207]
    v_exp_f32 v210, v210
    v_cvt_pk_bf16_f32 v208, v208, v209
    v_mfma_f32_16x16x32_bf16 v[204:207], a[112:115], a[48:51], v[204:207]
    v_exp_f32 v211, v211
    v_smfmac_f32_16x16x64_bf16 a[224:227], a[244:247], v[192:199], v253
    v_mul_f32 v212, s44, v212
    v_mfma_f32_16x16x32_bf16 v[32:35], a[160:163], v[196:199], v[32:35]
    ds_read_b64_tr_b16 a[206:207], v245 offset:4096
    v_mul_f32 v213, s44, v213
    v_mfma_f32_16x16x32_bf16 v[36:39], a[164:167], v[196:199], v[36:39]
    v_exp_f32 v212, v212
    v_cvt_pk_bf16_f32 v209, v210, v211
    v_mfma_f32_16x16x32_bf16 v[40:43], a[168:171], v[196:199], v[40:43]
    v_exp_f32 v213, v213
    v_mfma_f32_16x16x32_bf16 v[44:47], a[172:175], v[196:199], v[44:47]
    v_mul_f32 v214, s44, v214
    v_mul_f32 v215, s44, v215
    v_mfma_f32_16x16x32_bf16 v[48:51], a[176:179], v[196:199], v[48:51]
    v_exp_f32 v214, v214
    v_mfma_f32_16x16x32_bf16 v[52:55], a[180:183], v[196:199], v[52:55]
    ds_read_b64_tr_b16 a[208:209], v242 offset:1024
    v_cvt_pk_bf16_f32 v210, v212, v213
    v_mfma_f32_16x16x32_bf16 v[56:59], a[184:187], v[196:199], v[56:59]
    buffer_load_dwordx4 v248, s[12:15], s30 offen offset:128 sc1 nt lds
    v_mfma_f32_16x16x32_bf16 v[60:63], a[188:191], v[196:199], v[60:63]
    s_mov_b32 m0, s27
    v_exp_f32 v215, v215
    v_mfma_f32_16x16x32_bf16 v[192:195], a[96:99], a[64:67], v[232:235]
    s_addk_i32 s30, 8192
    v_mul_f32 v200, s44, v200
    v_cvt_pk_bf16_f32 v211, v214, v215
    v_mfma_f32_16x16x32_bf16 v[192:195], a[100:103], a[68:71], v[192:195]
    ds_read_b64_tr_b16 a[210:211], v242 offset:5120
    v_mul_f32 v201, s44, v201
    v_mfma_f32_16x16x32_bf16 v[192:195], a[104:107], a[72:75], v[192:195]
    v_exp_f32 v200, v200
    v_mfma_f32_16x16x32_bf16 v[192:195], a[108:111], a[76:79], v[192:195]
    v_exp_f32 v201, v201
    v_mfma_f32_16x16x32_bf16 v[196:199], a[124:127], a[76:79], v[232:235]
    ds_read_b64_tr_b16 a[212:213], v243 offset:1024
    v_mul_f32 v202, s44, v202
    v_mfma_f32_16x16x32_bf16 v[196:199], a[120:123], a[72:75], v[196:199]
    v_exp_f32 v202, v202
    v_mfma_f32_16x16x32_bf16 v[196:199], a[116:119], a[68:71], v[196:199]
    v_mul_f32 v203, s44, v203
    v_cvt_pk_bf16_f32 v212, v200, v201
    v_mfma_f32_16x16x32_bf16 v[196:199], a[112:115], a[64:67], v[196:199]
    v_exp_f32 v203, v203
    v_mfma_f32_16x16x32_bf16 v[64:67], a[160:163], v[208:211], v[64:67]
    v_mul_f32 v204, s44, v204
    v_mul_f32 v205, s44, v205
    v_mfma_f32_16x16x32_bf16 v[68:71], a[164:167], v[208:211], v[68:71]
    v_exp_f32 v204, v204
    v_mfma_f32_16x16x32_bf16 v[72:75], a[168:171], v[208:211], v[72:75]
    ds_read_b64_tr_b16 a[214:215], v243 offset:5120
    v_cvt_pk_bf16_f32 v213, v202, v203
    v_mfma_f32_16x16x32_bf16 v[76:79], a[172:175], v[208:211], v[76:79]
    v_exp_f32 v205, v205
    v_mfma_f32_16x16x32_bf16 v[80:83], a[176:179], v[208:211], v[80:83]
    v_mul_f32 v206, s44, v206
    v_mul_f32 v207, s44, v207
    v_mfma_f32_16x16x32_bf16 v[84:87], a[180:183], v[208:211], v[84:87]
    v_exp_f32 v206, v206
    v_mfma_f32_16x16x32_bf16 v[88:91], a[184:187], v[208:211], v[88:91]
    ds_read_b64_tr_b16 a[216:217], v244 offset:1024
    v_cvt_pk_bf16_f32 v214, v204, v205
    v_mfma_f32_16x16x32_bf16 v[92:95], a[188:191], v[208:211], v[92:95]
    v_exp_f32 v207, v207
    v_mfma_f32_16x16x32_bf16 v[200:203], a[96:99], a[80:83], v[236:239]
    v_mul_f32 v192, s44, v192
    v_cvt_pk_bf16_f32 v215, v206, v207
    v_mfma_f32_16x16x32_bf16 v[200:203], a[100:103], a[84:87], v[200:203]
    v_exp_f32 v192, v192
    v_mfma_f32_16x16x32_bf16 v[200:203], a[104:107], a[88:91], v[200:203]
    ds_read_b64_tr_b16 a[218:219], v244 offset:5120
    v_mul_f32 v193, s44, v193
    v_mfma_f32_16x16x32_bf16 v[200:203], a[108:111], a[92:95], v[200:203]
    v_exp_f32 v193, v193
    v_mfma_f32_16x16x32_bf16 v[204:207], a[124:127], a[92:95], v[236:239]
    v_mul_f32 v194, s44, v194
    v_mul_f32 v195, s44, v195
    v_mfma_f32_16x16x32_bf16 v[204:207], a[120:123], a[88:91], v[204:207]
    v_exp_f32 v194, v194
    v_mfma_f32_16x16x32_bf16 v[204:207], a[116:119], a[84:87], v[204:207]
    ds_read_b64_tr_b16 a[220:221], v245 offset:1024
    v_cvt_pk_bf16_f32 v192, v192, v193
    v_mfma_f32_16x16x32_bf16 v[204:207], a[112:115], a[80:83], v[204:207]
    v_exp_f32 v195, v195
    v_smfmac_f32_16x16x64_bf16 a[228:231], a[244:247], v[208:215], v253
    v_mul_f32 v196, s44, v196
    v_mfma_f32_16x16x32_bf16 v[96:99], a[160:163], v[212:215], v[96:99]
    v_exp_f32 v196, v196
    v_mfma_f32_16x16x32_bf16 v[100:103], a[164:167], v[212:215], v[100:103]
    v_mul_f32 v197, s44, v197
    v_cvt_pk_bf16_f32 v193, v194, v195
    v_mfma_f32_16x16x32_bf16 v[104:107], a[168:171], v[212:215], v[104:107]
    ds_read_b64_tr_b16 a[222:223], v245 offset:5120
    v_mul_f32 v198, s44, v198
    v_mfma_f32_16x16x32_bf16 v[108:111], a[172:175], v[212:215], v[108:111]
    v_exp_f32 v197, v197
    v_mfma_f32_16x16x32_bf16 v[112:115], a[176:179], v[212:215], v[112:115]
    v_exp_f32 v198, v198
    v_mfma_f32_16x16x32_bf16 v[116:119], a[180:183], v[212:215], v[116:119]
    v_mul_f32 v199, s44, v199
    v_cvt_pk_bf16_f32 v194, v196, v197
    v_mfma_f32_16x16x32_bf16 v[120:123], a[184:187], v[212:215], v[120:123]
    v_exp_f32 v199, v199
    v_mfma_f32_16x16x32_bf16 v[124:127], a[188:191], v[212:215], v[124:127]
    v_mul_f32 v200, s44, v200
    v_cvt_pk_bf16_f32 v195, v198, v199
    v_mfma_f32_16x16x32_bf16 v[208:211], a[128:131], a[0:3], v[216:219]
    s_waitcnt vmcnt(12) lgkmcnt(0)
    v_exp_f32 v200, v200
    v_mfma_f32_16x16x32_bf16 v[208:211], a[132:135], a[4:7], v[208:211]
    s_barrier
    v_mul_f32 v201, s44, v201
    v_mfma_f32_16x16x32_bf16 v[208:211], a[136:139], a[8:11], v[208:211]
    v_exp_f32 v201, v201
    v_mfma_f32_16x16x32_bf16 v[208:211], a[140:143], a[12:15], v[208:211]
    ds_read_b128 a[96:99], v240 offset:8192
    v_mul_f32 v202, s44, v202
    v_mfma_f32_16x16x32_bf16 v[212:215], a[156:159], a[12:15], v[216:219]
    buffer_load_dwordx4 v248, s[8:11], s30 offen sc1 nt lds
    v_mfma_f32_16x16x32_bf16 v[212:215], a[152:155], a[8:11], v[212:215]
    s_addk_i32 m0, 896
    v_exp_f32 v202, v202
    v_mfma_f32_16x16x32_bf16 v[212:215], a[148:151], a[4:7], v[212:215]
    v_mul_f32 v203, s44, v203
    v_cvt_pk_bf16_f32 v196, v200, v201
    v_mfma_f32_16x16x32_bf16 v[212:215], a[144:147], a[0:3], v[212:215]
    ds_read_b128 a[100:103], v241 offset:8192
    v_mul_f32 v204, s44, v204
    v_mfma_f32_16x16x32_bf16 v[128:131], a[160:163], v[192:195], v[128:131]
    v_exp_f32 v203, v203
    v_mfma_f32_16x16x32_bf16 v[132:135], a[164:167], v[192:195], v[132:135]
    v_exp_f32 v204, v204
    v_mfma_f32_16x16x32_bf16 v[136:139], a[168:171], v[192:195], v[136:139]
    v_mul_f32 v205, s44, v205
    v_cvt_pk_bf16_f32 v197, v202, v203
    v_mfma_f32_16x16x32_bf16 v[140:143], a[172:175], v[192:195], v[140:143]
    ds_read_b128 a[104:107], v240 offset:9216
    v_mul_f32 v206, s44, v206
    v_mfma_f32_16x16x32_bf16 v[144:147], a[176:179], v[192:195], v[144:147]
    v_exp_f32 v205, v205
    v_mfma_f32_16x16x32_bf16 v[148:151], a[180:183], v[192:195], v[148:151]
    ds_read_b128 a[108:111], v241 offset:9216
    v_mul_f32 v207, s44, v207
    v_mfma_f32_16x16x32_bf16 v[152:155], a[184:187], v[192:195], v[152:155]
    v_exp_f32 v206, v206
    v_cvt_pk_bf16_f32 v198, v204, v205
    v_mfma_f32_16x16x32_bf16 v[156:159], a[188:191], v[192:195], v[156:159]
    v_exp_f32 v207, v207
    v_mfma_f32_16x16x32_bf16 v[200:203], a[128:131], a[16:19], v[220:223]
    ds_read_b128 a[112:115], v240 offset:12288
    v_mul_f32 v208, s44, v208
    v_mfma_f32_16x16x32_bf16 v[200:203], a[132:135], a[20:23], v[200:203]
    buffer_load_dwordx4 v248, s[8:11], s30 offen offset:128 sc1 nt lds
    v_mfma_f32_16x16x32_bf16 v[200:203], a[136:139], a[24:27], v[200:203]
    s_addk_i32 m0, 31872
    v_cvt_pk_bf16_f32 v199, v206, v207
    v_mul_f32 v209, s44, v209
    v_exp_f32 v208, v208
    v_mfma_f32_16x16x32_bf16 v[200:203], a[140:143], a[28:31], v[200:203]
    ds_read_b128 a[116:119], v241 offset:12288
    v_mul_f32 v210, s44, v210
    v_mfma_f32_16x16x32_bf16 v[204:207], a[156:159], a[28:31], v[220:223]
    v_exp_f32 v209, v209
    v_mfma_f32_16x16x32_bf16 v[204:207], a[152:155], a[24:27], v[204:207]
    v_exp_f32 v210, v210
    v_mfma_f32_16x16x32_bf16 v[204:207], a[148:151], a[20:23], v[204:207]
    v_mul_f32 v211, s44, v211
    v_cvt_pk_bf16_f32 v208, v208, v209
    v_mfma_f32_16x16x32_bf16 v[204:207], a[144:147], a[16:19], v[204:207]
    ds_read_b128 a[120:123], v240 offset:13312
    v_mul_f32 v212, s44, v212
    v_smfmac_f32_16x16x64_bf16 a[232:235], a[244:247], v[192:199], v253
    ds_read_b128 a[124:127], v241 offset:13312
    v_exp_f32 v211, v211
    v_mfma_f32_16x16x32_bf16 v[160:163], a[160:163], v[196:199], v[160:163]
    v_exp_f32 v212, v212
    v_mfma_f32_16x16x32_bf16 v[164:167], a[164:167], v[196:199], v[164:167]
    v_mul_f32 v213, s44, v213
    v_cvt_pk_bf16_f32 v209, v210, v211
    v_mfma_f32_16x16x32_bf16 v[168:171], a[168:171], v[196:199], v[168:171]
    v_exp_f32 v213, v213
    v_mfma_f32_16x16x32_bf16 v[172:175], a[172:175], v[196:199], v[172:175]
    ds_read_b64_tr_b16 a[160:161], v242 offset:8192
    v_mul_f32 v214, s44, v214
    v_mfma_f32_16x16x32_bf16 v[176:179], a[176:179], v[196:199], v[176:179]
    v_exp_f32 v214, v214
    v_mfma_f32_16x16x32_bf16 v[180:183], a[180:183], v[196:199], v[180:183]
    v_mul_f32 v215, s44, v215
    v_cvt_pk_bf16_f32 v210, v212, v213
    v_mfma_f32_16x16x32_bf16 v[184:187], a[184:187], v[196:199], v[184:187]
    v_exp_f32 v215, v215
    v_mfma_f32_16x16x32_bf16 v[188:191], a[188:191], v[196:199], v[188:191]
    ds_read_b64_tr_b16 a[162:163], v242 offset:12288
    v_mul_f32 v200, s44, v200
    v_mfma_f32_16x16x32_bf16 v[192:195], a[128:131], a[32:35], v[224:227]
    v_cvt_pk_bf16_f32 v211, v214, v215
    v_mul_f32 v201, s44, v201
    v_mfma_f32_16x16x32_bf16 v[192:195], a[132:135], a[36:39], v[192:195]
    v_exp_f32 v200, v200
    v_mfma_f32_16x16x32_bf16 v[192:195], a[136:139], a[40:43], v[192:195]
    ds_read_b64_tr_b16 a[164:165], v243 offset:8192
    v_mul_f32 v202, s44, v202
    v_mfma_f32_16x16x32_bf16 v[192:195], a[140:143], a[44:47], v[192:195]
    v_exp_f32 v201, v201
    v_mfma_f32_16x16x32_bf16 v[196:199], a[156:159], a[44:47], v[224:227]
    v_exp_f32 v202, v202
    v_mfma_f32_16x16x32_bf16 v[196:199], a[152:155], a[40:43], v[196:199]
    v_mul_f32 v203, s44, v203
    v_cvt_pk_bf16_f32 v212, v200, v201
    v_mfma_f32_16x16x32_bf16 v[196:199], a[148:151], a[36:39], v[196:199]
    v_exp_f32 v203, v203
    v_mfma_f32_16x16x32_bf16 v[196:199], a[144:147], a[32:35], v[196:199]
    ds_read_b64_tr_b16 a[166:167], v243 offset:12288
    v_mul_f32 v204, s44, v204
    v_mfma_f32_16x16x32_bf16 v[0:3], a[192:195], v[208:211], v[0:3]
    v_exp_f32 v204, v204
    v_mfma_f32_16x16x32_bf16 v[4:7], a[196:199], v[208:211], v[4:7]
    v_mul_f32 v205, s44, v205
    v_cvt_pk_bf16_f32 v213, v202, v203
    v_mfma_f32_16x16x32_bf16 v[8:11], a[200:203], v[208:211], v[8:11]
    v_exp_f32 v205, v205
    v_mfma_f32_16x16x32_bf16 v[12:15], a[204:207], v[208:211], v[12:15]
    ds_read_b64_tr_b16 a[168:169], v244 offset:8192
    v_mul_f32 v206, s44, v206
    v_mfma_f32_16x16x32_bf16 v[16:19], a[208:211], v[208:211], v[16:19]
    s_add_u32 s31, s21, 12288
    v_exp_f32 v206, v206
    v_mfma_f32_16x16x32_bf16 v[20:23], a[212:215], v[208:211], v[20:23]
    v_mul_f32 v207, s44, v207
    v_cvt_pk_bf16_f32 v214, v204, v205
    v_mfma_f32_16x16x32_bf16 v[24:27], a[216:219], v[208:211], v[24:27]
    v_exp_f32 v207, v207
    v_mfma_f32_16x16x32_bf16 v[28:31], a[220:223], v[208:211], v[28:31]
    ds_read_b64_tr_b16 a[170:171], v244 offset:12288
    v_mul_f32 v192, s44, v192
    v_mfma_f32_16x16x32_bf16 v[200:203], a[128:131], a[48:51], v[228:231]
    v_cvt_pk_bf16_f32 v215, v206, v207
    v_mul_f32 v193, s44, v193
    v_mfma_f32_16x16x32_bf16 v[200:203], a[132:135], a[52:55], v[200:203]
    v_exp_f32 v192, v192
    v_mfma_f32_16x16x32_bf16 v[200:203], a[136:139], a[56:59], v[200:203]
    buffer_load_dwordx4 v248, s[12:15], s30 offen sc1 nt lds
    v_mfma_f32_16x16x32_bf16 v[200:203], a[140:143], a[60:63], v[200:203]
    s_addk_i32 m0, 896
    v_exp_f32 v193, v193
    v_mfma_f32_16x16x32_bf16 v[204:207], a[156:159], a[60:63], v[228:231]
    ds_read_b64_tr_b16 a[172:173], v245 offset:8192
    v_mul_f32 v194, s44, v194
    v_mfma_f32_16x16x32_bf16 v[204:207], a[152:155], a[56:59], v[204:207]
    v_exp_f32 v194, v194
    v_mfma_f32_16x16x32_bf16 v[204:207], a[148:151], a[52:55], v[204:207]
    v_mul_f32 v195, s44, v195
    v_cvt_pk_bf16_f32 v192, v192, v193
    v_mfma_f32_16x16x32_bf16 v[204:207], a[144:147], a[48:51], v[204:207]
    v_exp_f32 v195, v195
    v_smfmac_f32_16x16x64_bf16 a[224:227], a[244:247], v[208:215], v253
    v_mul_f32 v196, s44, v196
    v_mfma_f32_16x16x32_bf16 v[32:35], a[192:195], v[212:215], v[32:35]
    ds_read_b64_tr_b16 a[174:175], v245 offset:12288
    v_mul_f32 v197, s44, v197
    v_mfma_f32_16x16x32_bf16 v[36:39], a[196:199], v[212:215], v[36:39]
    v_exp_f32 v196, v196
    v_cvt_pk_bf16_f32 v193, v194, v195
    v_mfma_f32_16x16x32_bf16 v[40:43], a[200:203], v[212:215], v[40:43]
    v_exp_f32 v197, v197
    v_mfma_f32_16x16x32_bf16 v[44:47], a[204:207], v[212:215], v[44:47]
    v_mul_f32 v198, s44, v198
    v_mul_f32 v199, s44, v199
    v_mfma_f32_16x16x32_bf16 v[48:51], a[208:211], v[212:215], v[48:51]
    v_exp_f32 v198, v198
    v_mfma_f32_16x16x32_bf16 v[52:55], a[212:215], v[212:215], v[52:55]
    ds_read_b64_tr_b16 a[176:177], v242 offset:9216
    v_cvt_pk_bf16_f32 v194, v196, v197
    v_mfma_f32_16x16x32_bf16 v[56:59], a[216:219], v[212:215], v[56:59]
    buffer_load_dwordx4 v248, s[12:15], s30 offen offset:128 sc1 nt lds
    v_mfma_f32_16x16x32_bf16 v[60:63], a[220:223], v[212:215], v[60:63]
    s_addk_i32 m0, -25472
    v_exp_f32 v199, v199
    v_mfma_f32_16x16x32_bf16 v[208:211], a[128:131], a[64:67], v[232:235]
    s_addk_i32 s30, 8192
    v_mul_f32 v200, s44, v200
    v_cvt_pk_bf16_f32 v195, v198, v199
    v_mfma_f32_16x16x32_bf16 v[208:211], a[132:135], a[68:71], v[208:211]
    ds_read_b64_tr_b16 a[178:179], v242 offset:13312
    v_mul_f32 v201, s44, v201
    v_mfma_f32_16x16x32_bf16 v[208:211], a[136:139], a[72:75], v[208:211]
    v_exp_f32 v200, v200
    v_mfma_f32_16x16x32_bf16 v[208:211], a[140:143], a[76:79], v[208:211]
    v_exp_f32 v201, v201
    v_mfma_f32_16x16x32_bf16 v[212:215], a[156:159], a[76:79], v[232:235]
    ds_read_b64_tr_b16 a[180:181], v243 offset:9216
    v_mul_f32 v202, s44, v202
    v_mfma_f32_16x16x32_bf16 v[212:215], a[152:155], a[72:75], v[212:215]
    v_exp_f32 v202, v202
    v_mfma_f32_16x16x32_bf16 v[212:215], a[148:151], a[68:71], v[212:215]
    v_mul_f32 v203, s44, v203
    v_cvt_pk_bf16_f32 v196, v200, v201
    v_mfma_f32_16x16x32_bf16 v[212:215], a[144:147], a[64:67], v[212:215]
    v_exp_f32 v203, v203
    v_mfma_f32_16x16x32_bf16 v[64:67], a[192:195], v[192:195], v[64:67]
    v_mul_f32 v204, s44, v204
    v_mul_f32 v205, s44, v205
    v_mfma_f32_16x16x32_bf16 v[68:71], a[196:199], v[192:195], v[68:71]
    v_exp_f32 v204, v204
    v_mfma_f32_16x16x32_bf16 v[72:75], a[200:203], v[192:195], v[72:75]
    ds_read_b64_tr_b16 a[182:183], v243 offset:13312
    v_cvt_pk_bf16_f32 v197, v202, v203
    v_mfma_f32_16x16x32_bf16 v[76:79], a[204:207], v[192:195], v[76:79]
    v_exp_f32 v205, v205
    v_mfma_f32_16x16x32_bf16 v[80:83], a[208:211], v[192:195], v[80:83]
    v_mul_f32 v206, s44, v206
    v_mul_f32 v207, s44, v207
    v_mfma_f32_16x16x32_bf16 v[84:87], a[212:215], v[192:195], v[84:87]
    v_exp_f32 v206, v206
    v_mfma_f32_16x16x32_bf16 v[88:91], a[216:219], v[192:195], v[88:91]
    ds_read_b64_tr_b16 a[184:185], v244 offset:9216
    v_cvt_pk_bf16_f32 v198, v204, v205
    v_mfma_f32_16x16x32_bf16 v[92:95], a[220:223], v[192:195], v[92:95]
    v_exp_f32 v207, v207
    v_mfma_f32_16x16x32_bf16 v[200:203], a[128:131], a[80:83], v[236:239]
    v_mul_f32 v208, s44, v208
    v_cvt_pk_bf16_f32 v199, v206, v207
    v_mfma_f32_16x16x32_bf16 v[200:203], a[132:135], a[84:87], v[200:203]
    v_exp_f32 v208, v208
    v_mfma_f32_16x16x32_bf16 v[200:203], a[136:139], a[88:91], v[200:203]
    ds_read_b64_tr_b16 a[186:187], v244 offset:13312
    v_mul_f32 v209, s44, v209
    v_mfma_f32_16x16x32_bf16 v[200:203], a[140:143], a[92:95], v[200:203]
    v_exp_f32 v209, v209
    v_mfma_f32_16x16x32_bf16 v[204:207], a[156:159], a[92:95], v[236:239]
    v_mul_f32 v210, s44, v210
    v_mul_f32 v211, s44, v211
    v_mfma_f32_16x16x32_bf16 v[204:207], a[152:155], a[88:91], v[204:207]
    v_exp_f32 v210, v210
    v_mfma_f32_16x16x32_bf16 v[204:207], a[148:151], a[84:87], v[204:207]
    ds_read_b64_tr_b16 a[188:189], v245 offset:9216
    v_cvt_pk_bf16_f32 v208, v208, v209
    v_mfma_f32_16x16x32_bf16 v[204:207], a[144:147], a[80:83], v[204:207]
    v_exp_f32 v211, v211
    v_smfmac_f32_16x16x64_bf16 a[228:231], a[244:247], v[192:199], v253
    v_mul_f32 v212, s44, v212
    v_mfma_f32_16x16x32_bf16 v[96:99], a[192:195], v[196:199], v[96:99]
    v_exp_f32 v212, v212
    v_mfma_f32_16x16x32_bf16 v[100:103], a[196:199], v[196:199], v[100:103]
    v_mul_f32 v213, s44, v213
    v_cvt_pk_bf16_f32 v209, v210, v211
    v_mfma_f32_16x16x32_bf16 v[104:107], a[200:203], v[196:199], v[104:107]
    ds_read_b64_tr_b16 a[190:191], v245 offset:13312
    v_mul_f32 v214, s44, v214
    v_mfma_f32_16x16x32_bf16 v[108:111], a[204:207], v[196:199], v[108:111]
    v_exp_f32 v213, v213
    v_mfma_f32_16x16x32_bf16 v[112:115], a[208:211], v[196:199], v[112:115]
    v_exp_f32 v214, v214
    v_mfma_f32_16x16x32_bf16 v[116:119], a[212:215], v[196:199], v[116:119]
    v_mul_f32 v215, s44, v215
    v_cvt_pk_bf16_f32 v210, v212, v213
    v_mfma_f32_16x16x32_bf16 v[120:123], a[216:219], v[196:199], v[120:123]
    v_exp_f32 v215, v215
    v_mfma_f32_16x16x32_bf16 v[124:127], a[220:223], v[196:199], v[124:127]
    s_waitcnt lgkmcnt(1)
    v_mul_f32 v200, s44, v200
    v_cvt_pk_bf16_f32 v211, v214, v215
    v_mfma_f32_16x16x32_bf16 v[192:195], a[96:99], a[0:3], v[216:219]
    s_waitcnt vmcnt(12) lgkmcnt(0)
    v_exp_f32 v200, v200
    v_mfma_f32_16x16x32_bf16 v[192:195], a[100:103], a[4:7], v[192:195]
    s_barrier
    v_mul_f32 v201, s44, v201
    v_mfma_f32_16x16x32_bf16 v[192:195], a[104:107], a[8:11], v[192:195]
    v_exp_f32 v201, v201
    v_mfma_f32_16x16x32_bf16 v[192:195], a[108:111], a[12:15], v[192:195]
    ds_read_b128 a[128:131], v240 offset:16384
    v_mul_f32 v202, s44, v202
    v_mfma_f32_16x16x32_bf16 v[196:199], a[124:127], a[12:15], v[216:219]
    buffer_load_dwordx4 v248, s[8:11], s30 offen sc1 nt lds
    v_mfma_f32_16x16x32_bf16 v[196:199], a[120:123], a[8:11], v[196:199]
    s_addk_i32 m0, 896
    v_exp_f32 v202, v202
    v_mfma_f32_16x16x32_bf16 v[196:199], a[116:119], a[4:7], v[196:199]
    ds_read_b128 a[248:251], v250 offset:13056
    v_mul_f32 v203, s44, v203
    v_cvt_pk_bf16_f32 v212, v200, v201
    v_mfma_f32_16x16x32_bf16 v[196:199], a[112:115], a[0:3], v[196:199]
    ds_read_b128 a[132:135], v241 offset:16384
    v_mul_f32 v204, s44, v204
    v_mfma_f32_16x16x32_bf16 v[128:131], a[192:195], v[208:211], v[128:131]
    v_exp_f32 v203, v203
    v_mfma_f32_16x16x32_bf16 v[132:135], a[196:199], v[208:211], v[132:135]
    v_exp_f32 v204, v204
    v_mfma_f32_16x16x32_bf16 v[136:139], a[200:203], v[208:211], v[136:139]
    v_mul_f32 v205, s44, v205
    v_cvt_pk_bf16_f32 v213, v202, v203
    v_mfma_f32_16x16x32_bf16 v[140:143], a[204:207], v[208:211], v[140:143]
    ds_read_b128 a[136:139], v240 offset:17408
    v_mul_f32 v206, s44, v206
    v_mfma_f32_16x16x32_bf16 v[144:147], a[208:211], v[208:211], v[144:147]
    v_exp_f32 v205, v205
    v_mfma_f32_16x16x32_bf16 v[148:151], a[212:215], v[208:211], v[148:151]
    s_waitcnt lgkmcnt(2)
    ds_read_b128 a[140:143], v241 offset:17408
    buffer_store_dwordx4 a[248:251], v248, s[16:19], s31 offen offset:0 sc1
    v_mul_f32 v207, s44, v207
    v_mfma_f32_16x16x32_bf16 v[152:155], a[216:219], v[208:211], v[152:155]
    v_exp_f32 v206, v206
    v_cvt_pk_bf16_f32 v214, v204, v205
    v_mfma_f32_16x16x32_bf16 v[156:159], a[220:223], v[208:211], v[156:159]
    ds_read_b128 a[252:255], v250 offset:15232
    v_mul_f32 v192, s44, v192
    v_mfma_f32_16x16x32_bf16 v[200:203], a[96:99], a[16:19], v[220:223]
    v_exp_f32 v207, v207
    v_mfma_f32_16x16x32_bf16 v[200:203], a[100:103], a[20:23], v[200:203]
    ds_read_b128 a[144:147], v240 offset:20480
    v_cvt_pk_bf16_f32 v215, v206, v207
    v_mfma_f32_16x16x32_bf16 v[200:203], a[104:107], a[24:27], v[200:203]
    buffer_load_dwordx4 v248, s[8:11], s30 offen offset:128 sc1 nt lds
    v_exp_f32 v192, v192
    v_mul_f32 v193, s44, v193
    v_mfma_f32_16x16x32_bf16 v[200:203], a[108:111], a[28:31], v[200:203]
    s_addk_i32 m0, 31872
    ds_read_b128 a[148:151], v241 offset:20480
    v_mul_f32 v194, s44, v194
    v_mfma_f32_16x16x32_bf16 v[204:207], a[124:127], a[28:31], v[220:223]
    v_exp_f32 v193, v193
    v_mfma_f32_16x16x32_bf16 v[204:207], a[120:123], a[24:27], v[204:207]
    v_exp_f32 v194, v194
    v_mfma_f32_16x16x32_bf16 v[204:207], a[116:119], a[20:23], v[204:207]
    s_waitcnt lgkmcnt(2)
    buffer_store_dwordx4 a[252:255], v248, s[16:19], s31 offen offset:2048 sc1
    v_mul_f32 v195, s44, v195
    v_cvt_pk_bf16_f32 v192, v192, v193
    v_mfma_f32_16x16x32_bf16 v[204:207], a[112:115], a[16:19], v[204:207]
    ds_read_b128 a[152:155], v240 offset:21504
    v_mul_f32 v196, s44, v196
    v_smfmac_f32_16x16x64_bf16 a[232:235], a[244:247], v[208:215], v253
    ds_read_b128 a[248:251], v250 offset:13184
    v_exp_f32 v195, v195
    v_mfma_f32_16x16x32_bf16 v[160:163], a[192:195], v[212:215], v[160:163]
    ds_read_b128 a[156:159], v241 offset:21504
    v_mul_f32 v197, s44, v197
    v_mfma_f32_16x16x32_bf16 v[164:167], a[196:199], v[212:215], v[164:167]
    v_exp_f32 v196, v196
    v_cvt_pk_bf16_f32 v193, v194, v195
    v_mfma_f32_16x16x32_bf16 v[168:171], a[200:203], v[212:215], v[168:171]
    v_exp_f32 v197, v197
    v_mfma_f32_16x16x32_bf16 v[172:175], a[204:207], v[212:215], v[172:175]
    ds_read_b64_tr_b16 a[192:193], v242 offset:16384
    v_mul_f32 v198, s44, v198
    v_mfma_f32_16x16x32_bf16 v[176:179], a[208:211], v[212:215], v[176:179]
    v_exp_f32 v198, v198
    v_mfma_f32_16x16x32_bf16 v[180:183], a[212:215], v[212:215], v[180:183]
    v_mul_f32 v199, s44, v199
    v_cvt_pk_bf16_f32 v194, v196, v197
    v_mfma_f32_16x16x32_bf16 v[184:187], a[216:219], v[212:215], v[184:187]
    s_waitcnt lgkmcnt(2)
    buffer_store_dwordx4 a[248:251], v248, s[16:19], s31 offen offset:128 sc1
    v_exp_f32 v199, v199
    v_mfma_f32_16x16x32_bf16 v[188:191], a[220:223], v[212:215], v[188:191]
    ds_read_b64_tr_b16 a[194:195], v242 offset:20480
    v_mul_f32 v200, s44, v200
    v_mfma_f32_16x16x32_bf16 v[208:211], a[96:99], a[32:35], v[224:227]
    ds_read_b128 a[252:255], v250 offset:15360
    v_cvt_pk_bf16_f32 v195, v198, v199
    v_mfma_f32_16x16x32_bf16 v[208:211], a[100:103], a[36:39], v[208:211]
    v_exp_f32 v200, v200
    v_mfma_f32_16x16x32_bf16 v[208:211], a[104:107], a[40:43], v[208:211]
    ds_read_b64_tr_b16 a[196:197], v243 offset:16384
    v_mul_f32 v201, s44, v201
    v_mfma_f32_16x16x32_bf16 v[208:211], a[108:111], a[44:47], v[208:211]
    v_exp_f32 v201, v201
    v_mfma_f32_16x16x32_bf16 v[212:215], a[124:127], a[44:47], v[224:227]
    v_mul_f32 v202, s44, v202
    v_mul_f32 v203, s44, v203
    v_mfma_f32_16x16x32_bf16 v[212:215], a[120:123], a[40:43], v[212:215]
    v_exp_f32 v202, v202
    v_mfma_f32_16x16x32_bf16 v[212:215], a[116:119], a[36:39], v[212:215]
    v_cvt_pk_bf16_f32 v196, v200, v201
    v_mul_f32 v204, s44, v204
    v_mfma_f32_16x16x32_bf16 v[212:215], a[112:115], a[32:35], v[212:215]
    s_waitcnt lgkmcnt(1)
    buffer_store_dwordx4 a[252:255], v248, s[16:19], s31 offen offset:2176 sc1
    v_exp_f32 v203, v203
    v_mfma_f32_16x16x32_bf16 v[0:3], a[160:163], v[192:195], v[0:3]
    ds_read_b64_tr_b16 a[198:199], v243 offset:20480
    v_mul_f32 v205, s44, v205
    v_mfma_f32_16x16x32_bf16 v[4:7], a[164:167], v[192:195], v[4:7]
    v_exp_f32 v204, v204
    v_mfma_f32_16x16x32_bf16 v[8:11], a[168:171], v[192:195], v[8:11]
    v_cvt_pk_bf16_f32 v197, v202, v203
    v_mul_f32 v206, s44, v206
    v_mfma_f32_16x16x32_bf16 v[12:15], a[172:175], v[192:195], v[12:15]
    v_exp_f32 v205, v205
    v_mfma_f32_16x16x32_bf16 v[16:19], a[176:179], v[192:195], v[16:19]
    ds_read_b64_tr_b16 a[200:201], v244 offset:16384
    v_mul_f32 v207, s44, v207
    v_mfma_f32_16x16x32_bf16 v[20:23], a[180:183], v[192:195], v[20:23]
L_pad9:
    s_cbranch_execz L_pad13
    v_exp_f32 v206, v206
    v_mfma_f32_16x16x32_bf16 v[24:27], a[184:187], v[192:195], v[24:27]
    v_cvt_pk_bf16_f32 v198, v204, v205
    v_mul_f32 v208, s44, v208
    v_mfma_f32_16x16x32_bf16 v[28:31], a[188:191], v[192:195], v[28:31]
    v_exp_f32 v207, v207
    v_mfma_f32_16x16x32_bf16 v[200:203], a[96:99], a[48:51], v[228:231]
    ds_read_b64_tr_b16 a[202:203], v244 offset:20480
    v_cvt_pk_bf16_f32 v199, v206, v207
    v_mfma_f32_16x16x32_bf16 v[200:203], a[100:103], a[52:55], v[200:203]
    v_exp_f32 v208, v208
    v_mfma_f32_16x16x32_bf16 v[200:203], a[104:107], a[56:59], v[200:203]
    v_mul_f32 v209, s44, v209
    v_mul_f32 v210, s44, v210
    v_mfma_f32_16x16x32_bf16 v[200:203], a[108:111], a[60:63], v[200:203]
    buffer_load_dwordx4 v248, s[12:15], s30 offen sc1 nt lds
    v_mfma_f32_16x16x32_bf16 v[204:207], a[124:127], a[60:63], v[228:231]
    s_addk_i32 m0, 896
    v_exp_f32 v209, v209
    v_mfma_f32_16x16x32_bf16 v[204:207], a[120:123], a[56:59], v[204:207]
    ds_read_b64_tr_b16 a[204:205], v245 offset:16384
    v_mul_f32 v211, s44, v211
    v_mfma_f32_16x16x32_bf16 v[204:207], a[116:119], a[52:55], v[204:207]
    v_exp_f32 v210, v210
    v_cvt_pk_bf16_f32 v208, v208, v209
    v_mfma_f32_16x16x32_bf16 v[204:207], a[112:115], a[48:51], v[204:207]
    v_exp_f32 v211, v211
    v_smfmac_f32_16x16x64_bf16 a[224:227], a[244:247], v[192:199], v253
    v_mul_f32 v212, s44, v212
    v_mfma_f32_16x16x32_bf16 v[32:35], a[160:163], v[196:199], v[32:35]
    ds_read_b64_tr_b16 a[206:207], v245 offset:20480
    v_mul_f32 v213, s44, v213
    v_mfma_f32_16x16x32_bf16 v[36:39], a[164:167], v[196:199], v[36:39]
    v_exp_f32 v212, v212
    v_cvt_pk_bf16_f32 v209, v210, v211
    v_mfma_f32_16x16x32_bf16 v[40:43], a[168:171], v[196:199], v[40:43]
    v_exp_f32 v213, v213
    v_mfma_f32_16x16x32_bf16 v[44:47], a[172:175], v[196:199], v[44:47]
    v_mul_f32 v214, s44, v214
    v_mul_f32 v215, s44, v215
    v_mfma_f32_16x16x32_bf16 v[48:51], a[176:179], v[196:199], v[48:51]
    v_exp_f32 v214, v214
    v_mfma_f32_16x16x32_bf16 v[52:55], a[180:183], v[196:199], v[52:55]
    ds_read_b64_tr_b16 a[208:209], v242 offset:17408
    v_cvt_pk_bf16_f32 v210, v212, v213
    v_mfma_f32_16x16x32_bf16 v[56:59], a[184:187], v[196:199], v[56:59]
    buffer_load_dwordx4 v248, s[12:15], s30 offen offset:128 sc1 nt lds
    v_mfma_f32_16x16x32_bf16 v[60:63], a[188:191], v[196:199], v[60:63]
    s_addk_i32 m0, -25472
    v_exp_f32 v215, v215
    v_mfma_f32_16x16x32_bf16 v[192:195], a[96:99], a[64:67], v[232:235]
    s_addk_i32 s30, 8192
    v_mul_f32 v200, s44, v200
    v_cvt_pk_bf16_f32 v211, v214, v215
    v_mfma_f32_16x16x32_bf16 v[192:195], a[100:103], a[68:71], v[192:195]
    ds_read_b64_tr_b16 a[210:211], v242 offset:21504
    v_mul_f32 v201, s44, v201
    v_mfma_f32_16x16x32_bf16 v[192:195], a[104:107], a[72:75], v[192:195]
    v_exp_f32 v200, v200
    v_mfma_f32_16x16x32_bf16 v[192:195], a[108:111], a[76:79], v[192:195]
    v_exp_f32 v201, v201
    v_mfma_f32_16x16x32_bf16 v[196:199], a[124:127], a[76:79], v[232:235]
    ds_read_b64_tr_b16 a[212:213], v243 offset:17408
    v_mul_f32 v202, s44, v202
    v_mfma_f32_16x16x32_bf16 v[196:199], a[120:123], a[72:75], v[196:199]
    v_exp_f32 v202, v202
    v_mfma_f32_16x16x32_bf16 v[196:199], a[116:119], a[68:71], v[196:199]
    v_mul_f32 v203, s44, v203
    v_cvt_pk_bf16_f32 v212, v200, v201
    v_mfma_f32_16x16x32_bf16 v[196:199], a[112:115], a[64:67], v[196:199]
    v_exp_f32 v203, v203
    v_mfma_f32_16x16x32_bf16 v[64:67], a[160:163], v[208:211], v[64:67]
    v_mul_f32 v204, s44, v204
    v_mul_f32 v205, s44, v205
    v_mfma_f32_16x16x32_bf16 v[68:71], a[164:167], v[208:211], v[68:71]
    v_exp_f32 v204, v204
    v_mfma_f32_16x16x32_bf16 v[72:75], a[168:171], v[208:211], v[72:75]
    ds_read_b64_tr_b16 a[214:215], v243 offset:21504
    v_cvt_pk_bf16_f32 v213, v202, v203
    v_mfma_f32_16x16x32_bf16 v[76:79], a[172:175], v[208:211], v[76:79]
    v_exp_f32 v205, v205
    v_mfma_f32_16x16x32_bf16 v[80:83], a[176:179], v[208:211], v[80:83]
    v_mul_f32 v206, s44, v206
    v_mul_f32 v207, s44, v207
    v_mfma_f32_16x16x32_bf16 v[84:87], a[180:183], v[208:211], v[84:87]
    v_exp_f32 v206, v206
    v_mfma_f32_16x16x32_bf16 v[88:91], a[184:187], v[208:211], v[88:91]
    ds_read_b64_tr_b16 a[216:217], v244 offset:17408
    v_cvt_pk_bf16_f32 v214, v204, v205
    v_mfma_f32_16x16x32_bf16 v[92:95], a[188:191], v[208:211], v[92:95]
    v_exp_f32 v207, v207
    v_mfma_f32_16x16x32_bf16 v[200:203], a[96:99], a[80:83], v[236:239]
    v_mul_f32 v192, s44, v192
    v_cvt_pk_bf16_f32 v215, v206, v207
    v_mfma_f32_16x16x32_bf16 v[200:203], a[100:103], a[84:87], v[200:203]
    v_exp_f32 v192, v192
    v_mfma_f32_16x16x32_bf16 v[200:203], a[104:107], a[88:91], v[200:203]
    ds_read_b64_tr_b16 a[218:219], v244 offset:21504
    v_mul_f32 v193, s44, v193
    v_mfma_f32_16x16x32_bf16 v[200:203], a[108:111], a[92:95], v[200:203]
    v_exp_f32 v193, v193
    v_mfma_f32_16x16x32_bf16 v[204:207], a[124:127], a[92:95], v[236:239]
    v_mul_f32 v194, s44, v194
    v_mul_f32 v195, s44, v195
    v_mfma_f32_16x16x32_bf16 v[204:207], a[120:123], a[88:91], v[204:207]
    v_exp_f32 v194, v194
    v_mfma_f32_16x16x32_bf16 v[204:207], a[116:119], a[84:87], v[204:207]
    ds_read_b64_tr_b16 a[220:221], v245 offset:17408
    v_cvt_pk_bf16_f32 v192, v192, v193
    v_mfma_f32_16x16x32_bf16 v[204:207], a[112:115], a[80:83], v[204:207]
    v_exp_f32 v195, v195
    v_smfmac_f32_16x16x64_bf16 a[228:231], a[244:247], v[208:215], v253
    v_mul_f32 v196, s44, v196
    v_mfma_f32_16x16x32_bf16 v[96:99], a[160:163], v[212:215], v[96:99]
    v_exp_f32 v196, v196
    v_mfma_f32_16x16x32_bf16 v[100:103], a[164:167], v[212:215], v[100:103]
    v_mul_f32 v197, s44, v197
    v_cvt_pk_bf16_f32 v193, v194, v195
    v_mfma_f32_16x16x32_bf16 v[104:107], a[168:171], v[212:215], v[104:107]
    ds_read_b64_tr_b16 a[222:223], v245 offset:21504
    v_mul_f32 v198, s44, v198
    v_mfma_f32_16x16x32_bf16 v[108:111], a[172:175], v[212:215], v[108:111]
    v_exp_f32 v197, v197
    v_mfma_f32_16x16x32_bf16 v[112:115], a[176:179], v[212:215], v[112:115]
    v_exp_f32 v198, v198
    v_mfma_f32_16x16x32_bf16 v[116:119], a[180:183], v[212:215], v[116:119]
    v_mul_f32 v199, s44, v199
    v_cvt_pk_bf16_f32 v194, v196, v197
    v_mfma_f32_16x16x32_bf16 v[120:123], a[184:187], v[212:215], v[120:123]
    v_exp_f32 v199, v199
    v_mfma_f32_16x16x32_bf16 v[124:127], a[188:191], v[212:215], v[124:127]
    v_mul_f32 v200, s44, v200
    v_cvt_pk_bf16_f32 v195, v198, v199
    v_mfma_f32_16x16x32_bf16 v[208:211], a[128:131], a[0:3], v[216:219]
    s_waitcnt vmcnt(12) lgkmcnt(0)
    v_exp_f32 v200, v200
    v_mfma_f32_16x16x32_bf16 v[208:211], a[132:135], a[4:7], v[208:211]
    s_barrier
    v_mul_f32 v201, s44, v201
    v_mfma_f32_16x16x32_bf16 v[208:211], a[136:139], a[8:11], v[208:211]
    v_exp_f32 v201, v201
    v_mfma_f32_16x16x32_bf16 v[208:211], a[140:143], a[12:15], v[208:211]
    ds_read_b128 a[96:99], v240 offset:24576
    v_mul_f32 v202, s44, v202
    v_mfma_f32_16x16x32_bf16 v[212:215], a[156:159], a[12:15], v[216:219]
    buffer_load_dwordx4 v248, s[8:11], s30 offen sc1 nt lds
    v_mfma_f32_16x16x32_bf16 v[212:215], a[152:155], a[8:11], v[212:215]
    s_addk_i32 m0, 896
    v_exp_f32 v202, v202
    v_mfma_f32_16x16x32_bf16 v[212:215], a[148:151], a[4:7], v[212:215]
    v_mul_f32 v203, s44, v203
    v_cvt_pk_bf16_f32 v196, v200, v201
    v_mfma_f32_16x16x32_bf16 v[212:215], a[144:147], a[0:3], v[212:215]
    ds_read_b128 a[100:103], v241 offset:24576
    v_mul_f32 v204, s44, v204
    v_mfma_f32_16x16x32_bf16 v[128:131], a[160:163], v[192:195], v[128:131]
    v_exp_f32 v203, v203
    v_mfma_f32_16x16x32_bf16 v[132:135], a[164:167], v[192:195], v[132:135]
    v_exp_f32 v204, v204
    v_mfma_f32_16x16x32_bf16 v[136:139], a[168:171], v[192:195], v[136:139]
    v_mul_f32 v205, s44, v205
    v_cvt_pk_bf16_f32 v197, v202, v203
    v_mfma_f32_16x16x32_bf16 v[140:143], a[172:175], v[192:195], v[140:143]
    ds_read_b128 a[104:107], v240 offset:25600
    v_mul_f32 v206, s44, v206
    v_mfma_f32_16x16x32_bf16 v[144:147], a[176:179], v[192:195], v[144:147]
    v_exp_f32 v205, v205
    v_mfma_f32_16x16x32_bf16 v[148:151], a[180:183], v[192:195], v[148:151]
    ds_read_b128 a[108:111], v241 offset:25600
    v_mul_f32 v207, s44, v207
    v_mfma_f32_16x16x32_bf16 v[152:155], a[184:187], v[192:195], v[152:155]
    v_exp_f32 v206, v206
    v_cvt_pk_bf16_f32 v198, v204, v205
    v_mfma_f32_16x16x32_bf16 v[156:159], a[188:191], v[192:195], v[156:159]
    v_exp_f32 v207, v207
    v_mfma_f32_16x16x32_bf16 v[200:203], a[128:131], a[16:19], v[220:223]
    ds_read_b128 a[112:115], v240 offset:28672
    v_mul_f32 v208, s44, v208
    v_mfma_f32_16x16x32_bf16 v[200:203], a[132:135], a[20:23], v[200:203]
    buffer_load_dwordx4 v248, s[8:11], s30 offen offset:128 sc1 nt lds
    v_mfma_f32_16x16x32_bf16 v[200:203], a[136:139], a[24:27], v[200:203]
    s_addk_i32 m0, 31872
    v_cvt_pk_bf16_f32 v199, v206, v207
    v_mul_f32 v209, s44, v209
    v_exp_f32 v208, v208
    v_mfma_f32_16x16x32_bf16 v[200:203], a[140:143], a[28:31], v[200:203]
    ds_read_b128 a[116:119], v241 offset:28672
    v_mul_f32 v210, s44, v210
    v_mfma_f32_16x16x32_bf16 v[204:207], a[156:159], a[28:31], v[220:223]
    v_exp_f32 v209, v209
    v_mfma_f32_16x16x32_bf16 v[204:207], a[152:155], a[24:27], v[204:207]
    v_exp_f32 v210, v210
    v_mfma_f32_16x16x32_bf16 v[204:207], a[148:151], a[20:23], v[204:207]
    v_mul_f32 v211, s44, v211
    v_cvt_pk_bf16_f32 v208, v208, v209
    v_mfma_f32_16x16x32_bf16 v[204:207], a[144:147], a[16:19], v[204:207]
    ds_read_b128 a[120:123], v240 offset:29696
    v_mul_f32 v212, s44, v212
    v_smfmac_f32_16x16x64_bf16 a[232:235], a[244:247], v[192:199], v253
    ds_read_b128 a[124:127], v241 offset:29696
    v_exp_f32 v211, v211
    v_mfma_f32_16x16x32_bf16 v[160:163], a[160:163], v[196:199], v[160:163]
    v_exp_f32 v212, v212
    v_mfma_f32_16x16x32_bf16 v[164:167], a[164:167], v[196:199], v[164:167]
    v_mul_f32 v213, s44, v213
    v_cvt_pk_bf16_f32 v209, v210, v211
    v_mfma_f32_16x16x32_bf16 v[168:171], a[168:171], v[196:199], v[168:171]
    v_exp_f32 v213, v213
    v_mfma_f32_16x16x32_bf16 v[172:175], a[172:175], v[196:199], v[172:175]
    ds_read_b64_tr_b16 a[160:161], v242 offset:24576
    v_mul_f32 v214, s44, v214
    v_mfma_f32_16x16x32_bf16 v[176:179], a[176:179], v[196:199], v[176:179]
    v_exp_f32 v214, v214
    v_mfma_f32_16x16x32_bf16 v[180:183], a[180:183], v[196:199], v[180:183]
    v_mul_f32 v215, s44, v215
    v_cvt_pk_bf16_f32 v210, v212, v213
    v_mfma_f32_16x16x32_bf16 v[184:187], a[184:187], v[196:199], v[184:187]
    v_exp_f32 v215, v215
    v_mfma_f32_16x16x32_bf16 v[188:191], a[188:191], v[196:199], v[188:191]
    ds_read_b64_tr_b16 a[162:163], v242 offset:28672
    v_mul_f32 v200, s44, v200
    v_mfma_f32_16x16x32_bf16 v[192:195], a[128:131], a[32:35], v[224:227]
    v_cvt_pk_bf16_f32 v211, v214, v215
    v_mul_f32 v201, s44, v201
    v_mfma_f32_16x16x32_bf16 v[192:195], a[132:135], a[36:39], v[192:195]
    v_exp_f32 v200, v200
    v_mfma_f32_16x16x32_bf16 v[192:195], a[136:139], a[40:43], v[192:195]
    ds_read_b64_tr_b16 a[164:165], v243 offset:24576
    v_mul_f32 v202, s44, v202
    v_mfma_f32_16x16x32_bf16 v[192:195], a[140:143], a[44:47], v[192:195]
    v_exp_f32 v201, v201
    v_mfma_f32_16x16x32_bf16 v[196:199], a[156:159], a[44:47], v[224:227]
    v_exp_f32 v202, v202
    v_mfma_f32_16x16x32_bf16 v[196:199], a[152:155], a[40:43], v[196:199]
    v_mul_f32 v203, s44, v203
    v_cvt_pk_bf16_f32 v212, v200, v201
    v_mfma_f32_16x16x32_bf16 v[196:199], a[148:151], a[36:39], v[196:199]
    v_exp_f32 v203, v203
    v_mfma_f32_16x16x32_bf16 v[196:199], a[144:147], a[32:35], v[196:199]
    ds_read_b64_tr_b16 a[166:167], v243 offset:28672
    v_mul_f32 v204, s44, v204
    v_mfma_f32_16x16x32_bf16 v[0:3], a[192:195], v[208:211], v[0:3]
    v_exp_f32 v204, v204
    v_mfma_f32_16x16x32_bf16 v[4:7], a[196:199], v[208:211], v[4:7]
    v_mul_f32 v205, s44, v205
    v_cvt_pk_bf16_f32 v213, v202, v203
    v_mfma_f32_16x16x32_bf16 v[8:11], a[200:203], v[208:211], v[8:11]
    v_exp_f32 v205, v205
    v_mfma_f32_16x16x32_bf16 v[12:15], a[204:207], v[208:211], v[12:15]
    ds_read_b64_tr_b16 a[168:169], v244 offset:24576
    v_mul_f32 v206, s44, v206
    v_mfma_f32_16x16x32_bf16 v[16:19], a[208:211], v[208:211], v[16:19]
    s_add_u32 s31, s21, 16384
    v_exp_f32 v206, v206
    v_mfma_f32_16x16x32_bf16 v[20:23], a[212:215], v[208:211], v[20:23]
    v_mul_f32 v207, s44, v207
    v_cvt_pk_bf16_f32 v214, v204, v205
    v_mfma_f32_16x16x32_bf16 v[24:27], a[216:219], v[208:211], v[24:27]
    v_exp_f32 v207, v207
    v_mfma_f32_16x16x32_bf16 v[28:31], a[220:223], v[208:211], v[28:31]
    ds_read_b64_tr_b16 a[170:171], v244 offset:28672
    v_mul_f32 v192, s44, v192
    v_mfma_f32_16x16x32_bf16 v[200:203], a[128:131], a[48:51], v[228:231]
    v_cvt_pk_bf16_f32 v215, v206, v207
    v_mul_f32 v193, s44, v193
    v_mfma_f32_16x16x32_bf16 v[200:203], a[132:135], a[52:55], v[200:203]
    v_exp_f32 v192, v192
    v_mfma_f32_16x16x32_bf16 v[200:203], a[136:139], a[56:59], v[200:203]
    buffer_load_dwordx4 v248, s[12:15], s30 offen sc1 nt lds
    v_mfma_f32_16x16x32_bf16 v[200:203], a[140:143], a[60:63], v[200:203]
    s_addk_i32 m0, 896
    v_exp_f32 v193, v193
    v_mfma_f32_16x16x32_bf16 v[204:207], a[156:159], a[60:63], v[228:231]
    ds_read_b64_tr_b16 a[172:173], v245 offset:24576
    v_mul_f32 v194, s44, v194
    v_mfma_f32_16x16x32_bf16 v[204:207], a[152:155], a[56:59], v[204:207]
    v_exp_f32 v194, v194
    v_mfma_f32_16x16x32_bf16 v[204:207], a[148:151], a[52:55], v[204:207]
    v_mul_f32 v195, s44, v195
    v_cvt_pk_bf16_f32 v192, v192, v193
    v_mfma_f32_16x16x32_bf16 v[204:207], a[144:147], a[48:51], v[204:207]
    v_exp_f32 v195, v195
    v_smfmac_f32_16x16x64_bf16 a[224:227], a[244:247], v[208:215], v253
    v_mul_f32 v196, s44, v196
    v_mfma_f32_16x16x32_bf16 v[32:35], a[192:195], v[212:215], v[32:35]
    ds_read_b64_tr_b16 a[174:175], v245 offset:28672
    v_mul_f32 v197, s44, v197
    v_mfma_f32_16x16x32_bf16 v[36:39], a[196:199], v[212:215], v[36:39]
    v_exp_f32 v196, v196
    v_cvt_pk_bf16_f32 v193, v194, v195
    v_mfma_f32_16x16x32_bf16 v[40:43], a[200:203], v[212:215], v[40:43]
    v_exp_f32 v197, v197
    v_mfma_f32_16x16x32_bf16 v[44:47], a[204:207], v[212:215], v[44:47]
    v_mul_f32 v198, s44, v198
    v_mul_f32 v199, s44, v199
    v_mfma_f32_16x16x32_bf16 v[48:51], a[208:211], v[212:215], v[48:51]
    v_exp_f32 v198, v198
    v_mfma_f32_16x16x32_bf16 v[52:55], a[212:215], v[212:215], v[52:55]
    ds_read_b64_tr_b16 a[176:177], v242 offset:25600
    v_cvt_pk_bf16_f32 v194, v196, v197
    v_mfma_f32_16x16x32_bf16 v[56:59], a[216:219], v[212:215], v[56:59]
    buffer_load_dwordx4 v248, s[12:15], s30 offen offset:128 sc1 nt lds
    v_mfma_f32_16x16x32_bf16 v[60:63], a[220:223], v[212:215], v[60:63]
    s_addk_i32 m0, -25472
    v_exp_f32 v199, v199
    v_mfma_f32_16x16x32_bf16 v[208:211], a[128:131], a[64:67], v[232:235]
    s_addk_i32 s30, 8192
    v_mul_f32 v200, s44, v200
    v_cvt_pk_bf16_f32 v195, v198, v199
    v_mfma_f32_16x16x32_bf16 v[208:211], a[132:135], a[68:71], v[208:211]
    ds_read_b64_tr_b16 a[178:179], v242 offset:29696
    v_mul_f32 v201, s44, v201
    v_mfma_f32_16x16x32_bf16 v[208:211], a[136:139], a[72:75], v[208:211]
    v_exp_f32 v200, v200
    v_mfma_f32_16x16x32_bf16 v[208:211], a[140:143], a[76:79], v[208:211]
    v_exp_f32 v201, v201
    v_mfma_f32_16x16x32_bf16 v[212:215], a[156:159], a[76:79], v[232:235]
    ds_read_b64_tr_b16 a[180:181], v243 offset:25600
    v_mul_f32 v202, s44, v202
    v_mfma_f32_16x16x32_bf16 v[212:215], a[152:155], a[72:75], v[212:215]
    v_exp_f32 v202, v202
    v_mfma_f32_16x16x32_bf16 v[212:215], a[148:151], a[68:71], v[212:215]
    v_mul_f32 v203, s44, v203
    v_cvt_pk_bf16_f32 v196, v200, v201
    v_mfma_f32_16x16x32_bf16 v[212:215], a[144:147], a[64:67], v[212:215]
    v_exp_f32 v203, v203
    v_mfma_f32_16x16x32_bf16 v[64:67], a[192:195], v[192:195], v[64:67]
    v_mul_f32 v204, s44, v204
    v_mul_f32 v205, s44, v205
    v_mfma_f32_16x16x32_bf16 v[68:71], a[196:199], v[192:195], v[68:71]
    v_exp_f32 v204, v204
    v_mfma_f32_16x16x32_bf16 v[72:75], a[200:203], v[192:195], v[72:75]
    ds_read_b64_tr_b16 a[182:183], v243 offset:29696
    v_cvt_pk_bf16_f32 v197, v202, v203
    v_mfma_f32_16x16x32_bf16 v[76:79], a[204:207], v[192:195], v[76:79]
    v_exp_f32 v205, v205
    v_mfma_f32_16x16x32_bf16 v[80:83], a[208:211], v[192:195], v[80:83]
    v_mul_f32 v206, s44, v206
    v_mul_f32 v207, s44, v207
    v_mfma_f32_16x16x32_bf16 v[84:87], a[212:215], v[192:195], v[84:87]
    v_exp_f32 v206, v206
    v_mfma_f32_16x16x32_bf16 v[88:91], a[216:219], v[192:195], v[88:91]
    ds_read_b64_tr_b16 a[184:185], v244 offset:25600
    v_cvt_pk_bf16_f32 v198, v204, v205
    v_mfma_f32_16x16x32_bf16 v[92:95], a[220:223], v[192:195], v[92:95]
    v_exp_f32 v207, v207
    v_mfma_f32_16x16x32_bf16 v[200:203], a[128:131], a[80:83], v[236:239]
    v_mul_f32 v208, s44, v208
    v_cvt_pk_bf16_f32 v199, v206, v207
    v_mfma_f32_16x16x32_bf16 v[200:203], a[132:135], a[84:87], v[200:203]
    v_exp_f32 v208, v208
    v_mfma_f32_16x16x32_bf16 v[200:203], a[136:139], a[88:91], v[200:203]
    ds_read_b64_tr_b16 a[186:187], v244 offset:29696
    v_mul_f32 v209, s44, v209
    v_mfma_f32_16x16x32_bf16 v[200:203], a[140:143], a[92:95], v[200:203]
    v_exp_f32 v209, v209
    v_mfma_f32_16x16x32_bf16 v[204:207], a[156:159], a[92:95], v[236:239]
    v_mul_f32 v210, s44, v210
    v_mul_f32 v211, s44, v211
    v_mfma_f32_16x16x32_bf16 v[204:207], a[152:155], a[88:91], v[204:207]
    v_exp_f32 v210, v210
    v_mfma_f32_16x16x32_bf16 v[204:207], a[148:151], a[84:87], v[204:207]
    ds_read_b64_tr_b16 a[188:189], v245 offset:25600
    v_cvt_pk_bf16_f32 v208, v208, v209
    v_mfma_f32_16x16x32_bf16 v[204:207], a[144:147], a[80:83], v[204:207]
    v_exp_f32 v211, v211
    v_smfmac_f32_16x16x64_bf16 a[228:231], a[244:247], v[192:199], v253
    v_mul_f32 v212, s44, v212
    v_mfma_f32_16x16x32_bf16 v[96:99], a[192:195], v[196:199], v[96:99]
    v_exp_f32 v212, v212
    v_mfma_f32_16x16x32_bf16 v[100:103], a[196:199], v[196:199], v[100:103]
    v_mul_f32 v213, s44, v213
    v_cvt_pk_bf16_f32 v209, v210, v211
    v_mfma_f32_16x16x32_bf16 v[104:107], a[200:203], v[196:199], v[104:107]
    ds_read_b64_tr_b16 a[190:191], v245 offset:29696
    v_mul_f32 v214, s44, v214
    v_mfma_f32_16x16x32_bf16 v[108:111], a[204:207], v[196:199], v[108:111]
    v_exp_f32 v213, v213
    v_mfma_f32_16x16x32_bf16 v[112:115], a[208:211], v[196:199], v[112:115]
    v_exp_f32 v214, v214
    v_mfma_f32_16x16x32_bf16 v[116:119], a[212:215], v[196:199], v[116:119]
    v_mul_f32 v215, s44, v215
    v_cvt_pk_bf16_f32 v210, v212, v213
    v_mfma_f32_16x16x32_bf16 v[120:123], a[216:219], v[196:199], v[120:123]
    v_exp_f32 v215, v215
    v_mfma_f32_16x16x32_bf16 v[124:127], a[220:223], v[196:199], v[124:127]
    s_waitcnt lgkmcnt(1)
    v_mul_f32 v200, s44, v200
    v_cvt_pk_bf16_f32 v211, v214, v215
    v_mfma_f32_16x16x32_bf16 v[192:195], a[96:99], a[0:3], v[216:219]
    s_waitcnt vmcnt(12) lgkmcnt(0)
    v_exp_f32 v200, v200
    v_mfma_f32_16x16x32_bf16 v[192:195], a[100:103], a[4:7], v[192:195]
    s_barrier
    v_mul_f32 v201, s44, v201
    v_mfma_f32_16x16x32_bf16 v[192:195], a[104:107], a[8:11], v[192:195]
    v_exp_f32 v201, v201
    v_mfma_f32_16x16x32_bf16 v[192:195], a[108:111], a[12:15], v[192:195]
    ds_read_b128 a[128:131], v240 offset:0
    v_mul_f32 v202, s44, v202
    v_mfma_f32_16x16x32_bf16 v[196:199], a[124:127], a[12:15], v[216:219]
    buffer_load_dwordx4 v248, s[8:11], s30 offen sc1 nt lds
    v_mfma_f32_16x16x32_bf16 v[196:199], a[120:123], a[8:11], v[196:199]
    s_addk_i32 m0, 896
    v_exp_f32 v202, v202
    v_mfma_f32_16x16x32_bf16 v[196:199], a[116:119], a[4:7], v[196:199]
    ds_read_b128 a[248:251], v250 offset:17408
    v_mul_f32 v203, s44, v203
    v_cvt_pk_bf16_f32 v212, v200, v201
    v_mfma_f32_16x16x32_bf16 v[196:199], a[112:115], a[0:3], v[196:199]
    ds_read_b128 a[132:135], v241 offset:0
    v_mul_f32 v204, s44, v204
    v_mfma_f32_16x16x32_bf16 v[128:131], a[192:195], v[208:211], v[128:131]
    v_exp_f32 v203, v203
    v_mfma_f32_16x16x32_bf16 v[132:135], a[196:199], v[208:211], v[132:135]
    v_exp_f32 v204, v204
    v_mfma_f32_16x16x32_bf16 v[136:139], a[200:203], v[208:211], v[136:139]
    v_mul_f32 v205, s44, v205
    v_cvt_pk_bf16_f32 v213, v202, v203
    v_mfma_f32_16x16x32_bf16 v[140:143], a[204:207], v[208:211], v[140:143]
    ds_read_b128 a[136:139], v240 offset:1024
    v_mul_f32 v206, s44, v206
    v_mfma_f32_16x16x32_bf16 v[144:147], a[208:211], v[208:211], v[144:147]
    v_exp_f32 v205, v205
    v_mfma_f32_16x16x32_bf16 v[148:151], a[212:215], v[208:211], v[148:151]
    s_waitcnt lgkmcnt(2)
    ds_read_b128 a[140:143], v241 offset:1024
    buffer_store_dwordx4 a[248:251], v248, s[16:19], s31 offen offset:0 sc1
    v_mul_f32 v207, s44, v207
    v_mfma_f32_16x16x32_bf16 v[152:155], a[216:219], v[208:211], v[152:155]
    v_exp_f32 v206, v206
    v_cvt_pk_bf16_f32 v214, v204, v205
    v_mfma_f32_16x16x32_bf16 v[156:159], a[220:223], v[208:211], v[156:159]
    ds_read_b128 a[252:255], v250 offset:19584
    v_mul_f32 v192, s44, v192
    v_mfma_f32_16x16x32_bf16 v[200:203], a[96:99], a[16:19], v[220:223]
    v_exp_f32 v207, v207
    v_mfma_f32_16x16x32_bf16 v[200:203], a[100:103], a[20:23], v[200:203]
    ds_read_b128 a[144:147], v240 offset:4096
    v_cvt_pk_bf16_f32 v215, v206, v207
    v_mfma_f32_16x16x32_bf16 v[200:203], a[104:107], a[24:27], v[200:203]
    buffer_load_dwordx4 v248, s[8:11], s30 offen offset:128 sc1 nt lds
    v_exp_f32 v192, v192
    v_mul_f32 v193, s44, v193
    v_mfma_f32_16x16x32_bf16 v[200:203], a[108:111], a[28:31], v[200:203]
    s_addk_i32 m0, 31872
    ds_read_b128 a[148:151], v241 offset:4096
    v_mul_f32 v194, s44, v194
    v_mfma_f32_16x16x32_bf16 v[204:207], a[124:127], a[28:31], v[220:223]
    v_exp_f32 v193, v193
    v_mfma_f32_16x16x32_bf16 v[204:207], a[120:123], a[24:27], v[204:207]
    v_exp_f32 v194, v194
    v_mfma_f32_16x16x32_bf16 v[204:207], a[116:119], a[20:23], v[204:207]
    s_waitcnt lgkmcnt(2)
    buffer_store_dwordx4 a[252:255], v248, s[16:19], s31 offen offset:2048 sc1
    v_mul_f32 v195, s44, v195
    v_cvt_pk_bf16_f32 v192, v192, v193
    v_mfma_f32_16x16x32_bf16 v[204:207], a[112:115], a[16:19], v[204:207]
    ds_read_b128 a[152:155], v240 offset:5120
    v_mul_f32 v196, s44, v196
    v_smfmac_f32_16x16x64_bf16 a[232:235], a[244:247], v[208:215], v253
    ds_read_b128 a[248:251], v250 offset:17536
    v_exp_f32 v195, v195
    v_mfma_f32_16x16x32_bf16 v[160:163], a[192:195], v[212:215], v[160:163]
    ds_read_b128 a[156:159], v241 offset:5120
    v_mul_f32 v197, s44, v197
    v_mfma_f32_16x16x32_bf16 v[164:167], a[196:199], v[212:215], v[164:167]
    v_exp_f32 v196, v196
    v_cvt_pk_bf16_f32 v193, v194, v195
    v_mfma_f32_16x16x32_bf16 v[168:171], a[200:203], v[212:215], v[168:171]
    v_exp_f32 v197, v197
    v_mfma_f32_16x16x32_bf16 v[172:175], a[204:207], v[212:215], v[172:175]
    ds_read_b64_tr_b16 a[192:193], v242 offset:0
    v_mul_f32 v198, s44, v198
    v_mfma_f32_16x16x32_bf16 v[176:179], a[208:211], v[212:215], v[176:179]
    v_exp_f32 v198, v198
    v_mfma_f32_16x16x32_bf16 v[180:183], a[212:215], v[212:215], v[180:183]
    v_mul_f32 v199, s44, v199
    v_cvt_pk_bf16_f32 v194, v196, v197
    v_mfma_f32_16x16x32_bf16 v[184:187], a[216:219], v[212:215], v[184:187]
    s_waitcnt lgkmcnt(2)
    buffer_store_dwordx4 a[248:251], v248, s[16:19], s31 offen offset:128 sc1
    v_exp_f32 v199, v199
    v_mfma_f32_16x16x32_bf16 v[188:191], a[220:223], v[212:215], v[188:191]
    ds_read_b64_tr_b16 a[194:195], v242 offset:4096
    v_mul_f32 v200, s44, v200
    v_mfma_f32_16x16x32_bf16 v[208:211], a[96:99], a[32:35], v[224:227]
    ds_read_b128 a[252:255], v250 offset:19712
    v_cvt_pk_bf16_f32 v195, v198, v199
    v_mfma_f32_16x16x32_bf16 v[208:211], a[100:103], a[36:39], v[208:211]
    v_exp_f32 v200, v200
    v_mfma_f32_16x16x32_bf16 v[208:211], a[104:107], a[40:43], v[208:211]
    ds_read_b64_tr_b16 a[196:197], v243 offset:0
    v_mul_f32 v201, s44, v201
    v_mfma_f32_16x16x32_bf16 v[208:211], a[108:111], a[44:47], v[208:211]
    v_exp_f32 v201, v201
    v_mfma_f32_16x16x32_bf16 v[212:215], a[124:127], a[44:47], v[224:227]
    v_mul_f32 v202, s44, v202
    v_mul_f32 v203, s44, v203
    v_mfma_f32_16x16x32_bf16 v[212:215], a[120:123], a[40:43], v[212:215]
    v_exp_f32 v202, v202
    v_mfma_f32_16x16x32_bf16 v[212:215], a[116:119], a[36:39], v[212:215]
    v_cvt_pk_bf16_f32 v196, v200, v201
    v_mul_f32 v204, s44, v204
    v_mfma_f32_16x16x32_bf16 v[212:215], a[112:115], a[32:35], v[212:215]
    s_waitcnt lgkmcnt(1)
    buffer_store_dwordx4 a[252:255], v248, s[16:19], s31 offen offset:2176 sc1
    v_exp_f32 v203, v203
    v_mfma_f32_16x16x32_bf16 v[0:3], a[160:163], v[192:195], v[0:3]
    ds_read_b64_tr_b16 a[198:199], v243 offset:4096
    v_mul_f32 v205, s44, v205
    v_mfma_f32_16x16x32_bf16 v[4:7], a[164:167], v[192:195], v[4:7]
    v_exp_f32 v204, v204
    v_mfma_f32_16x16x32_bf16 v[8:11], a[168:171], v[192:195], v[8:11]
    v_cvt_pk_bf16_f32 v197, v202, v203
    v_mul_f32 v206, s44, v206
    v_mfma_f32_16x16x32_bf16 v[12:15], a[172:175], v[192:195], v[12:15]
    v_exp_f32 v205, v205
    v_mfma_f32_16x16x32_bf16 v[16:19], a[176:179], v[192:195], v[16:19]
    ds_read_b64_tr_b16 a[200:201], v244 offset:0
    v_mul_f32 v207, s44, v207
    v_mfma_f32_16x16x32_bf16 v[20:23], a[180:183], v[192:195], v[20:23]
    v_exp_f32 v206, v206
    v_mfma_f32_16x16x32_bf16 v[24:27], a[184:187], v[192:195], v[24:27]
    v_cvt_pk_bf16_f32 v198, v204, v205
    v_mul_f32 v208, s44, v208
    v_mfma_f32_16x16x32_bf16 v[28:31], a[188:191], v[192:195], v[28:31]
    v_exp_f32 v207, v207
    v_mfma_f32_16x16x32_bf16 v[200:203], a[96:99], a[48:51], v[228:231]
    ds_read_b64_tr_b16 a[202:203], v244 offset:4096
    v_cvt_pk_bf16_f32 v199, v206, v207
    v_mfma_f32_16x16x32_bf16 v[200:203], a[100:103], a[52:55], v[200:203]
    v_exp_f32 v208, v208
    v_mfma_f32_16x16x32_bf16 v[200:203], a[104:107], a[56:59], v[200:203]
    v_mul_f32 v209, s44, v209
    v_mul_f32 v210, s44, v210
    v_mfma_f32_16x16x32_bf16 v[200:203], a[108:111], a[60:63], v[200:203]
    buffer_load_dwordx4 v248, s[12:15], s30 offen sc1 nt lds
    v_mfma_f32_16x16x32_bf16 v[204:207], a[124:127], a[60:63], v[228:231]
    s_addk_i32 m0, 896
    v_exp_f32 v209, v209
    v_mfma_f32_16x16x32_bf16 v[204:207], a[120:123], a[56:59], v[204:207]
    ds_read_b64_tr_b16 a[204:205], v245 offset:0
    v_mul_f32 v211, s44, v211
    v_mfma_f32_16x16x32_bf16 v[204:207], a[116:119], a[52:55], v[204:207]
    v_exp_f32 v210, v210
    v_cvt_pk_bf16_f32 v208, v208, v209
    v_mfma_f32_16x16x32_bf16 v[204:207], a[112:115], a[48:51], v[204:207]
    v_exp_f32 v211, v211
    v_smfmac_f32_16x16x64_bf16 a[224:227], a[244:247], v[192:199], v253
    v_mul_f32 v212, s44, v212
    v_mfma_f32_16x16x32_bf16 v[32:35], a[160:163], v[196:199], v[32:35]
    ds_read_b64_tr_b16 a[206:207], v245 offset:4096
    v_mul_f32 v213, s44, v213
    v_mfma_f32_16x16x32_bf16 v[36:39], a[164:167], v[196:199], v[36:39]
    v_exp_f32 v212, v212
    v_cvt_pk_bf16_f32 v209, v210, v211
    v_mfma_f32_16x16x32_bf16 v[40:43], a[168:171], v[196:199], v[40:43]
    v_exp_f32 v213, v213
    v_mfma_f32_16x16x32_bf16 v[44:47], a[172:175], v[196:199], v[44:47]
    v_mul_f32 v214, s44, v214
    v_mul_f32 v215, s44, v215
    v_mfma_f32_16x16x32_bf16 v[48:51], a[176:179], v[196:199], v[48:51]
    v_exp_f32 v214, v214
    v_mfma_f32_16x16x32_bf16 v[52:55], a[180:183], v[196:199], v[52:55]
    ds_read_b64_tr_b16 a[208:209], v242 offset:1024
    v_cvt_pk_bf16_f32 v210, v212, v213
    v_mfma_f32_16x16x32_bf16 v[56:59], a[184:187], v[196:199], v[56:59]
    buffer_load_dwordx4 v248, s[12:15], s30 offen offset:128 sc1 nt lds
    v_mfma_f32_16x16x32_bf16 v[60:63], a[188:191], v[196:199], v[60:63]
    s_mov_b32 m0, s27
    v_exp_f32 v215, v215
    v_mfma_f32_16x16x32_bf16 v[192:195], a[96:99], a[64:67], v[232:235]
    s_addk_i32 s30, 8192
    v_mul_f32 v200, s44, v200
    v_cvt_pk_bf16_f32 v211, v214, v215
    v_mfma_f32_16x16x32_bf16 v[192:195], a[100:103], a[68:71], v[192:195]
    ds_read_b64_tr_b16 a[210:211], v242 offset:5120
    v_mul_f32 v201, s44, v201
    v_mfma_f32_16x16x32_bf16 v[192:195], a[104:107], a[72:75], v[192:195]
    v_exp_f32 v200, v200
    v_mfma_f32_16x16x32_bf16 v[192:195], a[108:111], a[76:79], v[192:195]
    v_exp_f32 v201, v201
    v_mfma_f32_16x16x32_bf16 v[196:199], a[124:127], a[76:79], v[232:235]
    ds_read_b64_tr_b16 a[212:213], v243 offset:1024
    v_mul_f32 v202, s44, v202
    v_mfma_f32_16x16x32_bf16 v[196:199], a[120:123], a[72:75], v[196:199]
    v_exp_f32 v202, v202
    v_mfma_f32_16x16x32_bf16 v[196:199], a[116:119], a[68:71], v[196:199]
    v_mul_f32 v203, s44, v203
    v_cvt_pk_bf16_f32 v212, v200, v201
    v_mfma_f32_16x16x32_bf16 v[196:199], a[112:115], a[64:67], v[196:199]
    v_exp_f32 v203, v203
    v_mfma_f32_16x16x32_bf16 v[64:67], a[160:163], v[208:211], v[64:67]
    v_mul_f32 v204, s44, v204
    v_mul_f32 v205, s44, v205
    v_mfma_f32_16x16x32_bf16 v[68:71], a[164:167], v[208:211], v[68:71]
    v_exp_f32 v204, v204
    v_mfma_f32_16x16x32_bf16 v[72:75], a[168:171], v[208:211], v[72:75]
    ds_read_b64_tr_b16 a[214:215], v243 offset:5120
    v_cvt_pk_bf16_f32 v213, v202, v203
    v_mfma_f32_16x16x32_bf16 v[76:79], a[172:175], v[208:211], v[76:79]
    v_exp_f32 v205, v205
    v_mfma_f32_16x16x32_bf16 v[80:83], a[176:179], v[208:211], v[80:83]
    v_mul_f32 v206, s44, v206
    v_mul_f32 v207, s44, v207
    v_mfma_f32_16x16x32_bf16 v[84:87], a[180:183], v[208:211], v[84:87]
    v_exp_f32 v206, v206
    v_mfma_f32_16x16x32_bf16 v[88:91], a[184:187], v[208:211], v[88:91]
    ds_read_b64_tr_b16 a[216:217], v244 offset:1024
    v_cvt_pk_bf16_f32 v214, v204, v205
    v_mfma_f32_16x16x32_bf16 v[92:95], a[188:191], v[208:211], v[92:95]
    v_exp_f32 v207, v207
    v_mfma_f32_16x16x32_bf16 v[200:203], a[96:99], a[80:83], v[236:239]
    v_mul_f32 v192, s44, v192
    v_cvt_pk_bf16_f32 v215, v206, v207
    v_mfma_f32_16x16x32_bf16 v[200:203], a[100:103], a[84:87], v[200:203]
    v_exp_f32 v192, v192
    v_mfma_f32_16x16x32_bf16 v[200:203], a[104:107], a[88:91], v[200:203]
    ds_read_b64_tr_b16 a[218:219], v244 offset:5120
    v_mul_f32 v193, s44, v193
    v_mfma_f32_16x16x32_bf16 v[200:203], a[108:111], a[92:95], v[200:203]
    v_exp_f32 v193, v193
    v_mfma_f32_16x16x32_bf16 v[204:207], a[124:127], a[92:95], v[236:239]
    v_mul_f32 v194, s44, v194
    v_mul_f32 v195, s44, v195
    v_mfma_f32_16x16x32_bf16 v[204:207], a[120:123], a[88:91], v[204:207]
    v_exp_f32 v194, v194
    v_mfma_f32_16x16x32_bf16 v[204:207], a[116:119], a[84:87], v[204:207]
    ds_read_b64_tr_b16 a[220:221], v245 offset:1024
    v_cvt_pk_bf16_f32 v192, v192, v193
    v_mfma_f32_16x16x32_bf16 v[204:207], a[112:115], a[80:83], v[204:207]
    v_exp_f32 v195, v195
    v_smfmac_f32_16x16x64_bf16 a[228:231], a[244:247], v[208:215], v253
    v_mul_f32 v196, s44, v196
    v_mfma_f32_16x16x32_bf16 v[96:99], a[160:163], v[212:215], v[96:99]
    v_exp_f32 v196, v196
    v_mfma_f32_16x16x32_bf16 v[100:103], a[164:167], v[212:215], v[100:103]
    v_mul_f32 v197, s44, v197
    v_cvt_pk_bf16_f32 v193, v194, v195
    v_mfma_f32_16x16x32_bf16 v[104:107], a[168:171], v[212:215], v[104:107]
L_pad10:
    s_cbranch_execz L_padend0
    ds_read_b64_tr_b16 a[222:223], v245 offset:5120
    v_mul_f32 v198, s44, v198
    v_mfma_f32_16x16x32_bf16 v[108:111], a[172:175], v[212:215], v[108:111]
    v_exp_f32 v197, v197
    v_mfma_f32_16x16x32_bf16 v[112:115], a[176:179], v[212:215], v[112:115]
    v_exp_f32 v198, v198
    v_mfma_f32_16x16x32_bf16 v[116:119], a[180:183], v[212:215], v[116:119]
    v_mul_f32 v199, s44, v199
    v_cvt_pk_bf16_f32 v194, v196, v197
    v_mfma_f32_16x16x32_bf16 v[120:123], a[184:187], v[212:215], v[120:123]
    v_exp_f32 v199, v199
    v_mfma_f32_16x16x32_bf16 v[124:127], a[188:191], v[212:215], v[124:127]
    v_mul_f32 v200, s44, v200
    v_cvt_pk_bf16_f32 v195, v198, v199
    v_mfma_f32_16x16x32_bf16 v[208:211], a[128:131], a[0:3], v[216:219]
    s_waitcnt vmcnt(12) lgkmcnt(0)
    v_exp_f32 v200, v200
    v_mfma_f32_16x16x32_bf16 v[208:211], a[132:135], a[4:7], v[208:211]
    s_barrier
    v_mul_f32 v201, s44, v201
    v_mfma_f32_16x16x32_bf16 v[208:211], a[136:139], a[8:11], v[208:211]
    v_exp_f32 v201, v201
    v_mfma_f32_16x16x32_bf16 v[208:211], a[140:143], a[12:15], v[208:211]
    ds_read_b128 a[96:99], v240 offset:8192
    v_mul_f32 v202, s44, v202
    v_mfma_f32_16x16x32_bf16 v[212:215], a[156:159], a[12:15], v[216:219]
    buffer_load_dwordx4 v248, s[8:11], s30 offen sc1 nt lds
    v_mfma_f32_16x16x32_bf16 v[212:215], a[152:155], a[8:11], v[212:215]
    s_addk_i32 m0, 896
    v_exp_f32 v202, v202
    v_mfma_f32_16x16x32_bf16 v[212:215], a[148:151], a[4:7], v[212:215]
    v_mul_f32 v203, s44, v203
    v_cvt_pk_bf16_f32 v196, v200, v201
    v_mfma_f32_16x16x32_bf16 v[212:215], a[144:147], a[0:3], v[212:215]
    ds_read_b128 a[100:103], v241 offset:8192
    v_mul_f32 v204, s44, v204
    v_mfma_f32_16x16x32_bf16 v[128:131], a[160:163], v[192:195], v[128:131]
    v_exp_f32 v203, v203
    v_mfma_f32_16x16x32_bf16 v[132:135], a[164:167], v[192:195], v[132:135]
    v_exp_f32 v204, v204
    v_mfma_f32_16x16x32_bf16 v[136:139], a[168:171], v[192:195], v[136:139]
    v_mul_f32 v205, s44, v205
    v_cvt_pk_bf16_f32 v197, v202, v203
    v_mfma_f32_16x16x32_bf16 v[140:143], a[172:175], v[192:195], v[140:143]
    ds_read_b128 a[104:107], v240 offset:9216
    v_mul_f32 v206, s44, v206
    v_mfma_f32_16x16x32_bf16 v[144:147], a[176:179], v[192:195], v[144:147]
    v_exp_f32 v205, v205
    v_mfma_f32_16x16x32_bf16 v[148:151], a[180:183], v[192:195], v[148:151]
    ds_read_b128 a[108:111], v241 offset:9216
    v_mul_f32 v207, s44, v207
    v_mfma_f32_16x16x32_bf16 v[152:155], a[184:187], v[192:195], v[152:155]
    v_exp_f32 v206, v206
    v_cvt_pk_bf16_f32 v198, v204, v205
    v_mfma_f32_16x16x32_bf16 v[156:159], a[188:191], v[192:195], v[156:159]
    v_exp_f32 v207, v207
    v_mfma_f32_16x16x32_bf16 v[200:203], a[128:131], a[16:19], v[220:223]
    ds_read_b128 a[112:115], v240 offset:12288
    v_mul_f32 v208, s44, v208
    v_mfma_f32_16x16x32_bf16 v[200:203], a[132:135], a[20:23], v[200:203]
    buffer_load_dwordx4 v248, s[8:11], s30 offen offset:128 sc1 nt lds
    v_mfma_f32_16x16x32_bf16 v[200:203], a[136:139], a[24:27], v[200:203]
    s_addk_i32 m0, 31872
    v_cvt_pk_bf16_f32 v199, v206, v207
    v_mul_f32 v209, s44, v209
    v_exp_f32 v208, v208
    v_mfma_f32_16x16x32_bf16 v[200:203], a[140:143], a[28:31], v[200:203]
    ds_read_b128 a[116:119], v241 offset:12288
    v_mul_f32 v210, s44, v210
    v_mfma_f32_16x16x32_bf16 v[204:207], a[156:159], a[28:31], v[220:223]
    v_exp_f32 v209, v209
    v_mfma_f32_16x16x32_bf16 v[204:207], a[152:155], a[24:27], v[204:207]
    v_exp_f32 v210, v210
    v_mfma_f32_16x16x32_bf16 v[204:207], a[148:151], a[20:23], v[204:207]
    v_mul_f32 v211, s44, v211
    v_cvt_pk_bf16_f32 v208, v208, v209
    v_mfma_f32_16x16x32_bf16 v[204:207], a[144:147], a[16:19], v[204:207]
    ds_read_b128 a[120:123], v240 offset:13312
    v_mul_f32 v212, s44, v212
    v_smfmac_f32_16x16x64_bf16 a[232:235], a[244:247], v[192:199], v253
    ds_read_b128 a[124:127], v241 offset:13312
    v_exp_f32 v211, v211
    v_mfma_f32_16x16x32_bf16 v[160:163], a[160:163], v[196:199], v[160:163]
    v_exp_f32 v212, v212
    v_mfma_f32_16x16x32_bf16 v[164:167], a[164:167], v[196:199], v[164:167]
    v_mul_f32 v213, s44, v213
    v_cvt_pk_bf16_f32 v209, v210, v211
    v_mfma_f32_16x16x32_bf16 v[168:171], a[168:171], v[196:199], v[168:171]
    v_exp_f32 v213, v213
    v_mfma_f32_16x16x32_bf16 v[172:175], a[172:175], v[196:199], v[172:175]
    ds_read_b64_tr_b16 a[160:161], v242 offset:8192
    v_mul_f32 v214, s44, v214
    v_mfma_f32_16x16x32_bf16 v[176:179], a[176:179], v[196:199], v[176:179]
    v_exp_f32 v214, v214
    v_mfma_f32_16x16x32_bf16 v[180:183], a[180:183], v[196:199], v[180:183]
    v_mul_f32 v215, s44, v215
    v_cvt_pk_bf16_f32 v210, v212, v213
    v_mfma_f32_16x16x32_bf16 v[184:187], a[184:187], v[196:199], v[184:187]
    v_exp_f32 v215, v215
    v_mfma_f32_16x16x32_bf16 v[188:191], a[188:191], v[196:199], v[188:191]
    ds_read_b64_tr_b16 a[162:163], v242 offset:12288
    v_mul_f32 v200, s44, v200
    v_mfma_f32_16x16x32_bf16 v[192:195], a[128:131], a[32:35], v[224:227]
    v_cvt_pk_bf16_f32 v211, v214, v215
    v_mul_f32 v201, s44, v201
    v_mfma_f32_16x16x32_bf16 v[192:195], a[132:135], a[36:39], v[192:195]
    v_exp_f32 v200, v200
    v_mfma_f32_16x16x32_bf16 v[192:195], a[136:139], a[40:43], v[192:195]
    ds_read_b64_tr_b16 a[164:165], v243 offset:8192
    v_mul_f32 v202, s44, v202
    v_mfma_f32_16x16x32_bf16 v[192:195], a[140:143], a[44:47], v[192:195]
    v_exp_f32 v201, v201
    v_mfma_f32_16x16x32_bf16 v[196:199], a[156:159], a[44:47], v[224:227]
    v_exp_f32 v202, v202
    v_mfma_f32_16x16x32_bf16 v[196:199], a[152:155], a[40:43], v[196:199]
    v_mul_f32 v203, s44, v203
    v_cvt_pk_bf16_f32 v212, v200, v201
    v_mfma_f32_16x16x32_bf16 v[196:199], a[148:151], a[36:39], v[196:199]
    v_exp_f32 v203, v203
    v_mfma_f32_16x16x32_bf16 v[196:199], a[144:147], a[32:35], v[196:199]
    ds_read_b64_tr_b16 a[166:167], v243 offset:12288
    v_mul_f32 v204, s44, v204
    v_mfma_f32_16x16x32_bf16 v[0:3], a[192:195], v[208:211], v[0:3]
    v_exp_f32 v204, v204
    v_mfma_f32_16x16x32_bf16 v[4:7], a[196:199], v[208:211], v[4:7]
    v_mul_f32 v205, s44, v205
    v_cvt_pk_bf16_f32 v213, v202, v203
    v_mfma_f32_16x16x32_bf16 v[8:11], a[200:203], v[208:211], v[8:11]
    v_exp_f32 v205, v205
    v_mfma_f32_16x16x32_bf16 v[12:15], a[204:207], v[208:211], v[12:15]
    ds_read_b64_tr_b16 a[168:169], v244 offset:8192
    v_mul_f32 v206, s44, v206
    v_mfma_f32_16x16x32_bf16 v[16:19], a[208:211], v[208:211], v[16:19]
    s_add_u32 s31, s21, 20480
    v_exp_f32 v206, v206
    v_mfma_f32_16x16x32_bf16 v[20:23], a[212:215], v[208:211], v[20:23]
    v_mul_f32 v207, s44, v207
    v_cvt_pk_bf16_f32 v214, v204, v205
    v_mfma_f32_16x16x32_bf16 v[24:27], a[216:219], v[208:211], v[24:27]
    v_exp_f32 v207, v207
    v_mfma_f32_16x16x32_bf16 v[28:31], a[220:223], v[208:211], v[28:31]
    ds_read_b64_tr_b16 a[170:171], v244 offset:12288
    v_mul_f32 v192, s44, v192
    v_mfma_f32_16x16x32_bf16 v[200:203], a[128:131], a[48:51], v[228:231]
    v_cvt_pk_bf16_f32 v215, v206, v207
    v_mul_f32 v193, s44, v193
    v_mfma_f32_16x16x32_bf16 v[200:203], a[132:135], a[52:55], v[200:203]
    v_exp_f32 v192, v192
    v_mfma_f32_16x16x32_bf16 v[200:203], a[136:139], a[56:59], v[200:203]
    buffer_load_dwordx4 v248, s[12:15], s30 offen sc1 nt lds
    v_mfma_f32_16x16x32_bf16 v[200:203], a[140:143], a[60:63], v[200:203]
    s_addk_i32 m0, 896
    v_exp_f32 v193, v193
    v_mfma_f32_16x16x32_bf16 v[204:207], a[156:159], a[60:63], v[228:231]
    ds_read_b64_tr_b16 a[172:173], v245 offset:8192
    v_mul_f32 v194, s44, v194
    v_mfma_f32_16x16x32_bf16 v[204:207], a[152:155], a[56:59], v[204:207]
    v_exp_f32 v194, v194
    v_mfma_f32_16x16x32_bf16 v[204:207], a[148:151], a[52:55], v[204:207]
    v_mul_f32 v195, s44, v195
    v_cvt_pk_bf16_f32 v192, v192, v193
    v_mfma_f32_16x16x32_bf16 v[204:207], a[144:147], a[48:51], v[204:207]
    v_exp_f32 v195, v195
    v_smfmac_f32_16x16x64_bf16 a[224:227], a[244:247], v[208:215], v253
    v_mul_f32 v196, s44, v196
    v_mfma_f32_16x16x32_bf16 v[32:35], a[192:195], v[212:215], v[32:35]
    ds_read_b64_tr_b16 a[174:175], v245 offset:12288
    v_mul_f32 v197, s44, v197
    v_mfma_f32_16x16x32_bf16 v[36:39], a[196:199], v[212:215], v[36:39]
    v_exp_f32 v196, v196
    v_cvt_pk_bf16_f32 v193, v194, v195
    v_mfma_f32_16x16x32_bf16 v[40:43], a[200:203], v[212:215], v[40:43]
    v_exp_f32 v197, v197
    v_mfma_f32_16x16x32_bf16 v[44:47], a[204:207], v[212:215], v[44:47]
    v_mul_f32 v198, s44, v198
    v_mul_f32 v199, s44, v199
    v_mfma_f32_16x16x32_bf16 v[48:51], a[208:211], v[212:215], v[48:51]
    v_exp_f32 v198, v198
    v_mfma_f32_16x16x32_bf16 v[52:55], a[212:215], v[212:215], v[52:55]
    ds_read_b64_tr_b16 a[176:177], v242 offset:9216
    v_cvt_pk_bf16_f32 v194, v196, v197
    v_mfma_f32_16x16x32_bf16 v[56:59], a[216:219], v[212:215], v[56:59]
    buffer_load_dwordx4 v248, s[12:15], s30 offen offset:128 sc1 nt lds
    v_mfma_f32_16x16x32_bf16 v[60:63], a[220:223], v[212:215], v[60:63]
    s_addk_i32 m0, -25472
    v_exp_f32 v199, v199
    v_mfma_f32_16x16x32_bf16 v[208:211], a[128:131], a[64:67], v[232:235]
    s_addk_i32 s30, 8192
    v_mul_f32 v200, s44, v200
    v_cvt_pk_bf16_f32 v195, v198, v199
    v_mfma_f32_16x16x32_bf16 v[208:211], a[132:135], a[68:71], v[208:211]
    ds_read_b64_tr_b16 a[178:179], v242 offset:13312
    v_mul_f32 v201, s44, v201
    v_mfma_f32_16x16x32_bf16 v[208:211], a[136:139], a[72:75], v[208:211]
    v_exp_f32 v200, v200
    v_mfma_f32_16x16x32_bf16 v[208:211], a[140:143], a[76:79], v[208:211]
    v_exp_f32 v201, v201
    v_mfma_f32_16x16x32_bf16 v[212:215], a[156:159], a[76:79], v[232:235]
    ds_read_b64_tr_b16 a[180:181], v243 offset:9216
    v_mul_f32 v202, s44, v202
    v_mfma_f32_16x16x32_bf16 v[212:215], a[152:155], a[72:75], v[212:215]
    v_exp_f32 v202, v202
    v_mfma_f32_16x16x32_bf16 v[212:215], a[148:151], a[68:71], v[212:215]
    v_mul_f32 v203, s44, v203
    v_cvt_pk_bf16_f32 v196, v200, v201
    v_mfma_f32_16x16x32_bf16 v[212:215], a[144:147], a[64:67], v[212:215]
    v_exp_f32 v203, v203
    v_mfma_f32_16x16x32_bf16 v[64:67], a[192:195], v[192:195], v[64:67]
    v_mul_f32 v204, s44, v204
    v_mul_f32 v205, s44, v205
    v_mfma_f32_16x16x32_bf16 v[68:71], a[196:199], v[192:195], v[68:71]
    v_exp_f32 v204, v204
    v_mfma_f32_16x16x32_bf16 v[72:75], a[200:203], v[192:195], v[72:75]
    ds_read_b64_tr_b16 a[182:183], v243 offset:13312
    v_cvt_pk_bf16_f32 v197, v202, v203
    v_mfma_f32_16x16x32_bf16 v[76:79], a[204:207], v[192:195], v[76:79]
    v_exp_f32 v205, v205
    v_mfma_f32_16x16x32_bf16 v[80:83], a[208:211], v[192:195], v[80:83]
    v_mul_f32 v206, s44, v206
    v_mul_f32 v207, s44, v207
    v_mfma_f32_16x16x32_bf16 v[84:87], a[212:215], v[192:195], v[84:87]
    v_exp_f32 v206, v206
    v_mfma_f32_16x16x32_bf16 v[88:91], a[216:219], v[192:195], v[88:91]
    ds_read_b64_tr_b16 a[184:185], v244 offset:9216
    v_cvt_pk_bf16_f32 v198, v204, v205
    v_mfma_f32_16x16x32_bf16 v[92:95], a[220:223], v[192:195], v[92:95]
    v_exp_f32 v207, v207
    v_mfma_f32_16x16x32_bf16 v[200:203], a[128:131], a[80:83], v[236:239]
    v_mul_f32 v208, s44, v208
    v_cvt_pk_bf16_f32 v199, v206, v207
    v_mfma_f32_16x16x32_bf16 v[200:203], a[132:135], a[84:87], v[200:203]
    v_exp_f32 v208, v208
    v_mfma_f32_16x16x32_bf16 v[200:203], a[136:139], a[88:91], v[200:203]
    ds_read_b64_tr_b16 a[186:187], v244 offset:13312
    v_mul_f32 v209, s44, v209
    v_mfma_f32_16x16x32_bf16 v[200:203], a[140:143], a[92:95], v[200:203]
    v_exp_f32 v209, v209
    v_mfma_f32_16x16x32_bf16 v[204:207], a[156:159], a[92:95], v[236:239]
    v_mul_f32 v210, s44, v210
    v_mul_f32 v211, s44, v211
    v_mfma_f32_16x16x32_bf16 v[204:207], a[152:155], a[88:91], v[204:207]
    v_exp_f32 v210, v210
    v_mfma_f32_16x16x32_bf16 v[204:207], a[148:151], a[84:87], v[204:207]
    ds_read_b64_tr_b16 a[188:189], v245 offset:9216
    v_cvt_pk_bf16_f32 v208, v208, v209
    v_mfma_f32_16x16x32_bf16 v[204:207], a[144:147], a[80:83], v[204:207]
    v_exp_f32 v211, v211
    v_smfmac_f32_16x16x64_bf16 a[228:231], a[244:247], v[192:199], v253
    v_mul_f32 v212, s44, v212
    v_mfma_f32_16x16x32_bf16 v[96:99], a[192:195], v[196:199], v[96:99]
    v_exp_f32 v212, v212
    v_mfma_f32_16x16x32_bf16 v[100:103], a[196:199], v[196:199], v[100:103]
    v_mul_f32 v213, s44, v213
    v_cvt_pk_bf16_f32 v209, v210, v211
    v_mfma_f32_16x16x32_bf16 v[104:107], a[200:203], v[196:199], v[104:107]
    ds_read_b64_tr_b16 a[190:191], v245 offset:13312
    v_mul_f32 v214, s44, v214
    v_mfma_f32_16x16x32_bf16 v[108:111], a[204:207], v[196:199], v[108:111]
    v_exp_f32 v213, v213
    v_mfma_f32_16x16x32_bf16 v[112:115], a[208:211], v[196:199], v[112:115]
    v_exp_f32 v214, v214
    v_mfma_f32_16x16x32_bf16 v[116:119], a[212:215], v[196:199], v[116:119]
    v_mul_f32 v215, s44, v215
    v_cvt_pk_bf16_f32 v210, v212, v213
    v_mfma_f32_16x16x32_bf16 v[120:123], a[216:219], v[196:199], v[120:123]
    v_exp_f32 v215, v215
    v_mfma_f32_16x16x32_bf16 v[124:127], a[220:223], v[196:199], v[124:127]
    s_waitcnt lgkmcnt(1)
    v_mul_f32 v200, s44, v200
    v_cvt_pk_bf16_f32 v211, v214, v215
    v_mfma_f32_16x16x32_bf16 v[192:195], a[96:99], a[0:3], v[216:219]
    s_waitcnt vmcnt(12) lgkmcnt(0)
    v_exp_f32 v200, v200
    v_mfma_f32_16x16x32_bf16 v[192:195], a[100:103], a[4:7], v[192:195]
    s_barrier
    v_mul_f32 v201, s44, v201
    v_mfma_f32_16x16x32_bf16 v[192:195], a[104:107], a[8:11], v[192:195]
    v_exp_f32 v201, v201
    v_mfma_f32_16x16x32_bf16 v[192:195], a[108:111], a[12:15], v[192:195]
    ds_read_b128 a[128:131], v240 offset:16384
    v_mul_f32 v202, s44, v202
    v_mfma_f32_16x16x32_bf16 v[196:199], a[124:127], a[12:15], v[216:219]
    buffer_load_dwordx4 v248, s[8:11], s30 offen sc1 nt lds
    v_mfma_f32_16x16x32_bf16 v[196:199], a[120:123], a[8:11], v[196:199]
    s_addk_i32 m0, 896
    v_exp_f32 v202, v202
    v_mfma_f32_16x16x32_bf16 v[196:199], a[116:119], a[4:7], v[196:199]
    ds_read_b128 a[248:251], v250 offset:0
    v_mul_f32 v203, s44, v203
    v_cvt_pk_bf16_f32 v212, v200, v201
    v_mfma_f32_16x16x32_bf16 v[196:199], a[112:115], a[0:3], v[196:199]
    ds_read_b128 a[132:135], v241 offset:16384
    v_mul_f32 v204, s44, v204
    v_mfma_f32_16x16x32_bf16 v[128:131], a[192:195], v[208:211], v[128:131]
    v_exp_f32 v203, v203
    v_mfma_f32_16x16x32_bf16 v[132:135], a[196:199], v[208:211], v[132:135]
    v_exp_f32 v204, v204
    v_mfma_f32_16x16x32_bf16 v[136:139], a[200:203], v[208:211], v[136:139]
    v_mul_f32 v205, s44, v205
    v_cvt_pk_bf16_f32 v213, v202, v203
    v_mfma_f32_16x16x32_bf16 v[140:143], a[204:207], v[208:211], v[140:143]
    ds_read_b128 a[136:139], v240 offset:17408
    v_mul_f32 v206, s44, v206
    v_mfma_f32_16x16x32_bf16 v[144:147], a[208:211], v[208:211], v[144:147]
    v_exp_f32 v205, v205
    v_mfma_f32_16x16x32_bf16 v[148:151], a[212:215], v[208:211], v[148:151]
    s_waitcnt lgkmcnt(2)
    ds_read_b128 a[140:143], v241 offset:17408
    buffer_store_dwordx4 a[248:251], v248, s[16:19], s31 offen offset:0 sc1
    v_mul_f32 v207, s44, v207
    v_mfma_f32_16x16x32_bf16 v[152:155], a[216:219], v[208:211], v[152:155]
    v_exp_f32 v206, v206
    v_cvt_pk_bf16_f32 v214, v204, v205
    v_mfma_f32_16x16x32_bf16 v[156:159], a[220:223], v[208:211], v[156:159]
    ds_read_b128 a[252:255], v250 offset:2176
    v_mul_f32 v192, s44, v192
    v_mfma_f32_16x16x32_bf16 v[200:203], a[96:99], a[16:19], v[220:223]
    v_exp_f32 v207, v207
    v_mfma_f32_16x16x32_bf16 v[200:203], a[100:103], a[20:23], v[200:203]
    ds_read_b128 a[144:147], v240 offset:20480
    v_cvt_pk_bf16_f32 v215, v206, v207
    v_mfma_f32_16x16x32_bf16 v[200:203], a[104:107], a[24:27], v[200:203]
    buffer_load_dwordx4 v248, s[8:11], s30 offen offset:128 sc1 nt lds
    v_exp_f32 v192, v192
    v_mul_f32 v193, s44, v193
    v_mfma_f32_16x16x32_bf16 v[200:203], a[108:111], a[28:31], v[200:203]
    s_addk_i32 m0, 31872
    ds_read_b128 a[148:151], v241 offset:20480
    v_mul_f32 v194, s44, v194
    v_mfma_f32_16x16x32_bf16 v[204:207], a[124:127], a[28:31], v[220:223]
    v_exp_f32 v193, v193
    v_mfma_f32_16x16x32_bf16 v[204:207], a[120:123], a[24:27], v[204:207]
    v_exp_f32 v194, v194
    v_mfma_f32_16x16x32_bf16 v[204:207], a[116:119], a[20:23], v[204:207]
    s_waitcnt lgkmcnt(2)
    buffer_store_dwordx4 a[252:255], v248, s[16:19], s31 offen offset:2048 sc1
    v_mul_f32 v195, s44, v195
    v_cvt_pk_bf16_f32 v192, v192, v193
    v_mfma_f32_16x16x32_bf16 v[204:207], a[112:115], a[16:19], v[204:207]
    ds_read_b128 a[152:155], v240 offset:21504
    v_mul_f32 v196, s44, v196
    v_smfmac_f32_16x16x64_bf16 a[232:235], a[244:247], v[208:215], v253
    ds_read_b128 a[248:251], v250 offset:128
    v_exp_f32 v195, v195
    v_mfma_f32_16x16x32_bf16 v[160:163], a[192:195], v[212:215], v[160:163]
    ds_read_b128 a[156:159], v241 offset:21504
    v_mul_f32 v197, s44, v197
    v_mfma_f32_16x16x32_bf16 v[164:167], a[196:199], v[212:215], v[164:167]
    v_exp_f32 v196, v196
    v_cvt_pk_bf16_f32 v193, v194, v195
    v_mfma_f32_16x16x32_bf16 v[168:171], a[200:203], v[212:215], v[168:171]
    v_exp_f32 v197, v197
    v_mfma_f32_16x16x32_bf16 v[172:175], a[204:207], v[212:215], v[172:175]
    ds_read_b64_tr_b16 a[192:193], v242 offset:16384
    v_mul_f32 v198, s44, v198
    v_mfma_f32_16x16x32_bf16 v[176:179], a[208:211], v[212:215], v[176:179]
    v_exp_f32 v198, v198
    v_mfma_f32_16x16x32_bf16 v[180:183], a[212:215], v[212:215], v[180:183]
    v_mul_f32 v199, s44, v199
    v_cvt_pk_bf16_f32 v194, v196, v197
    v_mfma_f32_16x16x32_bf16 v[184:187], a[216:219], v[212:215], v[184:187]
    s_waitcnt lgkmcnt(2)
    buffer_store_dwordx4 a[248:251], v248, s[16:19], s31 offen offset:128 sc1
    v_exp_f32 v199, v199
    v_mfma_f32_16x16x32_bf16 v[188:191], a[220:223], v[212:215], v[188:191]
    ds_read_b64_tr_b16 a[194:195], v242 offset:20480
    v_mul_f32 v200, s44, v200
    v_mfma_f32_16x16x32_bf16 v[208:211], a[96:99], a[32:35], v[224:227]
    ds_read_b128 a[252:255], v250 offset:2304
    v_cvt_pk_bf16_f32 v195, v198, v199
    v_mfma_f32_16x16x32_bf16 v[208:211], a[100:103], a[36:39], v[208:211]
    v_exp_f32 v200, v200
    v_mfma_f32_16x16x32_bf16 v[208:211], a[104:107], a[40:43], v[208:211]
    ds_read_b64_tr_b16 a[196:197], v243 offset:16384
    v_mul_f32 v201, s44, v201
    v_mfma_f32_16x16x32_bf16 v[208:211], a[108:111], a[44:47], v[208:211]
    v_exp_f32 v201, v201
    v_mfma_f32_16x16x32_bf16 v[212:215], a[124:127], a[44:47], v[224:227]
    v_mul_f32 v202, s44, v202
    v_mul_f32 v203, s44, v203
    v_mfma_f32_16x16x32_bf16 v[212:215], a[120:123], a[40:43], v[212:215]
    v_exp_f32 v202, v202
    v_mfma_f32_16x16x32_bf16 v[212:215], a[116:119], a[36:39], v[212:215]
    v_cvt_pk_bf16_f32 v196, v200, v201
    v_mul_f32 v204, s44, v204
    v_mfma_f32_16x16x32_bf16 v[212:215], a[112:115], a[32:35], v[212:215]
    s_waitcnt lgkmcnt(1)
    buffer_store_dwordx4 a[252:255], v248, s[16:19], s31 offen offset:2176 sc1
    v_exp_f32 v203, v203
    v_mfma_f32_16x16x32_bf16 v[0:3], a[160:163], v[192:195], v[0:3]
    ds_read_b64_tr_b16 a[198:199], v243 offset:20480
    v_mul_f32 v205, s44, v205
    v_mfma_f32_16x16x32_bf16 v[4:7], a[164:167], v[192:195], v[4:7]
    v_exp_f32 v204, v204
    v_mfma_f32_16x16x32_bf16 v[8:11], a[168:171], v[192:195], v[8:11]
    v_cvt_pk_bf16_f32 v197, v202, v203
    v_mul_f32 v206, s44, v206
    v_mfma_f32_16x16x32_bf16 v[12:15], a[172:175], v[192:195], v[12:15]
    v_exp_f32 v205, v205
    v_mfma_f32_16x16x32_bf16 v[16:19], a[176:179], v[192:195], v[16:19]
    ds_read_b64_tr_b16 a[200:201], v244 offset:16384
    v_mul_f32 v207, s44, v207
    v_mfma_f32_16x16x32_bf16 v[20:23], a[180:183], v[192:195], v[20:23]
    v_exp_f32 v206, v206
    v_mfma_f32_16x16x32_bf16 v[24:27], a[184:187], v[192:195], v[24:27]
    v_cvt_pk_bf16_f32 v198, v204, v205
    v_mul_f32 v208, s44, v208
    v_mfma_f32_16x16x32_bf16 v[28:31], a[188:191], v[192:195], v[28:31]
    v_exp_f32 v207, v207
    v_mfma_f32_16x16x32_bf16 v[200:203], a[96:99], a[48:51], v[228:231]
    ds_read_b64_tr_b16 a[202:203], v244 offset:20480
    v_cvt_pk_bf16_f32 v199, v206, v207
    v_mfma_f32_16x16x32_bf16 v[200:203], a[100:103], a[52:55], v[200:203]
    v_exp_f32 v208, v208
    v_mfma_f32_16x16x32_bf16 v[200:203], a[104:107], a[56:59], v[200:203]
    v_mul_f32 v209, s44, v209
    v_mul_f32 v210, s44, v210
    v_mfma_f32_16x16x32_bf16 v[200:203], a[108:111], a[60:63], v[200:203]
    buffer_load_dwordx4 v248, s[12:15], s30 offen sc1 nt lds
    v_mfma_f32_16x16x32_bf16 v[204:207], a[124:127], a[60:63], v[228:231]
    s_addk_i32 m0, 896
    v_exp_f32 v209, v209
    v_mfma_f32_16x16x32_bf16 v[204:207], a[120:123], a[56:59], v[204:207]
    ds_read_b64_tr_b16 a[204:205], v245 offset:16384
    v_mul_f32 v211, s44, v211
    v_mfma_f32_16x16x32_bf16 v[204:207], a[116:119], a[52:55], v[204:207]
    v_exp_f32 v210, v210
    v_cvt_pk_bf16_f32 v208, v208, v209
    v_mfma_f32_16x16x32_bf16 v[204:207], a[112:115], a[48:51], v[204:207]
    v_exp_f32 v211, v211
    v_smfmac_f32_16x16x64_bf16 a[224:227], a[244:247], v[192:199], v253
    v_mul_f32 v212, s44, v212
    v_mfma_f32_16x16x32_bf16 v[32:35], a[160:163], v[196:199], v[32:35]
    ds_read_b64_tr_b16 a[206:207], v245 offset:20480
    v_mul_f32 v213, s44, v213
    v_mfma_f32_16x16x32_bf16 v[36:39], a[164:167], v[196:199], v[36:39]
    v_exp_f32 v212, v212
    v_cvt_pk_bf16_f32 v209, v210, v211
    v_mfma_f32_16x16x32_bf16 v[40:43], a[168:171], v[196:199], v[40:43]
    v_exp_f32 v213, v213
    v_mfma_f32_16x16x32_bf16 v[44:47], a[172:175], v[196:199], v[44:47]
    v_mul_f32 v214, s44, v214
    v_mul_f32 v215, s44, v215
    v_mfma_f32_16x16x32_bf16 v[48:51], a[176:179], v[196:199], v[48:51]
    v_exp_f32 v214, v214
    v_mfma_f32_16x16x32_bf16 v[52:55], a[180:183], v[196:199], v[52:55]
    ds_read_b64_tr_b16 a[208:209], v242 offset:17408
    v_cvt_pk_bf16_f32 v210, v212, v213
    v_mfma_f32_16x16x32_bf16 v[56:59], a[184:187], v[196:199], v[56:59]
    buffer_load_dwordx4 v248, s[12:15], s30 offen offset:128 sc1 nt lds
    v_mfma_f32_16x16x32_bf16 v[60:63], a[188:191], v[196:199], v[60:63]
    s_addk_i32 m0, -25472
    v_exp_f32 v215, v215
    v_mfma_f32_16x16x32_bf16 v[192:195], a[96:99], a[64:67], v[232:235]
    s_addk_i32 s30, 8192
    v_mul_f32 v200, s44, v200
    v_cvt_pk_bf16_f32 v211, v214, v215
    v_mfma_f32_16x16x32_bf16 v[192:195], a[100:103], a[68:71], v[192:195]
    ds_read_b64_tr_b16 a[210:211], v242 offset:21504
    v_mul_f32 v201, s44, v201
    v_mfma_f32_16x16x32_bf16 v[192:195], a[104:107], a[72:75], v[192:195]
    v_exp_f32 v200, v200
    v_mfma_f32_16x16x32_bf16 v[192:195], a[108:111], a[76:79], v[192:195]
    v_exp_f32 v201, v201
    v_mfma_f32_16x16x32_bf16 v[196:199], a[124:127], a[76:79], v[232:235]
    ds_read_b64_tr_b16 a[212:213], v243 offset:17408
    v_mul_f32 v202, s44, v202
    v_mfma_f32_16x16x32_bf16 v[196:199], a[120:123], a[72:75], v[196:199]
    v_exp_f32 v202, v202
    v_mfma_f32_16x16x32_bf16 v[196:199], a[116:119], a[68:71], v[196:199]
    v_mul_f32 v203, s44, v203
    v_cvt_pk_bf16_f32 v212, v200, v201
    v_mfma_f32_16x16x32_bf16 v[196:199], a[112:115], a[64:67], v[196:199]
    v_exp_f32 v203, v203
    v_mfma_f32_16x16x32_bf16 v[64:67], a[160:163], v[208:211], v[64:67]
    v_mul_f32 v204, s44, v204
    v_mul_f32 v205, s44, v205
    v_mfma_f32_16x16x32_bf16 v[68:71], a[164:167], v[208:211], v[68:71]
    v_exp_f32 v204, v204
    v_mfma_f32_16x16x32_bf16 v[72:75], a[168:171], v[208:211], v[72:75]
    ds_read_b64_tr_b16 a[214:215], v243 offset:21504
    v_cvt_pk_bf16_f32 v213, v202, v203
    v_mfma_f32_16x16x32_bf16 v[76:79], a[172:175], v[208:211], v[76:79]
    v_exp_f32 v205, v205
    v_mfma_f32_16x16x32_bf16 v[80:83], a[176:179], v[208:211], v[80:83]
    v_mul_f32 v206, s44, v206
    v_mul_f32 v207, s44, v207
    v_mfma_f32_16x16x32_bf16 v[84:87], a[180:183], v[208:211], v[84:87]
    v_exp_f32 v206, v206
    v_mfma_f32_16x16x32_bf16 v[88:91], a[184:187], v[208:211], v[88:91]
    ds_read_b64_tr_b16 a[216:217], v244 offset:17408
    v_cvt_pk_bf16_f32 v214, v204, v205
    v_mfma_f32_16x16x32_bf16 v[92:95], a[188:191], v[208:211], v[92:95]
    v_exp_f32 v207, v207
    v_mfma_f32_16x16x32_bf16 v[200:203], a[96:99], a[80:83], v[236:239]
    v_mul_f32 v192, s44, v192
    v_cvt_pk_bf16_f32 v215, v206, v207
    v_mfma_f32_16x16x32_bf16 v[200:203], a[100:103], a[84:87], v[200:203]
    v_exp_f32 v192, v192
    v_mfma_f32_16x16x32_bf16 v[200:203], a[104:107], a[88:91], v[200:203]
    ds_read_b64_tr_b16 a[218:219], v244 offset:21504
    v_mul_f32 v193, s44, v193
    v_mfma_f32_16x16x32_bf16 v[200:203], a[108:111], a[92:95], v[200:203]
    v_exp_f32 v193, v193
    v_mfma_f32_16x16x32_bf16 v[204:207], a[124:127], a[92:95], v[236:239]
    v_mul_f32 v194, s44, v194
    v_mul_f32 v195, s44, v195
    v_mfma_f32_16x16x32_bf16 v[204:207], a[120:123], a[88:91], v[204:207]
    v_exp_f32 v194, v194
    v_mfma_f32_16x16x32_bf16 v[204:207], a[116:119], a[84:87], v[204:207]
    ds_read_b64_tr_b16 a[220:221], v245 offset:17408
    v_cvt_pk_bf16_f32 v192, v192, v193
    v_mfma_f32_16x16x32_bf16 v[204:207], a[112:115], a[80:83], v[204:207]
    v_exp_f32 v195, v195
    v_smfmac_f32_16x16x64_bf16 a[228:231], a[244:247], v[208:215], v253
    v_mul_f32 v196, s44, v196
    v_mfma_f32_16x16x32_bf16 v[96:99], a[160:163], v[212:215], v[96:99]
    v_exp_f32 v196, v196
    v_mfma_f32_16x16x32_bf16 v[100:103], a[164:167], v[212:215], v[100:103]
    v_mul_f32 v197, s44, v197
    v_cvt_pk_bf16_f32 v193, v194, v195
    v_mfma_f32_16x16x32_bf16 v[104:107], a[168:171], v[212:215], v[104:107]
    ds_read_b64_tr_b16 a[222:223], v245 offset:21504
    v_mul_f32 v198, s44, v198
    v_mfma_f32_16x16x32_bf16 v[108:111], a[172:175], v[212:215], v[108:111]
    v_exp_f32 v197, v197
    v_mfma_f32_16x16x32_bf16 v[112:115], a[176:179], v[212:215], v[112:115]
    v_exp_f32 v198, v198
    v_mfma_f32_16x16x32_bf16 v[116:119], a[180:183], v[212:215], v[116:119]
    v_mul_f32 v199, s44, v199
    v_cvt_pk_bf16_f32 v194, v196, v197
    v_mfma_f32_16x16x32_bf16 v[120:123], a[184:187], v[212:215], v[120:123]
    v_exp_f32 v199, v199
    v_mfma_f32_16x16x32_bf16 v[124:127], a[188:191], v[212:215], v[124:127]
    v_mul_f32 v200, s44, v200
    v_cvt_pk_bf16_f32 v195, v198, v199
    v_mfma_f32_16x16x32_bf16 v[208:211], a[128:131], a[0:3], v[216:219]
    s_waitcnt vmcnt(12) lgkmcnt(0)
    v_exp_f32 v200, v200
    v_mfma_f32_16x16x32_bf16 v[208:211], a[132:135], a[4:7], v[208:211]
    s_barrier
    v_mul_f32 v201, s44, v201
    v_mfma_f32_16x16x32_bf16 v[208:211], a[136:139], a[8:11], v[208:211]
    v_exp_f32 v201, v201
    v_mfma_f32_16x16x32_bf16 v[208:211], a[140:143], a[12:15], v[208:211]
    ds_read_b128 a[96:99], v240 offset:24576
    v_mul_f32 v202, s44, v202
    v_mfma_f32_16x16x32_bf16 v[212:215], a[156:159], a[12:15], v[216:219]
    buffer_load_dwordx4 v248, s[8:11], s30 offen sc1 nt lds
    v_mfma_f32_16x16x32_bf16 v[212:215], a[152:155], a[8:11], v[212:215]
    s_addk_i32 m0, 896
    v_exp_f32 v202, v202
    v_mfma_f32_16x16x32_bf16 v[212:215], a[148:151], a[4:7], v[212:215]
    v_mul_f32 v203, s44, v203
    v_cvt_pk_bf16_f32 v196, v200, v201
    v_mfma_f32_16x16x32_bf16 v[212:215], a[144:147], a[0:3], v[212:215]
    ds_read_b128 a[100:103], v241 offset:24576
    v_mul_f32 v204, s44, v204
    v_mfma_f32_16x16x32_bf16 v[128:131], a[160:163], v[192:195], v[128:131]
    v_exp_f32 v203, v203
    v_mfma_f32_16x16x32_bf16 v[132:135], a[164:167], v[192:195], v[132:135]
    v_exp_f32 v204, v204
    v_mfma_f32_16x16x32_bf16 v[136:139], a[168:171], v[192:195], v[136:139]
    v_mul_f32 v205, s44, v205
    v_cvt_pk_bf16_f32 v197, v202, v203
    v_mfma_f32_16x16x32_bf16 v[140:143], a[172:175], v[192:195], v[140:143]
    ds_read_b128 a[104:107], v240 offset:25600
    v_mul_f32 v206, s44, v206
    v_mfma_f32_16x16x32_bf16 v[144:147], a[176:179], v[192:195], v[144:147]
    v_exp_f32 v205, v205
    v_mfma_f32_16x16x32_bf16 v[148:151], a[180:183], v[192:195], v[148:151]
    ds_read_b128 a[108:111], v241 offset:25600
    v_mul_f32 v207, s44, v207
    v_mfma_f32_16x16x32_bf16 v[152:155], a[184:187], v[192:195], v[152:155]
    v_exp_f32 v206, v206
    v_cvt_pk_bf16_f32 v198, v204, v205
    v_mfma_f32_16x16x32_bf16 v[156:159], a[188:191], v[192:195], v[156:159]
    v_exp_f32 v207, v207
    v_mfma_f32_16x16x32_bf16 v[200:203], a[128:131], a[16:19], v[220:223]
    ds_read_b128 a[112:115], v240 offset:28672
    v_mul_f32 v208, s44, v208
    v_mfma_f32_16x16x32_bf16 v[200:203], a[132:135], a[20:23], v[200:203]
    buffer_load_dwordx4 v248, s[8:11], s30 offen offset:128 sc1 nt lds
    v_mfma_f32_16x16x32_bf16 v[200:203], a[136:139], a[24:27], v[200:203]
    s_addk_i32 m0, 31872
    v_cvt_pk_bf16_f32 v199, v206, v207
    v_mul_f32 v209, s44, v209
    v_exp_f32 v208, v208
    v_mfma_f32_16x16x32_bf16 v[200:203], a[140:143], a[28:31], v[200:203]
    ds_read_b128 a[116:119], v241 offset:28672
    v_mul_f32 v210, s44, v210
    v_mfma_f32_16x16x32_bf16 v[204:207], a[156:159], a[28:31], v[220:223]
    v_exp_f32 v209, v209
    v_mfma_f32_16x16x32_bf16 v[204:207], a[152:155], a[24:27], v[204:207]
    v_exp_f32 v210, v210
    v_mfma_f32_16x16x32_bf16 v[204:207], a[148:151], a[20:23], v[204:207]
    v_mul_f32 v211, s44, v211
    v_cvt_pk_bf16_f32 v208, v208, v209
    v_mfma_f32_16x16x32_bf16 v[204:207], a[144:147], a[16:19], v[204:207]
    ds_read_b128 a[120:123], v240 offset:29696
    v_mul_f32 v212, s44, v212
    v_smfmac_f32_16x16x64_bf16 a[232:235], a[244:247], v[192:199], v253
    ds_read_b128 a[124:127], v241 offset:29696
    v_exp_f32 v211, v211
    v_mfma_f32_16x16x32_bf16 v[160:163], a[160:163], v[196:199], v[160:163]
    v_exp_f32 v212, v212
    v_mfma_f32_16x16x32_bf16 v[164:167], a[164:167], v[196:199], v[164:167]
    v_mul_f32 v213, s44, v213
    v_cvt_pk_bf16_f32 v209, v210, v211
    v_mfma_f32_16x16x32_bf16 v[168:171], a[168:171], v[196:199], v[168:171]
    v_exp_f32 v213, v213
    v_mfma_f32_16x16x32_bf16 v[172:175], a[172:175], v[196:199], v[172:175]
    ds_read_b64_tr_b16 a[160:161], v242 offset:24576
    v_mul_f32 v214, s44, v214
    v_mfma_f32_16x16x32_bf16 v[176:179], a[176:179], v[196:199], v[176:179]
    v_exp_f32 v214, v214
    v_mfma_f32_16x16x32_bf16 v[180:183], a[180:183], v[196:199], v[180:183]
    v_mul_f32 v215, s44, v215
    v_cvt_pk_bf16_f32 v210, v212, v213
    v_mfma_f32_16x16x32_bf16 v[184:187], a[184:187], v[196:199], v[184:187]
    v_exp_f32 v215, v215
    v_mfma_f32_16x16x32_bf16 v[188:191], a[188:191], v[196:199], v[188:191]
    ds_read_b64_tr_b16 a[162:163], v242 offset:28672
    v_mul_f32 v200, s44, v200
    v_mfma_f32_16x16x32_bf16 v[192:195], a[128:131], a[32:35], v[224:227]
    v_cvt_pk_bf16_f32 v211, v214, v215
    v_mul_f32 v201, s44, v201
    v_mfma_f32_16x16x32_bf16 v[192:195], a[132:135], a[36:39], v[192:195]
    v_exp_f32 v200, v200
    v_mfma_f32_16x16x32_bf16 v[192:195], a[136:139], a[40:43], v[192:195]
    ds_read_b64_tr_b16 a[164:165], v243 offset:24576
    v_mul_f32 v202, s44, v202
    v_mfma_f32_16x16x32_bf16 v[192:195], a[140:143], a[44:47], v[192:195]
    v_exp_f32 v201, v201
    v_mfma_f32_16x16x32_bf16 v[196:199], a[156:159], a[44:47], v[224:227]
    v_exp_f32 v202, v202
    v_mfma_f32_16x16x32_bf16 v[196:199], a[152:155], a[40:43], v[196:199]
    v_mul_f32 v203, s44, v203
    v_cvt_pk_bf16_f32 v212, v200, v201
    v_mfma_f32_16x16x32_bf16 v[196:199], a[148:151], a[36:39], v[196:199]
L_pad11:
    s_cbranch_execz L_padend0
    v_exp_f32 v203, v203
    v_mfma_f32_16x16x32_bf16 v[196:199], a[144:147], a[32:35], v[196:199]
    ds_read_b64_tr_b16 a[166:167], v243 offset:28672
    v_mul_f32 v204, s44, v204
    v_mfma_f32_16x16x32_bf16 v[0:3], a[192:195], v[208:211], v[0:3]
    v_exp_f32 v204, v204
    v_mfma_f32_16x16x32_bf16 v[4:7], a[196:199], v[208:211], v[4:7]
    v_mul_f32 v205, s44, v205
    v_cvt_pk_bf16_f32 v213, v202, v203
    v_mfma_f32_16x16x32_bf16 v[8:11], a[200:203], v[208:211], v[8:11]
    v_exp_f32 v205, v205
    v_mfma_f32_16x16x32_bf16 v[12:15], a[204:207], v[208:211], v[12:15]
    ds_read_b64_tr_b16 a[168:169], v244 offset:24576
    v_mul_f32 v206, s44, v206
    v_mfma_f32_16x16x32_bf16 v[16:19], a[208:211], v[208:211], v[16:19]
    v_exp_f32 v206, v206
    v_mfma_f32_16x16x32_bf16 v[20:23], a[212:215], v[208:211], v[20:23]
    v_mul_f32 v207, s44, v207
    v_cvt_pk_bf16_f32 v214, v204, v205
    v_mfma_f32_16x16x32_bf16 v[24:27], a[216:219], v[208:211], v[24:27]
    v_exp_f32 v207, v207
    v_mfma_f32_16x16x32_bf16 v[28:31], a[220:223], v[208:211], v[28:31]
    ds_read_b64_tr_b16 a[170:171], v244 offset:28672
    v_mul_f32 v192, s44, v192
    v_mfma_f32_16x16x32_bf16 v[200:203], a[128:131], a[48:51], v[228:231]
    v_cvt_pk_bf16_f32 v215, v206, v207
    v_mul_f32 v193, s44, v193
    v_mfma_f32_16x16x32_bf16 v[200:203], a[132:135], a[52:55], v[200:203]
    v_exp_f32 v192, v192
    v_mfma_f32_16x16x32_bf16 v[200:203], a[136:139], a[56:59], v[200:203]
    buffer_load_dwordx4 v248, s[12:15], s30 offen sc1 nt lds
    v_mfma_f32_16x16x32_bf16 v[200:203], a[140:143], a[60:63], v[200:203]
    s_addk_i32 m0, 896
    v_exp_f32 v193, v193
    v_mfma_f32_16x16x32_bf16 v[204:207], a[156:159], a[60:63], v[228:231]
    ds_read_b64_tr_b16 a[172:173], v245 offset:24576
    v_mul_f32 v194, s44, v194
    v_mfma_f32_16x16x32_bf16 v[204:207], a[152:155], a[56:59], v[204:207]
    v_exp_f32 v194, v194
    v_mfma_f32_16x16x32_bf16 v[204:207], a[148:151], a[52:55], v[204:207]
    v_mul_f32 v195, s44, v195
    v_cvt_pk_bf16_f32 v192, v192, v193
    v_mfma_f32_16x16x32_bf16 v[204:207], a[144:147], a[48:51], v[204:207]
    v_exp_f32 v195, v195
    v_smfmac_f32_16x16x64_bf16 a[224:227], a[244:247], v[208:215], v253
    v_mul_f32 v196, s44, v196
    v_mfma_f32_16x16x32_bf16 v[32:35], a[192:195], v[212:215], v[32:35]
    ds_read_b64_tr_b16 a[174:175], v245 offset:28672
    v_mul_f32 v197, s44, v197
    v_mfma_f32_16x16x32_bf16 v[36:39], a[196:199], v[212:215], v[36:39]
    v_exp_f32 v196, v196
    v_cvt_pk_bf16_f32 v193, v194, v195
    v_mfma_f32_16x16x32_bf16 v[40:43], a[200:203], v[212:215], v[40:43]
    v_exp_f32 v197, v197
    v_mfma_f32_16x16x32_bf16 v[44:47], a[204:207], v[212:215], v[44:47]
    v_mul_f32 v198, s44, v198
    v_mul_f32 v199, s44, v199
    v_mfma_f32_16x16x32_bf16 v[48:51], a[208:211], v[212:215], v[48:51]
    v_exp_f32 v198, v198
    v_mfma_f32_16x16x32_bf16 v[52:55], a[212:215], v[212:215], v[52:55]
    ds_read_b64_tr_b16 a[176:177], v242 offset:25600
    v_cvt_pk_bf16_f32 v194, v196, v197
    v_mfma_f32_16x16x32_bf16 v[56:59], a[216:219], v[212:215], v[56:59]
    buffer_load_dwordx4 v248, s[12:15], s30 offen offset:128 sc1 nt lds
    v_mfma_f32_16x16x32_bf16 v[60:63], a[220:223], v[212:215], v[60:63]
    s_addk_i32 m0, -25472
    v_exp_f32 v199, v199
    v_mfma_f32_16x16x32_bf16 v[208:211], a[128:131], a[64:67], v[232:235]
    s_addk_i32 s30, 8192
    v_mul_f32 v200, s44, v200
    v_cvt_pk_bf16_f32 v195, v198, v199
    v_mfma_f32_16x16x32_bf16 v[208:211], a[132:135], a[68:71], v[208:211]
    ds_read_b64_tr_b16 a[178:179], v242 offset:29696
    v_mul_f32 v201, s44, v201
    v_mfma_f32_16x16x32_bf16 v[208:211], a[136:139], a[72:75], v[208:211]
    v_exp_f32 v200, v200
    v_mfma_f32_16x16x32_bf16 v[208:211], a[140:143], a[76:79], v[208:211]
    v_exp_f32 v201, v201
    v_mfma_f32_16x16x32_bf16 v[212:215], a[156:159], a[76:79], v[232:235]
    ds_read_b64_tr_b16 a[180:181], v243 offset:25600
    v_mul_f32 v202, s44, v202
    v_mfma_f32_16x16x32_bf16 v[212:215], a[152:155], a[72:75], v[212:215]
    v_exp_f32 v202, v202
    v_mfma_f32_16x16x32_bf16 v[212:215], a[148:151], a[68:71], v[212:215]
    v_mul_f32 v203, s44, v203
    v_cvt_pk_bf16_f32 v196, v200, v201
    v_mfma_f32_16x16x32_bf16 v[212:215], a[144:147], a[64:67], v[212:215]
    v_exp_f32 v203, v203
    v_mfma_f32_16x16x32_bf16 v[64:67], a[192:195], v[192:195], v[64:67]
    v_mul_f32 v204, s44, v204
    v_mul_f32 v205, s44, v205
    v_mfma_f32_16x16x32_bf16 v[68:71], a[196:199], v[192:195], v[68:71]
    v_exp_f32 v204, v204
    v_mfma_f32_16x16x32_bf16 v[72:75], a[200:203], v[192:195], v[72:75]
    ds_read_b64_tr_b16 a[182:183], v243 offset:29696
    v_cvt_pk_bf16_f32 v197, v202, v203
    v_mfma_f32_16x16x32_bf16 v[76:79], a[204:207], v[192:195], v[76:79]
    v_exp_f32 v205, v205
    v_mfma_f32_16x16x32_bf16 v[80:83], a[208:211], v[192:195], v[80:83]
    v_mul_f32 v206, s44, v206
    v_mul_f32 v207, s44, v207
    v_mfma_f32_16x16x32_bf16 v[84:87], a[212:215], v[192:195], v[84:87]
    v_exp_f32 v206, v206
    v_mfma_f32_16x16x32_bf16 v[88:91], a[216:219], v[192:195], v[88:91]
    ds_read_b64_tr_b16 a[184:185], v244 offset:25600
    v_cvt_pk_bf16_f32 v198, v204, v205
    v_mfma_f32_16x16x32_bf16 v[92:95], a[220:223], v[192:195], v[92:95]
    v_exp_f32 v207, v207
    v_mfma_f32_16x16x32_bf16 v[200:203], a[128:131], a[80:83], v[236:239]
    v_mul_f32 v208, s44, v208
    v_cvt_pk_bf16_f32 v199, v206, v207
    v_mfma_f32_16x16x32_bf16 v[200:203], a[132:135], a[84:87], v[200:203]
    v_exp_f32 v208, v208
    v_mfma_f32_16x16x32_bf16 v[200:203], a[136:139], a[88:91], v[200:203]
    ds_read_b64_tr_b16 a[186:187], v244 offset:29696
    v_mul_f32 v209, s44, v209
    v_mfma_f32_16x16x32_bf16 v[200:203], a[140:143], a[92:95], v[200:203]
    v_exp_f32 v209, v209
    v_mfma_f32_16x16x32_bf16 v[204:207], a[156:159], a[92:95], v[236:239]
    v_mul_f32 v210, s44, v210
    v_mul_f32 v211, s44, v211
    v_mfma_f32_16x16x32_bf16 v[204:207], a[152:155], a[88:91], v[204:207]
    v_exp_f32 v210, v210
    v_mfma_f32_16x16x32_bf16 v[204:207], a[148:151], a[84:87], v[204:207]
    ds_read_b64_tr_b16 a[188:189], v245 offset:25600
    v_cvt_pk_bf16_f32 v208, v208, v209
    v_mfma_f32_16x16x32_bf16 v[204:207], a[144:147], a[80:83], v[204:207]
    v_exp_f32 v211, v211
    v_smfmac_f32_16x16x64_bf16 a[228:231], a[244:247], v[192:199], v253
    v_mul_f32 v212, s44, v212
    v_mfma_f32_16x16x32_bf16 v[96:99], a[192:195], v[196:199], v[96:99]
    v_exp_f32 v212, v212
    v_mfma_f32_16x16x32_bf16 v[100:103], a[196:199], v[196:199], v[100:103]
    v_mul_f32 v213, s44, v213
    v_cvt_pk_bf16_f32 v209, v210, v211
    v_mfma_f32_16x16x32_bf16 v[104:107], a[200:203], v[196:199], v[104:107]
    ds_read_b64_tr_b16 a[190:191], v245 offset:29696
    v_mul_f32 v214, s44, v214
    v_mfma_f32_16x16x32_bf16 v[108:111], a[204:207], v[196:199], v[108:111]
    v_exp_f32 v213, v213
    v_mfma_f32_16x16x32_bf16 v[112:115], a[208:211], v[196:199], v[112:115]
    v_exp_f32 v214, v214
    v_mfma_f32_16x16x32_bf16 v[116:119], a[212:215], v[196:199], v[116:119]
    v_mul_f32 v215, s44, v215
    v_cvt_pk_bf16_f32 v210, v212, v213
    v_mfma_f32_16x16x32_bf16 v[120:123], a[216:219], v[196:199], v[120:123]
    v_exp_f32 v215, v215
    v_mfma_f32_16x16x32_bf16 v[124:127], a[220:223], v[196:199], v[124:127]
    s_waitcnt lgkmcnt(1)
    v_mul_f32 v200, s44, v200
    v_cvt_pk_bf16_f32 v211, v214, v215
    v_mfma_f32_16x16x32_bf16 v[192:195], a[96:99], a[0:3], v[216:219]
    s_waitcnt vmcnt(12) lgkmcnt(0)
    v_exp_f32 v200, v200
    v_mfma_f32_16x16x32_bf16 v[192:195], a[100:103], a[4:7], v[192:195]
    s_barrier
    v_mul_f32 v201, s44, v201
    v_mfma_f32_16x16x32_bf16 v[192:195], a[104:107], a[8:11], v[192:195]
    v_exp_f32 v201, v201
    v_mfma_f32_16x16x32_bf16 v[192:195], a[108:111], a[12:15], v[192:195]
    ds_read_b128 a[128:131], v240 offset:0
    v_mul_f32 v202, s44, v202
    v_mfma_f32_16x16x32_bf16 v[196:199], a[124:127], a[12:15], v[216:219]
    buffer_load_dwordx4 v248, s[8:11], s30 offen sc1 nt lds
    v_mfma_f32_16x16x32_bf16 v[196:199], a[120:123], a[8:11], v[196:199]
    s_addk_i32 m0, 896
    v_exp_f32 v202, v202
    v_mfma_f32_16x16x32_bf16 v[196:199], a[116:119], a[4:7], v[196:199]
    v_mul_f32 v203, s44, v203
    v_cvt_pk_bf16_f32 v212, v200, v201
    v_mfma_f32_16x16x32_bf16 v[196:199], a[112:115], a[0:3], v[196:199]
    ds_read_b128 a[132:135], v241 offset:0
    v_mul_f32 v204, s44, v204
    v_mfma_f32_16x16x32_bf16 v[128:131], a[192:195], v[208:211], v[128:131]
    v_exp_f32 v203, v203
    v_mfma_f32_16x16x32_bf16 v[132:135], a[196:199], v[208:211], v[132:135]
    v_exp_f32 v204, v204
    v_mfma_f32_16x16x32_bf16 v[136:139], a[200:203], v[208:211], v[136:139]
    v_mul_f32 v205, s44, v205
    v_cvt_pk_bf16_f32 v213, v202, v203
    v_mfma_f32_16x16x32_bf16 v[140:143], a[204:207], v[208:211], v[140:143]
    ds_read_b128 a[136:139], v240 offset:1024
    v_mul_f32 v206, s44, v206
    v_mfma_f32_16x16x32_bf16 v[144:147], a[208:211], v[208:211], v[144:147]
    v_exp_f32 v205, v205
    v_mfma_f32_16x16x32_bf16 v[148:151], a[212:215], v[208:211], v[148:151]
    ds_read_b128 a[140:143], v241 offset:1024
    v_mul_f32 v207, s44, v207
    v_mfma_f32_16x16x32_bf16 v[152:155], a[216:219], v[208:211], v[152:155]
    v_exp_f32 v206, v206
    v_cvt_pk_bf16_f32 v214, v204, v205
    v_mfma_f32_16x16x32_bf16 v[156:159], a[220:223], v[208:211], v[156:159]
    v_exp_f32 v207, v207
    v_mfma_f32_16x16x32_bf16 v[200:203], a[96:99], a[16:19], v[220:223]
    ds_read_b128 a[144:147], v240 offset:4096
    v_mul_f32 v192, s44, v192
    v_mfma_f32_16x16x32_bf16 v[200:203], a[100:103], a[20:23], v[200:203]
    buffer_load_dwordx4 v248, s[8:11], s30 offen offset:128 sc1 nt lds
    v_mfma_f32_16x16x32_bf16 v[200:203], a[104:107], a[24:27], v[200:203]
    s_addk_i32 m0, 31872
    v_cvt_pk_bf16_f32 v215, v206, v207
    v_mul_f32 v193, s44, v193
    v_exp_f32 v192, v192
    v_mfma_f32_16x16x32_bf16 v[200:203], a[108:111], a[28:31], v[200:203]
    ds_read_b128 a[148:151], v241 offset:4096
    v_mul_f32 v194, s44, v194
    v_mfma_f32_16x16x32_bf16 v[204:207], a[124:127], a[28:31], v[220:223]
    v_exp_f32 v193, v193
    v_mfma_f32_16x16x32_bf16 v[204:207], a[120:123], a[24:27], v[204:207]
    v_exp_f32 v194, v194
    v_mfma_f32_16x16x32_bf16 v[204:207], a[116:119], a[20:23], v[204:207]
    v_mul_f32 v195, s44, v195
    v_cvt_pk_bf16_f32 v192, v192, v193
    v_mfma_f32_16x16x32_bf16 v[204:207], a[112:115], a[16:19], v[204:207]
    ds_read_b128 a[152:155], v240 offset:5120
    v_mul_f32 v196, s44, v196
    v_smfmac_f32_16x16x64_bf16 a[232:235], a[244:247], v[208:215], v253
    ds_read_b128 a[156:159], v241 offset:5120
    v_exp_f32 v195, v195
    v_mfma_f32_16x16x32_bf16 v[160:163], a[192:195], v[212:215], v[160:163]
    v_exp_f32 v196, v196
    v_mfma_f32_16x16x32_bf16 v[164:167], a[196:199], v[212:215], v[164:167]
    v_mul_f32 v197, s44, v197
    v_cvt_pk_bf16_f32 v193, v194, v195
    v_mfma_f32_16x16x32_bf16 v[168:171], a[200:203], v[212:215], v[168:171]
    v_exp_f32 v197, v197
    v_mfma_f32_16x16x32_bf16 v[172:175], a[204:207], v[212:215], v[172:175]
    ds_read_b64_tr_b16 a[192:193], v242 offset:0
    v_mul_f32 v198, s44, v198
    v_mfma_f32_16x16x32_bf16 v[176:179], a[208:211], v[212:215], v[176:179]
    v_exp_f32 v198, v198
    v_mfma_f32_16x16x32_bf16 v[180:183], a[212:215], v[212:215], v[180:183]
    v_mul_f32 v199, s44, v199
    v_cvt_pk_bf16_f32 v194, v196, v197
    v_mfma_f32_16x16x32_bf16 v[184:187], a[216:219], v[212:215], v[184:187]
    v_exp_f32 v199, v199
    v_mfma_f32_16x16x32_bf16 v[188:191], a[220:223], v[212:215], v[188:191]
    ds_read_b64_tr_b16 a[194:195], v242 offset:4096
    v_mul_f32 v200, s44, v200
    v_mfma_f32_16x16x32_bf16 v[208:211], a[96:99], a[32:35], v[224:227]
    v_cvt_pk_bf16_f32 v195, v198, v199
    v_mul_f32 v201, s44, v201
    v_mfma_f32_16x16x32_bf16 v[208:211], a[100:103], a[36:39], v[208:211]
    v_exp_f32 v200, v200
    v_mfma_f32_16x16x32_bf16 v[208:211], a[104:107], a[40:43], v[208:211]
    ds_read_b64_tr_b16 a[196:197], v243 offset:0
    v_mul_f32 v202, s44, v202
    v_mfma_f32_16x16x32_bf16 v[208:211], a[108:111], a[44:47], v[208:211]
    v_exp_f32 v201, v201
    v_mfma_f32_16x16x32_bf16 v[212:215], a[124:127], a[44:47], v[224:227]
    v_exp_f32 v202, v202
    v_mfma_f32_16x16x32_bf16 v[212:215], a[120:123], a[40:43], v[212:215]
    v_mul_f32 v203, s44, v203
    v_cvt_pk_bf16_f32 v196, v200, v201
    v_mfma_f32_16x16x32_bf16 v[212:215], a[116:119], a[36:39], v[212:215]
    v_exp_f32 v203, v203
    v_mfma_f32_16x16x32_bf16 v[212:215], a[112:115], a[32:35], v[212:215]
    ds_read_b64_tr_b16 a[198:199], v243 offset:4096
    v_mul_f32 v204, s44, v204
    v_mfma_f32_16x16x32_bf16 v[0:3], a[160:163], v[192:195], v[0:3]
    v_exp_f32 v204, v204
    v_mfma_f32_16x16x32_bf16 v[4:7], a[164:167], v[192:195], v[4:7]
    v_mul_f32 v205, s44, v205
    v_cvt_pk_bf16_f32 v197, v202, v203
    v_mfma_f32_16x16x32_bf16 v[8:11], a[168:171], v[192:195], v[8:11]
    v_exp_f32 v205, v205
    v_mfma_f32_16x16x32_bf16 v[12:15], a[172:175], v[192:195], v[12:15]
    ds_read_b64_tr_b16 a[200:201], v244 offset:0
    v_mul_f32 v206, s44, v206
    v_mfma_f32_16x16x32_bf16 v[16:19], a[176:179], v[192:195], v[16:19]
    v_exp_f32 v206, v206
    v_mfma_f32_16x16x32_bf16 v[20:23], a[180:183], v[192:195], v[20:23]
    v_mul_f32 v207, s44, v207
    v_cvt_pk_bf16_f32 v198, v204, v205
    v_mfma_f32_16x16x32_bf16 v[24:27], a[184:187], v[192:195], v[24:27]
    v_exp_f32 v207, v207
    v_mfma_f32_16x16x32_bf16 v[28:31], a[188:191], v[192:195], v[28:31]
    ds_read_b64_tr_b16 a[202:203], v244 offset:4096
    v_mul_f32 v208, s44, v208
    v_mfma_f32_16x16x32_bf16 v[200:203], a[96:99], a[48:51], v[228:231]
    v_cvt_pk_bf16_f32 v199, v206, v207
    v_mul_f32 v209, s44, v209
    v_mfma_f32_16x16x32_bf16 v[200:203], a[100:103], a[52:55], v[200:203]
    v_exp_f32 v208, v208
    v_mfma_f32_16x16x32_bf16 v[200:203], a[104:107], a[56:59], v[200:203]
    buffer_load_dwordx4 v248, s[12:15], s30 offen sc1 nt lds
    v_mfma_f32_16x16x32_bf16 v[200:203], a[108:111], a[60:63], v[200:203]
    s_addk_i32 m0, 896
    v_exp_f32 v209, v209
    v_mfma_f32_16x16x32_bf16 v[204:207], a[124:127], a[60:63], v[228:231]
    ds_read_b64_tr_b16 a[204:205], v245 offset:0
    v_mul_f32 v210, s44, v210
    v_mfma_f32_16x16x32_bf16 v[204:207], a[120:123], a[56:59], v[204:207]
    v_exp_f32 v210, v210
    v_mfma_f32_16x16x32_bf16 v[204:207], a[116:119], a[52:55], v[204:207]
    v_mul_f32 v211, s44, v211
    v_cvt_pk_bf16_f32 v208, v208, v209
    v_mfma_f32_16x16x32_bf16 v[204:207], a[112:115], a[48:51], v[204:207]
    v_exp_f32 v211, v211
    v_smfmac_f32_16x16x64_bf16 a[224:227], a[244:247], v[192:199], v253
    v_mul_f32 v212, s44, v212
    v_mfma_f32_16x16x32_bf16 v[32:35], a[160:163], v[196:199], v[32:35]
    ds_read_b64_tr_b16 a[206:207], v245 offset:4096
    v_mul_f32 v213, s44, v213
    v_mfma_f32_16x16x32_bf16 v[36:39], a[164:167], v[196:199], v[36:39]
    v_exp_f32 v212, v212
    v_cvt_pk_bf16_f32 v209, v210, v211
    v_mfma_f32_16x16x32_bf16 v[40:43], a[168:171], v[196:199], v[40:43]
    v_exp_f32 v213, v213
    v_mfma_f32_16x16x32_bf16 v[44:47], a[172:175], v[196:199], v[44:47]
    v_mul_f32 v214, s44, v214
    v_mul_f32 v215, s44, v215
    v_mfma_f32_16x16x32_bf16 v[48:51], a[176:179], v[196:199], v[48:51]
    v_exp_f32 v214, v214
    v_mfma_f32_16x16x32_bf16 v[52:55], a[180:183], v[196:199], v[52:55]
    ds_read_b64_tr_b16 a[208:209], v242 offset:1024
    v_cvt_pk_bf16_f32 v210, v212, v213
    v_mfma_f32_16x16x32_bf16 v[56:59], a[184:187], v[196:199], v[56:59]
    buffer_load_dwordx4 v248, s[12:15], s30 offen offset:128 sc1 nt lds
    v_mfma_f32_16x16x32_bf16 v[60:63], a[188:191], v[196:199], v[60:63]
    v_exp_f32 v215, v215
    v_mfma_f32_16x16x32_bf16 v[192:195], a[96:99], a[64:67], v[232:235]
    v_mul_f32 v200, s44, v200
    v_cvt_pk_bf16_f32 v211, v214, v215
    v_mfma_f32_16x16x32_bf16 v[192:195], a[100:103], a[68:71], v[192:195]
    ds_read_b64_tr_b16 a[210:211], v242 offset:5120
    v_mul_f32 v201, s44, v201
    v_mfma_f32_16x16x32_bf16 v[192:195], a[104:107], a[72:75], v[192:195]
    v_exp_f32 v200, v200
    v_mfma_f32_16x16x32_bf16 v[192:195], a[108:111], a[76:79], v[192:195]
    v_exp_f32 v201, v201
    v_mfma_f32_16x16x32_bf16 v[196:199], a[124:127], a[76:79], v[232:235]
    ds_read_b64_tr_b16 a[212:213], v243 offset:1024
    v_mul_f32 v202, s44, v202
    v_mfma_f32_16x16x32_bf16 v[196:199], a[120:123], a[72:75], v[196:199]
    v_exp_f32 v202, v202
    v_mfma_f32_16x16x32_bf16 v[196:199], a[116:119], a[68:71], v[196:199]
    v_mul_f32 v203, s44, v203
    v_cvt_pk_bf16_f32 v212, v200, v201
    v_mfma_f32_16x16x32_bf16 v[196:199], a[112:115], a[64:67], v[196:199]
    v_exp_f32 v203, v203
    v_mfma_f32_16x16x32_bf16 v[64:67], a[160:163], v[208:211], v[64:67]
    v_mul_f32 v204, s44, v204
    v_mul_f32 v205, s44, v205
    v_mfma_f32_16x16x32_bf16 v[68:71], a[164:167], v[208:211], v[68:71]
    v_exp_f32 v204, v204
    v_mfma_f32_16x16x32_bf16 v[72:75], a[168:171], v[208:211], v[72:75]
    ds_read_b64_tr_b16 a[214:215], v243 offset:5120
    v_cvt_pk_bf16_f32 v213, v202, v203
    v_mfma_f32_16x16x32_bf16 v[76:79], a[172:175], v[208:211], v[76:79]
    v_exp_f32 v205, v205
    v_mfma_f32_16x16x32_bf16 v[80:83], a[176:179], v[208:211], v[80:83]
    v_mul_f32 v206, s44, v206
    v_mul_f32 v207, s44, v207
    v_mfma_f32_16x16x32_bf16 v[84:87], a[180:183], v[208:211], v[84:87]
    v_exp_f32 v206, v206
    v_mfma_f32_16x16x32_bf16 v[88:91], a[184:187], v[208:211], v[88:91]
    ds_read_b64_tr_b16 a[216:217], v244 offset:1024
    v_cvt_pk_bf16_f32 v214, v204, v205
    v_mfma_f32_16x16x32_bf16 v[92:95], a[188:191], v[208:211], v[92:95]
    v_exp_f32 v207, v207
    v_mfma_f32_16x16x32_bf16 v[200:203], a[96:99], a[80:83], v[236:239]
    v_mul_f32 v192, s44, v192
    v_cvt_pk_bf16_f32 v215, v206, v207
    v_mfma_f32_16x16x32_bf16 v[200:203], a[100:103], a[84:87], v[200:203]
    v_exp_f32 v192, v192
    v_mfma_f32_16x16x32_bf16 v[200:203], a[104:107], a[88:91], v[200:203]
    ds_read_b64_tr_b16 a[218:219], v244 offset:5120
    v_mul_f32 v193, s44, v193
    v_mfma_f32_16x16x32_bf16 v[200:203], a[108:111], a[92:95], v[200:203]
    v_exp_f32 v193, v193
    v_mfma_f32_16x16x32_bf16 v[204:207], a[124:127], a[92:95], v[236:239]
    v_mul_f32 v194, s44, v194
    v_mul_f32 v195, s44, v195
    v_mfma_f32_16x16x32_bf16 v[204:207], a[120:123], a[88:91], v[204:207]
    v_exp_f32 v194, v194
    v_mfma_f32_16x16x32_bf16 v[204:207], a[116:119], a[84:87], v[204:207]
    ds_read_b64_tr_b16 a[220:221], v245 offset:1024
    v_cvt_pk_bf16_f32 v192, v192, v193
    v_mfma_f32_16x16x32_bf16 v[204:207], a[112:115], a[80:83], v[204:207]
    v_exp_f32 v195, v195
    v_smfmac_f32_16x16x64_bf16 a[228:231], a[244:247], v[208:215], v253
    v_mul_f32 v196, s44, v196
    v_mfma_f32_16x16x32_bf16 v[96:99], a[160:163], v[212:215], v[96:99]
    v_exp_f32 v196, v196
    v_mfma_f32_16x16x32_bf16 v[100:103], a[164:167], v[212:215], v[100:103]
    v_mul_f32 v197, s44, v197
    v_cvt_pk_bf16_f32 v193, v194, v195
    v_mfma_f32_16x16x32_bf16 v[104:107], a[168:171], v[212:215], v[104:107]
    ds_read_b64_tr_b16 a[222:223], v245 offset:5120
    v_mul_f32 v198, s44, v198
    v_mfma_f32_16x16x32_bf16 v[108:111], a[172:175], v[212:215], v[108:111]
    v_exp_f32 v197, v197
    v_mfma_f32_16x16x32_bf16 v[112:115], a[176:179], v[212:215], v[112:115]
    v_exp_f32 v198, v198
    v_mfma_f32_16x16x32_bf16 v[116:119], a[180:183], v[212:215], v[116:119]
    v_mul_f32 v199, s44, v199
    v_cvt_pk_bf16_f32 v194, v196, v197
    v_mfma_f32_16x16x32_bf16 v[120:123], a[184:187], v[212:215], v[120:123]
    v_exp_f32 v199, v199
    v_mfma_f32_16x16x32_bf16 v[124:127], a[188:191], v[212:215], v[124:127]
    s_waitcnt lgkmcnt(1)
    v_mul_f32 v200, s44, v200
    v_cvt_pk_bf16_f32 v195, v198, v199
    v_mfma_f32_16x16x32_bf16 v[208:211], a[128:131], a[0:3], v[216:219]
    s_waitcnt vmcnt(8)
    v_exp_f32 v200, v200
    v_mfma_f32_16x16x32_bf16 v[208:211], a[132:135], a[4:7], v[208:211]
    s_barrier
    v_mul_f32 v201, s44, v201
    v_mfma_f32_16x16x32_bf16 v[208:211], a[136:139], a[8:11], v[208:211]
    v_exp_f32 v201, v201
    v_mfma_f32_16x16x32_bf16 v[208:211], a[140:143], a[12:15], v[208:211]
    ds_read_b128 a[96:99], v240 offset:8192
    v_mul_f32 v202, s44, v202
    v_mfma_f32_16x16x32_bf16 v[212:215], a[156:159], a[12:15], v[216:219]
    v_exp_f32 v202, v202
    v_mfma_f32_16x16x32_bf16 v[212:215], a[152:155], a[8:11], v[212:215]
    v_mul_f32 v203, s44, v203
    v_cvt_pk_bf16_f32 v196, v200, v201
    v_mfma_f32_16x16x32_bf16 v[212:215], a[148:151], a[4:7], v[212:215]
    v_exp_f32 v203, v203
    v_mfma_f32_16x16x32_bf16 v[212:215], a[144:147], a[0:3], v[212:215]
    v_mul_f32 v204, s44, v204
    v_mul_f32 v205, s44, v205
    v_mfma_f32_16x16x32_bf16 v[128:131], a[160:163], v[192:195], v[128:131]
    v_exp_f32 v204, v204
    v_mfma_f32_16x16x32_bf16 v[132:135], a[164:167], v[192:195], v[132:135]
    ds_read_b128 a[100:103], v241 offset:8192
    v_cvt_pk_bf16_f32 v197, v202, v203
    v_mfma_f32_16x16x32_bf16 v[136:139], a[168:171], v[192:195], v[136:139]
    v_exp_f32 v205, v205
    v_mfma_f32_16x16x32_bf16 v[140:143], a[172:175], v[192:195], v[140:143]
    v_mul_f32 v206, s44, v206
    v_mul_f32 v207, s44, v207
    v_mfma_f32_16x16x32_bf16 v[144:147], a[176:179], v[192:195], v[144:147]
    v_exp_f32 v206, v206
    v_mfma_f32_16x16x32_bf16 v[148:151], a[180:183], v[192:195], v[148:151]
    v_cvt_pk_bf16_f32 v198, v204, v205
    v_mul_f32 v208, s44, v208
    v_mfma_f32_16x16x32_bf16 v[152:155], a[184:187], v[192:195], v[152:155]
    v_exp_f32 v207, v207
    v_mfma_f32_16x16x32_bf16 v[156:159], a[188:191], v[192:195], v[156:159]
    v_cvt_pk_bf16_f32 v199, v206, v207
    v_mul_f32 v209, s44, v209
    v_mfma_f32_16x16x32_bf16 v[200:203], a[128:131], a[16:19], v[220:223]
    v_exp_f32 v208, v208
    v_mfma_f32_16x16x32_bf16 v[200:203], a[132:135], a[20:23], v[200:203]
    ds_read_b128 a[104:107], v240 offset:9216
    v_mul_f32 v210, s44, v210
    v_mfma_f32_16x16x32_bf16 v[200:203], a[136:139], a[24:27], v[200:203]
    v_exp_f32 v209, v209
    v_mfma_f32_16x16x32_bf16 v[200:203], a[140:143], a[28:31], v[200:203]
    v_exp_f32 v210, v210
    v_mfma_f32_16x16x32_bf16 v[204:207], a[156:159], a[28:31], v[220:223]
    v_mul_f32 v211, s44, v211
    v_cvt_pk_bf16_f32 v208, v208, v209
    v_mfma_f32_16x16x32_bf16 v[204:207], a[152:155], a[24:27], v[204:207]
    v_exp_f32 v211, v211
    v_mfma_f32_16x16x32_bf16 v[204:207], a[148:151], a[20:23], v[204:207]
    ds_read_b128 a[108:111], v241 offset:9216
    v_mul_f32 v212, s44, v212
    v_mfma_f32_16x16x32_bf16 v[204:207], a[144:147], a[16:19], v[204:207]
    v_exp_f32 v212, v212
    v_smfmac_f32_16x16x64_bf16 a[232:235], a[244:247], v[192:199], v253
    v_mul_f32 v213, s44, v213
    v_mfma_f32_16x16x32_bf16 v[160:163], a[160:163], v[196:199], v[160:163]
    v_cvt_pk_bf16_f32 v209, v210, v211
    v_mul_f32 v214, s44, v214
    v_mfma_f32_16x16x32_bf16 v[164:167], a[164:167], v[196:199], v[164:167]
    v_exp_f32 v213, v213
    v_mfma_f32_16x16x32_bf16 v[168:171], a[168:171], v[196:199], v[168:171]
    ds_read_b64_tr_b16 a[160:161], v242 offset:8192
    v_mul_f32 v215, s44, v215
    v_mfma_f32_16x16x32_bf16 v[172:175], a[172:175], v[196:199], v[172:175]
    v_exp_f32 v214, v214
    v_mfma_f32_16x16x32_bf16 v[176:179], a[176:179], v[196:199], v[176:179]
    ds_read_b64_tr_b16 a[162:163], v242 offset:12288
    v_cvt_pk_bf16_f32 v210, v212, v213
    v_mfma_f32_16x16x32_bf16 v[180:183], a[180:183], v[196:199], v[180:183]
    v_exp_f32 v215, v215
    v_mfma_f32_16x16x32_bf16 v[184:187], a[184:187], v[196:199], v[184:187]
    ds_read_b128 a[112:115], v240 offset:12288
    v_mul_f32 v200, s44, v200
    v_mfma_f32_16x16x32_bf16 v[188:191], a[188:191], v[196:199], v[188:191]
    v_cvt_pk_bf16_f32 v211, v214, v215
    v_mul_f32 v201, s44, v201
    v_mfma_f32_16x16x32_bf16 v[192:195], a[128:131], a[32:35], v[224:227]
    v_exp_f32 v200, v200
    v_mfma_f32_16x16x32_bf16 v[192:195], a[132:135], a[36:39], v[192:195]
    v_exp_f32 v201, v201
    v_mfma_f32_16x16x32_bf16 v[192:195], a[136:139], a[40:43], v[192:195]
    ds_read_b64_tr_b16 a[164:165], v243 offset:8192
    v_mul_f32 v202, s44, v202
    v_mfma_f32_16x16x32_bf16 v[192:195], a[140:143], a[44:47], v[192:195]
    v_exp_f32 v202, v202
    v_mfma_f32_16x16x32_bf16 v[196:199], a[156:159], a[44:47], v[224:227]
    v_mul_f32 v203, s44, v203
    v_cvt_pk_bf16_f32 v212, v200, v201
    v_mfma_f32_16x16x32_bf16 v[196:199], a[152:155], a[40:43], v[196:199]
    ds_read_b128 a[116:119], v241 offset:12288
    v_mul_f32 v204, s44, v204
    v_mfma_f32_16x16x32_bf16 v[196:199], a[148:151], a[36:39], v[196:199]
    v_exp_f32 v203, v203
    v_mfma_f32_16x16x32_bf16 v[196:199], a[144:147], a[32:35], v[196:199]
    ds_read_b64_tr_b16 a[166:167], v243 offset:12288
    v_mul_f32 v205, s44, v205
    v_mfma_f32_16x16x32_bf16 v[0:3], a[192:195], v[208:211], v[0:3]
    v_exp_f32 v204, v204
    v_mfma_f32_16x16x32_bf16 v[4:7], a[196:199], v[208:211], v[4:7]
    v_cvt_pk_bf16_f32 v213, v202, v203
    v_mul_f32 v206, s44, v206
    v_mfma_f32_16x16x32_bf16 v[8:11], a[200:203], v[208:211], v[8:11]
    v_exp_f32 v205, v205
    v_mfma_f32_16x16x32_bf16 v[12:15], a[204:207], v[208:211], v[12:15]
    ds_read_b64_tr_b16 a[168:169], v244 offset:8192
    v_mul_f32 v207, s44, v207
    v_mfma_f32_16x16x32_bf16 v[16:19], a[208:211], v[208:211], v[16:19]
    v_exp_f32 v206, v206
    v_mfma_f32_16x16x32_bf16 v[20:23], a[212:215], v[208:211], v[20:23]
    ds_read_b128 a[120:123], v240 offset:13312
    v_cvt_pk_bf16_f32 v214, v204, v205
    v_mfma_f32_16x16x32_bf16 v[24:27], a[216:219], v[208:211], v[24:27]
    s_waitcnt lgkmcnt(3)
    v_exp_f32 v207, v207
    v_mfma_f32_16x16x32_bf16 v[28:31], a[220:223], v[208:211], v[28:31]
    v_mul_f32 v192, s44, v192
    v_cvt_pk_bf16_f32 v215, v206, v207
    v_mfma_f32_16x16x32_bf16 v[200:203], a[128:131], a[48:51], v[228:231]
    v_exp_f32 v192, v192
    v_mfma_f32_16x16x32_bf16 v[200:203], a[132:135], a[52:55], v[200:203]
    ds_read_b64_tr_b16 a[170:171], v244 offset:12288
    v_mul_f32 v193, s44, v193
    v_mfma_f32_16x16x32_bf16 v[200:203], a[136:139], a[56:59], v[200:203]
    v_exp_f32 v193, v193
    v_mfma_f32_16x16x32_bf16 v[200:203], a[140:143], a[60:63], v[200:203]
    ds_read_b128 a[124:127], v241 offset:13312
    v_mul_f32 v194, s44, v194
    v_mfma_f32_16x16x32_bf16 v[204:207], a[156:159], a[60:63], v[228:231]
    v_exp_f32 v194, v194
    v_mfma_f32_16x16x32_bf16 v[204:207], a[152:155], a[56:59], v[204:207]
    v_mul_f32 v195, s44, v195
    v_cvt_pk_bf16_f32 v192, v192, v193
    v_mfma_f32_16x16x32_bf16 v[204:207], a[148:151], a[52:55], v[204:207]
    ds_read_b64_tr_b16 a[172:173], v245 offset:8192
    v_mul_f32 v196, s44, v196
    v_mfma_f32_16x16x32_bf16 v[204:207], a[144:147], a[48:51], v[204:207]
    v_exp_f32 v195, v195
    v_smfmac_f32_16x16x64_bf16 a[224:227], a[244:247], v[208:215], v253
    v_mul_f32 v197, s44, v197
    v_mfma_f32_16x16x32_bf16 v[32:35], a[192:195], v[212:215], v[32:35]
    v_exp_f32 v196, v196
    v_mfma_f32_16x16x32_bf16 v[36:39], a[196:199], v[212:215], v[36:39]
    ds_read_b64_tr_b16 a[174:175], v245 offset:12288
    v_cvt_pk_bf16_f32 v193, v194, v195
    v_mfma_f32_16x16x32_bf16 v[40:43], a[200:203], v[212:215], v[40:43]
    v_exp_f32 v197, v197
    v_mfma_f32_16x16x32_bf16 v[44:47], a[204:207], v[212:215], v[44:47]
    v_mul_f32 v198, s44, v198
    v_mul_f32 v199, s44, v199
    v_mfma_f32_16x16x32_bf16 v[48:51], a[208:211], v[212:215], v[48:51]
    v_exp_f32 v198, v198
    v_mfma_f32_16x16x32_bf16 v[52:55], a[212:215], v[212:215], v[52:55]
    ds_read_b64_tr_b16 a[176:177], v242 offset:9216
    v_cvt_pk_bf16_f32 v194, v196, v197
    v_mfma_f32_16x16x32_bf16 v[56:59], a[216:219], v[212:215], v[56:59]
    v_exp_f32 v199, v199
    v_mfma_f32_16x16x32_bf16 v[60:63], a[220:223], v[212:215], v[60:63]
    v_mul_f32 v200, s44, v200
    v_cvt_pk_bf16_f32 v195, v198, v199
    v_mfma_f32_16x16x32_bf16 v[208:211], a[96:99], a[0:3], v[216:219]
    s_waitcnt vmcnt(4)
    v_exp_f32 v200, v200
    v_mfma_f32_16x16x32_bf16 v[208:211], a[100:103], a[4:7], v[208:211]
    s_barrier
    v_mul_f32 v201, s44, v201
    v_mfma_f32_16x16x32_bf16 v[208:211], a[104:107], a[8:11], v[208:211]
    v_exp_f32 v201, v201
    v_mfma_f32_16x16x32_bf16 v[208:211], a[108:111], a[12:15], v[208:211]
    s_waitcnt lgkmcnt(1)
    ds_read_b64_tr_b16 a[178:179], v242 offset:13312
    v_mul_f32 v202, s44, v202
    v_mfma_f32_16x16x32_bf16 v[212:215], a[124:127], a[12:15], v[216:219]
    ds_read_b128 a[128:131], v240 offset:16384
    v_mul_f32 v203, s44, v203
    v_mfma_f32_16x16x32_bf16 v[212:215], a[120:123], a[8:11], v[212:215]
    v_exp_f32 v202, v202
    v_mfma_f32_16x16x32_bf16 v[212:215], a[116:119], a[4:7], v[212:215]
    v_cvt_pk_bf16_f32 v196, v200, v201
    v_mul_f32 v204, s44, v204
    v_mfma_f32_16x16x32_bf16 v[212:215], a[112:115], a[0:3], v[212:215]
    v_exp_f32 v203, v203
    v_mfma_f32_16x16x32_bf16 v[64:67], a[192:195], v[192:195], v[64:67]
    ds_read_b64_tr_b16 a[180:181], v243 offset:9216
    v_mul_f32 v205, s44, v205
    v_mfma_f32_16x16x32_bf16 v[68:71], a[196:199], v[192:195], v[68:71]
    v_exp_f32 v204, v204
    v_mfma_f32_16x16x32_bf16 v[72:75], a[200:203], v[192:195], v[72:75]
    ds_read_b128 a[132:135], v241 offset:16384
    v_cvt_pk_bf16_f32 v197, v202, v203
    v_mfma_f32_16x16x32_bf16 v[76:79], a[204:207], v[192:195], v[76:79]
    v_exp_f32 v205, v205
    v_mfma_f32_16x16x32_bf16 v[80:83], a[208:211], v[192:195], v[80:83]
    ds_read_b64_tr_b16 a[182:183], v243 offset:13312
    v_mul_f32 v206, s44, v206
    v_mfma_f32_16x16x32_bf16 v[84:87], a[212:215], v[192:195], v[84:87]
    v_exp_f32 v206, v206
    v_mfma_f32_16x16x32_bf16 v[88:91], a[216:219], v[192:195], v[88:91]
    v_mul_f32 v207, s44, v207
    v_cvt_pk_bf16_f32 v198, v204, v205
    v_mfma_f32_16x16x32_bf16 v[92:95], a[220:223], v[192:195], v[92:95]
    v_exp_f32 v207, v207
    v_mfma_f32_16x16x32_bf16 v[200:203], a[96:99], a[16:19], v[220:223]
    v_mul_f32 v208, s44, v208
    v_cvt_pk_bf16_f32 v199, v206, v207
    v_mfma_f32_16x16x32_bf16 v[200:203], a[100:103], a[20:23], v[200:203]
    v_exp_f32 v208, v208
    v_mfma_f32_16x16x32_bf16 v[200:203], a[104:107], a[24:27], v[200:203]
    ds_read_b64_tr_b16 a[184:185], v244 offset:9216
    v_mul_f32 v209, s44, v209
    v_mfma_f32_16x16x32_bf16 v[200:203], a[108:111], a[28:31], v[200:203]
    ds_read_b128 a[136:139], v240 offset:17408
    v_mul_f32 v210, s44, v210
    v_mfma_f32_16x16x32_bf16 v[204:207], a[124:127], a[28:31], v[220:223]
    v_exp_f32 v209, v209
    v_mfma_f32_16x16x32_bf16 v[204:207], a[120:123], a[24:27], v[204:207]
    v_exp_f32 v210, v210
    v_mfma_f32_16x16x32_bf16 v[204:207], a[116:119], a[20:23], v[204:207]
    v_mul_f32 v211, s44, v211
    v_cvt_pk_bf16_f32 v208, v208, v209
    v_mfma_f32_16x16x32_bf16 v[204:207], a[112:115], a[16:19], v[204:207]
    ds_read_b64_tr_b16 a[186:187], v244 offset:13312
    v_mul_f32 v212, s44, v212
    v_smfmac_f32_16x16x64_bf16 a[228:231], a[244:247], v[192:199], v253
    ds_read_b128 a[140:143], v241 offset:17408
    v_exp_f32 v211, v211
    v_mfma_f32_16x16x32_bf16 v[96:99], a[192:195], v[196:199], v[96:99]
    v_exp_f32 v212, v212
    v_mfma_f32_16x16x32_bf16 v[100:103], a[196:199], v[196:199], v[100:103]
    v_mul_f32 v213, s44, v213
    v_cvt_pk_bf16_f32 v209, v210, v211
    v_mfma_f32_16x16x32_bf16 v[104:107], a[200:203], v[196:199], v[104:107]
L_pad12:
    s_cbranch_execz L_padend0
    ds_read_b64_tr_b16 a[188:189], v245 offset:9216
    v_mul_f32 v214, s44, v214
    v_mfma_f32_16x16x32_bf16 v[108:111], a[204:207], v[196:199], v[108:111]
    v_exp_f32 v213, v213
    v_mfma_f32_16x16x32_bf16 v[112:115], a[208:211], v[196:199], v[112:115]
    ds_read_b64_tr_b16 a[192:193], v242 offset:16384
    v_mul_f32 v215, s44, v215
    v_mfma_f32_16x16x32_bf16 v[116:119], a[212:215], v[196:199], v[116:119]
    v_exp_f32 v214, v214
    v_cvt_pk_bf16_f32 v210, v212, v213
    v_mfma_f32_16x16x32_bf16 v[120:123], a[216:219], v[196:199], v[120:123]
    v_exp_f32 v215, v215
    v_mfma_f32_16x16x32_bf16 v[124:127], a[220:223], v[196:199], v[124:127]
    ds_read_b64_tr_b16 a[190:191], v245 offset:13312
    v_mul_f32 v200, s44, v200
    v_mfma_f32_16x16x32_bf16 v[192:195], a[96:99], a[32:35], v[224:227]
    ds_read_b64_tr_b16 a[194:195], v242 offset:20480
    v_cvt_pk_bf16_f32 v211, v214, v215
    v_mfma_f32_16x16x32_bf16 v[192:195], a[100:103], a[36:39], v[192:195]
    ds_read_b128 a[144:147], v240 offset:20480
    v_mul_f32 v201, s44, v201
    v_mfma_f32_16x16x32_bf16 v[192:195], a[104:107], a[40:43], v[192:195]
    v_exp_f32 v200, v200
    v_mfma_f32_16x16x32_bf16 v[192:195], a[108:111], a[44:47], v[192:195]
    v_exp_f32 v201, v201
    v_mfma_f32_16x16x32_bf16 v[196:199], a[124:127], a[44:47], v[224:227]
    ds_read_b64_tr_b16 a[196:197], v243 offset:16384
    v_mul_f32 v202, s44, v202
    v_mfma_f32_16x16x32_bf16 v[196:199], a[120:123], a[40:43], v[196:199]
    v_exp_f32 v202, v202
    v_mfma_f32_16x16x32_bf16 v[196:199], a[116:119], a[36:39], v[196:199]
    v_mul_f32 v203, s44, v203
    v_cvt_pk_bf16_f32 v212, v200, v201
    v_mfma_f32_16x16x32_bf16 v[196:199], a[112:115], a[32:35], v[196:199]
    ds_read_b128 a[148:151], v241 offset:20480
    v_mul_f32 v204, s44, v204
    v_mfma_f32_16x16x32_bf16 v[0:3], a[160:163], v[208:211], v[0:3]
    v_exp_f32 v203, v203
    v_mfma_f32_16x16x32_bf16 v[4:7], a[164:167], v[208:211], v[4:7]
    ds_read_b64_tr_b16 a[198:199], v243 offset:20480
    v_mul_f32 v205, s44, v205
    v_mfma_f32_16x16x32_bf16 v[8:11], a[168:171], v[208:211], v[8:11]
    v_exp_f32 v204, v204
    v_cvt_pk_bf16_f32 v213, v202, v203
    v_mfma_f32_16x16x32_bf16 v[12:15], a[172:175], v[208:211], v[12:15]
    s_waitcnt lgkmcnt(3)
    v_exp_f32 v205, v205
    v_mfma_f32_16x16x32_bf16 v[16:19], a[176:179], v[208:211], v[16:19]
    v_mul_f32 v206, s44, v206
    v_mul_f32 v207, s44, v207
    v_mfma_f32_16x16x32_bf16 v[20:23], a[180:183], v[208:211], v[20:23]
    v_exp_f32 v206, v206
    v_mfma_f32_16x16x32_bf16 v[24:27], a[184:187], v[208:211], v[24:27]
    ds_read_b128 a[152:155], v240 offset:21504
    v_cvt_pk_bf16_f32 v214, v204, v205
    v_mfma_f32_16x16x32_bf16 v[28:31], a[188:191], v[208:211], v[28:31]
    ds_read_b64_tr_b16 a[200:201], v244 offset:16384
    v_mul_f32 v192, s44, v192
    v_mfma_f32_16x16x32_bf16 v[200:203], a[96:99], a[48:51], v[228:231]
    v_exp_f32 v207, v207
    v_mfma_f32_16x16x32_bf16 v[200:203], a[100:103], a[52:55], v[200:203]
    v_cvt_pk_bf16_f32 v215, v206, v207
    v_mul_f32 v193, s44, v193
    v_mfma_f32_16x16x32_bf16 v[200:203], a[104:107], a[56:59], v[200:203]
    v_exp_f32 v192, v192
    v_mfma_f32_16x16x32_bf16 v[200:203], a[108:111], a[60:63], v[200:203]
    ds_read_b64_tr_b16 a[202:203], v244 offset:20480
    v_mul_f32 v194, s44, v194
    v_mfma_f32_16x16x32_bf16 v[204:207], a[124:127], a[60:63], v[228:231]
    v_exp_f32 v193, v193
    v_mfma_f32_16x16x32_bf16 v[204:207], a[120:123], a[56:59], v[204:207]
    ds_read_b128 a[156:159], v241 offset:21504
    v_mul_f32 v195, s44, v195
    v_mfma_f32_16x16x32_bf16 v[204:207], a[116:119], a[52:55], v[204:207]
    v_exp_f32 v194, v194
    v_cvt_pk_bf16_f32 v192, v192, v193
    v_mfma_f32_16x16x32_bf16 v[204:207], a[112:115], a[48:51], v[204:207]
    ds_read_b64_tr_b16 a[204:205], v245 offset:16384
    v_mul_f32 v196, s44, v196
    v_smfmac_f32_16x16x64_bf16 a[224:227], a[244:247], v[208:215], v253
    v_mul_f32 v197, s44, v197
    v_exp_f32 v195, v195
    v_mfma_f32_16x16x32_bf16 v[32:35], a[160:163], v[212:215], v[32:35]
    v_exp_f32 v196, v196
    v_mfma_f32_16x16x32_bf16 v[36:39], a[164:167], v[212:215], v[36:39]
    v_cvt_pk_bf16_f32 v193, v194, v195
    v_mul_f32 v198, s44, v198
    v_mfma_f32_16x16x32_bf16 v[40:43], a[168:171], v[212:215], v[40:43]
    v_exp_f32 v197, v197
    v_mfma_f32_16x16x32_bf16 v[44:47], a[172:175], v[212:215], v[44:47]
    ds_read_b64_tr_b16 a[206:207], v245 offset:20480
    v_mul_f32 v199, s44, v199
    v_mfma_f32_16x16x32_bf16 v[48:51], a[176:179], v[212:215], v[48:51]
    v_exp_f32 v198, v198
    v_mfma_f32_16x16x32_bf16 v[52:55], a[180:183], v[212:215], v[52:55]
    v_cvt_pk_bf16_f32 v194, v196, v197
    v_mul_f32 v200, s44, v200
    v_mfma_f32_16x16x32_bf16 v[56:59], a[184:187], v[212:215], v[56:59]
    v_exp_f32 v199, v199
    v_mfma_f32_16x16x32_bf16 v[60:63], a[188:191], v[212:215], v[60:63]
    ds_read_b64_tr_b16 a[208:209], v242 offset:17408
    v_cvt_pk_bf16_f32 v195, v198, v199
    v_mfma_f32_16x16x32_bf16 v[208:211], a[128:131], a[0:3], v[216:219]
    s_waitcnt vmcnt(0)
    v_exp_f32 v200, v200
    v_mfma_f32_16x16x32_bf16 v[208:211], a[132:135], a[4:7], v[208:211]
    s_barrier
    v_mul_f32 v201, s44, v201
    v_mfma_f32_16x16x32_bf16 v[208:211], a[136:139], a[8:11], v[208:211]
    v_exp_f32 v201, v201
    v_mfma_f32_16x16x32_bf16 v[208:211], a[140:143], a[12:15], v[208:211]
    s_waitcnt lgkmcnt(1)
    ds_read_b64_tr_b16 a[210:211], v242 offset:21504
    v_mul_f32 v202, s44, v202
    v_mfma_f32_16x16x32_bf16 v[212:215], a[156:159], a[12:15], v[216:219]
    ds_read_b128 a[96:99], v240 offset:24576
    v_mul_f32 v203, s44, v203
    v_mfma_f32_16x16x32_bf16 v[212:215], a[152:155], a[8:11], v[212:215]
    ds_read_b128 a[100:103], v241 offset:24576
    v_cvt_pk_bf16_f32 v196, v200, v201
    v_mfma_f32_16x16x32_bf16 v[212:215], a[148:151], a[4:7], v[212:215]
    v_exp_f32 v202, v202
    v_mfma_f32_16x16x32_bf16 v[212:215], a[144:147], a[0:3], v[212:215]
    ds_read_b128 a[104:107], v240 offset:25600
    v_mul_f32 v204, s44, v204
    v_mfma_f32_16x16x32_bf16 v[64:67], a[160:163], v[192:195], v[64:67]
    ds_read_b128 a[108:111], v241 offset:25600
    v_mul_f32 v205, s44, v205
    v_exp_f32 v203, v203
    v_mfma_f32_16x16x32_bf16 v[68:71], a[164:167], v[192:195], v[68:71]
    ds_read_b128 a[112:115], v240 offset:28672
    v_cvt_pk_bf16_f32 v197, v202, v203
    v_mfma_f32_16x16x32_bf16 v[72:75], a[168:171], v[192:195], v[72:75]
    ds_read_b64_tr_b16 a[212:213], v243 offset:17408
    ds_read_b128 a[116:119], v241 offset:28672
    v_exp_f32 v204, v204
    v_mfma_f32_16x16x32_bf16 v[76:79], a[172:175], v[192:195], v[76:79]
    ds_read_b128 a[120:123], v240 offset:29696
    v_mul_f32 v206, s44, v206
    v_mfma_f32_16x16x32_bf16 v[80:83], a[176:179], v[192:195], v[80:83]
    ds_read_b128 a[124:127], v241 offset:29696
    v_mul_f32 v207, s44, v207
    v_exp_f32 v205, v205
    v_mfma_f32_16x16x32_bf16 v[84:87], a[180:183], v[192:195], v[84:87]
    v_exp_f32 v206, v206
    v_mfma_f32_16x16x32_bf16 v[88:91], a[184:187], v[192:195], v[88:91]
    ds_read_b64_tr_b16 a[214:215], v243 offset:21504
    v_cvt_pk_bf16_f32 v198, v204, v205
    v_mfma_f32_16x16x32_bf16 v[92:95], a[188:191], v[192:195], v[92:95]
    s_waitcnt lgkmcnt(7)
    v_exp_f32 v207, v207
    v_mfma_f32_16x16x32_bf16 v[200:203], a[96:99], a[0:3], v[216:219]
    v_mul_f32 v208, s44, v208
    v_cvt_pk_bf16_f32 v199, v206, v207
    v_mfma_f32_16x16x32_bf16 v[200:203], a[100:103], a[4:7], v[200:203]
    v_exp_f32 v208, v208
    v_mfma_f32_16x16x32_bf16 v[200:203], a[104:107], a[8:11], v[200:203]
    s_waitcnt lgkmcnt(3)
    ds_read_b64_tr_b16 a[216:217], v244 offset:17408
    v_mul_f32 v209, s44, v209
    v_mfma_f32_16x16x32_bf16 v[200:203], a[108:111], a[12:15], v[200:203]
    s_waitcnt lgkmcnt(2)
    v_exp_f32 v209, v209
    v_mfma_f32_16x16x32_bf16 v[204:207], a[124:127], a[12:15], v[216:219]
    s_add_u32 s31, s22, 0
    v_mul_f32 v210, s44, v210
    v_mul_f32 v211, s44, v211
    v_mfma_f32_16x16x32_bf16 v[204:207], a[120:123], a[8:11], v[204:207]
    v_exp_f32 v210, v210
    v_mfma_f32_16x16x32_bf16 v[204:207], a[116:119], a[4:7], v[204:207]
    ds_read_b64_tr_b16 a[218:219], v244 offset:21504
    v_cvt_pk_bf16_f32 v208, v208, v209
    v_mfma_f32_16x16x32_bf16 v[204:207], a[112:115], a[0:3], v[204:207]
    v_exp_f32 v211, v211
    v_smfmac_f32_16x16x64_bf16 a[228:231], a[244:247], v[192:199], v253
    v_mul_f32 v212, s44, v212
    v_mfma_f32_16x16x32_bf16 v[96:99], a[160:163], v[196:199], v[96:99]
    v_exp_f32 v212, v212
    v_mfma_f32_16x16x32_bf16 v[100:103], a[164:167], v[196:199], v[100:103]
    v_mul_f32 v213, s44, v213
    v_cvt_pk_bf16_f32 v209, v210, v211
    v_mfma_f32_16x16x32_bf16 v[104:107], a[168:171], v[196:199], v[104:107]
    v_exp_f32 v213, v213
    v_mfma_f32_16x16x32_bf16 v[108:111], a[172:175], v[196:199], v[108:111]
    ds_read_b64_tr_b16 a[220:221], v245 offset:17408
    v_mul_f32 v214, s44, v214
    v_mfma_f32_16x16x32_bf16 v[112:115], a[176:179], v[196:199], v[112:115]
    ds_read_b64_tr_b16 a[160:161], v242 offset:24576
    v_mul_f32 v215, s44, v215
    v_mfma_f32_16x16x32_bf16 v[116:119], a[180:183], v[196:199], v[116:119]
    ds_read_b64_tr_b16 a[162:163], v242 offset:28672
    v_cvt_pk_bf16_f32 v210, v212, v213
    v_exp_f32 v214, v214
    v_mfma_f32_16x16x32_bf16 v[120:123], a[184:187], v[196:199], v[120:123]
    ds_read_b64_tr_b16 a[164:165], v243 offset:24576
    v_mul_f32 v200, s44, v200
    v_mfma_f32_16x16x32_bf16 v[124:127], a[188:191], v[196:199], v[124:127]
    v_exp_f32 v215, v215
    v_mfma_f32_16x16x32_bf16 v[192:195], a[128:131], a[16:19], v[220:223]
    ds_read_b64_tr_b16 a[222:223], v245 offset:21504
    v_cvt_pk_bf16_f32 v211, v214, v215
    v_mfma_f32_16x16x32_bf16 v[192:195], a[132:135], a[20:23], v[192:195]
    ds_read_b64_tr_b16 a[166:167], v243 offset:28672
    v_mul_f32 v201, s44, v201
    v_mfma_f32_16x16x32_bf16 v[192:195], a[136:139], a[24:27], v[192:195]
    ds_read_b64_tr_b16 a[168:169], v244 offset:24576
    v_mul_f32 v202, s44, v202
    v_exp_f32 v200, v200
    v_mfma_f32_16x16x32_bf16 v[192:195], a[140:143], a[28:31], v[192:195]
    ds_read_b64_tr_b16 a[170:171], v244 offset:28672
    v_mul_f32 v203, s44, v203
    v_mfma_f32_16x16x32_bf16 v[196:199], a[156:159], a[28:31], v[220:223]
    v_exp_f32 v201, v201
    v_mfma_f32_16x16x32_bf16 v[196:199], a[152:155], a[24:27], v[196:199]
    ds_read_b64_tr_b16 a[172:173], v245 offset:24576
    v_cvt_pk_bf16_f32 v200, v200, v201
    v_mfma_f32_16x16x32_bf16 v[196:199], a[148:151], a[20:23], v[196:199]
    v_exp_f32 v202, v202
    v_mfma_f32_16x16x32_bf16 v[196:199], a[144:147], a[16:19], v[196:199]
    ds_read_b64_tr_b16 a[174:175], v245 offset:28672
    v_mul_f32 v204, s44, v204
    v_mfma_f32_16x16x32_bf16 a[224:227], a[236:239], v[208:211], a[224:227]
    v_exp_f32 v203, v203
    v_mfma_f32_16x16x32_bf16 v[0:3], a[192:195], v[208:211], v[0:3]
    ds_read_b64_tr_b16 a[176:177], v242 offset:25600
    v_mul_f32 v205, s44, v205
    v_mfma_f32_16x16x32_bf16 v[4:7], a[196:199], v[208:211], v[4:7]
    v_exp_f32 v204, v204
    v_cvt_pk_bf16_f32 v201, v202, v203
    v_mfma_f32_16x16x32_bf16 v[8:11], a[200:203], v[208:211], v[8:11]
    ds_read_b64_tr_b16 a[178:179], v242 offset:29696
    v_mul_f32 v206, s44, v206
    v_mfma_f32_16x16x32_bf16 v[12:15], a[204:207], v[208:211], v[12:15]
    ds_read_b64_tr_b16 a[180:181], v243 offset:25600
    v_mul_f32 v207, s44, v207
    v_exp_f32 v205, v205
    v_mfma_f32_16x16x32_bf16 v[16:19], a[208:211], v[208:211], v[16:19]
    s_waitcnt lgkmcnt(4)
    ds_read_b64_tr_b16 a[182:183], v243 offset:29696
    v_cvt_pk_bf16_f32 v202, v204, v205
    v_mfma_f32_16x16x32_bf16 v[20:23], a[212:215], v[208:211], v[20:23]
    v_exp_f32 v206, v206
    v_mfma_f32_16x16x32_bf16 v[24:27], a[216:219], v[208:211], v[24:27]
    ds_read_b64_tr_b16 a[184:185], v244 offset:25600
    v_mul_f32 v192, s44, v192
    v_mfma_f32_16x16x32_bf16 v[28:31], a[220:223], v[208:211], v[28:31]
    v_exp_f32 v207, v207
    v_mfma_f32_16x16x32_bf16 v[208:211], a[96:99], a[16:19], v[220:223]
    ds_read_b64_tr_b16 a[186:187], v244 offset:29696
    v_cvt_pk_bf16_f32 v203, v206, v207
    v_mfma_f32_16x16x32_bf16 v[208:211], a[100:103], a[20:23], v[208:211]
    ds_read_b64_tr_b16 a[188:189], v245 offset:25600
    v_mul_f32 v193, s44, v193
    v_mfma_f32_16x16x32_bf16 v[208:211], a[104:107], a[24:27], v[208:211]
    v_exp_f32 v192, v192
    v_mfma_f32_16x16x32_bf16 v[208:211], a[108:111], a[28:31], v[208:211]
    ds_read_b64_tr_b16 a[190:191], v245 offset:29696
    v_mul_f32 v194, s44, v194
    v_mfma_f32_16x16x32_bf16 v[212:215], a[124:127], a[28:31], v[220:223]
    v_exp_f32 v193, v193
    v_mfma_f32_16x16x32_bf16 v[212:215], a[120:123], a[24:27], v[212:215]
    v_exp_f32 v194, v194
    v_mfma_f32_16x16x32_bf16 v[212:215], a[116:119], a[20:23], v[212:215]
    v_mul_f32 v195, s44, v195
    v_cvt_pk_bf16_f32 v192, v192, v193
    v_mfma_f32_16x16x32_bf16 v[212:215], a[112:115], a[16:19], v[212:215]
    v_exp_f32 v195, v195
    v_mfma_f32_16x16x32_bf16 a[224:227], a[236:239], v[200:203], a[224:227]
    v_mul_f32 v196, s44, v196
    v_mul_f32 v197, s44, v197
    v_mfma_f32_16x16x32_bf16 v[0:3], a[160:163], v[200:203], v[0:3]
    v_exp_f32 v196, v196
    v_mfma_f32_16x16x32_bf16 v[4:7], a[164:167], v[200:203], v[4:7]
    v_cvt_pk_bf16_f32 v193, v194, v195
    v_mul_f32 v198, s44, v198
    v_mfma_f32_16x16x32_bf16 v[8:11], a[168:171], v[200:203], v[8:11]
    s_waitcnt lgkmcnt(0)
    v_exp_f32 v197, v197
    v_mfma_f32_16x16x32_bf16 v[12:15], a[172:175], v[200:203], v[12:15]
    v_accvgpr_read_b32 v217, a225
    v_accvgpr_read_b32 v252, a224
    v_mfma_f32_16x16x32_bf16 v[16:19], a[176:179], v[200:203], v[16:19]
    v_exp_f32 v198, v198
    v_mfma_f32_16x16x32_bf16 v[20:23], a[180:183], v[200:203], v[20:23]
    v_mul_f32 v199, s44, v199
    v_cvt_pk_bf16_f32 v194, v196, v197
    v_add_f32 v252, v252, v217
    v_mfma_f32_16x16x32_bf16 v[24:27], a[184:187], v[200:203], v[24:27]
    v_cmp_nge_f32 vcc, s46, v252
    v_mul_f32 v208, s44, v208
    v_mfma_f32_16x16x32_bf16 v[28:31], a[188:191], v[200:203], v[28:31]
    v_exp_f32 v199, v199
    v_rcp_f32 v252, v252
    v_mfma_f32_16x16x32_bf16 v[200:203], a[128:131], a[32:35], v[224:227]
    s_or_b64 s[32:33], s[32:33], vcc
    v_cvt_pk_bf16_f32 v195, v198, v199
    v_mul_f32 v209, s44, v209
    v_exp_f32 v208, v208
    v_exp_f32 v209, v209
    v_pk_mul_f32 v[0:1], v[0:1], v[252:253] op_sel_hi:[1,0]
    v_pk_mul_f32 v[2:3], v[2:3], v[252:253] op_sel_hi:[1,0]
    v_pk_mul_f32 v[4:5], v[4:5], v[252:253] op_sel_hi:[1,0]
    v_pk_mul_f32 v[6:7], v[6:7], v[252:253] op_sel_hi:[1,0]
    v_cvt_pk_bf16_f32 v0, v0, v1
    v_cvt_pk_bf16_f32 v1, v2, v3
    v_cvt_pk_bf16_f32 v4, v4, v5
    v_cvt_pk_bf16_f32 v5, v6, v7
    v_mfma_f32_16x16x32_bf16 v[200:203], a[132:135], a[36:39], v[200:203]
    v_cmp_nge_f32 vcc, s46, v252
    v_mul_f32 v210, s44, v210
    v_mfma_f32_16x16x32_bf16 v[200:203], a[136:139], a[40:43], v[200:203]
    ds_write_b64 v249, v[0:1] offset:0
    v_mfma_f32_16x16x32_bf16 v[200:203], a[140:143], a[44:47], v[200:203]
    s_or_b64 s[32:33], s[32:33], vcc
    v_exp_f32 v210, v210
    v_mul_f32 v211, s44, v211
    v_cvt_pk_bf16_f32 v208, v208, v209
    v_exp_f32 v211, v211
    v_pk_mul_f32 v[8:9], v[8:9], v[252:253] op_sel_hi:[1,0]
    v_pk_mul_f32 v[10:11], v[10:11], v[252:253] op_sel_hi:[1,0]
    v_pk_mul_f32 v[12:13], v[12:13], v[252:253] op_sel_hi:[1,0]
    v_pk_mul_f32 v[14:15], v[14:15], v[252:253] op_sel_hi:[1,0]
    v_cvt_pk_bf16_f32 v8, v8, v9
    v_cvt_pk_bf16_f32 v9, v10, v11
    v_cvt_pk_bf16_f32 v12, v12, v13
    v_cvt_pk_bf16_f32 v13, v14, v15
    v_mfma_f32_16x16x32_bf16 v[204:207], a[156:159], a[44:47], v[224:227]
    ds_write_b64 v249, v[4:5] offset:32
    v_mfma_f32_16x16x32_bf16 v[204:207], a[152:155], a[40:43], v[204:207]
    v_mul_f32 v212, s44, v212
    v_mul_f32 v213, s44, v213
    v_mfma_f32_16x16x32_bf16 v[204:207], a[148:151], a[36:39], v[204:207]
    ds_write_b64 v249, v[8:9] offset:64
    v_mfma_f32_16x16x32_bf16 v[204:207], a[144:147], a[32:35], v[204:207]
    v_exp_f32 v212, v212
    v_cvt_pk_bf16_f32 v209, v210, v211
    v_exp_f32 v213, v213
    v_pk_mul_f32 v[16:17], v[16:17], v[252:253] op_sel_hi:[1,0]
    v_pk_mul_f32 v[18:19], v[18:19], v[252:253] op_sel_hi:[1,0]
    v_pk_mul_f32 v[20:21], v[20:21], v[252:253] op_sel_hi:[1,0]
    v_pk_mul_f32 v[22:23], v[22:23], v[252:253] op_sel_hi:[1,0]
    v_cvt_pk_bf16_f32 v16, v16, v17
    v_cvt_pk_bf16_f32 v17, v18, v19
    v_cvt_pk_bf16_f32 v20, v20, v21
    v_cvt_pk_bf16_f32 v21, v22, v23
    v_mfma_f32_16x16x32_bf16 a[224:227], a[240:243], v[192:195], a[224:227]
    ds_write_b64 v249, v[12:13] offset:96
    v_mfma_f32_16x16x32_bf16 v[32:35], a[192:195], v[192:195], v[32:35]
    ds_read_b128 v[0:3], v250 offset:0
    v_mul_f32 v214, s44, v214
    v_mfma_f32_16x16x32_bf16 v[36:39], a[196:199], v[192:195], v[36:39]
    ds_write_b64 v249, v[16:17] offset:128
    v_mfma_f32_16x16x32_bf16 v[40:43], a[200:203], v[192:195], v[40:43]
    v_exp_f32 v214, v214
    v_mul_f32 v215, s44, v215
    v_cvt_pk_bf16_f32 v210, v212, v213
    v_exp_f32 v215, v215
    v_pk_mul_f32 v[24:25], v[24:25], v[252:253] op_sel_hi:[1,0]
    v_pk_mul_f32 v[26:27], v[26:27], v[252:253] op_sel_hi:[1,0]
    v_pk_mul_f32 v[28:29], v[28:29], v[252:253] op_sel_hi:[1,0]
    v_pk_mul_f32 v[30:31], v[30:31], v[252:253] op_sel_hi:[1,0]
    v_cvt_pk_bf16_f32 v24, v24, v25
    v_cvt_pk_bf16_f32 v25, v26, v27
    v_cvt_pk_bf16_f32 v28, v28, v29
    v_cvt_pk_bf16_f32 v29, v30, v31
    v_mfma_f32_16x16x32_bf16 v[44:47], a[204:207], v[192:195], v[44:47]
    ds_write_b64 v249, v[20:21] offset:160
    v_mfma_f32_16x16x32_bf16 v[48:51], a[208:211], v[192:195], v[48:51]
    v_mul_f32 v200, s44, v200
    v_cvt_pk_bf16_f32 v211, v214, v215
    v_mfma_f32_16x16x32_bf16 v[52:55], a[212:215], v[192:195], v[52:55]
    ds_write_b64 v249, v[24:25] offset:192
    v_mfma_f32_16x16x32_bf16 v[56:59], a[216:219], v[192:195], v[56:59]
    v_exp_f32 v200, v200
    v_mfma_f32_16x16x32_bf16 v[60:63], a[220:223], v[192:195], v[60:63]
    s_waitcnt lgkmcnt(3)
    v_mul_f32 v201, s44, v201
    v_mul_f32 v202, s44, v202
    v_mfma_f32_16x16x32_bf16 v[192:195], a[96:99], a[32:35], v[224:227]
    ds_write_b64 v249, v[28:29] offset:224
    v_mfma_f32_16x16x32_bf16 v[192:195], a[100:103], a[36:39], v[192:195]
    buffer_store_dwordx4 v[0:3], v248, s[16:19], s31 offen offset:0 sc1
    v_mul_f32 v203, s44, v203
    v_mul_f32 v204, s44, v204
    v_mfma_f32_16x16x32_bf16 v[192:195], a[104:107], a[40:43], v[192:195]
    v_exp_f32 v201, v201
    v_mfma_f32_16x16x32_bf16 v[192:195], a[108:111], a[44:47], v[192:195]
    ds_read_b128 v[4:7], v250 offset:2176
    v_cvt_pk_bf16_f32 v200, v200, v201
    v_mfma_f32_16x16x32_bf16 v[196:199], a[124:127], a[44:47], v[224:227]
    v_exp_f32 v202, v202
    v_mfma_f32_16x16x32_bf16 v[196:199], a[120:123], a[40:43], v[196:199]
    v_exp_f32 v203, v203
    v_mfma_f32_16x16x32_bf16 v[196:199], a[116:119], a[36:39], v[196:199]
    v_exp_f32 v204, v204
    v_mfma_f32_16x16x32_bf16 v[196:199], a[112:115], a[32:35], v[196:199]
    v_mul_f32 v205, s44, v205
    v_cvt_pk_bf16_f32 v201, v202, v203
    v_mfma_f32_16x16x32_bf16 a[224:227], a[240:243], v[208:211], a[224:227]
    ds_read_b128 v[16:19], v250 offset:128
    v_mul_f32 v206, s44, v206
    v_mfma_f32_16x16x32_bf16 v[32:35], a[160:163], v[208:211], v[32:35]
    v_exp_f32 v205, v205
    v_mfma_f32_16x16x32_bf16 v[36:39], a[164:167], v[208:211], v[36:39]
    s_waitcnt lgkmcnt(1)
    v_exp_f32 v206, v206
    v_mfma_f32_16x16x32_bf16 v[40:43], a[168:171], v[208:211], v[40:43]
    buffer_store_dwordx4 v[4:7], v248, s[16:19], s31 offen offset:2048 sc1
    v_mul_f32 v207, s44, v207
    v_cvt_pk_bf16_f32 v202, v204, v205
    v_mfma_f32_16x16x32_bf16 v[44:47], a[172:175], v[208:211], v[44:47]
    v_accvgpr_read_b32 v221, a227
    v_accvgpr_read_b32 v254, a226
    v_mfma_f32_16x16x32_bf16 v[48:51], a[176:179], v[208:211], v[48:51]
    v_add_f32 v254, v254, v221
    v_cmp_nge_f32 vcc, s46, v254
    v_mfma_f32_16x16x32_bf16 v[52:55], a[180:183], v[208:211], v[52:55]
    v_exp_f32 v207, v207
    v_mfma_f32_16x16x32_bf16 v[56:59], a[184:187], v[208:211], v[56:59]
    s_waitcnt lgkmcnt(0)
    buffer_store_dwordx4 v[16:19], v248, s[16:19], s31 offen offset:128 sc1
    v_rcp_f32 v254, v254
    v_mfma_f32_16x16x32_bf16 v[60:63], a[188:191], v[208:211], v[60:63]
    s_or_b64 s[32:33], s[32:33], vcc
    ds_read_b128 v[20:23], v250 offset:2304
    v_mul_f32 v192, s44, v192
    v_cvt_pk_bf16_f32 v203, v206, v207
    v_exp_f32 v192, v192
    v_pk_mul_f32 v[32:33], v[32:33], v[254:255] op_sel_hi:[1,0]
    v_pk_mul_f32 v[34:35], v[34:35], v[254:255] op_sel_hi:[1,0]
    v_pk_mul_f32 v[36:37], v[36:37], v[254:255] op_sel_hi:[1,0]
    v_pk_mul_f32 v[38:39], v[38:39], v[254:255] op_sel_hi:[1,0]
    v_cvt_pk_bf16_f32 v32, v32, v33
    v_cvt_pk_bf16_f32 v33, v34, v35
    v_cvt_pk_bf16_f32 v36, v36, v37
    v_cvt_pk_bf16_f32 v37, v38, v39
    v_mfma_f32_16x16x32_bf16 v[208:211], a[128:131], a[48:51], v[228:231]
    v_mul_f32 v193, s44, v193
    v_cmp_nge_f32 vcc, s46, v254
    v_mfma_f32_16x16x32_bf16 v[208:211], a[132:135], a[52:55], v[208:211]
    v_exp_f32 v193, v193
    v_mfma_f32_16x16x32_bf16 v[208:211], a[136:139], a[56:59], v[208:211]
    s_or_b64 s[32:33], s[32:33], vcc
    v_mul_f32 v194, s44, v194
    v_mul_f32 v195, s44, v195
    v_mfma_f32_16x16x32_bf16 v[208:211], a[140:143], a[60:63], v[208:211]
    ds_write_b64 v249, v[32:33] offset:4352
    v_exp_f32 v194, v194
    v_pk_mul_f32 v[40:41], v[40:41], v[254:255] op_sel_hi:[1,0]
    v_pk_mul_f32 v[42:43], v[42:43], v[254:255] op_sel_hi:[1,0]
    v_pk_mul_f32 v[44:45], v[44:45], v[254:255] op_sel_hi:[1,0]
    v_pk_mul_f32 v[46:47], v[46:47], v[254:255] op_sel_hi:[1,0]
    v_cvt_pk_bf16_f32 v40, v40, v41
    v_cvt_pk_bf16_f32 v41, v42, v43
    v_cvt_pk_bf16_f32 v44, v44, v45
    v_cvt_pk_bf16_f32 v45, v46, v47
    v_mfma_f32_16x16x32_bf16 v[212:215], a[156:159], a[60:63], v[228:231]
    v_cvt_pk_bf16_f32 v192, v192, v193
    v_mul_f32 v196, s44, v196
    v_mfma_f32_16x16x32_bf16 v[212:215], a[152:155], a[56:59], v[212:215]
    ds_write_b64 v249, v[36:37] offset:4384
    v_mfma_f32_16x16x32_bf16 v[212:215], a[148:151], a[52:55], v[212:215]
    s_waitcnt lgkmcnt(2)
    buffer_store_dwordx4 v[20:23], v248, s[16:19], s31 offen offset:2176 sc1
    v_exp_f32 v195, v195
    v_mfma_f32_16x16x32_bf16 v[212:215], a[144:147], a[48:51], v[212:215]
    s_add_u32 s31, s22, 4096
    ds_write_b64 v249, v[40:41] offset:4416
    v_exp_f32 v196, v196
    v_pk_mul_f32 v[48:49], v[48:49], v[254:255] op_sel_hi:[1,0]
    v_pk_mul_f32 v[50:51], v[50:51], v[254:255] op_sel_hi:[1,0]
    v_pk_mul_f32 v[52:53], v[52:53], v[254:255] op_sel_hi:[1,0]
    v_pk_mul_f32 v[54:55], v[54:55], v[254:255] op_sel_hi:[1,0]
    v_cvt_pk_bf16_f32 v48, v48, v49
    v_cvt_pk_bf16_f32 v49, v50, v51
    v_cvt_pk_bf16_f32 v52, v52, v53
    v_cvt_pk_bf16_f32 v53, v54, v55
    v_mfma_f32_16x16x32_bf16 a[228:231], a[236:239], v[200:203], a[228:231]
    v_mul_f32 v197, s44, v197
    v_cvt_pk_bf16_f32 v193, v194, v195
    v_mfma_f32_16x16x32_bf16 v[64:67], a[192:195], v[200:203], v[64:67]
    ds_write_b64 v249, v[44:45] offset:4448
    v_mfma_f32_16x16x32_bf16 v[68:71], a[196:199], v[200:203], v[68:71]
    v_exp_f32 v197, v197
    v_mfma_f32_16x16x32_bf16 v[72:75], a[200:203], v[200:203], v[72:75]
    ds_read_b128 v[32:35], v250 offset:4352
    ds_write_b64 v249, v[48:49] offset:4480
    v_mul_f32 v198, s44, v198
    v_pk_mul_f32 v[56:57], v[56:57], v[254:255] op_sel_hi:[1,0]
    v_pk_mul_f32 v[58:59], v[58:59], v[254:255] op_sel_hi:[1,0]
    v_pk_mul_f32 v[60:61], v[60:61], v[254:255] op_sel_hi:[1,0]
    v_pk_mul_f32 v[62:63], v[62:63], v[254:255] op_sel_hi:[1,0]
    v_cvt_pk_bf16_f32 v56, v56, v57
    v_cvt_pk_bf16_f32 v57, v58, v59
    v_cvt_pk_bf16_f32 v60, v60, v61
    v_cvt_pk_bf16_f32 v61, v62, v63
    v_mfma_f32_16x16x32_bf16 v[76:79], a[204:207], v[200:203], v[76:79]
    v_exp_f32 v198, v198
    v_mfma_f32_16x16x32_bf16 v[80:83], a[208:211], v[200:203], v[80:83]
    v_mul_f32 v199, s44, v199
    v_cvt_pk_bf16_f32 v194, v196, v197
    v_mfma_f32_16x16x32_bf16 v[84:87], a[212:215], v[200:203], v[84:87]
    ds_write_b64 v249, v[52:53] offset:4512
    v_mfma_f32_16x16x32_bf16 v[88:91], a[216:219], v[200:203], v[88:91]
    v_exp_f32 v199, v199
    v_mfma_f32_16x16x32_bf16 v[92:95], a[220:223], v[200:203], v[92:95]
    v_mul_f32 v208, s44, v208
    v_cvt_pk_bf16_f32 v195, v198, v199
    v_mfma_f32_16x16x32_bf16 v[200:203], a[96:99], a[48:51], v[228:231]
    ds_write_b64 v249, v[56:57] offset:4544
    v_mfma_f32_16x16x32_bf16 v[200:203], a[100:103], a[52:55], v[200:203]
    s_waitcnt lgkmcnt(3)
    v_exp_f32 v208, v208
    v_mfma_f32_16x16x32_bf16 v[200:203], a[104:107], a[56:59], v[200:203]
    ds_write_b64 v249, v[60:61] offset:4576
    v_mul_f32 v209, s44, v209
    v_mul_f32 v210, s44, v210
    v_mfma_f32_16x16x32_bf16 v[200:203], a[108:111], a[60:63], v[200:203]
    buffer_store_dwordx4 v[32:35], v248, s[16:19], s31 offen offset:0 sc1
    v_mul_f32 v211, s44, v211
    v_mul_f32 v212, s44, v212
    v_mfma_f32_16x16x32_bf16 v[204:207], a[124:127], a[60:63], v[228:231]
    ds_read_b128 v[36:39], v250 offset:6528
    v_exp_f32 v209, v209
    v_mfma_f32_16x16x32_bf16 v[204:207], a[120:123], a[56:59], v[204:207]
    v_exp_f32 v210, v210
    v_mfma_f32_16x16x32_bf16 v[204:207], a[116:119], a[52:55], v[204:207]
    v_cvt_pk_bf16_f32 v208, v208, v209
    v_mul_f32 v213, s44, v213
    v_mfma_f32_16x16x32_bf16 v[204:207], a[112:115], a[48:51], v[204:207]
    v_exp_f32 v211, v211
    v_mfma_f32_16x16x32_bf16 a[228:231], a[236:239], v[192:195], a[228:231]
    ds_read_b128 v[48:51], v250 offset:4480
    v_cvt_pk_bf16_f32 v209, v210, v211
    v_mfma_f32_16x16x32_bf16 v[64:67], a[160:163], v[192:195], v[64:67]
    v_exp_f32 v212, v212
    v_mfma_f32_16x16x32_bf16 v[68:71], a[164:167], v[192:195], v[68:71]
    v_exp_f32 v213, v213
    v_mfma_f32_16x16x32_bf16 v[72:75], a[168:171], v[192:195], v[72:75]
    s_waitcnt lgkmcnt(1)
    buffer_store_dwordx4 v[36:39], v248, s[16:19], s31 offen offset:2048 sc1
    v_mul_f32 v214, s44, v214
    v_mul_f32 v215, s44, v215
    v_mfma_f32_16x16x32_bf16 v[76:79], a[172:175], v[192:195], v[76:79]
    v_accvgpr_read_b32 v225, a229
    v_accvgpr_read_b32 v252, a228
    v_mfma_f32_16x16x32_bf16 v[80:83], a[176:179], v[192:195], v[80:83]
    v_exp_f32 v214, v214
    v_mfma_f32_16x16x32_bf16 v[84:87], a[180:183], v[192:195], v[84:87]
    v_cvt_pk_bf16_f32 v210, v212, v213
    v_add_f32 v252, v252, v225
    v_mfma_f32_16x16x32_bf16 v[88:91], a[184:187], v[192:195], v[88:91]
    s_waitcnt lgkmcnt(0)
    buffer_store_dwordx4 v[48:51], v248, s[16:19], s31 offen offset:128 sc1
    v_cmp_nge_f32 vcc, s46, v252
    v_mul_f32 v200, s44, v200
    v_mfma_f32_16x16x32_bf16 v[92:95], a[188:191], v[192:195], v[92:95]
    ds_read_b128 v[52:55], v250 offset:6656
    v_mul_f32 v201, s44, v201
    v_exp_f32 v215, v215
    v_rcp_f32 v252, v252
    v_mfma_f32_16x16x32_bf16 v[192:195], a[128:131], a[64:67], v[232:235]
    s_or_b64 s[32:33], s[32:33], vcc
    v_cvt_pk_bf16_f32 v211, v214, v215
    v_mul_f32 v202, s44, v202
    v_exp_f32 v200, v200
    v_exp_f32 v201, v201
    v_pk_mul_f32 v[64:65], v[64:65], v[252:253] op_sel_hi:[1,0]
    v_pk_mul_f32 v[66:67], v[66:67], v[252:253] op_sel_hi:[1,0]
    v_pk_mul_f32 v[68:69], v[68:69], v[252:253] op_sel_hi:[1,0]
    v_pk_mul_f32 v[70:71], v[70:71], v[252:253] op_sel_hi:[1,0]
    v_cvt_pk_bf16_f32 v64, v64, v65
    v_cvt_pk_bf16_f32 v65, v66, v67
    v_cvt_pk_bf16_f32 v68, v68, v69
    v_cvt_pk_bf16_f32 v69, v70, v71
    v_mfma_f32_16x16x32_bf16 v[192:195], a[132:135], a[68:71], v[192:195]
    v_cmp_nge_f32 vcc, s46, v252
    v_mul_f32 v203, s44, v203
    v_mfma_f32_16x16x32_bf16 v[192:195], a[136:139], a[72:75], v[192:195]
    ds_write_b64 v249, v[64:65] offset:8704
    v_mfma_f32_16x16x32_bf16 v[192:195], a[140:143], a[76:79], v[192:195]
    s_or_b64 s[32:33], s[32:33], vcc
    v_exp_f32 v202, v202
    v_cvt_pk_bf16_f32 v200, v200, v201
    v_exp_f32 v203, v203
    v_pk_mul_f32 v[72:73], v[72:73], v[252:253] op_sel_hi:[1,0]
    v_pk_mul_f32 v[74:75], v[74:75], v[252:253] op_sel_hi:[1,0]
    v_pk_mul_f32 v[76:77], v[76:77], v[252:253] op_sel_hi:[1,0]
    v_pk_mul_f32 v[78:79], v[78:79], v[252:253] op_sel_hi:[1,0]
    v_cvt_pk_bf16_f32 v72, v72, v73
    v_cvt_pk_bf16_f32 v73, v74, v75
    v_cvt_pk_bf16_f32 v76, v76, v77
    v_cvt_pk_bf16_f32 v77, v78, v79
    v_mfma_f32_16x16x32_bf16 v[196:199], a[156:159], a[76:79], v[232:235]
    ds_write_b64 v249, v[68:69] offset:8736
    v_mfma_f32_16x16x32_bf16 v[196:199], a[152:155], a[72:75], v[196:199]
    v_mul_f32 v204, s44, v204
    v_mul_f32 v205, s44, v205
    v_mfma_f32_16x16x32_bf16 v[196:199], a[148:151], a[68:71], v[196:199]
    s_waitcnt lgkmcnt(2)
    ds_write_b64 v249, v[72:73] offset:8768
    v_mfma_f32_16x16x32_bf16 v[196:199], a[144:147], a[64:67], v[196:199]
    buffer_store_dwordx4 v[52:55], v248, s[16:19], s31 offen offset:2176 sc1
    v_cvt_pk_bf16_f32 v201, v202, v203
    v_mul_f32 v206, s44, v206
    v_pk_mul_f32 v[80:81], v[80:81], v[252:253] op_sel_hi:[1,0]
    v_pk_mul_f32 v[82:83], v[82:83], v[252:253] op_sel_hi:[1,0]
    v_pk_mul_f32 v[84:85], v[84:85], v[252:253] op_sel_hi:[1,0]
    v_pk_mul_f32 v[86:87], v[86:87], v[252:253] op_sel_hi:[1,0]
    v_cvt_pk_bf16_f32 v80, v80, v81
    v_cvt_pk_bf16_f32 v81, v82, v83
    v_cvt_pk_bf16_f32 v84, v84, v85
    v_cvt_pk_bf16_f32 v85, v86, v87
    v_mfma_f32_16x16x32_bf16 a[228:231], a[240:243], v[208:211], a[228:231]
    s_add_u32 s31, s22, 8192
    v_exp_f32 v204, v204
    v_mfma_f32_16x16x32_bf16 v[96:99], a[192:195], v[208:211], v[96:99]
L_pad13:
    s_cbranch_execz L_padend0
    ds_write_b64 v249, v[76:77] offset:8800
    v_mfma_f32_16x16x32_bf16 v[100:103], a[196:199], v[208:211], v[100:103]
    v_exp_f32 v205, v205
    v_mfma_f32_16x16x32_bf16 v[104:107], a[200:203], v[208:211], v[104:107]
    ds_write_b64 v249, v[80:81] offset:8832
    ds_read_b128 v[64:67], v250 offset:8704
    v_exp_f32 v206, v206
    v_pk_mul_f32 v[88:89], v[88:89], v[252:253] op_sel_hi:[1,0]
    v_pk_mul_f32 v[90:91], v[90:91], v[252:253] op_sel_hi:[1,0]
    v_pk_mul_f32 v[92:93], v[92:93], v[252:253] op_sel_hi:[1,0]
    v_pk_mul_f32 v[94:95], v[94:95], v[252:253] op_sel_hi:[1,0]
    v_cvt_pk_bf16_f32 v88, v88, v89
    v_cvt_pk_bf16_f32 v89, v90, v91
    v_cvt_pk_bf16_f32 v92, v92, v93
    v_cvt_pk_bf16_f32 v93, v94, v95
    v_mfma_f32_16x16x32_bf16 v[108:111], a[204:207], v[208:211], v[108:111]
    v_mul_f32 v207, s44, v207
    v_cvt_pk_bf16_f32 v202, v204, v205
    v_mfma_f32_16x16x32_bf16 v[112:115], a[208:211], v[208:211], v[112:115]
    ds_write_b64 v249, v[84:85] offset:8864
    v_mfma_f32_16x16x32_bf16 v[116:119], a[212:215], v[208:211], v[116:119]
    v_exp_f32 v207, v207
    v_mfma_f32_16x16x32_bf16 v[120:123], a[216:219], v[208:211], v[120:123]
    v_mul_f32 v192, s44, v192
    v_cvt_pk_bf16_f32 v203, v206, v207
    v_mfma_f32_16x16x32_bf16 v[124:127], a[220:223], v[208:211], v[124:127]
    ds_write_b64 v249, v[88:89] offset:8896
    v_mfma_f32_16x16x32_bf16 v[208:211], a[128:131], a[80:83], v[236:239]
    v_exp_f32 v192, v192
    v_mfma_f32_16x16x32_bf16 v[208:211], a[132:135], a[84:87], v[208:211]
    s_waitcnt lgkmcnt(2)
    v_mul_f32 v193, s44, v193
    v_mul_f32 v194, s44, v194
    v_mfma_f32_16x16x32_bf16 v[208:211], a[136:139], a[88:91], v[208:211]
    ds_write_b64 v249, v[92:93] offset:8928
    v_mfma_f32_16x16x32_bf16 v[208:211], a[140:143], a[92:95], v[208:211]
    buffer_store_dwordx4 v[64:67], v248, s[16:19], s31 offen offset:0 sc1
    v_mul_f32 v195, s44, v195
    v_mul_f32 v196, s44, v196
    v_mfma_f32_16x16x32_bf16 v[212:215], a[156:159], a[92:95], v[236:239]
    ds_read_b128 v[68:71], v250 offset:10880
    v_exp_f32 v193, v193
    v_mfma_f32_16x16x32_bf16 v[212:215], a[152:155], a[88:91], v[212:215]
    v_exp_f32 v194, v194
    v_mfma_f32_16x16x32_bf16 v[212:215], a[148:151], a[84:87], v[212:215]
    v_cvt_pk_bf16_f32 v192, v192, v193
    v_mul_f32 v197, s44, v197
    v_mfma_f32_16x16x32_bf16 v[212:215], a[144:147], a[80:83], v[212:215]
    v_exp_f32 v195, v195
    v_mfma_f32_16x16x32_bf16 a[228:231], a[240:243], v[200:203], a[228:231]
    ds_read_b128 v[80:83], v250 offset:8832
    v_cvt_pk_bf16_f32 v193, v194, v195
    v_mfma_f32_16x16x32_bf16 v[96:99], a[160:163], v[200:203], v[96:99]
    v_exp_f32 v196, v196
    v_mfma_f32_16x16x32_bf16 v[100:103], a[164:167], v[200:203], v[100:103]
    v_exp_f32 v197, v197
    v_mfma_f32_16x16x32_bf16 v[104:107], a[168:171], v[200:203], v[104:107]
    s_waitcnt lgkmcnt(1)
    buffer_store_dwordx4 v[68:71], v248, s[16:19], s31 offen offset:2048 sc1
    v_mul_f32 v198, s44, v198
    v_mul_f32 v199, s44, v199
    v_mfma_f32_16x16x32_bf16 v[108:111], a[172:175], v[200:203], v[108:111]
    v_accvgpr_read_b32 v229, a231
    v_accvgpr_read_b32 v254, a230
    v_mfma_f32_16x16x32_bf16 v[112:115], a[176:179], v[200:203], v[112:115]
    v_exp_f32 v198, v198
    v_mfma_f32_16x16x32_bf16 v[116:119], a[180:183], v[200:203], v[116:119]
    v_cvt_pk_bf16_f32 v194, v196, v197
    v_add_f32 v254, v254, v229
    v_mfma_f32_16x16x32_bf16 v[120:123], a[184:187], v[200:203], v[120:123]
    s_waitcnt lgkmcnt(0)
    buffer_store_dwordx4 v[80:83], v248, s[16:19], s31 offen offset:128 sc1
    v_cmp_nge_f32 vcc, s46, v254
    v_mul_f32 v208, s44, v208
    v_mfma_f32_16x16x32_bf16 v[124:127], a[188:191], v[200:203], v[124:127]
    ds_read_b128 v[84:87], v250 offset:11008
    v_mul_f32 v209, s44, v209
    v_exp_f32 v199, v199
    v_rcp_f32 v254, v254
    v_mfma_f32_16x16x32_bf16 v[200:203], a[96:99], a[64:67], v[232:235]
    s_or_b64 s[32:33], s[32:33], vcc
    v_cvt_pk_bf16_f32 v195, v198, v199
    v_mul_f32 v210, s44, v210
    v_exp_f32 v208, v208
    v_exp_f32 v209, v209
    v_pk_mul_f32 v[96:97], v[96:97], v[254:255] op_sel_hi:[1,0]
    v_pk_mul_f32 v[98:99], v[98:99], v[254:255] op_sel_hi:[1,0]
    v_pk_mul_f32 v[100:101], v[100:101], v[254:255] op_sel_hi:[1,0]
    v_pk_mul_f32 v[102:103], v[102:103], v[254:255] op_sel_hi:[1,0]
    v_cvt_pk_bf16_f32 v96, v96, v97
    v_cvt_pk_bf16_f32 v97, v98, v99
    v_cvt_pk_bf16_f32 v100, v100, v101
    v_cvt_pk_bf16_f32 v101, v102, v103
    v_mfma_f32_16x16x32_bf16 v[200:203], a[100:103], a[68:71], v[200:203]
    ds_read_b128 a[128:131], v240 offset:0
    v_cmp_nge_f32 vcc, s46, v254
    v_mfma_f32_16x16x32_bf16 v[200:203], a[104:107], a[72:75], v[200:203]
    ds_write_b64 v249, v[96:97] offset:13056
    v_mfma_f32_16x16x32_bf16 v[200:203], a[108:111], a[76:79], v[200:203]
    s_or_b64 s[32:33], s[32:33], vcc
    ds_read_b128 a[132:135], v241 offset:0
    v_exp_f32 v210, v210
    v_mul_f32 v211, s44, v211
    v_cvt_pk_bf16_f32 v196, v208, v209
    v_pk_mul_f32 v[104:105], v[104:105], v[254:255] op_sel_hi:[1,0]
    v_pk_mul_f32 v[106:107], v[106:107], v[254:255] op_sel_hi:[1,0]
    v_pk_mul_f32 v[108:109], v[108:109], v[254:255] op_sel_hi:[1,0]
    v_pk_mul_f32 v[110:111], v[110:111], v[254:255] op_sel_hi:[1,0]
    v_cvt_pk_bf16_f32 v104, v104, v105
    v_cvt_pk_bf16_f32 v105, v106, v107
    v_cvt_pk_bf16_f32 v108, v108, v109
    v_cvt_pk_bf16_f32 v109, v110, v111
    v_mfma_f32_16x16x32_bf16 v[204:207], a[124:127], a[76:79], v[232:235]
    ds_write_b64 v249, v[100:101] offset:13088
    v_mfma_f32_16x16x32_bf16 v[204:207], a[120:123], a[72:75], v[204:207]
    v_exp_f32 v211, v211
    v_mfma_f32_16x16x32_bf16 v[204:207], a[116:119], a[68:71], v[204:207]
    s_waitcnt lgkmcnt(4)
    buffer_store_dwordx4 v[84:87], v248, s[16:19], s31 offen offset:2176 sc1
    v_mul_f32 v212, s44, v212
    v_mul_f32 v213, s44, v213
    v_mfma_f32_16x16x32_bf16 v[204:207], a[112:115], a[64:67], v[204:207]
    s_add_u32 s31, s22, 12288
    ds_write_b64 v249, v[104:105] offset:13120
    v_exp_f32 v212, v212
    v_pk_mul_f32 v[112:113], v[112:113], v[254:255] op_sel_hi:[1,0]
    v_pk_mul_f32 v[114:115], v[114:115], v[254:255] op_sel_hi:[1,0]
    v_pk_mul_f32 v[116:117], v[116:117], v[254:255] op_sel_hi:[1,0]
    v_pk_mul_f32 v[118:119], v[118:119], v[254:255] op_sel_hi:[1,0]
    v_cvt_pk_bf16_f32 v112, v112, v113
    v_cvt_pk_bf16_f32 v113, v114, v115
    v_cvt_pk_bf16_f32 v116, v116, v117
    v_cvt_pk_bf16_f32 v117, v118, v119
    v_mfma_f32_16x16x32_bf16 v[128:131], a[192:195], v[192:195], v[128:131]
    ds_read_b128 a[136:139], v240 offset:1024
    v_cvt_pk_bf16_f32 v197, v210, v211
    v_mfma_f32_16x16x32_bf16 v[132:135], a[196:199], v[192:195], v[132:135]
    ds_write_b64 v249, v[108:109] offset:13152
    v_mfma_f32_16x16x32_bf16 v[136:139], a[200:203], v[192:195], v[136:139]
    v_exp_f32 v213, v213
    v_mfma_f32_16x16x32_bf16 v[140:143], a[204:207], v[192:195], v[140:143]
    ds_read_b128 v[96:99], v250 offset:13056
    ds_write_b64 v249, v[112:113] offset:13184
    v_mul_f32 v214, s44, v214
    v_pk_mul_f32 v[120:121], v[120:121], v[254:255] op_sel_hi:[1,0]
    v_pk_mul_f32 v[122:123], v[122:123], v[254:255] op_sel_hi:[1,0]
    v_pk_mul_f32 v[124:125], v[124:125], v[254:255] op_sel_hi:[1,0]
    v_pk_mul_f32 v[126:127], v[126:127], v[254:255] op_sel_hi:[1,0]
    v_cvt_pk_bf16_f32 v120, v120, v121
    v_cvt_pk_bf16_f32 v121, v122, v123
    v_cvt_pk_bf16_f32 v124, v124, v125
    v_cvt_pk_bf16_f32 v125, v126, v127
    v_mfma_f32_16x16x32_bf16 v[144:147], a[208:211], v[192:195], v[144:147]
    ds_read_b128 a[140:143], v241 offset:1024
    v_mul_f32 v215, s44, v215
    v_mfma_f32_16x16x32_bf16 v[148:151], a[212:215], v[192:195], v[148:151]
    v_exp_f32 v214, v214
    v_mfma_f32_16x16x32_bf16 v[152:155], a[216:219], v[192:195], v[152:155]
    v_cvt_pk_bf16_f32 v198, v212, v213
    v_mul_f32 v200, s44, v200
    v_mfma_f32_16x16x32_bf16 v[156:159], a[220:223], v[192:195], v[156:159]
    ds_write_b64 v249, v[116:117] offset:13216
    v_mfma_f32_16x16x32_bf16 v[208:211], a[96:99], a[80:83], v[236:239]
    v_exp_f32 v215, v215
    v_mfma_f32_16x16x32_bf16 v[208:211], a[100:103], a[84:87], v[208:211]
    ds_read_b128 a[144:147], v240 offset:4096
    ds_write_b64 v249, v[120:121] offset:13248
    v_cvt_pk_bf16_f32 v199, v214, v215
    v_mfma_f32_16x16x32_bf16 v[208:211], a[104:107], a[88:91], v[208:211]
    s_waitcnt lgkmcnt(5)
    v_exp_f32 v200, v200
    v_mul_f32 v201, s44, v201
    v_mfma_f32_16x16x32_bf16 v[208:211], a[108:111], a[92:95], v[208:211]
    ds_write_b64 v249, v[124:125] offset:13280
    v_mfma_f32_16x16x32_bf16 v[212:215], a[124:127], a[92:95], v[236:239]
    ds_read_b128 a[148:151], v241 offset:4096
    buffer_store_dwordx4 v[96:99], v248, s[16:19], s31 offen offset:0 sc1
    v_mul_f32 v202, s44, v202
    v_exp_f32 v201, v201
    v_mfma_f32_16x16x32_bf16 v[212:215], a[120:123], a[88:91], v[212:215]
    ds_read_b128 v[100:103], v250 offset:15232
    v_mul_f32 v203, s44, v203
    v_mfma_f32_16x16x32_bf16 v[212:215], a[116:119], a[84:87], v[212:215]
    v_exp_f32 v202, v202
    v_cvt_pk_bf16_f32 v200, v200, v201
    v_mfma_f32_16x16x32_bf16 v[212:215], a[112:115], a[80:83], v[212:215]
    ds_read_b128 a[152:155], v240 offset:5120
    v_mul_f32 v204, s44, v204
    v_smfmac_f32_16x16x64_bf16 a[232:235], a[244:247], v[192:199], v253
    ds_read_b128 a[156:159], v241 offset:5120
    v_exp_f32 v203, v203
    v_mfma_f32_16x16x32_bf16 v[160:163], a[192:195], v[196:199], v[160:163]
    v_exp_f32 v204, v204
    v_mfma_f32_16x16x32_bf16 v[164:167], a[196:199], v[196:199], v[164:167]
    v_mul_f32 v205, s44, v205
    v_cvt_pk_bf16_f32 v201, v202, v203
    v_mfma_f32_16x16x32_bf16 v[168:171], a[200:203], v[196:199], v[168:171]
    v_exp_f32 v205, v205
    v_mfma_f32_16x16x32_bf16 v[172:175], a[204:207], v[196:199], v[172:175]
    s_waitcnt lgkmcnt(2)
    ds_read_b64_tr_b16 a[192:193], v242 offset:0
    buffer_store_dwordx4 v[100:103], v248, s[16:19], s31 offen offset:2048 sc1
    v_mul_f32 v206, s44, v206
    v_mfma_f32_16x16x32_bf16 v[176:179], a[208:211], v[196:199], v[176:179]
    ds_read_b128 v[112:115], v250 offset:13184
    v_mul_f32 v207, s44, v207
    v_mfma_f32_16x16x32_bf16 v[180:183], a[212:215], v[196:199], v[180:183]
    v_exp_f32 v206, v206
    v_cvt_pk_bf16_f32 v202, v204, v205
    v_mfma_f32_16x16x32_bf16 v[184:187], a[216:219], v[196:199], v[184:187]
    ds_read_b64_tr_b16 a[194:195], v242 offset:4096
    v_mul_f32 v208, s44, v208
    v_mfma_f32_16x16x32_bf16 v[188:191], a[220:223], v[196:199], v[188:191]
    v_exp_f32 v207, v207
    v_mfma_f32_16x16x32_bf16 v[192:195], a[128:131], a[64:67], v[232:235]
    ds_read_b64_tr_b16 a[196:197], v243 offset:0
    v_cvt_pk_bf16_f32 v203, v206, v207
    v_mfma_f32_16x16x32_bf16 v[192:195], a[132:135], a[68:71], v[192:195]
    v_exp_f32 v208, v208
    v_mfma_f32_16x16x32_bf16 v[192:195], a[136:139], a[72:75], v[192:195]
    ds_read_b64_tr_b16 a[198:199], v243 offset:4096
    v_mul_f32 v209, s44, v209
    v_mfma_f32_16x16x32_bf16 v[192:195], a[140:143], a[76:79], v[192:195]
    s_waitcnt lgkmcnt(3)
    buffer_store_dwordx4 v[112:115], v248, s[16:19], s31 offen offset:128 sc1
    v_exp_f32 v209, v209
    v_mfma_f32_16x16x32_bf16 v[196:199], a[156:159], a[76:79], v[232:235]
    ds_read_b128 v[116:119], v250 offset:15360
    v_mul_f32 v210, s44, v210
    v_mfma_f32_16x16x32_bf16 v[196:199], a[152:155], a[72:75], v[196:199]
    ds_read_b128 a[96:99], v240 offset:8192
    v_mul_f32 v211, s44, v211
    v_mfma_f32_16x16x32_bf16 v[196:199], a[148:151], a[68:71], v[196:199]
    ds_read_b64_tr_b16 a[200:201], v244 offset:0
    ds_read_b128 a[100:103], v241 offset:8192
    v_exp_f32 v210, v210
    v_cvt_pk_bf16_f32 v204, v208, v209
    v_mfma_f32_16x16x32_bf16 v[196:199], a[144:147], a[64:67], v[196:199]
    ds_read_b128 a[104:107], v240 offset:9216
    v_mul_f32 v212, s44, v212
    v_mfma_f32_16x16x32_bf16 v[128:131], a[160:163], v[200:203], v[128:131]
    ds_read_b128 a[108:111], v241 offset:9216
    v_mul_f32 v213, s44, v213
    v_exp_f32 v211, v211
    v_mfma_f32_16x16x32_bf16 v[132:135], a[164:167], v[200:203], v[132:135]
    ds_read_b64_tr_b16 a[202:203], v244 offset:4096
    ds_read_b128 a[112:115], v240 offset:12288
    v_mfma_f32_16x16x32_bf16 v[136:139], a[168:171], v[200:203], v[136:139]
    ds_read_b128 a[116:119], v241 offset:12288
    v_cvt_pk_bf16_f32 v205, v210, v211
    v_exp_f32 v212, v212
    v_mfma_f32_16x16x32_bf16 v[140:143], a[172:175], v[200:203], v[140:143]
    s_waitcnt lgkmcnt(8)
    ds_read_b128 a[120:123], v240 offset:13312
    buffer_store_dwordx4 v[116:119], v248, s[16:19], s31 offen offset:2176 sc1
    v_mul_f32 v214, s44, v214
    v_mfma_f32_16x16x32_bf16 v[144:147], a[176:179], v[200:203], v[144:147]
    ds_read_b64_tr_b16 a[204:205], v245 offset:0
    ds_read_b128 a[124:127], v241 offset:13312
    v_exp_f32 v213, v213
    v_mfma_f32_16x16x32_bf16 v[148:151], a[180:183], v[200:203], v[148:151]
    ds_read_b64_tr_b16 a[206:207], v245 offset:4096
    v_mul_f32 v215, s44, v215
    v_mfma_f32_16x16x32_bf16 v[152:155], a[184:187], v[200:203], v[152:155]
    v_exp_f32 v214, v214
    v_cvt_pk_bf16_f32 v206, v212, v213
    v_mfma_f32_16x16x32_bf16 v[156:159], a[188:191], v[200:203], v[156:159]
    s_waitcnt lgkmcnt(8)
    v_exp_f32 v215, v215
    v_mfma_f32_16x16x32_bf16 v[208:211], a[96:99], a[64:67], v[232:235]
    ds_read_b64_tr_b16 a[208:209], v242 offset:1024
    v_mul_f32 v192, s44, v192
    v_mfma_f32_16x16x32_bf16 v[208:211], a[100:103], a[68:71], v[208:211]
    v_cvt_pk_bf16_f32 v207, v214, v215
    v_mul_f32 v193, s44, v193
    v_mfma_f32_16x16x32_bf16 v[208:211], a[104:107], a[72:75], v[208:211]
    s_waitcnt lgkmcnt(5)
    v_exp_f32 v192, v192
    v_mfma_f32_16x16x32_bf16 v[208:211], a[108:111], a[76:79], v[208:211]
    s_waitcnt lgkmcnt(2)
    ds_read_b64_tr_b16 a[210:211], v242 offset:5120
    v_mul_f32 v194, s44, v194
    v_mfma_f32_16x16x32_bf16 v[212:215], a[124:127], a[76:79], v[232:235]
    s_add_u32 s31, s22, 16384
    v_exp_f32 v193, v193
    v_mfma_f32_16x16x32_bf16 v[212:215], a[120:123], a[72:75], v[212:215]
    ds_read_b64_tr_b16 a[212:213], v243 offset:1024
    v_mul_f32 v195, s44, v195
    v_mfma_f32_16x16x32_bf16 v[212:215], a[116:119], a[68:71], v[212:215]
    v_exp_f32 v194, v194
    v_cvt_pk_bf16_f32 v192, v192, v193
    v_mfma_f32_16x16x32_bf16 v[212:215], a[112:115], a[64:67], v[212:215]
    v_exp_f32 v195, v195
    v_smfmac_f32_16x16x64_bf16 a[232:235], a[244:247], v[200:207], v253
    v_mul_f32 v196, s44, v196
    v_mfma_f32_16x16x32_bf16 v[160:163], a[160:163], v[204:207], v[160:163]
    ds_read_b64_tr_b16 a[214:215], v243 offset:5120
    v_mul_f32 v197, s44, v197
    v_mfma_f32_16x16x32_bf16 v[164:167], a[164:167], v[204:207], v[164:167]
    v_exp_f32 v196, v196
    v_cvt_pk_bf16_f32 v193, v194, v195
    v_mfma_f32_16x16x32_bf16 v[168:171], a[168:171], v[204:207], v[168:171]
    ds_read_b64_tr_b16 a[216:217], v244 offset:1024
    v_mul_f32 v198, s44, v198
    v_mfma_f32_16x16x32_bf16 v[172:175], a[172:175], v[204:207], v[172:175]
    v_exp_f32 v197, v197
    v_mfma_f32_16x16x32_bf16 v[176:179], a[176:179], v[204:207], v[176:179]
    ds_read_b64_tr_b16 a[160:161], v242 offset:8192
    v_mul_f32 v199, s44, v199
    v_mfma_f32_16x16x32_bf16 v[180:183], a[180:183], v[204:207], v[180:183]
    ds_read_b64_tr_b16 a[218:219], v244 offset:5120
    ds_read_b64_tr_b16 a[162:163], v242 offset:12288
    v_exp_f32 v198, v198
    v_cvt_pk_bf16_f32 v194, v196, v197
    v_mfma_f32_16x16x32_bf16 v[184:187], a[184:187], v[204:207], v[184:187]
    ds_read_b64_tr_b16 a[164:165], v243 offset:8192
    v_mul_f32 v208, s44, v208
    v_mfma_f32_16x16x32_bf16 v[188:191], a[188:191], v[204:207], v[188:191]
    v_exp_f32 v199, v199
    v_mfma_f32_16x16x32_bf16 v[200:203], a[128:131], a[80:83], v[236:239]
    ds_read_b64_tr_b16 a[220:221], v245 offset:1024
    v_cvt_pk_bf16_f32 v195, v198, v199
    v_mfma_f32_16x16x32_bf16 v[200:203], a[132:135], a[84:87], v[200:203]
    ds_read_b64_tr_b16 a[166:167], v243 offset:12288
    v_mul_f32 v209, s44, v209
    v_mfma_f32_16x16x32_bf16 v[200:203], a[136:139], a[88:91], v[200:203]
    ds_read_b64_tr_b16 a[168:169], v244 offset:8192
    v_mul_f32 v210, s44, v210
    v_exp_f32 v208, v208
    v_mfma_f32_16x16x32_bf16 v[200:203], a[140:143], a[92:95], v[200:203]
    ds_read_b64_tr_b16 a[222:223], v245 offset:5120
    v_mul_f32 v211, s44, v211
    v_mfma_f32_16x16x32_bf16 v[204:207], a[156:159], a[92:95], v[236:239]
    ds_read_b64_tr_b16 a[170:171], v244 offset:12288
    v_mul_f32 v212, s44, v212
    v_exp_f32 v209, v209
    v_mfma_f32_16x16x32_bf16 v[204:207], a[152:155], a[88:91], v[204:207]
    ds_read_b64_tr_b16 a[172:173], v245 offset:8192
    v_cvt_pk_bf16_f32 v208, v208, v209
    v_mfma_f32_16x16x32_bf16 v[204:207], a[148:151], a[84:87], v[204:207]
    v_exp_f32 v210, v210
    v_mfma_f32_16x16x32_bf16 v[204:207], a[144:147], a[80:83], v[204:207]
    ds_read_b64_tr_b16 a[174:175], v245 offset:12288
    v_mul_f32 v213, s44, v213
    v_mfma_f32_16x16x32_bf16 a[232:235], a[236:239], v[192:195], a[232:235]
    v_exp_f32 v211, v211
    v_mfma_f32_16x16x32_bf16 v[128:131], a[192:195], v[192:195], v[128:131]
    ds_read_b64_tr_b16 a[176:177], v242 offset:9216
    v_cvt_pk_bf16_f32 v209, v210, v211
    v_mfma_f32_16x16x32_bf16 v[132:135], a[196:199], v[192:195], v[132:135]
    v_exp_f32 v212, v212
    v_mfma_f32_16x16x32_bf16 v[136:139], a[200:203], v[192:195], v[136:139]
    s_waitcnt lgkmcnt(4)
    ds_read_b64_tr_b16 a[178:179], v242 offset:13312
    v_mul_f32 v214, s44, v214
    v_mfma_f32_16x16x32_bf16 v[140:143], a[204:207], v[192:195], v[140:143]
    ds_read_b64_tr_b16 a[180:181], v243 offset:9216
    v_mul_f32 v215, s44, v215
    v_exp_f32 v213, v213
    v_mfma_f32_16x16x32_bf16 v[144:147], a[208:211], v[192:195], v[144:147]
    ds_read_b64_tr_b16 a[182:183], v243 offset:13312
    v_cvt_pk_bf16_f32 v210, v212, v213
    v_mfma_f32_16x16x32_bf16 v[148:151], a[212:215], v[192:195], v[148:151]
    v_exp_f32 v214, v214
    v_mfma_f32_16x16x32_bf16 v[152:155], a[216:219], v[192:195], v[152:155]
    ds_read_b64_tr_b16 a[184:185], v244 offset:9216
    v_mul_f32 v200, s44, v200
    v_mfma_f32_16x16x32_bf16 v[156:159], a[220:223], v[192:195], v[156:159]
    v_exp_f32 v215, v215
    v_mfma_f32_16x16x32_bf16 v[192:195], a[96:99], a[80:83], v[236:239]
    ds_read_b64_tr_b16 a[186:187], v244 offset:13312
    v_cvt_pk_bf16_f32 v211, v214, v215
    v_mfma_f32_16x16x32_bf16 v[192:195], a[100:103], a[84:87], v[192:195]
    ds_read_b64_tr_b16 a[188:189], v245 offset:9216
    v_mul_f32 v201, s44, v201
    v_mfma_f32_16x16x32_bf16 v[192:195], a[104:107], a[88:91], v[192:195]
    v_exp_f32 v200, v200
    v_mfma_f32_16x16x32_bf16 v[192:195], a[108:111], a[92:95], v[192:195]
    ds_read_b64_tr_b16 a[190:191], v245 offset:13312
    v_mul_f32 v202, s44, v202
    v_mfma_f32_16x16x32_bf16 v[196:199], a[124:127], a[92:95], v[236:239]
    v_exp_f32 v201, v201
    v_mfma_f32_16x16x32_bf16 v[196:199], a[120:123], a[88:91], v[196:199]
    v_exp_f32 v202, v202
    v_mfma_f32_16x16x32_bf16 v[196:199], a[116:119], a[84:87], v[196:199]
    v_mul_f32 v203, s44, v203
    v_cvt_pk_bf16_f32 v200, v200, v201
    v_mfma_f32_16x16x32_bf16 v[196:199], a[112:115], a[80:83], v[196:199]
    v_exp_f32 v203, v203
    v_mfma_f32_16x16x32_bf16 a[232:235], a[236:239], v[208:211], a[232:235]
    v_mul_f32 v204, s44, v204
    v_mul_f32 v205, s44, v205
    v_mfma_f32_16x16x32_bf16 v[128:131], a[160:163], v[208:211], v[128:131]
    v_exp_f32 v204, v204
    v_mfma_f32_16x16x32_bf16 v[132:135], a[164:167], v[208:211], v[132:135]
    s_waitcnt lgkmcnt(1)
    v_cvt_pk_bf16_f32 v201, v202, v203
    v_mul_f32 v206, s44, v206
    v_mfma_f32_16x16x32_bf16 v[136:139], a[168:171], v[208:211], v[136:139]
    v_exp_f32 v205, v205
    v_mfma_f32_16x16x32_bf16 v[140:143], a[172:175], v[208:211], v[140:143]
    v_accvgpr_read_b32 v233, a233
    v_accvgpr_read_b32 v252, a232
    v_mfma_f32_16x16x32_bf16 v[144:147], a[176:179], v[208:211], v[144:147]
    v_exp_f32 v206, v206
    v_mfma_f32_16x16x32_bf16 v[148:151], a[180:183], v[208:211], v[148:151]
    v_mul_f32 v207, s44, v207
    v_exp_f32 v207, v207
    v_cvt_pk_bf16_f32 v202, v204, v205
    v_add_f32 v252, v252, v233
    v_mfma_f32_16x16x32_bf16 v[152:155], a[184:187], v[208:211], v[152:155]
    s_waitcnt lgkmcnt(0)
    v_cvt_pk_bf16_f32 v203, v206, v207
    v_cmp_nge_f32 vcc, s46, v252
    v_mfma_f32_16x16x32_bf16 v[156:159], a[188:191], v[208:211], v[156:159]
    v_mul_f32 v192, s44, v192
    v_exp_f32 v192, v192
    v_rcp_f32 v252, v252
    v_mfma_f32_16x16x32_bf16 a[232:235], a[240:243], v[200:203], a[232:235]
    s_or_b64 s[32:33], s[32:33], vcc
    v_mul_f32 v193, s44, v193
    v_exp_f32 v193, v193
    v_mul_f32 v194, s44, v194
    v_exp_f32 v194, v194
    v_pk_mul_f32 v[128:129], v[128:129], v[252:253] op_sel_hi:[1,0]
    v_pk_mul_f32 v[130:131], v[130:131], v[252:253] op_sel_hi:[1,0]
    v_pk_mul_f32 v[132:133], v[132:133], v[252:253] op_sel_hi:[1,0]
    v_pk_mul_f32 v[134:135], v[134:135], v[252:253] op_sel_hi:[1,0]
    v_cvt_pk_bf16_f32 v128, v128, v129
    v_cvt_pk_bf16_f32 v129, v130, v131
    v_cvt_pk_bf16_f32 v132, v132, v133
    v_cvt_pk_bf16_f32 v133, v134, v135
    v_mfma_f32_16x16x32_bf16 v[160:163], a[192:195], v[200:203], v[160:163]
    v_cmp_nge_f32 vcc, s46, v252
    v_mul_f32 v195, s44, v195
    v_mfma_f32_16x16x32_bf16 v[164:167], a[196:199], v[200:203], v[164:167]
    v_exp_f32 v195, v195
    v_mfma_f32_16x16x32_bf16 v[168:171], a[200:203], v[200:203], v[168:171]
    s_or_b64 s[32:33], s[32:33], vcc
    ds_write_b64 v249, v[128:129] offset:17408
    v_mul_f32 v196, s44, v196
    v_exp_f32 v196, v196
    v_pk_mul_f32 v[136:137], v[136:137], v[252:253] op_sel_hi:[1,0]
    v_pk_mul_f32 v[138:139], v[138:139], v[252:253] op_sel_hi:[1,0]
    v_pk_mul_f32 v[140:141], v[140:141], v[252:253] op_sel_hi:[1,0]
    v_pk_mul_f32 v[142:143], v[142:143], v[252:253] op_sel_hi:[1,0]
    v_cvt_pk_bf16_f32 v136, v136, v137
    v_cvt_pk_bf16_f32 v137, v138, v139
    v_cvt_pk_bf16_f32 v140, v140, v141
    v_cvt_pk_bf16_f32 v141, v142, v143
    v_mfma_f32_16x16x32_bf16 v[172:175], a[204:207], v[200:203], v[172:175]
    v_mul_f32 v197, s44, v197
    v_exp_f32 v197, v197
    v_mfma_f32_16x16x32_bf16 v[176:179], a[208:211], v[200:203], v[176:179]
    v_mul_f32 v198, s44, v198
    v_exp_f32 v198, v198
    v_mfma_f32_16x16x32_bf16 v[180:183], a[212:215], v[200:203], v[180:183]
    v_mul_f32 v199, s44, v199
    v_exp_f32 v199, v199
    v_cvt_pk_bf16_f32 v192, v192, v193
    v_mfma_f32_16x16x32_bf16 v[184:187], a[216:219], v[200:203], v[184:187]
    ds_write_b64 v249, v[132:133] offset:17440
    v_cvt_pk_bf16_f32 v193, v194, v195
    v_cvt_pk_bf16_f32 v194, v196, v197
    v_cvt_pk_bf16_f32 v195, v198, v199
    v_pk_mul_f32 v[144:145], v[144:145], v[252:253] op_sel_hi:[1,0]
    v_pk_mul_f32 v[146:147], v[146:147], v[252:253] op_sel_hi:[1,0]
    v_pk_mul_f32 v[148:149], v[148:149], v[252:253] op_sel_hi:[1,0]
    v_pk_mul_f32 v[150:151], v[150:151], v[252:253] op_sel_hi:[1,0]
    v_cvt_pk_bf16_f32 v144, v144, v145
    v_cvt_pk_bf16_f32 v145, v146, v147
    v_cvt_pk_bf16_f32 v148, v148, v149
    v_cvt_pk_bf16_f32 v149, v150, v151
    v_mfma_f32_16x16x32_bf16 v[188:191], a[220:223], v[200:203], v[188:191]
    ds_write_b64 v249, v[136:137] offset:17472
    v_mfma_f32_16x16x32_bf16 a[232:235], a[240:243], v[192:195], a[232:235]
    ds_write_b64 v249, v[140:141] offset:17504
    v_mfma_f32_16x16x32_bf16 v[160:163], a[160:163], v[192:195], v[160:163]
    ds_write_b64 v249, v[144:145] offset:17536
    v_mfma_f32_16x16x32_bf16 v[164:167], a[164:167], v[192:195], v[164:167]
    ds_write_b64 v249, v[148:149] offset:17568
    ds_read_b128 v[128:131], v250 offset:17408
    v_pk_mul_f32 v[152:153], v[152:153], v[252:253] op_sel_hi:[1,0]
    v_pk_mul_f32 v[154:155], v[154:155], v[252:253] op_sel_hi:[1,0]
    v_pk_mul_f32 v[156:157], v[156:157], v[252:253] op_sel_hi:[1,0]
    v_pk_mul_f32 v[158:159], v[158:159], v[252:253] op_sel_hi:[1,0]
    v_cvt_pk_bf16_f32 v152, v152, v153
    v_cvt_pk_bf16_f32 v153, v154, v155
    v_cvt_pk_bf16_f32 v156, v156, v157
    v_cvt_pk_bf16_f32 v157, v158, v159
    v_mfma_f32_16x16x32_bf16 v[168:171], a[168:171], v[192:195], v[168:171]
    ds_write_b64 v249, v[152:153] offset:17600
    v_mfma_f32_16x16x32_bf16 v[172:175], a[172:175], v[192:195], v[172:175]
    v_accvgpr_read_b32 v237, a235
    v_accvgpr_read_b32 v254, a234
    v_mfma_f32_16x16x32_bf16 v[176:179], a[176:179], v[192:195], v[176:179]
    v_add_f32 v254, v254, v237
    v_cmp_nge_f32 vcc, s46, v254
    v_mfma_f32_16x16x32_bf16 v[180:183], a[180:183], v[192:195], v[180:183]
    ds_write_b64 v249, v[156:157] offset:17632
    v_mfma_f32_16x16x32_bf16 v[184:187], a[184:187], v[192:195], v[184:187]
    s_or_b64 s[32:33], s[32:33], vcc
    v_rcp_f32 v254, v254
    v_mfma_f32_16x16x32_bf16 v[188:191], a[188:191], v[192:195], v[188:191]
    ds_read_b128 v[132:135], v250 offset:19584
    v_cmp_nge_f32 vcc, s46, v254
    s_waitcnt lgkmcnt(3)
    buffer_store_dwordx4 v[128:131], v248, s[16:19], s31 offen offset:0 sc1
    v_pk_mul_f32 v[160:161], v[160:161], v[254:255] op_sel_hi:[1,0]
    v_pk_mul_f32 v[162:163], v[162:163], v[254:255] op_sel_hi:[1,0]
    v_pk_mul_f32 v[164:165], v[164:165], v[254:255] op_sel_hi:[1,0]
    v_pk_mul_f32 v[166:167], v[166:167], v[254:255] op_sel_hi:[1,0]
    v_cvt_pk_bf16_f32 v160, v160, v161
    v_cvt_pk_bf16_f32 v161, v162, v163
    v_cvt_pk_bf16_f32 v164, v164, v165
    v_cvt_pk_bf16_f32 v165, v166, v167
    s_or_b64 s[32:33], s[32:33], vcc
    ds_write_b64 v249, v[160:161] offset:0
    ds_write_b64 v249, v[164:165] offset:32
    v_pk_mul_f32 v[168:169], v[168:169], v[254:255] op_sel_hi:[1,0]
    v_pk_mul_f32 v[170:171], v[170:171], v[254:255] op_sel_hi:[1,0]
    v_pk_mul_f32 v[172:173], v[172:173], v[254:255] op_sel_hi:[1,0]
    v_pk_mul_f32 v[174:175], v[174:175], v[254:255] op_sel_hi:[1,0]
    v_cvt_pk_bf16_f32 v168, v168, v169
    v_cvt_pk_bf16_f32 v169, v170, v171
    v_cvt_pk_bf16_f32 v172, v172, v173
    v_cvt_pk_bf16_f32 v173, v174, v175
    ds_write_b64 v249, v[168:169] offset:64
    ds_write_b64 v249, v[172:173] offset:96
    v_pk_mul_f32 v[176:177], v[176:177], v[254:255] op_sel_hi:[1,0]
    v_pk_mul_f32 v[178:179], v[178:179], v[254:255] op_sel_hi:[1,0]
    v_pk_mul_f32 v[180:181], v[180:181], v[254:255] op_sel_hi:[1,0]
    v_pk_mul_f32 v[182:183], v[182:183], v[254:255] op_sel_hi:[1,0]
    v_cvt_pk_bf16_f32 v176, v176, v177
    v_cvt_pk_bf16_f32 v177, v178, v179
    v_cvt_pk_bf16_f32 v180, v180, v181
    v_cvt_pk_bf16_f32 v181, v182, v183
    s_waitcnt lgkmcnt(4)
    buffer_store_dwordx4 v[132:135], v248, s[16:19], s31 offen offset:2048 sc1
    ds_read_b128 v[144:147], v250 offset:17536
    ds_write_b64 v249, v[176:177] offset:128
    ds_read_b128 v[160:163], v250 offset:0
    ds_read_b128 v[164:167], v250 offset:2176
    ds_write_b64 v249, v[180:181] offset:160
    v_pk_mul_f32 v[184:185], v[184:185], v[254:255] op_sel_hi:[1,0]
    v_pk_mul_f32 v[186:187], v[186:187], v[254:255] op_sel_hi:[1,0]
    v_pk_mul_f32 v[188:189], v[188:189], v[254:255] op_sel_hi:[1,0]
    v_pk_mul_f32 v[190:191], v[190:191], v[254:255] op_sel_hi:[1,0]
    v_cvt_pk_bf16_f32 v184, v184, v185
    v_cvt_pk_bf16_f32 v185, v186, v187
    v_cvt_pk_bf16_f32 v188, v188, v189
    v_cvt_pk_bf16_f32 v189, v190, v191
    ds_write_b64 v249, v[184:185] offset:192
    ds_write_b64 v249, v[188:189] offset:224
    ds_read_b128 v[176:179], v250 offset:128
    ds_read_b128 v[180:183], v250 offset:2304
    s_waitcnt lgkmcnt(8)
    buffer_store_dwordx4 v[144:147], v248, s[16:19], s31 offen offset:128 sc1
    ds_read_b128 v[148:151], v250 offset:19712
    s_waitcnt lgkmcnt(0)
    buffer_store_dwordx4 v[148:151], v248, s[16:19], s31 offen offset:2176 sc1
    s_add_u32 s31, s22, 20480
    buffer_store_dwordx4 v[160:163], v248, s[16:19], s31 offen offset:0 sc1
    buffer_store_dwordx4 v[164:167], v248, s[16:19], s31 offen offset:2048 sc1
    buffer_store_dwordx4 v[176:179], v248, s[16:19], s31 offen offset:128 sc1
    buffer_store_dwordx4 v[180:183], v248, s[16:19], s31 offen offset:2176 sc1
    s_cmp_lg_u64 s[32:33], 0

    s_cbranch_scc1 L_slow
L_exit:
    s_endpgm
.section .rodata,"a"
.p2align 6
.amdhsa_kernel standalone__gqa_softmax__near_ridge_kernel
  .amdhsa_next_free_vgpr 512
  .amdhsa_next_free_sgpr 102
  .amdhsa_accum_offset 256
  .amdhsa_group_segment_fixed_size 0
  .amdhsa_kernarg_size 48
  .amdhsa_user_sgpr_count 2
  .amdhsa_user_sgpr_kernarg_segment_ptr 1
  .amdhsa_system_sgpr_workgroup_id_x 1
.end_amdhsa_kernel
```
